```python
import torch

def _softmax(x, axis=-1):
    return torch.softmax(x, dim=axis)
def _gelu(x):
    return torch.nn.functional.gelu(x, approximate="tanh")
def _silu(x):
    return torch.nn.functional.silu(x)
def _sigmoid(x):
    return torch.sigmoid(x)
def _layernorm(x, axis=-1, eps=1e-5):
    m = x.mean(dim=axis, keepdim=True)
    v = x.var(dim=axis, keepdim=True, unbiased=False)
    return (x - m) / torch.sqrt(v + eps)
def _scatter_add(tgt, idx, src, axis=0):
    return tgt.clone().index_add_(axis, idx, src)
def _segment_sum(src, seg, n):
    out = torch.zeros((n,) + src.shape[1:], dtype=src.dtype)
    return out.index_add_(0, seg, src)
def _pad(x, pw):
    flat = tuple(v for pair in reversed(pw) for v in pair)
    return torch.nn.functional.pad(x, flat)

kernel_name = 'standalone__mha_block_cached__near_ridge'

def setup_inputs():

    _w = (lambda a: (lambda t: t.to(torch.bfloat16) if t.is_floating_point() else t)(torch.as_tensor(a)))
    B, Sq, D = 8, 144, 448
    H, Sk, Dh = 16, 2048, 256
    return {
        "x": _w((lambda *s: torch.randn(*s, dtype=torch.bfloat16) * 0.8)(B, Sq, D)),
        "k_cache": _w((lambda *s: torch.randn(*s, dtype=torch.bfloat16) * 0.8)(B, H, Sk, Dh)),
        "v_cache": _w((lambda *s: torch.randn(*s, dtype=torch.bfloat16) * 0.05)(B, H, Sk, Dh)),
        "wq": _w((lambda *s: torch.randn(*s, dtype=torch.bfloat16) * 0.8)(D, H * Dh) * (D ** -0.5)),
        "wo": _w((lambda *s: torch.randn(*s, dtype=torch.bfloat16) * 0.05)(H * Dh, D) * ((H * Dh) ** -0.5)),
    }

def reference(x, k_cache, v_cache, wq, wo):
    B, Sq, D = x.shape
    H, Dh = 16, 256
    q = (lambda x, *d: x.permute(*d))((x @ wq).reshape(B, Sq, H, Dh), 0, 2, 1, 3)
    scores = torch.einsum("bhqd,bhkd->bhqk", q, k_cache) * (Dh ** -0.5)
    p = _softmax(scores, axis=-1)
    o = torch.einsum("bhqk,bhkd->bhqd", p, v_cache)
    return (lambda x, *d: x.permute(*d))(o, 0, 2, 1, 3).reshape(B, Sq, H * Dh) @ wo
```

```asm
; @launch grid=(256,1,1) block=(256,1,1) lds=163840
.amdgcn_target "amdgcn-amd-amdhsa--gfx950"
.text
.globl standalone__mha_block_cached__near_ridge_kernel
.p2align 8
.type standalone__mha_block_cached__near_ridge_kernel,@function
standalone__mha_block_cached__near_ridge_kernel:
s_cmp_lt_u32 s2, 256
s_cbranch_scc1 L_go
s_endpgm
L_go:
s_load_dwordx2 s[76:77], s[0:1], 56
s_load_dwordx2 s[16:17], s[0:1], 0
s_load_dwordx2 s[4:5], s[0:1], 8
s_load_dwordx2 s[8:9], s[0:1], 16
s_load_dwordx4 s[12:15], s[0:1], 24
s_load_dwordx2 s[28:29], s[0:1], 40
s_load_dwordx2 s[24:25], s[0:1], 48
s_getpc_b64 s[92:93]
L_pc1:
s_sub_u32 s92, s92, L_pc1-standalone__mha_block_cached__near_ridge_kernel
s_subb_u32 s93, s93, 0
s_mov_b32 s94, L_end-standalone__mha_block_cached__near_ridge_kernel
s_mov_b32 s95, 0x20000
s_lshr_b32 s42, s2, 3
s_lshl_b32 s42, s42, 12
v_lshlrev_b32 v2, 4, v0
buffer_load_dwordx4 v[248:251], v2, s[92:95], s42 offen
v_lshrrev_b32 v1, 6, v0
v_and_b32 v0, 63, v0
v_readfirstlane_b32 s32, v1
s_lshr_b32 s35, s2, 7
s_and_b32 s42, s2, 7
s_bfe_u32 s34, s2, 0x10003
s_lshl_b32 s42, s42, 1
s_add_u32 s34, s34, s42
s_bfe_u32 s33, s2, 0x30004
s_and_b32 s36, s34, 1
s_mul_i32 s36, s36, 3
s_add_u32 s36, s36, s33
s_cmp_ge_u32 s36, 7
s_cselect_b32 s42, 7, 0
s_sub_u32 s36, s36, s42
s_lshl_b32 s37, s33, 4
s_add_u32 s37, s37, s34
s_mov_b32 s53, 0
s_mov_b32 s38, 0
s_mov_b32 s40, 0
s_waitcnt lgkmcnt(0)
s_lshl_b32 s42, s33, 7
s_add_u32 s42, s42, 37540864
s_add_u32 s51, s76, s42
s_addc_u32 s52, s77, 0
s_mov_b32 s58, s51
s_mov_b32 s59, s52
s_lshl_b32 s42, s37, 20
s_add_u32 s96, s4, s42
s_addc_u32 s97, s5, 0
s_mov_b32 s98, 16384
s_mov_b32 s99, 0x20000
s_mul_i32 s43, s35, 491520
s_add_u32 s42, s42, s43
s_cmp_eq_u32 s35, 0
s_mov_b32 s43, 557056
s_cselect_b32 s43, 491520, s43
s_add_u32 s4, s4, s42
s_addc_u32 s5, s5, 0
s_mov_b32 s6, s43
s_mov_b32 s7, 0x20000
s_add_u32 s8, s8, s42
s_addc_u32 s9, s9, 0
s_mov_b32 s10, s43
s_mov_b32 s11, 0x20000
s_mul_i32 s42, s34, 229376
s_add_u32 s88, s14, s42
s_addc_u32 s89, s15, 0
s_mov_b32 s90, 229376
s_mov_b32 s91, 0x20000
s_lshl_b32 s42, s34, 9
s_add_u32 s12, s12, s42
s_addc_u32 s13, s13, 0
s_sub_u32 s14, 3670016, s42
s_mov_b32 s15, 0x20000
s_mul_i32 s42, s33, 129024
s_add_u32 s16, s16, s42
s_addc_u32 s17, s17, 0
s_mov_b32 s18, 129024
s_mov_b32 s19, 0x20000
s_mov_b32 s20, s76
s_mov_b32 s21, s77
s_mov_b32 s22, 37541888
s_mov_b32 s23, 0x20000
s_mov_b32 s26, 256
s_mov_b32 s27, 0x20000
s_mov_b32 s30, 1032192
s_mov_b32 s31, 0x20000
s_cmp_eq_u32 s32, 3
s_cbranch_scc1 L_loader
s_load_dwordx2 s[56:57], s[58:59], 0
v_lshrrev_b32 v1, 3, v0
v_mul_u32_u24 v236, 896, v1
v_and_b32 v1, 6, v1
v_and_b32 v2, 7, v0
v_xor_b32 v1, v1, v2
v_lshl_add_u32 v236, v1, 4, v236
s_mul_i32 s80, s32, 43008
s_lshl_b32 s81, s36, 7
s_mul_i32 s46, s32, 18432
s_add_u32 s46, s46, 84480
s_add_u32 s52, s80, s81
s_add_u32 m0, s46, 0
s_add_u32 s43, s52, 0
buffer_load_dwordx4 v236, s[16:19], s43 offen lds
s_add_u32 m0, s46, 1024
s_add_u32 s43, s52, 7168
buffer_load_dwordx4 v236, s[16:19], s43 offen lds
s_add_u32 m0, s46, 2048
s_add_u32 s43, s52, 14336
buffer_load_dwordx4 v236, s[16:19], s43 offen lds
s_add_u32 m0, s46, 3072
s_add_u32 s43, s52, 21504
buffer_load_dwordx4 v236, s[16:19], s43 offen lds
s_add_u32 m0, s46, 4096
s_add_u32 s43, s52, 28672
buffer_load_dwordx4 v236, s[16:19], s43 offen lds
s_add_u32 m0, s46, 5120
s_add_u32 s43, s52, 35840
buffer_load_dwordx4 v236, s[16:19], s43 offen lds
s_add_u32 s81, s81, 128
s_cmp_eq_u32 s81, 896
s_cselect_b32 s81, 0, s81
s_barrier
v_and_b32 v12, 15, v0
v_lshrrev_b32 v13, 4, v0
v_and_b32 v15, 3, v0
v_mul_u32_u24 v1, 1056, v12
v_lshl_add_u32 v1, v13, 4, v1
v_lshrrev_b32 v16, 2, v0
v_mul_u32_u24 v16, 1056, v16
v_lshl_add_u32 v2, v15, 3, v16
v_lshl_add_u32 v3, v15, 4, v16
v_lshrrev_b32 v16, 5, v0
v_lshlrev_b32 v16, 10, v16
v_bfe_u32 v17, v0, 2, 3
v_lshl_add_u32 v16, v17, 6, v16
v_lshl_add_u32 v16, v15, 3, v16
v_and_b32 v17, 1, v13
v_lshl_add_u32 v4, v17, 5, v16
v_xor_b32 v5, 32, v4
s_lshl_b32 s42, s32, 8
s_add_u32 s42, s42, 152320
v_lshlrev_b32 v16, 2, v0
v_add_u32 v8, s42, v16
v_add_u32 v9, 152064, v16
v_mov_b32 v10, 0
v_lshlrev_b32 v26, 4, v0
v_lshlrev_b32 v16, 7, v12
v_and_b32 v17, 6, v12
v_xor_b32 v17, v17, v13
v_lshl_add_u32 v24, v17, 4, v16
s_mov_b32 s39, 0
s_mov_b32 s44, 0x4e800000
s_mov_b32 s82, 0x3db8aa3b
s_mul_i32 s54, s37, 81920
s_mul_i32 s43, s32, 24576
s_add_u32 s54, s54, s43
s_lshl_b32 s83, s37, 7
s_lshl_b32 s43, s32, 3
s_add_u32 s83, s83, s43
s_add_u32 s52, s80, s81
s_add_u32 m0, s46, 6144
s_add_u32 s43, s52, 0
buffer_load_dwordx4 v236, s[16:19], s43 offen lds
s_add_u32 m0, s46, 7168
s_add_u32 s43, s52, 7168
buffer_load_dwordx4 v236, s[16:19], s43 offen lds
s_add_u32 m0, s46, 8192
s_add_u32 s43, s52, 14336
buffer_load_dwordx4 v236, s[16:19], s43 offen lds
s_add_u32 m0, s46, 9216
s_add_u32 s43, s52, 21504
buffer_load_dwordx4 v236, s[16:19], s43 offen lds
s_add_u32 m0, s46, 10240
s_add_u32 s43, s52, 28672
buffer_load_dwordx4 v236, s[16:19], s43 offen lds
s_add_u32 m0, s46, 11264
s_add_u32 s43, s52, 35840
buffer_load_dwordx4 v236, s[16:19], s43 offen lds
s_add_u32 s81, s81, 128
s_cmp_eq_u32 s81, 896
s_cselect_b32 s81, 0, s81
s_add_u32 s52, s80, s81
s_add_u32 m0, s46, 12288
s_add_u32 s43, s52, 0
buffer_load_dwordx4 v236, s[16:19], s43 offen lds
s_add_u32 m0, s46, 13312
s_add_u32 s43, s52, 7168
buffer_load_dwordx4 v236, s[16:19], s43 offen lds
s_add_u32 m0, s46, 14336
s_add_u32 s43, s52, 14336
buffer_load_dwordx4 v236, s[16:19], s43 offen lds
s_add_u32 m0, s46, 15360
s_add_u32 s43, s52, 21504
buffer_load_dwordx4 v236, s[16:19], s43 offen lds
s_add_u32 m0, s46, 16384
s_add_u32 s43, s52, 28672
buffer_load_dwordx4 v236, s[16:19], s43 offen lds
s_add_u32 m0, s46, 17408
s_add_u32 s43, s52, 35840
buffer_load_dwordx4 v236, s[16:19], s43 offen lds
s_add_u32 s81, s81, 128
s_cmp_eq_u32 s81, 896
s_cselect_b32 s81, 0, s81
v_add_u32 v237, s46, v24
v_xor_b32 v238, 64, v237
v_accvgpr_write_b32 a168, 0
v_accvgpr_write_b32 a169, 0
v_accvgpr_write_b32 a170, 0
v_accvgpr_write_b32 a171, 0
v_accvgpr_write_b32 a172, 0
v_accvgpr_write_b32 a173, 0
v_accvgpr_write_b32 a174, 0
v_accvgpr_write_b32 a175, 0
v_accvgpr_write_b32 a176, 0
v_accvgpr_write_b32 a177, 0
v_accvgpr_write_b32 a178, 0
v_accvgpr_write_b32 a179, 0
v_accvgpr_write_b32 a180, 0
v_accvgpr_write_b32 a181, 0
v_accvgpr_write_b32 a182, 0
v_accvgpr_write_b32 a183, 0
v_accvgpr_write_b32 a184, 0
v_accvgpr_write_b32 a185, 0
v_accvgpr_write_b32 a186, 0
v_accvgpr_write_b32 a187, 0
v_accvgpr_write_b32 a188, 0
v_accvgpr_write_b32 a189, 0
v_accvgpr_write_b32 a190, 0
v_accvgpr_write_b32 a191, 0
s_waitcnt vmcnt(12)
ds_read_b128 a[0:3], v237 offset:0
ds_read_b128 a[4:7], v237 offset:2048
ds_read_b128 a[8:11], v237 offset:4096
ds_read_b128 a[12:15], v238 offset:0
ds_read_b128 a[16:19], v238 offset:2048
ds_read_b128 a[20:23], v238 offset:4096
s_waitcnt lgkmcnt(0)
s_add_u32 s52, s80, s81
s_add_u32 m0, s46, 0
s_add_u32 s43, s52, 0
buffer_load_dwordx4 v236, s[16:19], s43 offen lds
s_add_u32 m0, s46, 1024
s_add_u32 s43, s52, 7168
buffer_load_dwordx4 v236, s[16:19], s43 offen lds
s_add_u32 m0, s46, 2048
s_add_u32 s43, s52, 14336
buffer_load_dwordx4 v236, s[16:19], s43 offen lds
s_add_u32 m0, s46, 3072
s_add_u32 s43, s52, 21504
buffer_load_dwordx4 v236, s[16:19], s43 offen lds
s_add_u32 m0, s46, 4096
s_add_u32 s43, s52, 28672
buffer_load_dwordx4 v236, s[16:19], s43 offen lds
s_add_u32 m0, s46, 5120
s_add_u32 s43, s52, 35840
buffer_load_dwordx4 v236, s[16:19], s43 offen lds
s_add_u32 s81, s81, 128
s_cmp_eq_u32 s81, 896
s_cselect_b32 s81, 0, s81
s_cmp_lg_u32 s32, 0
s_cbranch_scc1 L_nn2
s_xor_b32 s56, s56, 0x5bd1e994
s_or_b32 s56, s56, 1
s_add_u32 s57, s57, 1
v_mov_b32 v240, s56
v_mov_b32 v241, s57
v_mov_b32 v242, 153088
s_mov_b64 exec, 1
ds_write_b64 v242, v[240:241]
s_mov_b64 exec, -1
s_waitcnt lgkmcnt(0)
L_nn2:
s_add_u32 s38, s38, 1
s_cmp_ge_u32 s39, s38
s_cbranch_scc0 L_poll3
L_ret4:
v_add_u32 v7, s40, v3
s_add_u32 s40, s40, 16896
s_cmp_eq_u32 s40, 152064
s_cselect_b32 s40, 0, s40
ds_read_b64_tr_b16 a[192:193], v7 offset:0
ds_read_b64_tr_b16 a[194:195], v7 offset:256
ds_read_b64_tr_b16 a[196:197], v7 offset:512
ds_read_b64_tr_b16 a[198:199], v7 offset:768
ds_read_b64_tr_b16 a[200:201], v7 offset:8
ds_read_b64_tr_b16 a[202:203], v7 offset:264
ds_read_b64_tr_b16 a[204:205], v7 offset:520
ds_read_b64_tr_b16 a[206:207], v7 offset:776
ds_read_b64_tr_b16 a[208:209], v7 offset:64
ds_read_b64_tr_b16 a[210:211], v7 offset:320
s_waitcnt lgkmcnt(8)
v_mfma_f32_16x16x32_bf16 v[32:35], a[192:195], a[0:3], 0
ds_read_b64_tr_b16 a[212:213], v7 offset:576
v_mfma_f32_16x16x32_bf16 v[36:39], a[192:195], a[4:7], 0
ds_read_b64_tr_b16 a[214:215], v7 offset:832
v_mfma_f32_16x16x32_bf16 v[40:43], a[192:195], a[8:11], 0
s_waitcnt lgkmcnt(8)
v_mfma_f32_16x16x32_bf16 v[32:35], a[196:199], a[12:15], v[32:35]
ds_read_b64_tr_b16 a[216:217], v7 offset:72
v_mfma_f32_16x16x32_bf16 v[36:39], a[196:199], a[16:19], v[36:39]
ds_read_b64_tr_b16 a[218:219], v7 offset:328
v_mfma_f32_16x16x32_bf16 v[40:43], a[196:199], a[20:23], v[40:43]
s_waitcnt lgkmcnt(8)
v_mfma_f32_16x16x32_bf16 v[44:47], a[200:203], a[0:3], 0
ds_read_b64_tr_b16 a[220:221], v7 offset:584
v_mfma_f32_16x16x32_bf16 v[48:51], a[200:203], a[4:7], 0
ds_read_b64_tr_b16 a[222:223], v7 offset:840
v_mfma_f32_16x16x32_bf16 v[52:55], a[200:203], a[8:11], 0
s_waitcnt lgkmcnt(8)
v_mfma_f32_16x16x32_bf16 v[44:47], a[204:207], a[12:15], v[44:47]
ds_read_b64_tr_b16 a[192:193], v7 offset:128
v_mfma_f32_16x16x32_bf16 v[48:51], a[204:207], a[16:19], v[48:51]
ds_read_b64_tr_b16 a[194:195], v7 offset:384
v_mfma_f32_16x16x32_bf16 v[52:55], a[204:207], a[20:23], v[52:55]
s_waitcnt lgkmcnt(8)
v_mfma_f32_16x16x32_bf16 v[56:59], a[208:211], a[0:3], 0
ds_read_b64_tr_b16 a[196:197], v7 offset:640
v_mfma_f32_16x16x32_bf16 v[60:63], a[208:211], a[4:7], 0
ds_read_b64_tr_b16 a[198:199], v7 offset:896
v_mfma_f32_16x16x32_bf16 v[64:67], a[208:211], a[8:11], 0
s_waitcnt lgkmcnt(8)
v_mfma_f32_16x16x32_bf16 v[56:59], a[212:215], a[12:15], v[56:59]
ds_read_b64_tr_b16 a[200:201], v7 offset:136
v_mfma_f32_16x16x32_bf16 v[60:63], a[212:215], a[16:19], v[60:63]
ds_read_b64_tr_b16 a[202:203], v7 offset:392
v_mfma_f32_16x16x32_bf16 v[64:67], a[212:215], a[20:23], v[64:67]
s_waitcnt lgkmcnt(8)
v_mfma_f32_16x16x32_bf16 v[68:71], a[216:219], a[0:3], 0
ds_read_b64_tr_b16 a[204:205], v7 offset:648
v_mfma_f32_16x16x32_bf16 v[72:75], a[216:219], a[4:7], 0
ds_read_b64_tr_b16 a[206:207], v7 offset:904
v_mfma_f32_16x16x32_bf16 v[76:79], a[216:219], a[8:11], 0
s_waitcnt lgkmcnt(8)
v_mfma_f32_16x16x32_bf16 v[68:71], a[220:223], a[12:15], v[68:71]
ds_read_b64_tr_b16 a[208:209], v7 offset:192
v_mfma_f32_16x16x32_bf16 v[72:75], a[220:223], a[16:19], v[72:75]
ds_read_b64_tr_b16 a[210:211], v7 offset:448
v_mfma_f32_16x16x32_bf16 v[76:79], a[220:223], a[20:23], v[76:79]
ds_read_b32 v25, v9
s_waitcnt lgkmcnt(9)
v_mfma_f32_16x16x32_bf16 v[80:83], a[192:195], a[0:3], 0
ds_read_b64_tr_b16 a[212:213], v7 offset:704
s_waitcnt vmcnt(12)
ds_read_b128 a[24:27], v237 offset:6144
v_mfma_f32_16x16x32_bf16 v[84:87], a[192:195], a[4:7], 0
ds_read_b64_tr_b16 a[214:215], v7 offset:960
v_mfma_f32_16x16x32_bf16 v[88:91], a[192:195], a[8:11], 0
s_waitcnt lgkmcnt(10)
v_mfma_f32_16x16x32_bf16 v[80:83], a[196:199], a[12:15], v[80:83]
ds_read_b64_tr_b16 a[216:217], v7 offset:200
ds_read_b128 a[28:31], v237 offset:8192
v_mfma_f32_16x16x32_bf16 v[84:87], a[196:199], a[16:19], v[84:87]
ds_read_b64_tr_b16 a[218:219], v7 offset:456
v_mfma_f32_16x16x32_bf16 v[88:91], a[196:199], a[20:23], v[88:91]
s_waitcnt lgkmcnt(11)
v_mfma_f32_16x16x32_bf16 v[92:95], a[200:203], a[0:3], 0
ds_read_b64_tr_b16 a[220:221], v7 offset:712
ds_read_b64_tr_b16 a[222:223], v7 offset:968
s_waitcnt lgkmcnt(8)
v_mfma_f32_16x16x32_bf16 v[96:99], a[200:203], a[4:7], 0
v_readfirstlane_b32 s39, v25
s_add_u32 s38, s38, 1
ds_read_b128 a[32:35], v237 offset:10240
v_mfma_f32_16x16x32_bf16 v[100:103], a[200:203], a[8:11], 0
s_cmp_ge_u32 s39, s38
s_cbranch_scc0 L_poll5
L_ret6:
v_add_u32 v7, s40, v3
v_mfma_f32_16x16x32_bf16 v[92:95], a[204:207], a[12:15], v[92:95]
ds_read_b64_tr_b16 a[192:193], v7 offset:0
ds_read_b128 a[36:39], v238 offset:6144
v_mfma_f32_16x16x32_bf16 v[96:99], a[204:207], a[16:19], v[96:99]
ds_read_b64_tr_b16 a[194:195], v7 offset:256
v_mfma_f32_16x16x32_bf16 v[100:103], a[204:207], a[20:23], v[100:103]
v_mfma_f32_16x16x32_bf16 v[104:107], a[208:211], a[0:3], 0
ds_read_b64_tr_b16 a[196:197], v7 offset:512
ds_read_b64_tr_b16 a[198:199], v7 offset:768
ds_read_b128 a[40:43], v238 offset:8192
v_mfma_f32_16x16x32_bf16 v[108:111], a[208:211], a[4:7], 0
s_add_u32 s40, s40, 16896
v_mfma_f32_16x16x32_bf16 v[112:115], a[208:211], a[8:11], 0
s_cmp_eq_u32 s40, 152064
s_cselect_b32 s40, 0, s40
s_waitcnt lgkmcnt(12)
v_mfma_f32_16x16x32_bf16 v[104:107], a[212:215], a[12:15], v[104:107]
ds_read_b64_tr_b16 a[200:201], v7 offset:8
ds_read_b128 a[44:47], v238 offset:10240
v_mfma_f32_16x16x32_bf16 v[108:111], a[212:215], a[16:19], v[108:111]
ds_read_b64_tr_b16 a[202:203], v7 offset:264
v_mfma_f32_16x16x32_bf16 v[112:115], a[212:215], a[20:23], v[112:115]
s_waitcnt lgkmcnt(12)
v_mfma_f32_16x16x32_bf16 v[116:119], a[216:219], a[0:3], 0
ds_read_b64_tr_b16 a[204:205], v7 offset:520
v_mfma_f32_16x16x32_bf16 v[120:123], a[216:219], a[4:7], 0
ds_read_b64_tr_b16 a[206:207], v7 offset:776
v_mfma_f32_16x16x32_bf16 v[124:127], a[216:219], a[8:11], 0
s_waitcnt lgkmcnt(12)
s_waitcnt lgkmcnt(3)
v_mfma_f32_16x16x32_bf16 v[116:119], a[220:223], a[12:15], v[116:119]
ds_read_b64_tr_b16 a[208:209], v7 offset:64
ds_read_b64_tr_b16 a[210:211], v7 offset:320
s_add_u32 s52, s80, s81
v_mfma_f32_16x16x32_bf16 v[120:123], a[220:223], a[16:19], v[120:123]
v_add_u32 v10, 1, v10
s_add_u32 m0, s46, 6144
s_add_u32 s43, s52, 0
buffer_load_dwordx4 v236, s[16:19], s43 offen lds
v_mfma_f32_16x16x32_bf16 v[124:127], a[220:223], a[20:23], v[124:127]
ds_write_b32 v8, v10
v_mfma_f32_16x16x32_bf16 v[32:35], a[192:195], a[24:27], v[32:35]
ds_read_b64_tr_b16 a[212:213], v7 offset:576
s_add_u32 m0, s46, 7168
s_add_u32 s43, s52, 7168
buffer_load_dwordx4 v236, s[16:19], s43 offen lds
s_add_u32 m0, s46, 8192
s_add_u32 s43, s52, 14336
buffer_load_dwordx4 v236, s[16:19], s43 offen lds
v_mfma_f32_16x16x32_bf16 v[36:39], a[192:195], a[28:31], v[36:39]
ds_read_b64_tr_b16 a[214:215], v7 offset:832
v_mfma_f32_16x16x32_bf16 v[40:43], a[192:195], a[32:35], v[40:43]
v_mfma_f32_16x16x32_bf16 v[32:35], a[196:199], a[36:39], v[32:35]
ds_read_b64_tr_b16 a[216:217], v7 offset:72
s_add_u32 m0, s46, 9216
s_add_u32 s43, s52, 21504
buffer_load_dwordx4 v236, s[16:19], s43 offen lds
s_add_u32 m0, s46, 10240
s_add_u32 s43, s52, 28672
buffer_load_dwordx4 v236, s[16:19], s43 offen lds
v_mfma_f32_16x16x32_bf16 v[36:39], a[196:199], a[40:43], v[36:39]
ds_read_b64_tr_b16 a[218:219], v7 offset:328
v_mfma_f32_16x16x32_bf16 v[40:43], a[196:199], a[44:47], v[40:43]
s_waitcnt lgkmcnt(9)
v_mfma_f32_16x16x32_bf16 v[44:47], a[200:203], a[24:27], v[44:47]
ds_read_b64_tr_b16 a[220:221], v7 offset:584
s_add_u32 m0, s46, 11264
s_add_u32 s43, s52, 35840
buffer_load_dwordx4 v236, s[16:19], s43 offen lds
s_add_u32 s81, s81, 128
v_mfma_f32_16x16x32_bf16 v[48:51], a[200:203], a[28:31], v[48:51]
ds_read_b64_tr_b16 a[222:223], v7 offset:840
v_mfma_f32_16x16x32_bf16 v[52:55], a[200:203], a[32:35], v[52:55]
s_waitcnt lgkmcnt(9)
v_mfma_f32_16x16x32_bf16 v[44:47], a[204:207], a[36:39], v[44:47]
ds_read_b64_tr_b16 a[192:193], v7 offset:128
s_cmp_eq_u32 s81, 896
s_cselect_b32 s81, 0, s81
v_mfma_f32_16x16x32_bf16 v[48:51], a[204:207], a[40:43], v[48:51]
ds_read_b64_tr_b16 a[194:195], v7 offset:384
v_mfma_f32_16x16x32_bf16 v[52:55], a[204:207], a[44:47], v[52:55]
s_waitcnt lgkmcnt(9)
v_mfma_f32_16x16x32_bf16 v[56:59], a[208:211], a[24:27], v[56:59]
ds_read_b64_tr_b16 a[196:197], v7 offset:640
v_mfma_f32_16x16x32_bf16 v[60:63], a[208:211], a[28:31], v[60:63]
ds_read_b64_tr_b16 a[198:199], v7 offset:896
v_mfma_f32_16x16x32_bf16 v[64:67], a[208:211], a[32:35], v[64:67]
s_waitcnt lgkmcnt(8)
v_mfma_f32_16x16x32_bf16 v[56:59], a[212:215], a[36:39], v[56:59]
ds_read_b64_tr_b16 a[200:201], v7 offset:136
v_mfma_f32_16x16x32_bf16 v[60:63], a[212:215], a[40:43], v[60:63]
ds_read_b64_tr_b16 a[202:203], v7 offset:392
v_mfma_f32_16x16x32_bf16 v[64:67], a[212:215], a[44:47], v[64:67]
s_waitcnt lgkmcnt(8)
v_mfma_f32_16x16x32_bf16 v[68:71], a[216:219], a[24:27], v[68:71]
ds_read_b64_tr_b16 a[204:205], v7 offset:648
v_mfma_f32_16x16x32_bf16 v[72:75], a[216:219], a[28:31], v[72:75]
ds_read_b64_tr_b16 a[206:207], v7 offset:904
v_mfma_f32_16x16x32_bf16 v[76:79], a[216:219], a[32:35], v[76:79]
s_waitcnt lgkmcnt(8)
v_mfma_f32_16x16x32_bf16 v[68:71], a[220:223], a[36:39], v[68:71]
ds_read_b64_tr_b16 a[208:209], v7 offset:192
v_mfma_f32_16x16x32_bf16 v[72:75], a[220:223], a[40:43], v[72:75]
ds_read_b64_tr_b16 a[210:211], v7 offset:448
v_mfma_f32_16x16x32_bf16 v[76:79], a[220:223], a[44:47], v[76:79]
ds_read_b32 v25, v9
s_waitcnt lgkmcnt(9)
v_mfma_f32_16x16x32_bf16 v[80:83], a[192:195], a[24:27], v[80:83]
ds_read_b64_tr_b16 a[212:213], v7 offset:704
s_waitcnt vmcnt(12)
ds_read_b128 a[48:51], v237 offset:12288
v_mfma_f32_16x16x32_bf16 v[84:87], a[192:195], a[28:31], v[84:87]
ds_read_b64_tr_b16 a[214:215], v7 offset:960
v_mfma_f32_16x16x32_bf16 v[88:91], a[192:195], a[32:35], v[88:91]
s_waitcnt lgkmcnt(10)
v_mfma_f32_16x16x32_bf16 v[80:83], a[196:199], a[36:39], v[80:83]
ds_read_b64_tr_b16 a[216:217], v7 offset:200
ds_read_b128 a[52:55], v237 offset:14336
v_mfma_f32_16x16x32_bf16 v[84:87], a[196:199], a[40:43], v[84:87]
ds_read_b64_tr_b16 a[218:219], v7 offset:456
v_mfma_f32_16x16x32_bf16 v[88:91], a[196:199], a[44:47], v[88:91]
s_waitcnt lgkmcnt(11)
v_mfma_f32_16x16x32_bf16 v[92:95], a[200:203], a[24:27], v[92:95]
ds_read_b64_tr_b16 a[220:221], v7 offset:712
ds_read_b64_tr_b16 a[222:223], v7 offset:968
s_waitcnt lgkmcnt(8)
v_mfma_f32_16x16x32_bf16 v[96:99], a[200:203], a[28:31], v[96:99]
v_readfirstlane_b32 s39, v25
s_add_u32 s38, s38, 1
ds_read_b128 a[56:59], v237 offset:16384
v_mfma_f32_16x16x32_bf16 v[100:103], a[200:203], a[32:35], v[100:103]
s_cmp_ge_u32 s39, s38
s_cbranch_scc0 L_poll7
L_ret8:
v_add_u32 v7, s40, v3
v_mfma_f32_16x16x32_bf16 v[92:95], a[204:207], a[36:39], v[92:95]
ds_read_b64_tr_b16 a[192:193], v7 offset:0
ds_read_b128 a[60:63], v238 offset:12288
v_mfma_f32_16x16x32_bf16 v[96:99], a[204:207], a[40:43], v[96:99]
ds_read_b64_tr_b16 a[194:195], v7 offset:256
v_mfma_f32_16x16x32_bf16 v[100:103], a[204:207], a[44:47], v[100:103]
v_mfma_f32_16x16x32_bf16 v[104:107], a[208:211], a[24:27], v[104:107]
ds_read_b64_tr_b16 a[196:197], v7 offset:512
ds_read_b64_tr_b16 a[198:199], v7 offset:768
ds_read_b128 a[64:67], v238 offset:14336
v_mfma_f32_16x16x32_bf16 v[108:111], a[208:211], a[28:31], v[108:111]
s_add_u32 s40, s40, 16896
v_mfma_f32_16x16x32_bf16 v[112:115], a[208:211], a[32:35], v[112:115]
s_cmp_eq_u32 s40, 152064
s_cselect_b32 s40, 0, s40
s_waitcnt lgkmcnt(12)
v_mfma_f32_16x16x32_bf16 v[104:107], a[212:215], a[36:39], v[104:107]
ds_read_b64_tr_b16 a[200:201], v7 offset:8
ds_read_b128 a[68:71], v238 offset:16384
v_mfma_f32_16x16x32_bf16 v[108:111], a[212:215], a[40:43], v[108:111]
ds_read_b64_tr_b16 a[202:203], v7 offset:264
v_mfma_f32_16x16x32_bf16 v[112:115], a[212:215], a[44:47], v[112:115]
s_waitcnt lgkmcnt(12)
v_mfma_f32_16x16x32_bf16 v[116:119], a[216:219], a[24:27], v[116:119]
ds_read_b64_tr_b16 a[204:205], v7 offset:520
v_mfma_f32_16x16x32_bf16 v[120:123], a[216:219], a[28:31], v[120:123]
ds_read_b64_tr_b16 a[206:207], v7 offset:776
v_mfma_f32_16x16x32_bf16 v[124:127], a[216:219], a[32:35], v[124:127]
s_waitcnt lgkmcnt(12)
s_waitcnt lgkmcnt(3)
v_mfma_f32_16x16x32_bf16 v[116:119], a[220:223], a[36:39], v[116:119]
ds_read_b64_tr_b16 a[208:209], v7 offset:64
ds_read_b64_tr_b16 a[210:211], v7 offset:320
s_add_u32 s52, s80, s81
v_mfma_f32_16x16x32_bf16 v[120:123], a[220:223], a[40:43], v[120:123]
v_add_u32 v10, 1, v10
s_add_u32 m0, s46, 12288
s_add_u32 s43, s52, 0
buffer_load_dwordx4 v236, s[16:19], s43 offen lds
v_mfma_f32_16x16x32_bf16 v[124:127], a[220:223], a[44:47], v[124:127]
ds_write_b32 v8, v10
v_mfma_f32_16x16x32_bf16 v[32:35], a[192:195], a[48:51], v[32:35]
ds_read_b64_tr_b16 a[212:213], v7 offset:576
s_add_u32 m0, s46, 13312
s_add_u32 s43, s52, 7168
buffer_load_dwordx4 v236, s[16:19], s43 offen lds
s_add_u32 m0, s46, 14336
s_add_u32 s43, s52, 14336
buffer_load_dwordx4 v236, s[16:19], s43 offen lds
v_mfma_f32_16x16x32_bf16 v[36:39], a[192:195], a[52:55], v[36:39]
ds_read_b64_tr_b16 a[214:215], v7 offset:832
v_mfma_f32_16x16x32_bf16 v[40:43], a[192:195], a[56:59], v[40:43]
v_mfma_f32_16x16x32_bf16 v[32:35], a[196:199], a[60:63], v[32:35]
ds_read_b64_tr_b16 a[216:217], v7 offset:72
s_add_u32 m0, s46, 15360
s_add_u32 s43, s52, 21504
buffer_load_dwordx4 v236, s[16:19], s43 offen lds
s_add_u32 m0, s46, 16384
s_add_u32 s43, s52, 28672
buffer_load_dwordx4 v236, s[16:19], s43 offen lds
v_mfma_f32_16x16x32_bf16 v[36:39], a[196:199], a[64:67], v[36:39]
ds_read_b64_tr_b16 a[218:219], v7 offset:328
v_mfma_f32_16x16x32_bf16 v[40:43], a[196:199], a[68:71], v[40:43]
s_waitcnt lgkmcnt(9)
v_mfma_f32_16x16x32_bf16 v[44:47], a[200:203], a[48:51], v[44:47]
ds_read_b64_tr_b16 a[220:221], v7 offset:584
s_add_u32 m0, s46, 17408
s_add_u32 s43, s52, 35840
buffer_load_dwordx4 v236, s[16:19], s43 offen lds
s_add_u32 s81, s81, 128
v_mfma_f32_16x16x32_bf16 v[48:51], a[200:203], a[52:55], v[48:51]
ds_read_b64_tr_b16 a[222:223], v7 offset:840
v_mfma_f32_16x16x32_bf16 v[52:55], a[200:203], a[56:59], v[52:55]
s_waitcnt lgkmcnt(9)
v_mfma_f32_16x16x32_bf16 v[44:47], a[204:207], a[60:63], v[44:47]
ds_read_b64_tr_b16 a[192:193], v7 offset:128
s_cmp_eq_u32 s81, 896
s_cselect_b32 s81, 0, s81
v_mfma_f32_16x16x32_bf16 v[48:51], a[204:207], a[64:67], v[48:51]
ds_read_b64_tr_b16 a[194:195], v7 offset:384
v_mfma_f32_16x16x32_bf16 v[52:55], a[204:207], a[68:71], v[52:55]
s_waitcnt lgkmcnt(9)
v_mfma_f32_16x16x32_bf16 v[56:59], a[208:211], a[48:51], v[56:59]
ds_read_b64_tr_b16 a[196:197], v7 offset:640
v_mfma_f32_16x16x32_bf16 v[60:63], a[208:211], a[52:55], v[60:63]
ds_read_b64_tr_b16 a[198:199], v7 offset:896
v_mfma_f32_16x16x32_bf16 v[64:67], a[208:211], a[56:59], v[64:67]
s_waitcnt lgkmcnt(8)
v_mfma_f32_16x16x32_bf16 v[56:59], a[212:215], a[60:63], v[56:59]
ds_read_b64_tr_b16 a[200:201], v7 offset:136
v_mfma_f32_16x16x32_bf16 v[60:63], a[212:215], a[64:67], v[60:63]
ds_read_b64_tr_b16 a[202:203], v7 offset:392
v_mfma_f32_16x16x32_bf16 v[64:67], a[212:215], a[68:71], v[64:67]
s_waitcnt lgkmcnt(8)
v_mfma_f32_16x16x32_bf16 v[68:71], a[216:219], a[48:51], v[68:71]
ds_read_b64_tr_b16 a[204:205], v7 offset:648
v_mfma_f32_16x16x32_bf16 v[72:75], a[216:219], a[52:55], v[72:75]
ds_read_b64_tr_b16 a[206:207], v7 offset:904
v_mfma_f32_16x16x32_bf16 v[76:79], a[216:219], a[56:59], v[76:79]
s_waitcnt lgkmcnt(8)
v_mfma_f32_16x16x32_bf16 v[68:71], a[220:223], a[60:63], v[68:71]
ds_read_b64_tr_b16 a[208:209], v7 offset:192
v_mfma_f32_16x16x32_bf16 v[72:75], a[220:223], a[64:67], v[72:75]
ds_read_b64_tr_b16 a[210:211], v7 offset:448
v_mfma_f32_16x16x32_bf16 v[76:79], a[220:223], a[68:71], v[76:79]
ds_read_b32 v25, v9
s_waitcnt lgkmcnt(9)
v_mfma_f32_16x16x32_bf16 v[80:83], a[192:195], a[48:51], v[80:83]
ds_read_b64_tr_b16 a[212:213], v7 offset:704
s_waitcnt vmcnt(12)
ds_read_b128 a[72:75], v237 offset:0
v_mfma_f32_16x16x32_bf16 v[84:87], a[192:195], a[52:55], v[84:87]
ds_read_b64_tr_b16 a[214:215], v7 offset:960
v_mfma_f32_16x16x32_bf16 v[88:91], a[192:195], a[56:59], v[88:91]
s_waitcnt lgkmcnt(10)
v_mfma_f32_16x16x32_bf16 v[80:83], a[196:199], a[60:63], v[80:83]
ds_read_b64_tr_b16 a[216:217], v7 offset:200
ds_read_b128 a[76:79], v237 offset:2048
v_mfma_f32_16x16x32_bf16 v[84:87], a[196:199], a[64:67], v[84:87]
ds_read_b64_tr_b16 a[218:219], v7 offset:456
v_mfma_f32_16x16x32_bf16 v[88:91], a[196:199], a[68:71], v[88:91]
s_waitcnt lgkmcnt(11)
v_mfma_f32_16x16x32_bf16 v[92:95], a[200:203], a[48:51], v[92:95]
ds_read_b64_tr_b16 a[220:221], v7 offset:712
ds_read_b64_tr_b16 a[222:223], v7 offset:968
s_waitcnt lgkmcnt(8)
v_mfma_f32_16x16x32_bf16 v[96:99], a[200:203], a[52:55], v[96:99]
v_readfirstlane_b32 s39, v25
s_add_u32 s38, s38, 1
ds_read_b128 a[80:83], v237 offset:4096
v_mfma_f32_16x16x32_bf16 v[100:103], a[200:203], a[56:59], v[100:103]
s_cmp_ge_u32 s39, s38
s_cbranch_scc0 L_poll9
L_ret10:
v_add_u32 v7, s40, v3
v_mfma_f32_16x16x32_bf16 v[92:95], a[204:207], a[60:63], v[92:95]
ds_read_b64_tr_b16 a[192:193], v7 offset:0
ds_read_b128 a[84:87], v238 offset:0
v_mfma_f32_16x16x32_bf16 v[96:99], a[204:207], a[64:67], v[96:99]
ds_read_b64_tr_b16 a[194:195], v7 offset:256
v_mfma_f32_16x16x32_bf16 v[100:103], a[204:207], a[68:71], v[100:103]
v_mfma_f32_16x16x32_bf16 v[104:107], a[208:211], a[48:51], v[104:107]
ds_read_b64_tr_b16 a[196:197], v7 offset:512
ds_read_b64_tr_b16 a[198:199], v7 offset:768
ds_read_b128 a[88:91], v238 offset:2048
v_mfma_f32_16x16x32_bf16 v[108:111], a[208:211], a[52:55], v[108:111]
s_add_u32 s40, s40, 16896
v_mfma_f32_16x16x32_bf16 v[112:115], a[208:211], a[56:59], v[112:115]
s_cmp_eq_u32 s40, 152064
s_cselect_b32 s40, 0, s40
s_waitcnt lgkmcnt(12)
v_mfma_f32_16x16x32_bf16 v[104:107], a[212:215], a[60:63], v[104:107]
ds_read_b64_tr_b16 a[200:201], v7 offset:8
ds_read_b128 a[92:95], v238 offset:4096
v_mfma_f32_16x16x32_bf16 v[108:111], a[212:215], a[64:67], v[108:111]
ds_read_b64_tr_b16 a[202:203], v7 offset:264
v_mfma_f32_16x16x32_bf16 v[112:115], a[212:215], a[68:71], v[112:115]
s_waitcnt lgkmcnt(12)
v_mfma_f32_16x16x32_bf16 v[116:119], a[216:219], a[48:51], v[116:119]
ds_read_b64_tr_b16 a[204:205], v7 offset:520
v_mfma_f32_16x16x32_bf16 v[120:123], a[216:219], a[52:55], v[120:123]
ds_read_b64_tr_b16 a[206:207], v7 offset:776
v_mfma_f32_16x16x32_bf16 v[124:127], a[216:219], a[56:59], v[124:127]
s_waitcnt lgkmcnt(12)
s_waitcnt lgkmcnt(3)
v_mfma_f32_16x16x32_bf16 v[116:119], a[220:223], a[60:63], v[116:119]
ds_read_b64_tr_b16 a[208:209], v7 offset:64
ds_read_b64_tr_b16 a[210:211], v7 offset:320
s_add_u32 s52, s80, s81
v_mfma_f32_16x16x32_bf16 v[120:123], a[220:223], a[64:67], v[120:123]
v_add_u32 v10, 1, v10
s_add_u32 m0, s46, 0
s_add_u32 s43, s52, 0
buffer_load_dwordx4 v236, s[16:19], s43 offen lds
v_mfma_f32_16x16x32_bf16 v[124:127], a[220:223], a[68:71], v[124:127]
ds_write_b32 v8, v10
v_mfma_f32_16x16x32_bf16 v[32:35], a[192:195], a[72:75], v[32:35]
ds_read_b64_tr_b16 a[212:213], v7 offset:576
s_add_u32 m0, s46, 1024
s_add_u32 s43, s52, 7168
buffer_load_dwordx4 v236, s[16:19], s43 offen lds
s_add_u32 m0, s46, 2048
s_add_u32 s43, s52, 14336
buffer_load_dwordx4 v236, s[16:19], s43 offen lds
v_mfma_f32_16x16x32_bf16 v[36:39], a[192:195], a[76:79], v[36:39]
ds_read_b64_tr_b16 a[214:215], v7 offset:832
v_mfma_f32_16x16x32_bf16 v[40:43], a[192:195], a[80:83], v[40:43]
v_mfma_f32_16x16x32_bf16 v[32:35], a[196:199], a[84:87], v[32:35]
ds_read_b64_tr_b16 a[216:217], v7 offset:72
s_add_u32 m0, s46, 3072
s_add_u32 s43, s52, 21504
buffer_load_dwordx4 v236, s[16:19], s43 offen lds
s_add_u32 m0, s46, 4096
s_add_u32 s43, s52, 28672
buffer_load_dwordx4 v236, s[16:19], s43 offen lds
v_mfma_f32_16x16x32_bf16 v[36:39], a[196:199], a[88:91], v[36:39]
ds_read_b64_tr_b16 a[218:219], v7 offset:328
v_mfma_f32_16x16x32_bf16 v[40:43], a[196:199], a[92:95], v[40:43]
s_waitcnt lgkmcnt(9)
v_mfma_f32_16x16x32_bf16 v[44:47], a[200:203], a[72:75], v[44:47]
ds_read_b64_tr_b16 a[220:221], v7 offset:584
s_add_u32 m0, s46, 5120
s_add_u32 s43, s52, 35840
buffer_load_dwordx4 v236, s[16:19], s43 offen lds
s_add_u32 s81, s81, 128
v_mfma_f32_16x16x32_bf16 v[48:51], a[200:203], a[76:79], v[48:51]
ds_read_b64_tr_b16 a[222:223], v7 offset:840
v_mfma_f32_16x16x32_bf16 v[52:55], a[200:203], a[80:83], v[52:55]
s_waitcnt lgkmcnt(9)
v_mfma_f32_16x16x32_bf16 v[44:47], a[204:207], a[84:87], v[44:47]
ds_read_b64_tr_b16 a[192:193], v7 offset:128
s_cmp_eq_u32 s81, 896
s_cselect_b32 s81, 0, s81
v_mfma_f32_16x16x32_bf16 v[48:51], a[204:207], a[88:91], v[48:51]
ds_read_b64_tr_b16 a[194:195], v7 offset:384
v_mfma_f32_16x16x32_bf16 v[52:55], a[204:207], a[92:95], v[52:55]
s_waitcnt lgkmcnt(9)
v_mfma_f32_16x16x32_bf16 v[56:59], a[208:211], a[72:75], v[56:59]
ds_read_b64_tr_b16 a[196:197], v7 offset:640
v_mfma_f32_16x16x32_bf16 v[60:63], a[208:211], a[76:79], v[60:63]
ds_read_b64_tr_b16 a[198:199], v7 offset:896
v_mfma_f32_16x16x32_bf16 v[64:67], a[208:211], a[80:83], v[64:67]
s_waitcnt lgkmcnt(8)
v_mfma_f32_16x16x32_bf16 v[56:59], a[212:215], a[84:87], v[56:59]
ds_read_b64_tr_b16 a[200:201], v7 offset:136
v_mfma_f32_16x16x32_bf16 v[60:63], a[212:215], a[88:91], v[60:63]
ds_read_b64_tr_b16 a[202:203], v7 offset:392
v_mfma_f32_16x16x32_bf16 v[64:67], a[212:215], a[92:95], v[64:67]
s_waitcnt lgkmcnt(8)
v_mfma_f32_16x16x32_bf16 v[68:71], a[216:219], a[72:75], v[68:71]
ds_read_b64_tr_b16 a[204:205], v7 offset:648
v_mfma_f32_16x16x32_bf16 v[72:75], a[216:219], a[76:79], v[72:75]
ds_read_b64_tr_b16 a[206:207], v7 offset:904
v_mfma_f32_16x16x32_bf16 v[76:79], a[216:219], a[80:83], v[76:79]
s_waitcnt lgkmcnt(8)
v_mfma_f32_16x16x32_bf16 v[68:71], a[220:223], a[84:87], v[68:71]
ds_read_b64_tr_b16 a[208:209], v7 offset:192
v_mfma_f32_16x16x32_bf16 v[72:75], a[220:223], a[88:91], v[72:75]
ds_read_b64_tr_b16 a[210:211], v7 offset:448
v_mfma_f32_16x16x32_bf16 v[76:79], a[220:223], a[92:95], v[76:79]
ds_read_b32 v25, v9
s_waitcnt lgkmcnt(9)
v_mfma_f32_16x16x32_bf16 v[80:83], a[192:195], a[72:75], v[80:83]
ds_read_b64_tr_b16 a[212:213], v7 offset:704
s_waitcnt vmcnt(12)
ds_read_b128 a[96:99], v237 offset:6144
v_mfma_f32_16x16x32_bf16 v[84:87], a[192:195], a[76:79], v[84:87]
ds_read_b64_tr_b16 a[214:215], v7 offset:960
v_mfma_f32_16x16x32_bf16 v[88:91], a[192:195], a[80:83], v[88:91]
s_waitcnt lgkmcnt(10)
v_mfma_f32_16x16x32_bf16 v[80:83], a[196:199], a[84:87], v[80:83]
ds_read_b64_tr_b16 a[216:217], v7 offset:200
ds_read_b128 a[100:103], v237 offset:8192
v_mfma_f32_16x16x32_bf16 v[84:87], a[196:199], a[88:91], v[84:87]
ds_read_b64_tr_b16 a[218:219], v7 offset:456
v_mfma_f32_16x16x32_bf16 v[88:91], a[196:199], a[92:95], v[88:91]
s_waitcnt lgkmcnt(11)
v_mfma_f32_16x16x32_bf16 v[92:95], a[200:203], a[72:75], v[92:95]
ds_read_b64_tr_b16 a[220:221], v7 offset:712
ds_read_b64_tr_b16 a[222:223], v7 offset:968
s_waitcnt lgkmcnt(8)
v_mfma_f32_16x16x32_bf16 v[96:99], a[200:203], a[76:79], v[96:99]
v_readfirstlane_b32 s39, v25
s_add_u32 s38, s38, 1
ds_read_b128 a[104:107], v237 offset:10240
v_mfma_f32_16x16x32_bf16 v[100:103], a[200:203], a[80:83], v[100:103]
s_cmp_ge_u32 s39, s38
s_cbranch_scc0 L_poll11
L_ret12:
v_add_u32 v7, s40, v3
v_mfma_f32_16x16x32_bf16 v[92:95], a[204:207], a[84:87], v[92:95]
ds_read_b64_tr_b16 a[192:193], v7 offset:0
ds_read_b128 a[108:111], v238 offset:6144
v_mfma_f32_16x16x32_bf16 v[96:99], a[204:207], a[88:91], v[96:99]
ds_read_b64_tr_b16 a[194:195], v7 offset:256
v_mfma_f32_16x16x32_bf16 v[100:103], a[204:207], a[92:95], v[100:103]
v_mfma_f32_16x16x32_bf16 v[104:107], a[208:211], a[72:75], v[104:107]
ds_read_b64_tr_b16 a[196:197], v7 offset:512
ds_read_b64_tr_b16 a[198:199], v7 offset:768
ds_read_b128 a[112:115], v238 offset:8192
v_mfma_f32_16x16x32_bf16 v[108:111], a[208:211], a[76:79], v[108:111]
s_add_u32 s40, s40, 16896
v_mfma_f32_16x16x32_bf16 v[112:115], a[208:211], a[80:83], v[112:115]
s_cmp_eq_u32 s40, 152064
s_cselect_b32 s40, 0, s40
s_waitcnt lgkmcnt(12)
v_mfma_f32_16x16x32_bf16 v[104:107], a[212:215], a[84:87], v[104:107]
ds_read_b64_tr_b16 a[200:201], v7 offset:8
ds_read_b128 a[116:119], v238 offset:10240
v_mfma_f32_16x16x32_bf16 v[108:111], a[212:215], a[88:91], v[108:111]
ds_read_b64_tr_b16 a[202:203], v7 offset:264
v_mfma_f32_16x16x32_bf16 v[112:115], a[212:215], a[92:95], v[112:115]
s_waitcnt lgkmcnt(12)
v_mfma_f32_16x16x32_bf16 v[116:119], a[216:219], a[72:75], v[116:119]
ds_read_b64_tr_b16 a[204:205], v7 offset:520
v_mfma_f32_16x16x32_bf16 v[120:123], a[216:219], a[76:79], v[120:123]
ds_read_b64_tr_b16 a[206:207], v7 offset:776
v_mfma_f32_16x16x32_bf16 v[124:127], a[216:219], a[80:83], v[124:127]
s_waitcnt lgkmcnt(12)
s_waitcnt lgkmcnt(3)
v_mfma_f32_16x16x32_bf16 v[116:119], a[220:223], a[84:87], v[116:119]
ds_read_b64_tr_b16 a[208:209], v7 offset:64
ds_read_b64_tr_b16 a[210:211], v7 offset:320
v_mfma_f32_16x16x32_bf16 v[120:123], a[220:223], a[88:91], v[120:123]
v_add_u32 v10, 1, v10
v_mfma_f32_16x16x32_bf16 v[124:127], a[220:223], a[92:95], v[124:127]
ds_write_b32 v8, v10
v_mfma_f32_16x16x32_bf16 v[32:35], a[192:195], a[96:99], v[32:35]
ds_read_b64_tr_b16 a[212:213], v7 offset:576
v_mfma_f32_16x16x32_bf16 v[36:39], a[192:195], a[100:103], v[36:39]
ds_read_b64_tr_b16 a[214:215], v7 offset:832
v_mfma_f32_16x16x32_bf16 v[40:43], a[192:195], a[104:107], v[40:43]
v_mfma_f32_16x16x32_bf16 v[32:35], a[196:199], a[108:111], v[32:35]
ds_read_b64_tr_b16 a[216:217], v7 offset:72
v_mfma_f32_16x16x32_bf16 v[36:39], a[196:199], a[112:115], v[36:39]
ds_read_b64_tr_b16 a[218:219], v7 offset:328
v_mfma_f32_16x16x32_bf16 v[40:43], a[196:199], a[116:119], v[40:43]
s_waitcnt lgkmcnt(9)
v_mfma_f32_16x16x32_bf16 v[44:47], a[200:203], a[96:99], v[44:47]
ds_read_b64_tr_b16 a[220:221], v7 offset:584
v_mfma_f32_16x16x32_bf16 v[48:51], a[200:203], a[100:103], v[48:51]
ds_read_b64_tr_b16 a[222:223], v7 offset:840
v_mfma_f32_16x16x32_bf16 v[52:55], a[200:203], a[104:107], v[52:55]
s_waitcnt lgkmcnt(9)
v_mfma_f32_16x16x32_bf16 v[44:47], a[204:207], a[108:111], v[44:47]
ds_read_b64_tr_b16 a[192:193], v7 offset:128
v_mfma_f32_16x16x32_bf16 v[48:51], a[204:207], a[112:115], v[48:51]
ds_read_b64_tr_b16 a[194:195], v7 offset:384
v_mfma_f32_16x16x32_bf16 v[52:55], a[204:207], a[116:119], v[52:55]
s_waitcnt lgkmcnt(9)
v_mfma_f32_16x16x32_bf16 v[56:59], a[208:211], a[96:99], v[56:59]
ds_read_b64_tr_b16 a[196:197], v7 offset:640
v_mfma_f32_16x16x32_bf16 v[60:63], a[208:211], a[100:103], v[60:63]
ds_read_b64_tr_b16 a[198:199], v7 offset:896
v_mfma_f32_16x16x32_bf16 v[64:67], a[208:211], a[104:107], v[64:67]
s_waitcnt lgkmcnt(8)
v_mfma_f32_16x16x32_bf16 v[56:59], a[212:215], a[108:111], v[56:59]
ds_read_b64_tr_b16 a[200:201], v7 offset:136
v_mfma_f32_16x16x32_bf16 v[60:63], a[212:215], a[112:115], v[60:63]
ds_read_b64_tr_b16 a[202:203], v7 offset:392
v_mfma_f32_16x16x32_bf16 v[64:67], a[212:215], a[116:119], v[64:67]
s_waitcnt lgkmcnt(8)
v_mfma_f32_16x16x32_bf16 v[68:71], a[216:219], a[96:99], v[68:71]
ds_read_b64_tr_b16 a[204:205], v7 offset:648
v_mfma_f32_16x16x32_bf16 v[72:75], a[216:219], a[100:103], v[72:75]
ds_read_b64_tr_b16 a[206:207], v7 offset:904
v_mfma_f32_16x16x32_bf16 v[76:79], a[216:219], a[104:107], v[76:79]
s_waitcnt lgkmcnt(8)
v_mfma_f32_16x16x32_bf16 v[68:71], a[220:223], a[108:111], v[68:71]
ds_read_b64_tr_b16 a[208:209], v7 offset:192
v_mfma_f32_16x16x32_bf16 v[72:75], a[220:223], a[112:115], v[72:75]
ds_read_b64_tr_b16 a[210:211], v7 offset:448
v_mfma_f32_16x16x32_bf16 v[76:79], a[220:223], a[116:119], v[76:79]
ds_read_b32 v25, v9
s_waitcnt lgkmcnt(9)
v_mfma_f32_16x16x32_bf16 v[80:83], a[192:195], a[96:99], v[80:83]
ds_read_b64_tr_b16 a[212:213], v7 offset:704
s_waitcnt vmcnt(6)
ds_read_b128 a[120:123], v237 offset:12288
v_mfma_f32_16x16x32_bf16 v[84:87], a[192:195], a[100:103], v[84:87]
ds_read_b64_tr_b16 a[214:215], v7 offset:960
v_mfma_f32_16x16x32_bf16 v[88:91], a[192:195], a[104:107], v[88:91]
s_waitcnt lgkmcnt(10)
v_mfma_f32_16x16x32_bf16 v[80:83], a[196:199], a[108:111], v[80:83]
ds_read_b64_tr_b16 a[216:217], v7 offset:200
ds_read_b128 a[124:127], v237 offset:14336
v_mfma_f32_16x16x32_bf16 v[84:87], a[196:199], a[112:115], v[84:87]
ds_read_b64_tr_b16 a[218:219], v7 offset:456
v_mfma_f32_16x16x32_bf16 v[88:91], a[196:199], a[116:119], v[88:91]
s_waitcnt lgkmcnt(11)
v_mfma_f32_16x16x32_bf16 v[92:95], a[200:203], a[96:99], v[92:95]
ds_read_b64_tr_b16 a[220:221], v7 offset:712
ds_read_b64_tr_b16 a[222:223], v7 offset:968
s_waitcnt lgkmcnt(8)
v_mfma_f32_16x16x32_bf16 v[96:99], a[200:203], a[100:103], v[96:99]
v_readfirstlane_b32 s39, v25
s_add_u32 s38, s38, 5
s_mov_b32 s40, 0
v_mfma_f32_16x16x32_bf16 v[100:103], a[200:203], a[104:107], v[100:103]
s_cmp_ge_u32 s39, s38
s_cbranch_scc0 L_poll13
L_ret14:
v_add_u32 v7, s40, v3
v_mfma_f32_16x16x32_bf16 v[92:95], a[204:207], a[108:111], v[92:95]
ds_read_b64_tr_b16 a[192:193], v7 offset:0
ds_read_b128 a[128:131], v237 offset:16384
ds_read_b128 a[132:135], v238 offset:12288
v_mfma_f32_16x16x32_bf16 v[96:99], a[204:207], a[112:115], v[96:99]
ds_read_b64_tr_b16 a[194:195], v7 offset:256
v_mfma_f32_16x16x32_bf16 v[100:103], a[204:207], a[116:119], v[100:103]
v_mfma_f32_16x16x32_bf16 v[104:107], a[208:211], a[96:99], v[104:107]
ds_read_b64_tr_b16 a[196:197], v7 offset:512
ds_read_b64_tr_b16 a[198:199], v7 offset:768
ds_read_b128 a[136:139], v238 offset:14336
v_mfma_f32_16x16x32_bf16 v[108:111], a[208:211], a[100:103], v[108:111]
s_add_u32 s40, s40, 16896
v_mfma_f32_16x16x32_bf16 v[112:115], a[208:211], a[104:107], v[112:115]
s_cmp_eq_u32 s40, 152064
s_cselect_b32 s40, 0, s40
s_waitcnt lgkmcnt(12)
v_mfma_f32_16x16x32_bf16 v[104:107], a[212:215], a[108:111], v[104:107]
ds_read_b64_tr_b16 a[200:201], v7 offset:8
ds_read_b128 a[140:143], v238 offset:16384
v_mfma_f32_16x16x32_bf16 v[108:111], a[212:215], a[112:115], v[108:111]
ds_read_b64_tr_b16 a[202:203], v7 offset:264
v_mfma_f32_16x16x32_bf16 v[112:115], a[212:215], a[116:119], v[112:115]
s_waitcnt lgkmcnt(12)
v_mfma_f32_16x16x32_bf16 v[116:119], a[216:219], a[96:99], v[116:119]
ds_read_b64_tr_b16 a[204:205], v7 offset:520
v_mfma_f32_16x16x32_bf16 v[120:123], a[216:219], a[100:103], v[120:123]
ds_read_b64_tr_b16 a[206:207], v7 offset:776
v_mfma_f32_16x16x32_bf16 v[124:127], a[216:219], a[104:107], v[124:127]
s_waitcnt lgkmcnt(12)
s_waitcnt lgkmcnt(3)
v_mfma_f32_16x16x32_bf16 v[116:119], a[220:223], a[108:111], v[116:119]
ds_read_b64_tr_b16 a[208:209], v7 offset:64
ds_read_b64_tr_b16 a[210:211], v7 offset:320
v_mfma_f32_16x16x32_bf16 v[120:123], a[220:223], a[112:115], v[120:123]
v_add_u32 v10, 1, v10
v_mfma_f32_16x16x32_bf16 v[124:127], a[220:223], a[116:119], v[124:127]
ds_write_b32 v8, v10
v_mfma_f32_16x16x32_bf16 v[32:35], a[192:195], a[120:123], v[32:35]
ds_read_b64_tr_b16 a[212:213], v7 offset:576
v_mfma_f32_16x16x32_bf16 v[36:39], a[192:195], a[124:127], v[36:39]
ds_read_b64_tr_b16 a[214:215], v7 offset:832
v_mfma_f32_16x16x32_bf16 v[40:43], a[192:195], a[128:131], v[40:43]
v_mfma_f32_16x16x32_bf16 v[32:35], a[196:199], a[132:135], v[32:35]
ds_read_b64_tr_b16 a[216:217], v7 offset:72
v_mfma_f32_16x16x32_bf16 v[36:39], a[196:199], a[136:139], v[36:39]
ds_read_b64_tr_b16 a[218:219], v7 offset:328
v_mfma_f32_16x16x32_bf16 v[40:43], a[196:199], a[140:143], v[40:43]
s_waitcnt lgkmcnt(9)
v_mfma_f32_16x16x32_bf16 v[44:47], a[200:203], a[120:123], v[44:47]
ds_read_b64_tr_b16 a[220:221], v7 offset:584
v_mfma_f32_16x16x32_bf16 v[48:51], a[200:203], a[124:127], v[48:51]
ds_read_b64_tr_b16 a[222:223], v7 offset:840
v_mfma_f32_16x16x32_bf16 v[52:55], a[200:203], a[128:131], v[52:55]
s_waitcnt lgkmcnt(9)
v_mfma_f32_16x16x32_bf16 v[44:47], a[204:207], a[132:135], v[44:47]
ds_read_b64_tr_b16 a[192:193], v7 offset:128
v_mfma_f32_16x16x32_bf16 v[48:51], a[204:207], a[136:139], v[48:51]
ds_read_b64_tr_b16 a[194:195], v7 offset:384
v_mfma_f32_16x16x32_bf16 v[52:55], a[204:207], a[140:143], v[52:55]
s_waitcnt lgkmcnt(9)
v_mfma_f32_16x16x32_bf16 v[56:59], a[208:211], a[120:123], v[56:59]
ds_read_b64_tr_b16 a[196:197], v7 offset:640
v_mfma_f32_16x16x32_bf16 v[60:63], a[208:211], a[124:127], v[60:63]
ds_read_b64_tr_b16 a[198:199], v7 offset:896
v_mfma_f32_16x16x32_bf16 v[64:67], a[208:211], a[128:131], v[64:67]
s_waitcnt lgkmcnt(8)
v_mfma_f32_16x16x32_bf16 v[56:59], a[212:215], a[132:135], v[56:59]
ds_read_b64_tr_b16 a[200:201], v7 offset:136
v_mfma_f32_16x16x32_bf16 v[60:63], a[212:215], a[136:139], v[60:63]
ds_read_b64_tr_b16 a[202:203], v7 offset:392
v_mfma_f32_16x16x32_bf16 v[64:67], a[212:215], a[140:143], v[64:67]
s_waitcnt lgkmcnt(8)
v_mfma_f32_16x16x32_bf16 v[68:71], a[216:219], a[120:123], v[68:71]
ds_read_b64_tr_b16 a[204:205], v7 offset:648
v_mfma_f32_16x16x32_bf16 v[72:75], a[216:219], a[124:127], v[72:75]
ds_read_b64_tr_b16 a[206:207], v7 offset:904
v_mfma_f32_16x16x32_bf16 v[76:79], a[216:219], a[128:131], v[76:79]
s_waitcnt lgkmcnt(8)
v_mfma_f32_16x16x32_bf16 v[68:71], a[220:223], a[132:135], v[68:71]
ds_read_b64_tr_b16 a[208:209], v7 offset:192
v_mfma_f32_16x16x32_bf16 v[72:75], a[220:223], a[136:139], v[72:75]
ds_read_b64_tr_b16 a[210:211], v7 offset:448
v_mfma_f32_16x16x32_bf16 v[76:79], a[220:223], a[140:143], v[76:79]
ds_read_b32 v25, v9
s_waitcnt lgkmcnt(9)
v_mfma_f32_16x16x32_bf16 v[80:83], a[192:195], a[120:123], v[80:83]
ds_read_b64_tr_b16 a[212:213], v7 offset:704
s_waitcnt vmcnt(0)
ds_read_b128 a[144:147], v237 offset:0
v_mfma_f32_16x16x32_bf16 v[84:87], a[192:195], a[124:127], v[84:87]
ds_read_b64_tr_b16 a[214:215], v7 offset:960
v_mfma_f32_16x16x32_bf16 v[88:91], a[192:195], a[128:131], v[88:91]
s_waitcnt lgkmcnt(10)
v_mfma_f32_16x16x32_bf16 v[80:83], a[196:199], a[132:135], v[80:83]
ds_read_b64_tr_b16 a[216:217], v7 offset:200
ds_read_b128 a[148:151], v237 offset:2048
v_mfma_f32_16x16x32_bf16 v[84:87], a[196:199], a[136:139], v[84:87]
ds_read_b64_tr_b16 a[218:219], v7 offset:456
v_mfma_f32_16x16x32_bf16 v[88:91], a[196:199], a[140:143], v[88:91]
s_waitcnt lgkmcnt(11)
v_mfma_f32_16x16x32_bf16 v[92:95], a[200:203], a[120:123], v[92:95]
ds_read_b64_tr_b16 a[220:221], v7 offset:712
ds_read_b64_tr_b16 a[222:223], v7 offset:968
s_waitcnt lgkmcnt(8)
v_mfma_f32_16x16x32_bf16 v[96:99], a[200:203], a[124:127], v[96:99]
v_readfirstlane_b32 s39, v25
s_add_u32 s38, s38, 1
ds_read_b128 a[152:155], v237 offset:4096
v_mfma_f32_16x16x32_bf16 v[100:103], a[200:203], a[128:131], v[100:103]
s_cmp_ge_u32 s39, s38
s_cbranch_scc0 L_poll15
L_ret16:
v_add_u32 v7, s40, v3
v_mfma_f32_16x16x32_bf16 v[92:95], a[204:207], a[132:135], v[92:95]
ds_read_b64_tr_b16 a[192:193], v7 offset:0
ds_read_b128 a[156:159], v238 offset:0
v_mfma_f32_16x16x32_bf16 v[96:99], a[204:207], a[136:139], v[96:99]
ds_read_b64_tr_b16 a[194:195], v7 offset:256
v_mfma_f32_16x16x32_bf16 v[100:103], a[204:207], a[140:143], v[100:103]
v_mfma_f32_16x16x32_bf16 v[104:107], a[208:211], a[120:123], v[104:107]
ds_read_b64_tr_b16 a[196:197], v7 offset:512
ds_read_b64_tr_b16 a[198:199], v7 offset:768
ds_read_b128 a[160:163], v238 offset:2048
v_mfma_f32_16x16x32_bf16 v[108:111], a[208:211], a[124:127], v[108:111]
s_add_u32 s40, s40, 16896
v_mfma_f32_16x16x32_bf16 v[112:115], a[208:211], a[128:131], v[112:115]
s_cmp_eq_u32 s40, 152064
s_cselect_b32 s40, 0, s40
s_waitcnt lgkmcnt(12)
v_mfma_f32_16x16x32_bf16 v[104:107], a[212:215], a[132:135], v[104:107]
ds_read_b64_tr_b16 a[200:201], v7 offset:8
ds_read_b128 a[164:167], v238 offset:4096
v_mfma_f32_16x16x32_bf16 v[108:111], a[212:215], a[136:139], v[108:111]
ds_read_b64_tr_b16 a[202:203], v7 offset:264
v_mfma_f32_16x16x32_bf16 v[112:115], a[212:215], a[140:143], v[112:115]
s_waitcnt lgkmcnt(12)
v_mfma_f32_16x16x32_bf16 v[116:119], a[216:219], a[120:123], v[116:119]
ds_read_b64_tr_b16 a[204:205], v7 offset:520
v_mfma_f32_16x16x32_bf16 v[120:123], a[216:219], a[124:127], v[120:123]
ds_read_b64_tr_b16 a[206:207], v7 offset:776
v_mfma_f32_16x16x32_bf16 v[124:127], a[216:219], a[128:131], v[124:127]
s_waitcnt lgkmcnt(12)
s_waitcnt lgkmcnt(3)
v_mfma_f32_16x16x32_bf16 v[116:119], a[220:223], a[132:135], v[116:119]
ds_read_b64_tr_b16 a[208:209], v7 offset:64
ds_read_b64_tr_b16 a[210:211], v7 offset:320
v_mfma_f32_16x16x32_bf16 v[120:123], a[220:223], a[136:139], v[120:123]
v_add_u32 v10, 5, v10
v_mfma_f32_16x16x32_bf16 v[124:127], a[220:223], a[140:143], v[124:127]
ds_write_b32 v8, v10
v_mfma_f32_16x16x32_bf16 v[32:35], a[192:195], a[144:147], v[32:35]
ds_read_b64_tr_b16 a[212:213], v7 offset:576
v_mfma_f32_16x16x32_bf16 v[36:39], a[192:195], a[148:151], v[36:39]
ds_read_b64_tr_b16 a[214:215], v7 offset:832
v_mfma_f32_16x16x32_bf16 v[40:43], a[192:195], a[152:155], v[40:43]
v_mfma_f32_16x16x32_bf16 v[32:35], a[196:199], a[156:159], v[32:35]
ds_read_b64_tr_b16 a[216:217], v7 offset:72
v_mfma_f32_16x16x32_bf16 v[36:39], a[196:199], a[160:163], v[36:39]
ds_read_b64_tr_b16 a[218:219], v7 offset:328
v_mfma_f32_16x16x32_bf16 v[40:43], a[196:199], a[164:167], v[40:43]
s_waitcnt lgkmcnt(9)
v_mfma_f32_16x16x32_bf16 v[44:47], a[200:203], a[144:147], v[44:47]
ds_read_b64_tr_b16 a[220:221], v7 offset:584
v_mfma_f32_16x16x32_bf16 v[48:51], a[200:203], a[148:151], v[48:51]
ds_read_b64_tr_b16 a[222:223], v7 offset:840
v_mfma_f32_16x16x32_bf16 v[52:55], a[200:203], a[152:155], v[52:55]
s_waitcnt lgkmcnt(9)
v_mfma_f32_16x16x32_bf16 v[44:47], a[204:207], a[156:159], v[44:47]
ds_read_b64_tr_b16 a[192:193], v7 offset:128
v_mfma_f32_16x16x32_bf16 v[48:51], a[204:207], a[160:163], v[48:51]
ds_read_b64_tr_b16 a[194:195], v7 offset:384
v_mfma_f32_16x16x32_bf16 v[52:55], a[204:207], a[164:167], v[52:55]
s_waitcnt lgkmcnt(9)
v_mfma_f32_16x16x32_bf16 v[56:59], a[208:211], a[144:147], v[56:59]
ds_read_b64_tr_b16 a[196:197], v7 offset:640
v_mfma_f32_16x16x32_bf16 v[60:63], a[208:211], a[148:151], v[60:63]
ds_read_b64_tr_b16 a[198:199], v7 offset:896
v_mfma_f32_16x16x32_bf16 v[64:67], a[208:211], a[152:155], v[64:67]
s_waitcnt lgkmcnt(8)
v_mfma_f32_16x16x32_bf16 v[56:59], a[212:215], a[156:159], v[56:59]
ds_read_b64_tr_b16 a[200:201], v7 offset:136
v_mfma_f32_16x16x32_bf16 v[60:63], a[212:215], a[160:163], v[60:63]
ds_read_b64_tr_b16 a[202:203], v7 offset:392
v_mfma_f32_16x16x32_bf16 v[64:67], a[212:215], a[164:167], v[64:67]
s_waitcnt lgkmcnt(8)
v_mfma_f32_16x16x32_bf16 v[68:71], a[216:219], a[144:147], v[68:71]
ds_read_b64_tr_b16 a[204:205], v7 offset:648
v_mfma_f32_16x16x32_bf16 v[72:75], a[216:219], a[148:151], v[72:75]
ds_read_b64_tr_b16 a[206:207], v7 offset:904
v_mfma_f32_16x16x32_bf16 v[76:79], a[216:219], a[152:155], v[76:79]
s_waitcnt lgkmcnt(8)
v_mfma_f32_16x16x32_bf16 v[68:71], a[220:223], a[156:159], v[68:71]
ds_read_b64_tr_b16 a[208:209], v7 offset:192
v_mfma_f32_16x16x32_bf16 v[72:75], a[220:223], a[160:163], v[72:75]
ds_read_b64_tr_b16 a[210:211], v7 offset:448
v_mfma_f32_16x16x32_bf16 v[76:79], a[220:223], a[164:167], v[76:79]
ds_read_b32 v25, v9
s_waitcnt lgkmcnt(9)
v_mfma_f32_16x16x32_bf16 v[80:83], a[192:195], a[144:147], v[80:83]
ds_read_b64_tr_b16 a[212:213], v7 offset:704
v_mfma_f32_16x16x32_bf16 v[84:87], a[192:195], a[148:151], v[84:87]
ds_read_b64_tr_b16 a[214:215], v7 offset:960
v_mfma_f32_16x16x32_bf16 v[88:91], a[192:195], a[152:155], v[88:91]
s_waitcnt lgkmcnt(9)
v_mfma_f32_16x16x32_bf16 v[80:83], a[196:199], a[156:159], v[80:83]
ds_read_b64_tr_b16 a[216:217], v7 offset:200
v_mfma_f32_16x16x32_bf16 v[84:87], a[196:199], a[160:163], v[84:87]
ds_read_b64_tr_b16 a[218:219], v7 offset:456
v_mfma_f32_16x16x32_bf16 v[88:91], a[196:199], a[164:167], v[88:91]
s_waitcnt lgkmcnt(9)
v_mfma_f32_16x16x32_bf16 v[92:95], a[200:203], a[144:147], v[92:95]
ds_read_b64_tr_b16 a[220:221], v7 offset:712
ds_read_b64_tr_b16 a[222:223], v7 offset:968
s_waitcnt lgkmcnt(6)
v_mfma_f32_16x16x32_bf16 v[96:99], a[200:203], a[148:151], v[96:99]
v_readfirstlane_b32 s39, v25
s_add_u32 s38, s38, 1
v_mfma_f32_16x16x32_bf16 v[100:103], a[200:203], a[152:155], v[100:103]
s_cmp_ge_u32 s39, s38
s_cbranch_scc0 L_poll17
L_ret18:
v_add_u32 v7, s40, v3
v_mfma_f32_16x16x32_bf16 v[92:95], a[204:207], a[156:159], v[92:95]
ds_read_b64_tr_b16 a[192:193], v7 offset:0
v_mfma_f32_16x16x32_bf16 v[96:99], a[204:207], a[160:163], v[96:99]
ds_read_b64_tr_b16 a[194:195], v7 offset:256
v_mfma_f32_16x16x32_bf16 v[100:103], a[204:207], a[164:167], v[100:103]
v_mfma_f32_16x16x32_bf16 v[104:107], a[208:211], a[144:147], v[104:107]
ds_read_b64_tr_b16 a[196:197], v7 offset:512
ds_read_b64_tr_b16 a[198:199], v7 offset:768
v_mfma_f32_16x16x32_bf16 v[108:111], a[208:211], a[148:151], v[108:111]
s_add_u32 s40, s40, 16896
v_mfma_f32_16x16x32_bf16 v[112:115], a[208:211], a[152:155], v[112:115]
s_cmp_eq_u32 s40, 152064
s_cselect_b32 s40, 0, s40
s_waitcnt lgkmcnt(8)
v_mfma_f32_16x16x32_bf16 v[104:107], a[212:215], a[156:159], v[104:107]
ds_read_b64_tr_b16 a[200:201], v7 offset:8
v_mfma_f32_16x16x32_bf16 v[108:111], a[212:215], a[160:163], v[108:111]
ds_read_b64_tr_b16 a[202:203], v7 offset:264
v_mfma_f32_16x16x32_bf16 v[112:115], a[212:215], a[164:167], v[112:115]
s_waitcnt lgkmcnt(8)
v_mfma_f32_16x16x32_bf16 v[116:119], a[216:219], a[144:147], v[116:119]
ds_read_b64_tr_b16 a[204:205], v7 offset:520
v_mfma_f32_16x16x32_bf16 v[120:123], a[216:219], a[148:151], v[120:123]
ds_read_b64_tr_b16 a[206:207], v7 offset:776
v_mfma_f32_16x16x32_bf16 v[124:127], a[216:219], a[152:155], v[124:127]
s_waitcnt lgkmcnt(8)
v_mfma_f32_16x16x32_bf16 v[116:119], a[220:223], a[156:159], v[116:119]
ds_read_b64_tr_b16 a[208:209], v7 offset:64
ds_read_b64_tr_b16 a[210:211], v7 offset:320
v_mfma_f32_16x16x32_bf16 v[120:123], a[220:223], a[160:163], v[120:123]
v_add_u32 v10, 1, v10
v_mfma_f32_16x16x32_bf16 v[124:127], a[220:223], a[164:167], v[124:127]
ds_write_b32 v8, v10
s_waitcnt lgkmcnt(9)
v_mfma_f32_16x16x32_bf16 v[128:131], a[192:195], a[0:3], 0
ds_read_b64_tr_b16 a[212:213], v7 offset:576
v_mfma_f32_16x16x32_bf16 v[132:135], a[192:195], a[4:7], 0
ds_read_b64_tr_b16 a[214:215], v7 offset:832
v_mfma_f32_16x16x32_bf16 v[136:139], a[192:195], a[8:11], 0
s_waitcnt lgkmcnt(9)
v_mfma_f32_16x16x32_bf16 v[128:131], a[196:199], a[12:15], v[128:131]
ds_read_b64_tr_b16 a[216:217], v7 offset:72
v_mfma_f32_16x16x32_bf16 v[132:135], a[196:199], a[16:19], v[132:135]
ds_read_b64_tr_b16 a[218:219], v7 offset:328
v_mfma_f32_16x16x32_bf16 v[136:139], a[196:199], a[20:23], v[136:139]
s_waitcnt lgkmcnt(9)
v_mfma_f32_16x16x32_bf16 v[140:143], a[200:203], a[0:3], 0
ds_read_b64_tr_b16 a[220:221], v7 offset:584
v_mfma_f32_16x16x32_bf16 v[144:147], a[200:203], a[4:7], 0
ds_read_b64_tr_b16 a[222:223], v7 offset:840
v_mfma_f32_16x16x32_bf16 v[148:151], a[200:203], a[8:11], 0
s_waitcnt lgkmcnt(9)
v_mfma_f32_16x16x32_bf16 v[140:143], a[204:207], a[12:15], v[140:143]
ds_read_b64_tr_b16 a[192:193], v7 offset:128
v_mul_f32 v32, s82, v32
v_mfma_f32_16x16x32_bf16 v[144:147], a[204:207], a[16:19], v[144:147]
ds_read_b64_tr_b16 a[194:195], v7 offset:384
v_mul_f32 v33, s82, v33
v_mfma_f32_16x16x32_bf16 v[148:151], a[204:207], a[20:23], v[148:151]
s_waitcnt lgkmcnt(9)
v_mul_f32 v34, s82, v34
v_mul_f32 v35, s82, v35
v_mfma_f32_16x16x32_bf16 v[152:155], a[208:211], a[0:3], 0
ds_read_b64_tr_b16 a[196:197], v7 offset:640
v_cvt_pk_bf16_f32 v32, v32, v33
v_mfma_f32_16x16x32_bf16 v[156:159], a[208:211], a[4:7], 0
ds_read_b64_tr_b16 a[198:199], v7 offset:896
v_cvt_pk_bf16_f32 v33, v34, v35
v_mfma_f32_16x16x32_bf16 v[160:163], a[208:211], a[8:11], 0
s_waitcnt lgkmcnt(8)
v_mul_f32 v44, s82, v44
v_mul_f32 v45, s82, v45
v_mfma_f32_16x16x32_bf16 v[152:155], a[212:215], a[12:15], v[152:155]
ds_read_b64_tr_b16 a[200:201], v7 offset:136
v_mul_f32 v46, s82, v46
v_mfma_f32_16x16x32_bf16 v[156:159], a[212:215], a[16:19], v[156:159]
ds_read_b64_tr_b16 a[202:203], v7 offset:392
v_mul_f32 v47, s82, v47
v_mfma_f32_16x16x32_bf16 v[160:163], a[212:215], a[20:23], v[160:163]
s_waitcnt lgkmcnt(8)
v_cvt_pk_bf16_f32 v34, v44, v45
v_mfma_f32_16x16x32_bf16 v[164:167], a[216:219], a[0:3], 0
ds_read_b64_tr_b16 a[204:205], v7 offset:648
v_cvt_pk_bf16_f32 v35, v46, v47
v_mfma_f32_16x16x32_bf16 v[168:171], a[216:219], a[4:7], 0
ds_read_b64_tr_b16 a[206:207], v7 offset:904
v_mul_f32 v36, s82, v36
v_mfma_f32_16x16x32_bf16 v[172:175], a[216:219], a[8:11], 0
s_waitcnt lgkmcnt(8)
v_mul_f32 v37, s82, v37
v_mul_f32 v38, s82, v38
v_mfma_f32_16x16x32_bf16 v[164:167], a[220:223], a[12:15], v[164:167]
ds_read_b64_tr_b16 a[208:209], v7 offset:192
v_mul_f32 v39, s82, v39
v_mfma_f32_16x16x32_bf16 v[168:171], a[220:223], a[16:19], v[168:171]
ds_read_b64_tr_b16 a[210:211], v7 offset:448
v_cvt_pk_bf16_f32 v36, v36, v37
v_mfma_f32_16x16x32_bf16 v[172:175], a[220:223], a[20:23], v[172:175]
ds_read_b32 v25, v9
s_waitcnt lgkmcnt(9)
v_cvt_pk_bf16_f32 v37, v38, v39
v_mfma_f32_16x16x32_bf16 v[176:179], a[192:195], a[0:3], 0
ds_read_b64_tr_b16 a[212:213], v7 offset:704
v_mul_f32 v48, s82, v48
v_mfma_f32_16x16x32_bf16 v[180:183], a[192:195], a[4:7], 0
ds_read_b64_tr_b16 a[214:215], v7 offset:960
v_mul_f32 v49, s82, v49
v_mfma_f32_16x16x32_bf16 v[184:187], a[192:195], a[8:11], 0
s_waitcnt lgkmcnt(9)
v_mul_f32 v50, s82, v50
v_mul_f32 v51, s82, v51
v_mfma_f32_16x16x32_bf16 v[176:179], a[196:199], a[12:15], v[176:179]
ds_read_b64_tr_b16 a[216:217], v7 offset:200
v_cvt_pk_bf16_f32 v38, v48, v49
v_mfma_f32_16x16x32_bf16 v[180:183], a[196:199], a[16:19], v[180:183]
ds_read_b64_tr_b16 a[218:219], v7 offset:456
v_cvt_pk_bf16_f32 v39, v50, v51
v_mfma_f32_16x16x32_bf16 v[184:187], a[196:199], a[20:23], v[184:187]
s_waitcnt lgkmcnt(9)
v_mul_f32 v40, s82, v40
v_mul_f32 v41, s82, v41
v_mfma_f32_16x16x32_bf16 v[188:191], a[200:203], a[0:3], 0
ds_read_b64_tr_b16 a[220:221], v7 offset:712
ds_read_b64_tr_b16 a[222:223], v7 offset:968
s_waitcnt lgkmcnt(6)
v_mfma_f32_16x16x32_bf16 v[192:195], a[200:203], a[4:7], 0
v_readfirstlane_b32 s39, v25
s_add_u32 s38, s38, 1
v_mul_f32 v42, s82, v42
v_mfma_f32_16x16x32_bf16 v[196:199], a[200:203], a[8:11], 0
s_cmp_ge_u32 s39, s38
s_cbranch_scc0 L_poll19
L_ret20:
v_add_u32 v7, s40, v3
v_mfma_f32_16x16x32_bf16 v[188:191], a[204:207], a[12:15], v[188:191]
ds_read_b64_tr_b16 a[192:193], v7 offset:0
v_mul_f32 v43, s82, v43
v_mfma_f32_16x16x32_bf16 v[192:195], a[204:207], a[16:19], v[192:195]
ds_read_b64_tr_b16 a[194:195], v7 offset:256
v_cvt_pk_bf16_f32 v40, v40, v41
v_mfma_f32_16x16x32_bf16 v[196:199], a[204:207], a[20:23], v[196:199]
v_cvt_pk_bf16_f32 v41, v42, v43
v_mul_f32 v52, s82, v52
v_mfma_f32_16x16x32_bf16 v[200:203], a[208:211], a[0:3], 0
ds_read_b64_tr_b16 a[196:197], v7 offset:512
ds_read_b64_tr_b16 a[198:199], v7 offset:768
v_mul_f32 v53, s82, v53
v_mfma_f32_16x16x32_bf16 v[204:207], a[208:211], a[4:7], 0
s_add_u32 s40, s40, 16896
v_mul_f32 v54, s82, v54
v_mul_f32 v55, s82, v55
v_mfma_f32_16x16x32_bf16 v[208:211], a[208:211], a[8:11], 0
s_cmp_eq_u32 s40, 152064
s_cselect_b32 s40, 0, s40
s_waitcnt lgkmcnt(8)
v_mfma_f32_16x16x32_bf16 v[200:203], a[212:215], a[12:15], v[200:203]
ds_read_b64_tr_b16 a[200:201], v7 offset:8
v_cvt_pk_bf16_f32 v42, v52, v53
v_mfma_f32_16x16x32_bf16 v[204:207], a[212:215], a[16:19], v[204:207]
ds_read_b64_tr_b16 a[202:203], v7 offset:264
v_cvt_pk_bf16_f32 v43, v54, v55
v_mfma_f32_16x16x32_bf16 v[208:211], a[212:215], a[20:23], v[208:211]
s_waitcnt lgkmcnt(8)
v_mfma_f32_16x16x32_bf16 v[212:215], a[216:219], a[0:3], 0
ds_read_b64_tr_b16 a[204:205], v7 offset:520
v_mfma_f32_16x16x32_bf16 v[216:219], a[216:219], a[4:7], 0
ds_read_b64_tr_b16 a[206:207], v7 offset:776
v_mfma_f32_16x16x32_bf16 v[220:223], a[216:219], a[8:11], 0
s_waitcnt lgkmcnt(8)
v_mfma_f32_16x16x32_bf16 v[212:215], a[220:223], a[12:15], v[212:215]
ds_read_b64_tr_b16 a[208:209], v7 offset:64
ds_read_b64_tr_b16 a[210:211], v7 offset:320
v_mfma_f32_16x16x32_bf16 v[216:219], a[220:223], a[16:19], v[216:219]
v_add_u32 v10, 1, v10
v_mfma_f32_16x16x32_bf16 v[220:223], a[220:223], a[20:23], v[220:223]
ds_write_b32 v8, v10
s_waitcnt lgkmcnt(9)
v_mfma_f32_16x16x32_bf16 v[128:131], a[192:195], a[24:27], v[128:131]
ds_read_b64_tr_b16 a[212:213], v7 offset:576
v_mfma_f32_16x16x32_bf16 v[132:135], a[192:195], a[28:31], v[132:135]
ds_read_b64_tr_b16 a[214:215], v7 offset:832
v_mfma_f32_16x16x32_bf16 v[136:139], a[192:195], a[32:35], v[136:139]
s_waitcnt lgkmcnt(9)
v_mfma_f32_16x16x32_bf16 v[128:131], a[196:199], a[36:39], v[128:131]
ds_read_b64_tr_b16 a[216:217], v7 offset:72
v_accvgpr_write_b32 a0, 0
v_mfma_f32_16x16x32_bf16 v[132:135], a[196:199], a[40:43], v[132:135]
ds_read_b64_tr_b16 a[218:219], v7 offset:328
v_accvgpr_write_b32 a1, 0
v_mfma_f32_16x16x32_bf16 v[136:139], a[196:199], a[44:47], v[136:139]
s_waitcnt lgkmcnt(9)
v_mfma_f32_16x16x32_bf16 v[140:143], a[200:203], a[24:27], v[140:143]
ds_read_b64_tr_b16 a[220:221], v7 offset:584
v_accvgpr_write_b32 a2, 0
v_mfma_f32_16x16x32_bf16 v[144:147], a[200:203], a[28:31], v[144:147]
ds_read_b64_tr_b16 a[222:223], v7 offset:840
v_accvgpr_write_b32 a3, 0
v_mfma_f32_16x16x32_bf16 v[148:151], a[200:203], a[32:35], v[148:151]
s_waitcnt lgkmcnt(9)
v_mfma_f32_16x16x32_bf16 v[140:143], a[204:207], a[36:39], v[140:143]
ds_read_b64_tr_b16 a[192:193], v7 offset:128
v_mul_f32 v56, s82, v56
v_mfma_f32_16x16x32_bf16 v[144:147], a[204:207], a[40:43], v[144:147]
ds_read_b64_tr_b16 a[194:195], v7 offset:384
v_mul_f32 v57, s82, v57
v_mfma_f32_16x16x32_bf16 v[148:151], a[204:207], a[44:47], v[148:151]
s_waitcnt lgkmcnt(9)
v_mul_f32 v58, s82, v58
v_mul_f32 v59, s82, v59
v_mfma_f32_16x16x32_bf16 v[152:155], a[208:211], a[24:27], v[152:155]
ds_read_b64_tr_b16 a[196:197], v7 offset:640
v_accvgpr_write_b32 a4, 0
v_mfma_f32_16x16x32_bf16 v[156:159], a[208:211], a[28:31], v[156:159]
ds_read_b64_tr_b16 a[198:199], v7 offset:896
v_cvt_pk_bf16_f32 v44, v56, v57
v_mfma_f32_16x16x32_bf16 v[160:163], a[208:211], a[32:35], v[160:163]
s_waitcnt lgkmcnt(8)
v_cvt_pk_bf16_f32 v45, v58, v59
v_mul_f32 v68, s82, v68
v_mfma_f32_16x16x32_bf16 v[152:155], a[212:215], a[36:39], v[152:155]
ds_read_b64_tr_b16 a[200:201], v7 offset:136
v_mul_f32 v69, s82, v69
v_mfma_f32_16x16x32_bf16 v[156:159], a[212:215], a[40:43], v[156:159]
ds_read_b64_tr_b16 a[202:203], v7 offset:392
v_accvgpr_write_b32 a5, 0
v_mfma_f32_16x16x32_bf16 v[160:163], a[212:215], a[44:47], v[160:163]
s_waitcnt lgkmcnt(8)
v_accvgpr_write_b32 a6, 0
v_mul_f32 v70, s82, v70
v_mfma_f32_16x16x32_bf16 v[164:167], a[216:219], a[24:27], v[164:167]
ds_read_b64_tr_b16 a[204:205], v7 offset:648
v_mul_f32 v71, s82, v71
v_mfma_f32_16x16x32_bf16 v[168:171], a[216:219], a[28:31], v[168:171]
ds_read_b64_tr_b16 a[206:207], v7 offset:904
v_cvt_pk_bf16_f32 v46, v68, v69
v_mfma_f32_16x16x32_bf16 v[172:175], a[216:219], a[32:35], v[172:175]
s_waitcnt lgkmcnt(8)
v_accvgpr_write_b32 a7, 0
v_cvt_pk_bf16_f32 v47, v70, v71
v_mfma_f32_16x16x32_bf16 v[164:167], a[220:223], a[36:39], v[164:167]
ds_read_b64_tr_b16 a[208:209], v7 offset:192
v_mul_f32 v60, s82, v60
v_mfma_f32_16x16x32_bf16 v[168:171], a[220:223], a[40:43], v[168:171]
ds_read_b64_tr_b16 a[210:211], v7 offset:448
v_mul_f32 v61, s82, v61
v_mfma_f32_16x16x32_bf16 v[172:175], a[220:223], a[44:47], v[172:175]
ds_read_b32 v25, v9
s_waitcnt lgkmcnt(9)
v_mul_f32 v62, s82, v62
v_mfma_f32_16x16x32_bf16 v[176:179], a[192:195], a[24:27], v[176:179]
ds_read_b64_tr_b16 a[212:213], v7 offset:704
v_accvgpr_write_b32 a8, 0
v_mfma_f32_16x16x32_bf16 v[180:183], a[192:195], a[28:31], v[180:183]
ds_read_b64_tr_b16 a[214:215], v7 offset:960
v_accvgpr_write_b32 a9, 0
v_mfma_f32_16x16x32_bf16 v[184:187], a[192:195], a[32:35], v[184:187]
s_waitcnt lgkmcnt(9)
v_mul_f32 v63, s82, v63
v_cvt_pk_bf16_f32 v48, v60, v61
v_mfma_f32_16x16x32_bf16 v[176:179], a[196:199], a[36:39], v[176:179]
ds_read_b64_tr_b16 a[216:217], v7 offset:200
v_cvt_pk_bf16_f32 v49, v62, v63
v_mfma_f32_16x16x32_bf16 v[180:183], a[196:199], a[40:43], v[180:183]
ds_read_b64_tr_b16 a[218:219], v7 offset:456
v_accvgpr_write_b32 a10, 0
v_mfma_f32_16x16x32_bf16 v[184:187], a[196:199], a[44:47], v[184:187]
s_waitcnt lgkmcnt(9)
v_accvgpr_write_b32 a11, 0
v_mul_f32 v72, s82, v72
v_mfma_f32_16x16x32_bf16 v[188:191], a[200:203], a[24:27], v[188:191]
ds_read_b64_tr_b16 a[220:221], v7 offset:712
ds_read_b64_tr_b16 a[222:223], v7 offset:968
s_waitcnt lgkmcnt(6)
v_mfma_f32_16x16x32_bf16 v[192:195], a[200:203], a[28:31], v[192:195]
v_readfirstlane_b32 s39, v25
s_add_u32 s38, s38, 1
v_mul_f32 v73, s82, v73
v_mfma_f32_16x16x32_bf16 v[196:199], a[200:203], a[32:35], v[196:199]
s_cmp_ge_u32 s39, s38
s_cbranch_scc0 L_poll21
L_ret22:
v_add_u32 v7, s40, v3
v_mfma_f32_16x16x32_bf16 v[188:191], a[204:207], a[36:39], v[188:191]
ds_read_b64_tr_b16 a[192:193], v7 offset:0
v_mul_f32 v74, s82, v74
v_mfma_f32_16x16x32_bf16 v[192:195], a[204:207], a[40:43], v[192:195]
ds_read_b64_tr_b16 a[194:195], v7 offset:256
v_mul_f32 v75, s82, v75
v_mfma_f32_16x16x32_bf16 v[196:199], a[204:207], a[44:47], v[196:199]
v_accvgpr_write_b32 a12, 0
v_cvt_pk_bf16_f32 v50, v72, v73
v_mfma_f32_16x16x32_bf16 v[200:203], a[208:211], a[24:27], v[200:203]
ds_read_b64_tr_b16 a[196:197], v7 offset:512
ds_read_b64_tr_b16 a[198:199], v7 offset:768
v_cvt_pk_bf16_f32 v51, v74, v75
v_mfma_f32_16x16x32_bf16 v[204:207], a[208:211], a[28:31], v[204:207]
s_add_u32 s40, s40, 16896
v_mul_f32 v64, s82, v64
v_mul_f32 v65, s82, v65
v_mfma_f32_16x16x32_bf16 v[208:211], a[208:211], a[32:35], v[208:211]
s_cmp_eq_u32 s40, 152064
s_cselect_b32 s40, 0, s40
s_waitcnt lgkmcnt(8)
v_mfma_f32_16x16x32_bf16 v[200:203], a[212:215], a[36:39], v[200:203]
ds_read_b64_tr_b16 a[200:201], v7 offset:8
v_accvgpr_write_b32 a13, 0
v_mfma_f32_16x16x32_bf16 v[204:207], a[212:215], a[40:43], v[204:207]
ds_read_b64_tr_b16 a[202:203], v7 offset:264
v_accvgpr_write_b32 a14, 0
v_mfma_f32_16x16x32_bf16 v[208:211], a[212:215], a[44:47], v[208:211]
s_waitcnt lgkmcnt(8)
v_mul_f32 v66, s82, v66
v_mul_f32 v67, s82, v67
v_mfma_f32_16x16x32_bf16 v[212:215], a[216:219], a[24:27], v[212:215]
ds_read_b64_tr_b16 a[204:205], v7 offset:520
v_cvt_pk_bf16_f32 v52, v64, v65
v_mfma_f32_16x16x32_bf16 v[216:219], a[216:219], a[28:31], v[216:219]
ds_read_b64_tr_b16 a[206:207], v7 offset:776
v_accvgpr_write_b32 a15, 0
v_mfma_f32_16x16x32_bf16 v[220:223], a[216:219], a[32:35], v[220:223]
s_waitcnt lgkmcnt(8)
v_cvt_pk_bf16_f32 v53, v66, v67
v_mul_f32 v76, s82, v76
v_mfma_f32_16x16x32_bf16 v[212:215], a[220:223], a[36:39], v[212:215]
ds_read_b64_tr_b16 a[208:209], v7 offset:64
ds_read_b64_tr_b16 a[210:211], v7 offset:320
v_mul_f32 v77, s82, v77
v_mfma_f32_16x16x32_bf16 v[216:219], a[220:223], a[40:43], v[216:219]
v_add_u32 v10, 1, v10
v_mul_f32 v78, s82, v78
v_mfma_f32_16x16x32_bf16 v[220:223], a[220:223], a[44:47], v[220:223]
ds_write_b32 v8, v10
s_waitcnt lgkmcnt(9)
v_accvgpr_write_b32 a16, 0
v_mfma_f32_16x16x32_bf16 v[128:131], a[192:195], a[48:51], v[128:131]
ds_read_b64_tr_b16 a[212:213], v7 offset:576
v_accvgpr_write_b32 a17, 0
v_mfma_f32_16x16x32_bf16 v[132:135], a[192:195], a[52:55], v[132:135]
ds_read_b64_tr_b16 a[214:215], v7 offset:832
v_mul_f32 v79, s82, v79
v_mfma_f32_16x16x32_bf16 v[136:139], a[192:195], a[56:59], v[136:139]
s_waitcnt lgkmcnt(9)
v_cvt_pk_bf16_f32 v54, v76, v77
v_cvt_pk_bf16_f32 v55, v78, v79
v_mfma_f32_16x16x32_bf16 v[128:131], a[196:199], a[60:63], v[128:131]
ds_read_b64_tr_b16 a[216:217], v7 offset:72
v_accvgpr_write_b32 a18, 0
v_mfma_f32_16x16x32_bf16 v[132:135], a[196:199], a[64:67], v[132:135]
ds_read_b64_tr_b16 a[218:219], v7 offset:328
v_accvgpr_write_b32 a19, 0
v_mfma_f32_16x16x32_bf16 v[136:139], a[196:199], a[68:71], v[136:139]
s_waitcnt lgkmcnt(9)
v_accvgpr_write_b32 a20, 0
v_accvgpr_write_b32 a21, 0
v_mfma_f32_16x16x32_bf16 v[140:143], a[200:203], a[48:51], v[140:143]
ds_read_b64_tr_b16 a[220:221], v7 offset:584
v_accvgpr_write_b32 a22, 0
v_mfma_f32_16x16x32_bf16 v[144:147], a[200:203], a[52:55], v[144:147]
ds_read_b64_tr_b16 a[222:223], v7 offset:840
v_accvgpr_write_b32 a23, 0
v_mfma_f32_16x16x32_bf16 v[148:151], a[200:203], a[56:59], v[148:151]
s_waitcnt lgkmcnt(9)
v_accvgpr_write_b32 a24, 0
v_accvgpr_write_b32 a25, 0
v_mfma_f32_16x16x32_bf16 v[140:143], a[204:207], a[60:63], v[140:143]
ds_read_b64_tr_b16 a[192:193], v7 offset:128
v_accvgpr_write_b32 a26, 0
v_mfma_f32_16x16x32_bf16 v[144:147], a[204:207], a[64:67], v[144:147]
ds_read_b64_tr_b16 a[194:195], v7 offset:384
v_accvgpr_write_b32 a27, 0
v_mfma_f32_16x16x32_bf16 v[148:151], a[204:207], a[68:71], v[148:151]
s_waitcnt lgkmcnt(9)
v_mul_f32 v80, s82, v80
v_mul_f32 v81, s82, v81
v_mfma_f32_16x16x32_bf16 v[152:155], a[208:211], a[48:51], v[152:155]
ds_read_b64_tr_b16 a[196:197], v7 offset:640
v_mul_f32 v82, s82, v82
v_mfma_f32_16x16x32_bf16 v[156:159], a[208:211], a[52:55], v[156:159]
ds_read_b64_tr_b16 a[198:199], v7 offset:896
v_mul_f32 v83, s82, v83
v_mfma_f32_16x16x32_bf16 v[160:163], a[208:211], a[56:59], v[160:163]
s_waitcnt lgkmcnt(8)
v_accvgpr_write_b32 a28, 0
v_cvt_pk_bf16_f32 v56, v80, v81
v_mfma_f32_16x16x32_bf16 v[152:155], a[212:215], a[60:63], v[152:155]
ds_read_b64_tr_b16 a[200:201], v7 offset:136
v_cvt_pk_bf16_f32 v57, v82, v83
v_mfma_f32_16x16x32_bf16 v[156:159], a[212:215], a[64:67], v[156:159]
ds_read_b64_tr_b16 a[202:203], v7 offset:392
v_mul_f32 v92, s82, v92
v_mfma_f32_16x16x32_bf16 v[160:163], a[212:215], a[68:71], v[160:163]
s_waitcnt lgkmcnt(8)
v_mul_f32 v93, s82, v93
v_accvgpr_write_b32 a29, 0
v_mfma_f32_16x16x32_bf16 v[164:167], a[216:219], a[48:51], v[164:167]
ds_read_b64_tr_b16 a[204:205], v7 offset:648
v_accvgpr_write_b32 a30, 0
v_mfma_f32_16x16x32_bf16 v[168:171], a[216:219], a[52:55], v[168:171]
ds_read_b64_tr_b16 a[206:207], v7 offset:904
v_mul_f32 v94, s82, v94
v_mfma_f32_16x16x32_bf16 v[172:175], a[216:219], a[56:59], v[172:175]
s_waitcnt lgkmcnt(8)
v_mul_f32 v95, s82, v95
v_cvt_pk_bf16_f32 v58, v92, v93
v_mfma_f32_16x16x32_bf16 v[164:167], a[220:223], a[60:63], v[164:167]
ds_read_b64_tr_b16 a[208:209], v7 offset:192
v_accvgpr_write_b32 a31, 0
v_mfma_f32_16x16x32_bf16 v[168:171], a[220:223], a[64:67], v[168:171]
ds_read_b64_tr_b16 a[210:211], v7 offset:448
v_cvt_pk_bf16_f32 v59, v94, v95
v_mfma_f32_16x16x32_bf16 v[172:175], a[220:223], a[68:71], v[172:175]
ds_read_b32 v25, v9
s_waitcnt lgkmcnt(9)
v_mul_f32 v84, s82, v84
v_mfma_f32_16x16x32_bf16 v[176:179], a[192:195], a[48:51], v[176:179]
ds_read_b64_tr_b16 a[212:213], v7 offset:704
v_mul_f32 v85, s82, v85
v_mfma_f32_16x16x32_bf16 v[180:183], a[192:195], a[52:55], v[180:183]
ds_read_b64_tr_b16 a[214:215], v7 offset:960
v_mul_f32 v86, s82, v86
v_mfma_f32_16x16x32_bf16 v[184:187], a[192:195], a[56:59], v[184:187]
s_waitcnt lgkmcnt(9)
v_accvgpr_write_b32 a32, 0
v_accvgpr_write_b32 a33, 0
v_mfma_f32_16x16x32_bf16 v[176:179], a[196:199], a[60:63], v[176:179]
ds_read_b64_tr_b16 a[216:217], v7 offset:200
v_mul_f32 v87, s82, v87
v_mfma_f32_16x16x32_bf16 v[180:183], a[196:199], a[64:67], v[180:183]
ds_read_b64_tr_b16 a[218:219], v7 offset:456
v_cvt_pk_bf16_f32 v60, v84, v85
v_mfma_f32_16x16x32_bf16 v[184:187], a[196:199], a[68:71], v[184:187]
s_waitcnt lgkmcnt(9)
v_cvt_pk_bf16_f32 v61, v86, v87
v_accvgpr_write_b32 a34, 0
v_mfma_f32_16x16x32_bf16 v[188:191], a[200:203], a[48:51], v[188:191]
ds_read_b64_tr_b16 a[220:221], v7 offset:712
ds_read_b64_tr_b16 a[222:223], v7 offset:968
s_waitcnt lgkmcnt(6)
v_mfma_f32_16x16x32_bf16 v[192:195], a[200:203], a[52:55], v[192:195]
v_readfirstlane_b32 s39, v25
s_add_u32 s38, s38, 1
v_accvgpr_write_b32 a35, 0
v_mfma_f32_16x16x32_bf16 v[196:199], a[200:203], a[56:59], v[196:199]
s_cmp_ge_u32 s39, s38
s_cbranch_scc0 L_poll23
L_ret24:
v_add_u32 v7, s40, v3
v_mfma_f32_16x16x32_bf16 v[188:191], a[204:207], a[60:63], v[188:191]
ds_read_b64_tr_b16 a[192:193], v7 offset:0
v_mul_f32 v96, s82, v96
v_mfma_f32_16x16x32_bf16 v[192:195], a[204:207], a[64:67], v[192:195]
ds_read_b64_tr_b16 a[194:195], v7 offset:256
v_mul_f32 v97, s82, v97
v_mfma_f32_16x16x32_bf16 v[196:199], a[204:207], a[68:71], v[196:199]
v_mul_f32 v98, s82, v98
v_mul_f32 v99, s82, v99
v_mfma_f32_16x16x32_bf16 v[200:203], a[208:211], a[48:51], v[200:203]
ds_read_b64_tr_b16 a[196:197], v7 offset:512
ds_read_b64_tr_b16 a[198:199], v7 offset:768
v_accvgpr_write_b32 a36, 0
v_mfma_f32_16x16x32_bf16 v[204:207], a[208:211], a[52:55], v[204:207]
s_add_u32 s40, s40, 16896
v_cvt_pk_bf16_f32 v62, v96, v97
v_cvt_pk_bf16_f32 v63, v98, v99
v_mfma_f32_16x16x32_bf16 v[208:211], a[208:211], a[56:59], v[208:211]
s_cmp_eq_u32 s40, 152064
s_cselect_b32 s40, 0, s40
s_waitcnt lgkmcnt(8)
v_mfma_f32_16x16x32_bf16 v[200:203], a[212:215], a[60:63], v[200:203]
ds_read_b64_tr_b16 a[200:201], v7 offset:8
v_mul_f32 v88, s82, v88
v_mfma_f32_16x16x32_bf16 v[204:207], a[212:215], a[64:67], v[204:207]
ds_read_b64_tr_b16 a[202:203], v7 offset:264
v_mul_f32 v89, s82, v89
v_mfma_f32_16x16x32_bf16 v[208:211], a[212:215], a[68:71], v[208:211]
s_waitcnt lgkmcnt(8)
v_accvgpr_write_b32 a37, 0
v_accvgpr_write_b32 a38, 0
v_mfma_f32_16x16x32_bf16 v[212:215], a[216:219], a[48:51], v[212:215]
ds_read_b64_tr_b16 a[204:205], v7 offset:520
v_mul_f32 v90, s82, v90
v_mfma_f32_16x16x32_bf16 v[216:219], a[216:219], a[52:55], v[216:219]
ds_read_b64_tr_b16 a[206:207], v7 offset:776
v_mul_f32 v91, s82, v91
v_mfma_f32_16x16x32_bf16 v[220:223], a[216:219], a[56:59], v[220:223]
s_waitcnt lgkmcnt(8)
v_cvt_pk_bf16_f32 v64, v88, v89
v_accvgpr_write_b32 a39, 0
v_mfma_f32_16x16x32_bf16 v[212:215], a[220:223], a[60:63], v[212:215]
ds_read_b64_tr_b16 a[208:209], v7 offset:64
ds_read_b64_tr_b16 a[210:211], v7 offset:320
v_cvt_pk_bf16_f32 v65, v90, v91
v_mfma_f32_16x16x32_bf16 v[216:219], a[220:223], a[64:67], v[216:219]
v_add_u32 v10, 1, v10
v_mul_f32 v100, s82, v100
v_mfma_f32_16x16x32_bf16 v[220:223], a[220:223], a[68:71], v[220:223]
ds_write_b32 v8, v10
s_waitcnt lgkmcnt(9)
v_mul_f32 v101, s82, v101
v_mfma_f32_16x16x32_bf16 v[128:131], a[192:195], a[72:75], v[128:131]
ds_read_b64_tr_b16 a[212:213], v7 offset:576
v_mul_f32 v102, s82, v102
v_mfma_f32_16x16x32_bf16 v[132:135], a[192:195], a[76:79], v[132:135]
ds_read_b64_tr_b16 a[214:215], v7 offset:832
v_accvgpr_write_b32 a40, 0
v_mfma_f32_16x16x32_bf16 v[136:139], a[192:195], a[80:83], v[136:139]
s_waitcnt lgkmcnt(9)
v_accvgpr_write_b32 a41, 0
v_mul_f32 v103, s82, v103
v_mfma_f32_16x16x32_bf16 v[128:131], a[196:199], a[84:87], v[128:131]
ds_read_b64_tr_b16 a[216:217], v7 offset:72
v_cvt_pk_bf16_f32 v66, v100, v101
v_mfma_f32_16x16x32_bf16 v[132:135], a[196:199], a[88:91], v[132:135]
ds_read_b64_tr_b16 a[218:219], v7 offset:328
v_cvt_pk_bf16_f32 v67, v102, v103
v_mfma_f32_16x16x32_bf16 v[136:139], a[196:199], a[92:95], v[136:139]
s_waitcnt lgkmcnt(9)
v_accvgpr_write_b32 a42, 0
v_accvgpr_write_b32 a43, 0
v_mfma_f32_16x16x32_bf16 v[140:143], a[200:203], a[72:75], v[140:143]
ds_read_b64_tr_b16 a[220:221], v7 offset:584
v_accvgpr_write_b32 a44, 0
v_mfma_f32_16x16x32_bf16 v[144:147], a[200:203], a[76:79], v[144:147]
ds_read_b64_tr_b16 a[222:223], v7 offset:840
v_accvgpr_write_b32 a45, 0
v_mfma_f32_16x16x32_bf16 v[148:151], a[200:203], a[80:83], v[148:151]
s_waitcnt lgkmcnt(9)
v_accvgpr_write_b32 a46, 0
v_accvgpr_write_b32 a47, 0
v_mfma_f32_16x16x32_bf16 v[140:143], a[204:207], a[84:87], v[140:143]
ds_read_b64_tr_b16 a[192:193], v7 offset:128
v_accvgpr_write_b32 a48, 0
v_mfma_f32_16x16x32_bf16 v[144:147], a[204:207], a[88:91], v[144:147]
ds_read_b64_tr_b16 a[194:195], v7 offset:384
v_accvgpr_write_b32 a49, 0
v_mfma_f32_16x16x32_bf16 v[148:151], a[204:207], a[92:95], v[148:151]
s_waitcnt lgkmcnt(9)
v_accvgpr_write_b32 a50, 0
v_accvgpr_write_b32 a51, 0
v_mfma_f32_16x16x32_bf16 v[152:155], a[208:211], a[72:75], v[152:155]
ds_read_b64_tr_b16 a[196:197], v7 offset:640
v_mul_f32 v104, s82, v104
v_mfma_f32_16x16x32_bf16 v[156:159], a[208:211], a[76:79], v[156:159]
ds_read_b64_tr_b16 a[198:199], v7 offset:896
v_mul_f32 v105, s82, v105
v_mfma_f32_16x16x32_bf16 v[160:163], a[208:211], a[80:83], v[160:163]
s_waitcnt lgkmcnt(8)
v_mul_f32 v106, s82, v106
v_mul_f32 v107, s82, v107
v_mfma_f32_16x16x32_bf16 v[152:155], a[212:215], a[84:87], v[152:155]
ds_read_b64_tr_b16 a[200:201], v7 offset:136
v_accvgpr_write_b32 a52, 0
v_mfma_f32_16x16x32_bf16 v[156:159], a[212:215], a[88:91], v[156:159]
ds_read_b64_tr_b16 a[202:203], v7 offset:392
v_cvt_pk_bf16_f32 v68, v104, v105
v_mfma_f32_16x16x32_bf16 v[160:163], a[212:215], a[92:95], v[160:163]
s_waitcnt lgkmcnt(8)
v_cvt_pk_bf16_f32 v69, v106, v107
v_mul_f32 v116, s82, v116
v_mfma_f32_16x16x32_bf16 v[164:167], a[216:219], a[72:75], v[164:167]
ds_read_b64_tr_b16 a[204:205], v7 offset:648
v_mul_f32 v117, s82, v117
v_mfma_f32_16x16x32_bf16 v[168:171], a[216:219], a[76:79], v[168:171]
ds_read_b64_tr_b16 a[206:207], v7 offset:904
v_accvgpr_write_b32 a53, 0
v_mfma_f32_16x16x32_bf16 v[172:175], a[216:219], a[80:83], v[172:175]
s_waitcnt lgkmcnt(8)
v_accvgpr_write_b32 a54, 0
v_mul_f32 v118, s82, v118
v_mfma_f32_16x16x32_bf16 v[164:167], a[220:223], a[84:87], v[164:167]
ds_read_b64_tr_b16 a[208:209], v7 offset:192
v_mul_f32 v119, s82, v119
v_mfma_f32_16x16x32_bf16 v[168:171], a[220:223], a[88:91], v[168:171]
ds_read_b64_tr_b16 a[210:211], v7 offset:448
v_cvt_pk_bf16_f32 v70, v116, v117
v_mfma_f32_16x16x32_bf16 v[172:175], a[220:223], a[92:95], v[172:175]
ds_read_b32 v25, v9
s_waitcnt lgkmcnt(9)
v_accvgpr_write_b32 a55, 0
v_mfma_f32_16x16x32_bf16 v[176:179], a[192:195], a[72:75], v[176:179]
ds_read_b64_tr_b16 a[212:213], v7 offset:704
v_cvt_pk_bf16_f32 v71, v118, v119
v_mfma_f32_16x16x32_bf16 v[180:183], a[192:195], a[76:79], v[180:183]
ds_read_b64_tr_b16 a[214:215], v7 offset:960
v_mul_f32 v108, s82, v108
v_mfma_f32_16x16x32_bf16 v[184:187], a[192:195], a[80:83], v[184:187]
s_waitcnt lgkmcnt(9)
v_mul_f32 v109, s82, v109
v_mul_f32 v110, s82, v110
v_mfma_f32_16x16x32_bf16 v[176:179], a[196:199], a[84:87], v[176:179]
ds_read_b64_tr_b16 a[216:217], v7 offset:200
v_accvgpr_write_b32 a56, 0
v_mfma_f32_16x16x32_bf16 v[180:183], a[196:199], a[88:91], v[180:183]
ds_read_b64_tr_b16 a[218:219], v7 offset:456
v_accvgpr_write_b32 a57, 0
v_mfma_f32_16x16x32_bf16 v[184:187], a[196:199], a[92:95], v[184:187]
s_waitcnt lgkmcnt(9)
v_mul_f32 v111, s82, v111
v_cvt_pk_bf16_f32 v72, v108, v109
v_mfma_f32_16x16x32_bf16 v[188:191], a[200:203], a[72:75], v[188:191]
ds_read_b64_tr_b16 a[220:221], v7 offset:712
ds_read_b64_tr_b16 a[222:223], v7 offset:968
s_waitcnt lgkmcnt(6)
v_mfma_f32_16x16x32_bf16 v[192:195], a[200:203], a[76:79], v[192:195]
v_readfirstlane_b32 s39, v25
s_add_u32 s38, s38, 1
v_cvt_pk_bf16_f32 v73, v110, v111
v_mfma_f32_16x16x32_bf16 v[196:199], a[200:203], a[80:83], v[196:199]
s_cmp_ge_u32 s39, s38
s_cbranch_scc0 L_poll25
L_ret26:
v_add_u32 v7, s40, v3
v_mfma_f32_16x16x32_bf16 v[188:191], a[204:207], a[84:87], v[188:191]
ds_read_b64_tr_b16 a[192:193], v7 offset:0
v_accvgpr_write_b32 a58, 0
v_mfma_f32_16x16x32_bf16 v[192:195], a[204:207], a[88:91], v[192:195]
ds_read_b64_tr_b16 a[194:195], v7 offset:256
v_accvgpr_write_b32 a59, 0
v_mfma_f32_16x16x32_bf16 v[196:199], a[204:207], a[92:95], v[196:199]
v_mul_f32 v120, s82, v120
v_mul_f32 v121, s82, v121
v_mfma_f32_16x16x32_bf16 v[200:203], a[208:211], a[72:75], v[200:203]
ds_read_b64_tr_b16 a[196:197], v7 offset:512
ds_read_b64_tr_b16 a[198:199], v7 offset:768
v_mul_f32 v122, s82, v122
v_mfma_f32_16x16x32_bf16 v[204:207], a[208:211], a[76:79], v[204:207]
s_add_u32 s40, s40, 16896
v_mul_f32 v123, s82, v123
v_accvgpr_write_b32 a60, 0
v_mfma_f32_16x16x32_bf16 v[208:211], a[208:211], a[80:83], v[208:211]
s_cmp_eq_u32 s40, 152064
s_cselect_b32 s40, 0, s40
s_waitcnt lgkmcnt(8)
v_mfma_f32_16x16x32_bf16 v[200:203], a[212:215], a[84:87], v[200:203]
ds_read_b64_tr_b16 a[200:201], v7 offset:8
v_cvt_pk_bf16_f32 v74, v120, v121
v_mfma_f32_16x16x32_bf16 v[204:207], a[212:215], a[88:91], v[204:207]
ds_read_b64_tr_b16 a[202:203], v7 offset:264
v_cvt_pk_bf16_f32 v75, v122, v123
v_mfma_f32_16x16x32_bf16 v[208:211], a[212:215], a[92:95], v[208:211]
s_waitcnt lgkmcnt(8)
v_mul_f32 v112, s82, v112
v_mul_f32 v113, s82, v113
v_mfma_f32_16x16x32_bf16 v[212:215], a[216:219], a[72:75], v[212:215]
ds_read_b64_tr_b16 a[204:205], v7 offset:520
v_accvgpr_write_b32 a61, 0
v_mfma_f32_16x16x32_bf16 v[216:219], a[216:219], a[76:79], v[216:219]
ds_read_b64_tr_b16 a[206:207], v7 offset:776
v_accvgpr_write_b32 a62, 0
v_mfma_f32_16x16x32_bf16 v[220:223], a[216:219], a[80:83], v[220:223]
s_waitcnt lgkmcnt(8)
v_mul_f32 v114, s82, v114
v_mul_f32 v115, s82, v115
v_mfma_f32_16x16x32_bf16 v[212:215], a[220:223], a[84:87], v[212:215]
ds_read_b64_tr_b16 a[208:209], v7 offset:64
ds_read_b64_tr_b16 a[210:211], v7 offset:320
v_cvt_pk_bf16_f32 v76, v112, v113
v_mfma_f32_16x16x32_bf16 v[216:219], a[220:223], a[88:91], v[216:219]
v_add_u32 v10, 1, v10
v_accvgpr_write_b32 a63, 0
v_mfma_f32_16x16x32_bf16 v[220:223], a[220:223], a[92:95], v[220:223]
ds_write_b32 v8, v10
s_waitcnt lgkmcnt(9)
v_cvt_pk_bf16_f32 v77, v114, v115
v_mfma_f32_16x16x32_bf16 v[128:131], a[192:195], a[96:99], v[128:131]
ds_read_b64_tr_b16 a[212:213], v7 offset:576
v_mul_f32 v124, s82, v124
v_mfma_f32_16x16x32_bf16 v[132:135], a[192:195], a[100:103], v[132:135]
ds_read_b64_tr_b16 a[214:215], v7 offset:832
v_mul_f32 v125, s82, v125
v_mfma_f32_16x16x32_bf16 v[136:139], a[192:195], a[104:107], v[136:139]
s_waitcnt lgkmcnt(9)
v_mul_f32 v126, s82, v126
v_accvgpr_write_b32 a64, 0
v_mfma_f32_16x16x32_bf16 v[128:131], a[196:199], a[108:111], v[128:131]
ds_read_b64_tr_b16 a[216:217], v7 offset:72
v_accvgpr_write_b32 a65, 0
v_mfma_f32_16x16x32_bf16 v[132:135], a[196:199], a[112:115], v[132:135]
ds_read_b64_tr_b16 a[218:219], v7 offset:328
v_mul_f32 v127, s82, v127
v_mfma_f32_16x16x32_bf16 v[136:139], a[196:199], a[116:119], v[136:139]
s_waitcnt lgkmcnt(9)
v_cvt_pk_bf16_f32 v78, v124, v125
v_cvt_pk_bf16_f32 v79, v126, v127
v_mfma_f32_16x16x32_bf16 v[140:143], a[200:203], a[96:99], v[140:143]
ds_read_b64_tr_b16 a[220:221], v7 offset:584
v_accvgpr_write_b32 a66, 0
v_mfma_f32_16x16x32_bf16 v[144:147], a[200:203], a[100:103], v[144:147]
ds_read_b64_tr_b16 a[222:223], v7 offset:840
v_accvgpr_write_b32 a67, 0
v_mfma_f32_16x16x32_bf16 v[148:151], a[200:203], a[104:107], v[148:151]
s_waitcnt lgkmcnt(9)
v_accvgpr_write_b32 a68, 0
v_accvgpr_write_b32 a69, 0
v_mfma_f32_16x16x32_bf16 v[140:143], a[204:207], a[108:111], v[140:143]
ds_read_b64_tr_b16 a[192:193], v7 offset:128
v_accvgpr_write_b32 a70, 0
v_mfma_f32_16x16x32_bf16 v[144:147], a[204:207], a[112:115], v[144:147]
ds_read_b64_tr_b16 a[194:195], v7 offset:384
v_accvgpr_write_b32 a71, 0
v_mfma_f32_16x16x32_bf16 v[148:151], a[204:207], a[116:119], v[148:151]
s_waitcnt lgkmcnt(9)
v_accvgpr_write_b32 a72, 0
v_accvgpr_write_b32 a73, 0
v_mfma_f32_16x16x32_bf16 v[152:155], a[208:211], a[96:99], v[152:155]
ds_read_b64_tr_b16 a[196:197], v7 offset:640
v_accvgpr_write_b32 a74, 0
v_mfma_f32_16x16x32_bf16 v[156:159], a[208:211], a[100:103], v[156:159]
ds_read_b64_tr_b16 a[198:199], v7 offset:896
v_accvgpr_write_b32 a75, 0
v_mfma_f32_16x16x32_bf16 v[160:163], a[208:211], a[104:107], v[160:163]
s_waitcnt lgkmcnt(8)
v_accvgpr_write_b32 a76, 0
v_accvgpr_write_b32 a77, 0
v_mfma_f32_16x16x32_bf16 v[152:155], a[212:215], a[108:111], v[152:155]
ds_read_b64_tr_b16 a[200:201], v7 offset:136
v_accvgpr_write_b32 a78, 0
v_mfma_f32_16x16x32_bf16 v[156:159], a[212:215], a[112:115], v[156:159]
ds_read_b64_tr_b16 a[202:203], v7 offset:392
v_accvgpr_write_b32 a79, 0
v_mfma_f32_16x16x32_bf16 v[160:163], a[212:215], a[116:119], v[160:163]
s_waitcnt lgkmcnt(8)
v_mfma_f32_16x16x32_bf16 v[164:167], a[216:219], a[96:99], v[164:167]
ds_read_b64_tr_b16 a[204:205], v7 offset:648
v_accvgpr_write_b32 a80, 0
v_mfma_f32_16x16x32_bf16 v[168:171], a[216:219], a[100:103], v[168:171]
ds_read_b64_tr_b16 a[206:207], v7 offset:904
v_accvgpr_write_b32 a81, 0
v_mfma_f32_16x16x32_bf16 v[172:175], a[216:219], a[104:107], v[172:175]
s_waitcnt lgkmcnt(8)
v_mfma_f32_16x16x32_bf16 v[164:167], a[220:223], a[108:111], v[164:167]
ds_read_b64_tr_b16 a[208:209], v7 offset:192
v_accvgpr_write_b32 a82, 0
v_mfma_f32_16x16x32_bf16 v[168:171], a[220:223], a[112:115], v[168:171]
ds_read_b64_tr_b16 a[210:211], v7 offset:448
v_accvgpr_write_b32 a83, 0
v_mfma_f32_16x16x32_bf16 v[172:175], a[220:223], a[116:119], v[172:175]
ds_read_b32 v25, v9
s_waitcnt lgkmcnt(9)
v_mfma_f32_16x16x32_bf16 v[176:179], a[192:195], a[96:99], v[176:179]
ds_read_b64_tr_b16 a[212:213], v7 offset:704
v_accvgpr_write_b32 a84, 0
v_mfma_f32_16x16x32_bf16 v[180:183], a[192:195], a[100:103], v[180:183]
ds_read_b64_tr_b16 a[214:215], v7 offset:960
v_mfma_f32_16x16x32_bf16 v[184:187], a[192:195], a[104:107], v[184:187]
s_waitcnt lgkmcnt(9)
v_mfma_f32_16x16x32_bf16 v[176:179], a[196:199], a[108:111], v[176:179]
ds_read_b64_tr_b16 a[216:217], v7 offset:200
v_accvgpr_write_b32 a85, 0
v_mfma_f32_16x16x32_bf16 v[180:183], a[196:199], a[112:115], v[180:183]
ds_read_b64_tr_b16 a[218:219], v7 offset:456
v_accvgpr_write_b32 a86, 0
v_mfma_f32_16x16x32_bf16 v[184:187], a[196:199], a[116:119], v[184:187]
s_waitcnt lgkmcnt(9)
v_mfma_f32_16x16x32_bf16 v[188:191], a[200:203], a[96:99], v[188:191]
ds_read_b64_tr_b16 a[220:221], v7 offset:712
ds_read_b64_tr_b16 a[222:223], v7 offset:968
s_waitcnt lgkmcnt(6)
v_mfma_f32_16x16x32_bf16 v[192:195], a[200:203], a[100:103], v[192:195]
v_readfirstlane_b32 s39, v25
s_add_u32 s38, s38, 1
v_accvgpr_write_b32 a87, 0
v_mfma_f32_16x16x32_bf16 v[196:199], a[200:203], a[104:107], v[196:199]
s_cmp_ge_u32 s39, s38
s_cbranch_scc0 L_poll27
L_ret28:
v_add_u32 v7, s40, v3
v_mfma_f32_16x16x32_bf16 v[188:191], a[204:207], a[108:111], v[188:191]
ds_read_b64_tr_b16 a[192:193], v7 offset:0
v_accvgpr_write_b32 a88, 0
v_mfma_f32_16x16x32_bf16 v[192:195], a[204:207], a[112:115], v[192:195]
ds_read_b64_tr_b16 a[194:195], v7 offset:256
v_accvgpr_write_b32 a89, 0
v_mfma_f32_16x16x32_bf16 v[196:199], a[204:207], a[116:119], v[196:199]
v_mfma_f32_16x16x32_bf16 v[200:203], a[208:211], a[96:99], v[200:203]
ds_read_b64_tr_b16 a[196:197], v7 offset:512
ds_read_b64_tr_b16 a[198:199], v7 offset:768
v_accvgpr_write_b32 a90, 0
v_mfma_f32_16x16x32_bf16 v[204:207], a[208:211], a[100:103], v[204:207]
s_add_u32 s40, s40, 16896
v_accvgpr_write_b32 a91, 0
v_mfma_f32_16x16x32_bf16 v[208:211], a[208:211], a[104:107], v[208:211]
s_cmp_eq_u32 s40, 152064
s_cselect_b32 s40, 0, s40
s_waitcnt lgkmcnt(8)
v_mfma_f32_16x16x32_bf16 v[200:203], a[212:215], a[108:111], v[200:203]
ds_read_b64_tr_b16 a[200:201], v7 offset:8
v_accvgpr_write_b32 a92, 0
v_mfma_f32_16x16x32_bf16 v[204:207], a[212:215], a[112:115], v[204:207]
ds_read_b64_tr_b16 a[202:203], v7 offset:264
v_mfma_f32_16x16x32_bf16 v[208:211], a[212:215], a[116:119], v[208:211]
s_waitcnt lgkmcnt(8)
v_mfma_f32_16x16x32_bf16 v[212:215], a[216:219], a[96:99], v[212:215]
ds_read_b64_tr_b16 a[204:205], v7 offset:520
v_accvgpr_write_b32 a93, 0
v_mfma_f32_16x16x32_bf16 v[216:219], a[216:219], a[100:103], v[216:219]
ds_read_b64_tr_b16 a[206:207], v7 offset:776
v_accvgpr_write_b32 a94, 0
v_mfma_f32_16x16x32_bf16 v[220:223], a[216:219], a[104:107], v[220:223]
s_waitcnt lgkmcnt(8)
v_mfma_f32_16x16x32_bf16 v[212:215], a[220:223], a[108:111], v[212:215]
ds_read_b64_tr_b16 a[208:209], v7 offset:64
ds_read_b64_tr_b16 a[210:211], v7 offset:320
v_accvgpr_write_b32 a95, 0
v_mfma_f32_16x16x32_bf16 v[216:219], a[220:223], a[112:115], v[216:219]
v_add_u32 v10, 1, v10
v_mfma_f32_16x16x32_bf16 v[220:223], a[220:223], a[116:119], v[220:223]
ds_write_b32 v8, v10
s_waitcnt lgkmcnt(9)
v_mfma_f32_16x16x32_bf16 v[128:131], a[192:195], a[120:123], v[128:131]
ds_read_b64_tr_b16 a[212:213], v7 offset:576
v_mfma_f32_16x16x32_bf16 v[132:135], a[192:195], a[124:127], v[132:135]
ds_read_b64_tr_b16 a[214:215], v7 offset:832
v_mfma_f32_16x16x32_bf16 v[136:139], a[192:195], a[128:131], v[136:139]
s_waitcnt lgkmcnt(9)
v_mfma_f32_16x16x32_bf16 v[128:131], a[196:199], a[132:135], v[128:131]
ds_read_b64_tr_b16 a[216:217], v7 offset:72
v_accvgpr_write_b32 a96, 0
v_mfma_f32_16x16x32_bf16 v[132:135], a[196:199], a[136:139], v[132:135]
ds_read_b64_tr_b16 a[218:219], v7 offset:328
v_accvgpr_write_b32 a97, 0
v_mfma_f32_16x16x32_bf16 v[136:139], a[196:199], a[140:143], v[136:139]
s_waitcnt lgkmcnt(9)
v_mfma_f32_16x16x32_bf16 v[140:143], a[200:203], a[120:123], v[140:143]
ds_read_b64_tr_b16 a[220:221], v7 offset:584
v_accvgpr_write_b32 a98, 0
v_mfma_f32_16x16x32_bf16 v[144:147], a[200:203], a[124:127], v[144:147]
ds_read_b64_tr_b16 a[222:223], v7 offset:840
v_accvgpr_write_b32 a99, 0
v_mfma_f32_16x16x32_bf16 v[148:151], a[200:203], a[128:131], v[148:151]
s_waitcnt lgkmcnt(9)
v_mfma_f32_16x16x32_bf16 v[140:143], a[204:207], a[132:135], v[140:143]
ds_read_b64_tr_b16 a[192:193], v7 offset:128
v_accvgpr_write_b32 a100, 0
v_mfma_f32_16x16x32_bf16 v[144:147], a[204:207], a[136:139], v[144:147]
ds_read_b64_tr_b16 a[194:195], v7 offset:384
v_mfma_f32_16x16x32_bf16 v[148:151], a[204:207], a[140:143], v[148:151]
s_waitcnt lgkmcnt(9)
v_mfma_f32_16x16x32_bf16 v[152:155], a[208:211], a[120:123], v[152:155]
ds_read_b64_tr_b16 a[196:197], v7 offset:640
v_accvgpr_write_b32 a101, 0
v_mfma_f32_16x16x32_bf16 v[156:159], a[208:211], a[124:127], v[156:159]
ds_read_b64_tr_b16 a[198:199], v7 offset:896
v_accvgpr_write_b32 a102, 0
v_mfma_f32_16x16x32_bf16 v[160:163], a[208:211], a[128:131], v[160:163]
s_waitcnt lgkmcnt(8)
v_mfma_f32_16x16x32_bf16 v[152:155], a[212:215], a[132:135], v[152:155]
ds_read_b64_tr_b16 a[200:201], v7 offset:136
v_accvgpr_write_b32 a103, 0
v_mfma_f32_16x16x32_bf16 v[156:159], a[212:215], a[136:139], v[156:159]
ds_read_b64_tr_b16 a[202:203], v7 offset:392
v_mfma_f32_16x16x32_bf16 v[160:163], a[212:215], a[140:143], v[160:163]
s_waitcnt lgkmcnt(8)
v_mfma_f32_16x16x32_bf16 v[164:167], a[216:219], a[120:123], v[164:167]
ds_read_b64_tr_b16 a[204:205], v7 offset:648
v_accvgpr_write_b32 a104, 0
v_mfma_f32_16x16x32_bf16 v[168:171], a[216:219], a[124:127], v[168:171]
ds_read_b64_tr_b16 a[206:207], v7 offset:904
v_accvgpr_write_b32 a105, 0
v_mfma_f32_16x16x32_bf16 v[172:175], a[216:219], a[128:131], v[172:175]
s_waitcnt lgkmcnt(8)
v_mfma_f32_16x16x32_bf16 v[164:167], a[220:223], a[132:135], v[164:167]
ds_read_b64_tr_b16 a[208:209], v7 offset:192
v_accvgpr_write_b32 a106, 0
v_mfma_f32_16x16x32_bf16 v[168:171], a[220:223], a[136:139], v[168:171]
ds_read_b64_tr_b16 a[210:211], v7 offset:448
v_accvgpr_write_b32 a107, 0
v_mfma_f32_16x16x32_bf16 v[172:175], a[220:223], a[140:143], v[172:175]
ds_read_b32 v25, v9
s_waitcnt lgkmcnt(9)
v_mfma_f32_16x16x32_bf16 v[176:179], a[192:195], a[120:123], v[176:179]
ds_read_b64_tr_b16 a[212:213], v7 offset:704
v_accvgpr_write_b32 a108, 0
v_mfma_f32_16x16x32_bf16 v[180:183], a[192:195], a[124:127], v[180:183]
ds_read_b64_tr_b16 a[214:215], v7 offset:960
v_mfma_f32_16x16x32_bf16 v[184:187], a[192:195], a[128:131], v[184:187]
s_waitcnt lgkmcnt(9)
v_mfma_f32_16x16x32_bf16 v[176:179], a[196:199], a[132:135], v[176:179]
ds_read_b64_tr_b16 a[216:217], v7 offset:200
v_accvgpr_write_b32 a109, 0
v_mfma_f32_16x16x32_bf16 v[180:183], a[196:199], a[136:139], v[180:183]
ds_read_b64_tr_b16 a[218:219], v7 offset:456
v_accvgpr_write_b32 a110, 0
v_mfma_f32_16x16x32_bf16 v[184:187], a[196:199], a[140:143], v[184:187]
s_waitcnt lgkmcnt(9)
v_mfma_f32_16x16x32_bf16 v[188:191], a[200:203], a[120:123], v[188:191]
ds_read_b64_tr_b16 a[220:221], v7 offset:712
ds_read_b64_tr_b16 a[222:223], v7 offset:968
s_waitcnt lgkmcnt(6)
v_mfma_f32_16x16x32_bf16 v[192:195], a[200:203], a[124:127], v[192:195]
v_readfirstlane_b32 s39, v25
s_add_u32 s38, s38, 1
v_accvgpr_write_b32 a111, 0
v_mfma_f32_16x16x32_bf16 v[196:199], a[200:203], a[128:131], v[196:199]
s_cmp_ge_u32 s39, s38
s_cbranch_scc0 L_poll29
L_ret30:
v_add_u32 v7, s40, v3
v_mfma_f32_16x16x32_bf16 v[188:191], a[204:207], a[132:135], v[188:191]
ds_read_b64_tr_b16 a[192:193], v7 offset:0
v_accvgpr_write_b32 a112, 0
v_mfma_f32_16x16x32_bf16 v[192:195], a[204:207], a[136:139], v[192:195]
ds_read_b64_tr_b16 a[194:195], v7 offset:256
v_accvgpr_write_b32 a113, 0
v_mfma_f32_16x16x32_bf16 v[196:199], a[204:207], a[140:143], v[196:199]
v_mfma_f32_16x16x32_bf16 v[200:203], a[208:211], a[120:123], v[200:203]
ds_read_b64_tr_b16 a[196:197], v7 offset:512
ds_read_b64_tr_b16 a[198:199], v7 offset:768
v_accvgpr_write_b32 a114, 0
v_mfma_f32_16x16x32_bf16 v[204:207], a[208:211], a[124:127], v[204:207]
s_add_u32 s40, s40, 16896
v_accvgpr_write_b32 a115, 0
v_mfma_f32_16x16x32_bf16 v[208:211], a[208:211], a[128:131], v[208:211]
s_cmp_eq_u32 s40, 152064
s_cselect_b32 s40, 0, s40
s_waitcnt lgkmcnt(8)
v_mfma_f32_16x16x32_bf16 v[200:203], a[212:215], a[132:135], v[200:203]
ds_read_b64_tr_b16 a[200:201], v7 offset:8
v_accvgpr_write_b32 a116, 0
v_mfma_f32_16x16x32_bf16 v[204:207], a[212:215], a[136:139], v[204:207]
ds_read_b64_tr_b16 a[202:203], v7 offset:264
v_mfma_f32_16x16x32_bf16 v[208:211], a[212:215], a[140:143], v[208:211]
s_waitcnt lgkmcnt(8)
v_mfma_f32_16x16x32_bf16 v[212:215], a[216:219], a[120:123], v[212:215]
ds_read_b64_tr_b16 a[204:205], v7 offset:520
v_accvgpr_write_b32 a117, 0
v_mfma_f32_16x16x32_bf16 v[216:219], a[216:219], a[124:127], v[216:219]
ds_read_b64_tr_b16 a[206:207], v7 offset:776
v_accvgpr_write_b32 a118, 0
v_mfma_f32_16x16x32_bf16 v[220:223], a[216:219], a[128:131], v[220:223]
s_waitcnt lgkmcnt(8)
v_mfma_f32_16x16x32_bf16 v[212:215], a[220:223], a[132:135], v[212:215]
ds_read_b64_tr_b16 a[208:209], v7 offset:64
ds_read_b64_tr_b16 a[210:211], v7 offset:320
v_accvgpr_write_b32 a119, 0
v_mfma_f32_16x16x32_bf16 v[216:219], a[220:223], a[136:139], v[216:219]
v_add_u32 v10, 1, v10
v_mfma_f32_16x16x32_bf16 v[220:223], a[220:223], a[140:143], v[220:223]
ds_write_b32 v8, v10
s_waitcnt lgkmcnt(9)
v_mfma_f32_16x16x32_bf16 v[128:131], a[192:195], a[144:147], v[128:131]
ds_read_b64_tr_b16 a[212:213], v7 offset:576
v_mfma_f32_16x16x32_bf16 v[132:135], a[192:195], a[148:151], v[132:135]
ds_read_b64_tr_b16 a[214:215], v7 offset:832
v_mfma_f32_16x16x32_bf16 v[136:139], a[192:195], a[152:155], v[136:139]
s_waitcnt lgkmcnt(9)
v_mfma_f32_16x16x32_bf16 v[128:131], a[196:199], a[156:159], v[128:131]
ds_read_b64_tr_b16 a[216:217], v7 offset:72
v_accvgpr_write_b32 a120, 0
v_accvgpr_write_b32 a121, 0
v_mfma_f32_16x16x32_bf16 v[132:135], a[196:199], a[160:163], v[132:135]
ds_read_b64_tr_b16 a[218:219], v7 offset:328
v_accvgpr_write_b32 a122, 0
v_accvgpr_write_b32 a123, 0
v_mfma_f32_16x16x32_bf16 v[136:139], a[196:199], a[164:167], v[136:139]
s_waitcnt lgkmcnt(9)
v_accvgpr_write_b32 a124, 0
v_mfma_f32_16x16x32_bf16 v[140:143], a[200:203], a[144:147], v[140:143]
ds_read_b64_tr_b16 a[220:221], v7 offset:584
v_accvgpr_write_b32 a125, 0
v_accvgpr_write_b32 a126, 0
v_mfma_f32_16x16x32_bf16 v[144:147], a[200:203], a[148:151], v[144:147]
ds_read_b64_tr_b16 a[222:223], v7 offset:840
v_accvgpr_write_b32 a127, 0
v_accvgpr_write_b32 a128, 0
v_mfma_f32_16x16x32_bf16 v[148:151], a[200:203], a[152:155], v[148:151]
s_waitcnt lgkmcnt(9)
v_accvgpr_write_b32 a129, 0
v_mfma_f32_16x16x32_bf16 v[140:143], a[204:207], a[156:159], v[140:143]
ds_read_b64_tr_b16 a[192:193], v7 offset:128
v_accvgpr_write_b32 a130, 0
v_accvgpr_write_b32 a131, 0
v_mfma_f32_16x16x32_bf16 v[144:147], a[204:207], a[160:163], v[144:147]
ds_read_b64_tr_b16 a[194:195], v7 offset:384
v_accvgpr_write_b32 a132, 0
v_accvgpr_write_b32 a133, 0
v_mfma_f32_16x16x32_bf16 v[148:151], a[204:207], a[164:167], v[148:151]
s_waitcnt lgkmcnt(9)
v_accvgpr_write_b32 a134, 0
v_mfma_f32_16x16x32_bf16 v[152:155], a[208:211], a[144:147], v[152:155]
ds_read_b64_tr_b16 a[196:197], v7 offset:640
v_accvgpr_write_b32 a135, 0
v_accvgpr_write_b32 a136, 0
v_mfma_f32_16x16x32_bf16 v[156:159], a[208:211], a[148:151], v[156:159]
ds_read_b64_tr_b16 a[198:199], v7 offset:896
v_accvgpr_write_b32 a137, 0
v_accvgpr_write_b32 a138, 0
v_mfma_f32_16x16x32_bf16 v[160:163], a[208:211], a[152:155], v[160:163]
s_waitcnt lgkmcnt(8)
v_accvgpr_write_b32 a139, 0
v_mfma_f32_16x16x32_bf16 v[152:155], a[212:215], a[156:159], v[152:155]
ds_read_b64_tr_b16 a[200:201], v7 offset:136
v_accvgpr_write_b32 a140, 0
v_accvgpr_write_b32 a141, 0
v_mfma_f32_16x16x32_bf16 v[156:159], a[212:215], a[160:163], v[156:159]
ds_read_b64_tr_b16 a[202:203], v7 offset:392
v_accvgpr_write_b32 a142, 0
v_accvgpr_write_b32 a143, 0
v_mfma_f32_16x16x32_bf16 v[160:163], a[212:215], a[164:167], v[160:163]
s_waitcnt lgkmcnt(8)
v_mfma_f32_16x16x32_bf16 v[164:167], a[216:219], a[144:147], v[164:167]
ds_read_b64_tr_b16 a[204:205], v7 offset:648
v_mul_f32 v128, s82, v128
v_mul_f32 v129, s82, v129
v_mfma_f32_16x16x32_bf16 v[168:171], a[216:219], a[148:151], v[168:171]
ds_read_b64_tr_b16 a[206:207], v7 offset:904
v_mul_f32 v130, s82, v130
v_mul_f32 v131, s82, v131
v_mfma_f32_16x16x32_bf16 v[172:175], a[216:219], a[152:155], v[172:175]
s_waitcnt lgkmcnt(8)
v_cvt_pk_bf16_f32 v80, v128, v129
v_cvt_pk_bf16_f32 v81, v130, v131
v_mfma_f32_16x16x32_bf16 v[164:167], a[220:223], a[156:159], v[164:167]
ds_read_b64_tr_b16 a[208:209], v7 offset:192
v_mul_f32 v140, s82, v140
v_mul_f32 v141, s82, v141
v_mfma_f32_16x16x32_bf16 v[168:171], a[220:223], a[160:163], v[168:171]
ds_read_b64_tr_b16 a[210:211], v7 offset:448
v_mul_f32 v142, s82, v142
v_mul_f32 v143, s82, v143
v_mfma_f32_16x16x32_bf16 v[172:175], a[220:223], a[164:167], v[172:175]
ds_read_b32 v25, v9
s_waitcnt lgkmcnt(9)
v_cvt_pk_bf16_f32 v82, v140, v141
v_mfma_f32_16x16x32_bf16 v[176:179], a[192:195], a[144:147], v[176:179]
ds_read_b64_tr_b16 a[212:213], v7 offset:704
v_cvt_pk_bf16_f32 v83, v142, v143
v_mul_f32 v132, s82, v132
v_mfma_f32_16x16x32_bf16 v[180:183], a[192:195], a[148:151], v[180:183]
ds_read_b64_tr_b16 a[214:215], v7 offset:960
v_mul_f32 v133, s82, v133
v_mul_f32 v134, s82, v134
v_mfma_f32_16x16x32_bf16 v[184:187], a[192:195], a[152:155], v[184:187]
s_waitcnt lgkmcnt(9)
v_mul_f32 v135, s82, v135
v_cvt_pk_bf16_f32 v84, v132, v133
v_mfma_f32_16x16x32_bf16 v[176:179], a[196:199], a[156:159], v[176:179]
ds_read_b64_tr_b16 a[216:217], v7 offset:200
v_cvt_pk_bf16_f32 v85, v134, v135
v_mul_f32 v144, s82, v144
v_mfma_f32_16x16x32_bf16 v[180:183], a[196:199], a[160:163], v[180:183]
ds_read_b64_tr_b16 a[218:219], v7 offset:456
v_mul_f32 v145, s82, v145
v_mul_f32 v146, s82, v146
v_mfma_f32_16x16x32_bf16 v[184:187], a[196:199], a[164:167], v[184:187]
s_waitcnt lgkmcnt(9)
v_mul_f32 v147, s82, v147
v_cvt_pk_bf16_f32 v86, v144, v145
v_mfma_f32_16x16x32_bf16 v[188:191], a[200:203], a[144:147], v[188:191]
ds_read_b64_tr_b16 a[220:221], v7 offset:712
ds_read_b64_tr_b16 a[222:223], v7 offset:968
s_waitcnt lgkmcnt(6)
v_mfma_f32_16x16x32_bf16 v[192:195], a[200:203], a[148:151], v[192:195]
v_readfirstlane_b32 s39, v25
s_add_u32 s38, s38, 1
v_cvt_pk_bf16_f32 v87, v146, v147
v_mfma_f32_16x16x32_bf16 v[196:199], a[200:203], a[152:155], v[196:199]
s_cmp_ge_u32 s39, s38
s_cbranch_scc0 L_poll31
L_ret32:
v_add_u32 v6, s40, v1
v_mfma_f32_16x16x32_bf16 v[188:191], a[204:207], a[156:159], v[188:191]
ds_read_b128 a[192:195], v6 offset:0
v_mul_f32 v136, s82, v136
v_mul_f32 v137, s82, v137
v_mfma_f32_16x16x32_bf16 v[192:195], a[204:207], a[160:163], v[192:195]
v_mul_f32 v138, s82, v138
v_mul_f32 v139, s82, v139
v_mfma_f32_16x16x32_bf16 v[196:199], a[204:207], a[164:167], v[196:199]
v_cvt_pk_bf16_f32 v88, v136, v137
v_cvt_pk_bf16_f32 v89, v138, v139
v_mfma_f32_16x16x32_bf16 v[200:203], a[208:211], a[144:147], v[200:203]
ds_read_b128 a[196:199], v6 offset:64
v_mul_f32 v148, s82, v148
v_mul_f32 v149, s82, v149
v_mfma_f32_16x16x32_bf16 v[204:207], a[208:211], a[148:151], v[204:207]
s_add_u32 s40, s40, 16896
v_mul_f32 v150, s82, v150
v_mul_f32 v151, s82, v151
v_mfma_f32_16x16x32_bf16 v[208:211], a[208:211], a[152:155], v[208:211]
s_cmp_eq_u32 s40, 152064
s_cselect_b32 s40, 0, s40
s_waitcnt lgkmcnt(6)
v_mfma_f32_16x16x32_bf16 v[200:203], a[212:215], a[156:159], v[200:203]
ds_read_b128 a[200:203], v6 offset:128
v_cvt_pk_bf16_f32 v90, v148, v149
v_cvt_pk_bf16_f32 v91, v150, v151
v_mfma_f32_16x16x32_bf16 v[204:207], a[212:215], a[160:163], v[204:207]
v_mul_f32 v152, s82, v152
v_mul_f32 v153, s82, v153
v_mfma_f32_16x16x32_bf16 v[208:211], a[212:215], a[164:167], v[208:211]
s_waitcnt lgkmcnt(5)
v_mul_f32 v154, s82, v154
v_mul_f32 v155, s82, v155
v_mfma_f32_16x16x32_bf16 v[212:215], a[216:219], a[144:147], v[212:215]
ds_read_b128 a[204:207], v6 offset:192
v_cvt_pk_bf16_f32 v92, v152, v153
v_cvt_pk_bf16_f32 v93, v154, v155
v_mfma_f32_16x16x32_bf16 v[216:219], a[216:219], a[148:151], v[216:219]
v_mul_f32 v164, s82, v164
v_mul_f32 v165, s82, v165
v_mfma_f32_16x16x32_bf16 v[220:223], a[216:219], a[152:155], v[220:223]
s_waitcnt lgkmcnt(4)
v_mul_f32 v166, s82, v166
v_mul_f32 v167, s82, v167
v_mfma_f32_16x16x32_bf16 v[212:215], a[220:223], a[156:159], v[212:215]
ds_read_b128 a[208:211], v6 offset:256
ds_read_b32 v25, v9
v_cvt_pk_bf16_f32 v94, v164, v165
v_mfma_f32_16x16x32_bf16 v[216:219], a[220:223], a[160:163], v[216:219]
v_add_u32 v10, 1, v10
v_cvt_pk_bf16_f32 v95, v166, v167
v_mfma_f32_16x16x32_bf16 v[220:223], a[220:223], a[164:167], v[220:223]
ds_write_b32 v8, v10
s_waitcnt lgkmcnt(6)
v_mul_f32 v156, s82, v156
v_mfma_f32_16x16x32_bf16 v[224:227], a[192:195], v[32:35], 0
ds_read_b128 a[212:215], v6 offset:320
v_mul_f32 v157, s82, v157
v_mul_f32 v158, s82, v158
v_mfma_f32_16x16x32_bf16 v[228:231], a[192:195], v[36:39], 0
v_mul_f32 v159, s82, v159
v_cvt_pk_bf16_f32 v96, v156, v157
v_mfma_f32_16x16x32_bf16 v[232:235], a[192:195], v[40:43], 0
s_waitcnt lgkmcnt(6)
v_cvt_pk_bf16_f32 v97, v158, v159
v_mul_f32 v168, s82, v168
v_mfma_f32_16x16x32_bf16 v[224:227], a[196:199], v[44:47], v[224:227]
ds_read_b128 a[216:219], v6 offset:384
v_mul_f32 v169, s82, v169
v_mul_f32 v170, s82, v170
v_mfma_f32_16x16x32_bf16 v[228:231], a[196:199], v[48:51], v[228:231]
v_mul_f32 v171, s82, v171
v_cvt_pk_bf16_f32 v98, v168, v169
v_mfma_f32_16x16x32_bf16 v[232:235], a[196:199], v[52:55], v[232:235]
s_waitcnt lgkmcnt(6)
v_cvt_pk_bf16_f32 v99, v170, v171
v_mul_f32 v160, s82, v160
v_mfma_f32_16x16x32_bf16 v[224:227], a[200:203], v[56:59], v[224:227]
ds_read_b128 a[220:223], v6 offset:448
s_waitcnt lgkmcnt(4)
v_mul_f32 v161, s82, v161
v_mfma_f32_16x16x32_bf16 v[228:231], a[200:203], v[60:63], v[228:231]
v_readfirstlane_b32 s39, v25
s_add_u32 s38, s38, 1
v_mul_f32 v162, s82, v162
v_mfma_f32_16x16x32_bf16 v[232:235], a[200:203], v[64:67], v[232:235]
s_cmp_ge_u32 s39, s38
s_cbranch_scc0 L_poll33
L_ret34:
v_add_u32 v6, s40, v1
v_mfma_f32_16x16x32_bf16 v[224:227], a[204:207], v[68:71], v[224:227]
ds_read_b128 a[192:195], v6 offset:0
v_mul_f32 v163, s82, v163
v_cvt_pk_bf16_f32 v100, v160, v161
v_mfma_f32_16x16x32_bf16 v[228:231], a[204:207], v[72:75], v[228:231]
v_cvt_pk_bf16_f32 v101, v162, v163
v_mul_f32 v172, s82, v172
v_mfma_f32_16x16x32_bf16 v[232:235], a[204:207], v[76:79], v[232:235]
v_mul_f32 v173, s82, v173
v_mul_f32 v174, s82, v174
v_mfma_f32_16x16x32_bf16 v[224:227], a[208:211], v[80:83], v[224:227]
ds_read_b128 a[196:199], v6 offset:64
v_mul_f32 v175, s82, v175
v_cvt_pk_bf16_f32 v102, v172, v173
v_mfma_f32_16x16x32_bf16 v[228:231], a[208:211], v[84:87], v[228:231]
s_add_u32 s40, s40, 16896
v_mfma_f32_16x16x32_bf16 v[232:235], a[208:211], v[88:91], v[232:235]
s_cmp_eq_u32 s40, 152064
s_cselect_b32 s40, 0, s40
s_waitcnt lgkmcnt(4)
v_cvt_pk_bf16_f32 v103, v174, v175
s_nop 1
v_mfma_f32_16x16x32_bf16 v[224:227], a[212:215], v[92:95], v[224:227]
ds_read_b128 a[200:203], v6 offset:128
v_mul_f32 v176, s82, v176
v_mul_f32 v177, s82, v177
v_mfma_f32_16x16x32_bf16 v[228:231], a[212:215], v[96:99], v[228:231]
v_mul_f32 v178, s82, v178
v_mul_f32 v179, s82, v179
v_mfma_f32_16x16x32_bf16 v[232:235], a[212:215], v[100:103], v[232:235]
s_waitcnt lgkmcnt(4)
v_cvt_pk_bf16_f32 v104, v176, v177
v_cvt_pk_bf16_f32 v105, v178, v179
v_mul_f32 v188, s82, v188
v_mul_f32 v189, s82, v189
v_mul_f32 v190, s82, v190
v_mul_f32 v191, s82, v191
v_cvt_pk_bf16_f32 v106, v188, v189
v_cvt_pk_bf16_f32 v107, v190, v191
v_mul_f32 v180, s82, v180
v_mul_f32 v181, s82, v181
v_mul_f32 v182, s82, v182
v_mul_f32 v183, s82, v183
v_cvt_pk_bf16_f32 v108, v180, v181
v_cvt_pk_bf16_f32 v109, v182, v183
v_mul_f32 v192, s82, v192
v_mul_f32 v193, s82, v193
v_mul_f32 v194, s82, v194
v_mul_f32 v195, s82, v195
v_cvt_pk_bf16_f32 v110, v192, v193
v_cvt_pk_bf16_f32 v111, v194, v195
v_mul_f32 v184, s82, v184
v_mul_f32 v185, s82, v185
v_mul_f32 v186, s82, v186
v_mul_f32 v187, s82, v187
v_cvt_pk_bf16_f32 v112, v184, v185
v_cvt_pk_bf16_f32 v113, v186, v187
v_mul_f32 v196, s82, v196
v_mul_f32 v197, s82, v197
v_mul_f32 v198, s82, v198
v_mul_f32 v199, s82, v199
v_cvt_pk_bf16_f32 v114, v196, v197
v_cvt_pk_bf16_f32 v115, v198, v199
s_nop 1
v_mfma_f32_16x16x32_bf16 v[224:227], a[216:219], v[104:107], v[224:227]
ds_read_b128 a[204:207], v6 offset:192
v_mul_f32 v200, s82, v200
v_mul_f32 v201, s82, v201
v_mfma_f32_16x16x32_bf16 v[228:231], a[216:219], v[108:111], v[228:231]
v_mul_f32 v202, s82, v202
v_mul_f32 v203, s82, v203
v_mfma_f32_16x16x32_bf16 v[232:235], a[216:219], v[112:115], v[232:235]
s_waitcnt lgkmcnt(4)
v_cvt_pk_bf16_f32 v116, v200, v201
v_cvt_pk_bf16_f32 v117, v202, v203
v_mul_f32 v212, s82, v212
v_mul_f32 v213, s82, v213
v_mul_f32 v214, s82, v214
v_mul_f32 v215, s82, v215
v_cvt_pk_bf16_f32 v118, v212, v213
v_cvt_pk_bf16_f32 v119, v214, v215
v_mul_f32 v204, s82, v204
v_mul_f32 v205, s82, v205
v_mul_f32 v206, s82, v206
v_mul_f32 v207, s82, v207
v_cvt_pk_bf16_f32 v120, v204, v205
v_cvt_pk_bf16_f32 v121, v206, v207
v_mul_f32 v216, s82, v216
v_mul_f32 v217, s82, v217
v_mul_f32 v218, s82, v218
v_mul_f32 v219, s82, v219
v_cvt_pk_bf16_f32 v122, v216, v217
v_cvt_pk_bf16_f32 v123, v218, v219
v_mul_f32 v208, s82, v208
v_mul_f32 v209, s82, v209
v_mul_f32 v210, s82, v210
v_mul_f32 v211, s82, v211
v_cvt_pk_bf16_f32 v124, v208, v209
v_cvt_pk_bf16_f32 v125, v210, v211
v_mul_f32 v220, s82, v220
v_mul_f32 v221, s82, v221
v_mul_f32 v222, s82, v222
v_mul_f32 v223, s82, v223
v_cvt_pk_bf16_f32 v126, v220, v221
v_cvt_pk_bf16_f32 v127, v222, v223
s_nop 1
v_mfma_f32_16x16x32_bf16 v[224:227], a[220:223], v[116:119], v[224:227]
ds_read_b128 a[208:211], v6 offset:256
v_mfma_f32_16x16x32_bf16 v[228:231], a[220:223], v[120:123], v[228:231]
v_add_u32 v10, 1, v10
v_mfma_f32_16x16x32_bf16 v[232:235], a[220:223], v[124:127], v[232:235]
ds_write_b32 v8, v10
s_waitcnt lgkmcnt(5)
v_mfma_f32_16x16x32_bf16 v[128:131], a[192:195], v[32:35], 0
ds_read_b128 a[212:215], v6 offset:320
v_mfma_f32_16x16x32_bf16 v[132:135], a[192:195], v[36:39], 0
v_mfma_f32_16x16x32_bf16 v[136:139], a[192:195], v[40:43], 0
s_waitcnt lgkmcnt(5)
v_mfma_f32_16x16x32_bf16 v[128:131], a[196:199], v[44:47], v[128:131]
ds_read_b128 a[216:219], v6 offset:384
v_mfma_f32_16x16x32_bf16 v[132:135], a[196:199], v[48:51], v[132:135]
v_mfma_f32_16x16x32_bf16 v[136:139], a[196:199], v[52:55], v[136:139]
s_waitcnt lgkmcnt(5)
v_mfma_f32_16x16x32_bf16 v[128:131], a[200:203], v[56:59], v[128:131]
ds_read_b128 a[220:223], v6 offset:448
v_max3_f32 v224, v224, v225, v226
v_max_f32 v224, v224, v227
v_mfma_f32_16x16x32_bf16 v[132:135], a[200:203], v[60:63], v[132:135]
v_mov_b32 v225, v224
v_max3_f32 v228, v228, v229, v230
v_mfma_f32_16x16x32_bf16 v[136:139], a[200:203], v[64:67], v[136:139]
s_waitcnt lgkmcnt(5)
v_max_f32 v228, v228, v231
v_mov_b32 v229, v228
v_mfma_f32_16x16x32_bf16 v[128:131], a[204:207], v[68:71], v[128:131]
ds_read_b128 a[192:195], v6 offset:512
v_max3_f32 v232, v232, v233, v234
v_max_f32 v232, v232, v235
v_mfma_f32_16x16x32_bf16 v[132:135], a[204:207], v[72:75], v[132:135]
v_mov_b32 v233, v232
s_nop 0
v_mfma_f32_16x16x32_bf16 v[136:139], a[204:207], v[76:79], v[136:139]
s_waitcnt lgkmcnt(5)
v_permlane32_swap_b32 v225, v224
v_permlane32_swap_b32 v229, v228
v_mfma_f32_16x16x32_bf16 v[128:131], a[208:211], v[80:83], v[128:131]
ds_read_b128 a[196:199], v6 offset:576
v_permlane32_swap_b32 v233, v232
s_nop 0
v_mfma_f32_16x16x32_bf16 v[132:135], a[208:211], v[84:87], v[132:135]
v_max_f32 v224, v224, v225
v_mov_b32 v225, v224
v_mfma_f32_16x16x32_bf16 v[136:139], a[208:211], v[88:91], v[136:139]
s_waitcnt lgkmcnt(4)
v_max_f32 v228, v228, v229
v_mov_b32 v229, v228
v_mfma_f32_16x16x32_bf16 v[128:131], a[212:215], v[92:95], v[128:131]
ds_read_b128 a[200:203], v6 offset:640
v_max_f32 v232, v232, v233
v_mov_b32 v233, v232
v_mfma_f32_16x16x32_bf16 v[132:135], a[212:215], v[96:99], v[132:135]
s_nop 0
v_mfma_f32_16x16x32_bf16 v[136:139], a[212:215], v[100:103], v[136:139]
s_waitcnt lgkmcnt(4)
v_permlane16_swap_b32 v225, v224
v_permlane16_swap_b32 v229, v228
v_mfma_f32_16x16x32_bf16 v[128:131], a[216:219], v[104:107], v[128:131]
ds_read_b128 a[204:207], v6 offset:704
v_permlane16_swap_b32 v233, v232
s_nop 0
v_mfma_f32_16x16x32_bf16 v[132:135], a[216:219], v[108:111], v[132:135]
v_max_f32 v227, v224, v225
v_sub_f32 v224, 0, v227
v_mfma_f32_16x16x32_bf16 v[136:139], a[216:219], v[112:115], v[136:139]
s_waitcnt lgkmcnt(4)
v_sub_f32 v225, 0, v227
v_sub_f32 v226, 0, v227
v_mfma_f32_16x16x32_bf16 v[128:131], a[220:223], v[116:119], v[128:131]
ds_read_b128 a[208:211], v6 offset:768
v_sub_f32 v227, 0, v227
v_max_f32 v231, v228, v229
v_mfma_f32_16x16x32_bf16 v[132:135], a[220:223], v[120:123], v[132:135]
ds_read_b32 v25, v9
v_sub_f32 v228, 0, v231
v_sub_f32 v229, 0, v231
v_mfma_f32_16x16x32_bf16 v[136:139], a[220:223], v[124:127], v[136:139]
s_waitcnt lgkmcnt(5)
v_sub_f32 v230, 0, v231
v_sub_f32 v231, 0, v231
v_max_f32 v235, v232, v233
v_sub_f32 v232, 0, v235
v_sub_f32 v233, 0, v235
v_sub_f32 v234, 0, v235
v_sub_f32 v235, 0, v235
s_nop 1
v_mfma_f32_16x16x32_bf16 v[140:143], a[192:195], v[32:35], v[224:227]
ds_read_b128 a[212:215], v6 offset:832
v_accvgpr_write_b32 a144, 0
v_accvgpr_write_b32 a145, 0
v_mfma_f32_16x16x32_bf16 v[144:147], a[192:195], v[36:39], v[228:231]
v_accvgpr_write_b32 a146, 0
v_accvgpr_write_b32 a147, 0
v_mfma_f32_16x16x32_bf16 v[148:151], a[192:195], v[40:43], v[232:235]
s_waitcnt lgkmcnt(5)
v_accvgpr_write_b32 a148, 0
v_accvgpr_write_b32 a149, 0
v_mfma_f32_16x16x32_bf16 v[140:143], a[196:199], v[44:47], v[140:143]
ds_read_b128 a[216:219], v6 offset:896
v_accvgpr_write_b32 a150, 0
v_accvgpr_write_b32 a151, 0
v_mfma_f32_16x16x32_bf16 v[144:147], a[196:199], v[48:51], v[144:147]
v_accvgpr_write_b32 a152, 0
v_accvgpr_write_b32 a153, 0
v_mfma_f32_16x16x32_bf16 v[148:151], a[196:199], v[52:55], v[148:151]
s_waitcnt lgkmcnt(5)
v_accvgpr_write_b32 a154, 0
v_accvgpr_write_b32 a155, 0
v_mfma_f32_16x16x32_bf16 v[140:143], a[200:203], v[56:59], v[140:143]
ds_read_b128 a[220:223], v6 offset:960
s_waitcnt lgkmcnt(3)
v_accvgpr_write_b32 a156, 0
v_mfma_f32_16x16x32_bf16 v[144:147], a[200:203], v[60:63], v[144:147]
v_readfirstlane_b32 s39, v25
s_add_u32 s38, s38, 1
v_accvgpr_write_b32 a157, 0
v_mfma_f32_16x16x32_bf16 v[148:151], a[200:203], v[64:67], v[148:151]
s_cmp_ge_u32 s39, s38
s_cbranch_scc0 L_poll35
L_ret36:
v_add_u32 v6, s40, v1
v_mfma_f32_16x16x32_bf16 v[140:143], a[204:207], v[68:71], v[140:143]
ds_read_b128 a[192:195], v6 offset:0
v_accvgpr_write_b32 a158, 0
v_accvgpr_write_b32 a159, 0
v_mfma_f32_16x16x32_bf16 v[144:147], a[204:207], v[72:75], v[144:147]
v_accvgpr_write_b32 a160, 0
v_accvgpr_write_b32 a161, 0
v_mfma_f32_16x16x32_bf16 v[148:151], a[204:207], v[76:79], v[148:151]
v_accvgpr_write_b32 a162, 0
v_accvgpr_write_b32 a163, 0
v_mfma_f32_16x16x32_bf16 v[140:143], a[208:211], v[80:83], v[140:143]
ds_read_b128 a[196:199], v6 offset:64
v_accvgpr_write_b32 a164, 0
v_accvgpr_write_b32 a165, 0
v_mfma_f32_16x16x32_bf16 v[144:147], a[208:211], v[84:87], v[144:147]
s_add_u32 s40, s40, 16896
v_accvgpr_write_b32 a166, 0
v_accvgpr_write_b32 a167, 0
v_mfma_f32_16x16x32_bf16 v[148:151], a[208:211], v[88:91], v[148:151]
s_cmp_eq_u32 s40, 152064
s_cselect_b32 s40, 0, s40
s_waitcnt lgkmcnt(4)
v_mfma_f32_16x16x32_bf16 v[140:143], a[212:215], v[92:95], v[140:143]
ds_read_b128 a[200:203], v6 offset:128
v_add_f32 v128, v128, v224
v_add_f32 v129, v129, v224
v_mfma_f32_16x16x32_bf16 v[144:147], a[212:215], v[96:99], v[144:147]
v_add_f32 v130, v130, v224
v_add_f32 v131, v131, v224
v_mfma_f32_16x16x32_bf16 v[148:151], a[212:215], v[100:103], v[148:151]
s_waitcnt lgkmcnt(4)
v_add_f32 v132, v132, v228
v_add_f32 v133, v133, v228
v_mfma_f32_16x16x32_bf16 v[140:143], a[216:219], v[104:107], v[140:143]
ds_read_b128 a[204:207], v6 offset:192
v_add_f32 v134, v134, v228
v_add_f32 v135, v135, v228
v_mfma_f32_16x16x32_bf16 v[144:147], a[216:219], v[108:111], v[144:147]
v_add_f32 v136, v136, v232
v_add_f32 v137, v137, v232
v_mfma_f32_16x16x32_bf16 v[148:151], a[216:219], v[112:115], v[148:151]
s_waitcnt lgkmcnt(4)
v_add_f32 v138, v138, v232
v_add_f32 v139, v139, v232
v_mfma_f32_16x16x32_bf16 v[140:143], a[220:223], v[116:119], v[140:143]
ds_read_b128 a[208:211], v6 offset:256
v_lshlrev_b32 v216, 2, v0
v_mov_b32 v217, 0
v_mfma_f32_16x16x32_bf16 v[144:147], a[220:223], v[120:123], v[144:147]
v_add_u32 v10, 1, v10
v_mov_b32 v19, 0
v_mfma_f32_16x16x32_bf16 v[148:151], a[220:223], v[124:127], v[148:151]
ds_write_b32 v8, v10
s_waitcnt lgkmcnt(5)
v_mov_b32 v20, 0
v_mov_b32 v21, 0
s_cmp_eq_u32 s35, 0
s_cselect_b32 s41, 14, 16
s_nop 3
v_exp_f32 v12, v128
v_exp_f32 v13, v129
v_exp_f32 v14, v130
v_add_f32 v16, v12, v13
v_cvt_pk_bf16_f32 v176, v12, v13
v_exp_f32 v15, v131
v_add_f32 v16, v16, v14
v_exp_f32 v12, v140
v_add_f32 v16, v16, v15
v_cvt_pk_bf16_f32 v177, v14, v15
v_exp_f32 v13, v141
v_add_f32 v16, v16, v12
v_exp_f32 v14, v142
v_add_f32 v16, v16, v13
v_cvt_pk_bf16_f32 v178, v12, v13
v_exp_f32 v15, v143
v_add_f32 v16, v16, v14
v_add_f32 v16, v16, v15
v_cvt_pk_bf16_f32 v179, v14, v15
v_exp_f32 v12, v132
v_exp_f32 v13, v133
v_exp_f32 v14, v134
v_add_f32 v17, v12, v13
v_cvt_pk_bf16_f32 v180, v12, v13
v_exp_f32 v15, v135
v_add_f32 v17, v17, v14
v_exp_f32 v12, v144
v_add_f32 v17, v17, v15
s_nop 1
.p2align 4
L_main:
v_mfma_f32_16x16x32_bf16 v[152:155], a[192:195], v[32:35], v[224:227]
ds_read_b128 a[212:215], v6 offset:320
v_cvt_pk_bf16_f32 v181, v14, v15
v_mfma_f32_16x16x32_bf16 v[156:159], a[192:195], v[36:39], v[228:231]
v_exp_f32 v13, v145
v_mfma_f32_16x16x32_bf16 v[160:163], a[192:195], v[40:43], v[232:235]
s_waitcnt lgkmcnt(5)
v_add_f32 v17, v17, v12
v_mfma_f32_16x16x32_bf16 v[152:155], a[196:199], v[44:47], v[152:155]
ds_read_b128 a[216:219], v6 offset:384
v_mfma_f32_16x16x32_bf16 v[156:159], a[196:199], v[48:51], v[156:159]
v_exp_f32 v14, v146
v_mfma_f32_16x16x32_bf16 v[160:163], a[196:199], v[52:55], v[160:163]
s_waitcnt lgkmcnt(5)
v_add_f32 v17, v17, v13
v_mfma_f32_16x16x32_bf16 v[152:155], a[200:203], v[56:59], v[152:155]
ds_read_b128 a[220:223], v6 offset:448
v_cvt_pk_bf16_f32 v182, v12, v13
v_mfma_f32_16x16x32_bf16 v[156:159], a[200:203], v[60:63], v[156:159]
v_exp_f32 v15, v147
v_mfma_f32_16x16x32_bf16 v[160:163], a[200:203], v[64:67], v[160:163]
s_waitcnt lgkmcnt(5)
v_mfma_f32_16x16x32_bf16 v[152:155], a[204:207], v[68:71], v[152:155]
ds_read_b128 a[192:195], v6 offset:512
v_add_f32 v17, v17, v14
v_mfma_f32_16x16x32_bf16 v[156:159], a[204:207], v[72:75], v[156:159]
v_add_f32 v17, v17, v15
v_cvt_pk_bf16_f32 v183, v14, v15
v_mfma_f32_16x16x32_bf16 v[160:163], a[204:207], v[76:79], v[160:163]
s_waitcnt lgkmcnt(5)
v_exp_f32 v12, v136
v_mfma_f32_16x16x32_bf16 v[152:155], a[208:211], v[80:83], v[152:155]
ds_read_b128 a[196:199], v6 offset:576
v_mfma_f32_16x16x32_bf16 v[156:159], a[208:211], v[84:87], v[156:159]
v_exp_f32 v13, v137
v_mfma_f32_16x16x32_bf16 v[160:163], a[208:211], v[88:91], v[160:163]
s_waitcnt lgkmcnt(4)
v_mfma_f32_16x16x32_bf16 v[152:155], a[212:215], v[92:95], v[152:155]
ds_read_b128 a[200:203], v6 offset:640
v_mfma_f32_16x16x32_bf16 v[156:159], a[212:215], v[96:99], v[156:159]
v_exp_f32 v14, v138
v_mfma_f32_16x16x32_bf16 v[160:163], a[212:215], v[100:103], v[160:163]
s_waitcnt lgkmcnt(4)
v_add_f32 v18, v12, v13
v_mfma_f32_16x16x32_bf16 v[152:155], a[216:219], v[104:107], v[152:155]
ds_read_b128 a[204:207], v6 offset:704
v_cvt_pk_bf16_f32 v184, v12, v13
v_mfma_f32_16x16x32_bf16 v[156:159], a[216:219], v[108:111], v[156:159]
v_exp_f32 v15, v139
v_mfma_f32_16x16x32_bf16 v[160:163], a[216:219], v[112:115], v[160:163]
s_waitcnt lgkmcnt(4)
v_add_f32 v18, v18, v14
v_mfma_f32_16x16x32_bf16 v[152:155], a[220:223], v[116:119], v[152:155]
ds_read_b128 a[208:211], v6 offset:768
v_mfma_f32_16x16x32_bf16 v[156:159], a[220:223], v[120:123], v[156:159]
ds_read_b32 v25, v9
v_mfma_f32_16x16x32_bf16 v[160:163], a[220:223], v[124:127], v[160:163]
s_waitcnt lgkmcnt(5)
v_exp_f32 v12, v148
v_mfma_f32_16x16x32_bf16 v[164:167], a[192:195], v[32:35], v[224:227]
ds_read_b128 a[212:215], v6 offset:832
v_add_f32 v18, v18, v15
v_mfma_f32_16x16x32_bf16 v[168:171], a[192:195], v[36:39], v[228:231]
v_cvt_pk_bf16_f32 v185, v14, v15
v_mfma_f32_16x16x32_bf16 v[172:175], a[192:195], v[40:43], v[232:235]
s_waitcnt lgkmcnt(5)
v_exp_f32 v13, v149
v_mfma_f32_16x16x32_bf16 v[164:167], a[196:199], v[44:47], v[164:167]
ds_read_b128 a[216:219], v6 offset:896
v_add_f32 v18, v18, v12
v_mfma_f32_16x16x32_bf16 v[168:171], a[196:199], v[48:51], v[168:171]
v_exp_f32 v14, v150
v_mfma_f32_16x16x32_bf16 v[172:175], a[196:199], v[52:55], v[172:175]
s_waitcnt lgkmcnt(5)
v_add_f32 v18, v18, v13
v_mfma_f32_16x16x32_bf16 v[164:167], a[200:203], v[56:59], v[164:167]
ds_read_b128 a[220:223], v6 offset:960
s_waitcnt lgkmcnt(3)
v_cvt_pk_bf16_f32 v186, v12, v13
v_mfma_f32_16x16x32_bf16 v[168:171], a[200:203], v[60:63], v[168:171]
v_readfirstlane_b32 s39, v25
s_add_u32 s38, s38, 1
v_mfma_f32_16x16x32_bf16 v[172:175], a[200:203], v[64:67], v[172:175]
s_cmp_ge_u32 s39, s38
s_cbranch_scc0 L_poll39
L_ret40:
v_add_u32 v7, s40, v2
v_mfma_f32_16x16x32_bf16 v[164:167], a[204:207], v[68:71], v[164:167]
ds_read_b64_tr_b16 a[192:193], v7 offset:0
v_mfma_f32_16x16x32_bf16 v[168:171], a[204:207], v[72:75], v[168:171]
ds_read_b64_tr_b16 a[194:195], v7 offset:512
v_mfma_f32_16x16x32_bf16 v[172:175], a[204:207], v[76:79], v[172:175]
v_exp_f32 v15, v151
v_mfma_f32_16x16x32_bf16 v[164:167], a[208:211], v[80:83], v[164:167]
ds_read_b64_tr_b16 a[196:197], v7 offset:32
ds_read_b64_tr_b16 a[198:199], v7 offset:544
v_add_f32 v18, v18, v14
v_mfma_f32_16x16x32_bf16 v[168:171], a[208:211], v[84:87], v[168:171]
s_add_u32 s40, s40, 16896
v_add_f32 v18, v18, v15
v_cvt_pk_bf16_f32 v187, v14, v15
v_mfma_f32_16x16x32_bf16 v[172:175], a[208:211], v[88:91], v[172:175]
s_cmp_eq_u32 s40, 152064
s_cselect_b32 s40, 0, s40
s_waitcnt lgkmcnt(6)
v_mfma_f32_16x16x32_bf16 v[164:167], a[212:215], v[92:95], v[164:167]
ds_read_b64_tr_b16 a[200:201], v7 offset:64
v_max3_f32 v28, v16, v17, v18
v_mfma_f32_16x16x32_bf16 v[168:171], a[212:215], v[96:99], v[168:171]
ds_read_b64_tr_b16 a[202:203], v7 offset:576
v_cmp_lt_f32 vcc, s44, v28
s_cbranch_vccnz L_slow37
L_back38:
v_mfma_f32_16x16x32_bf16 v[172:175], a[212:215], v[100:103], v[172:175]
s_waitcnt lgkmcnt(7)
v_add_f32 v19, v19, v16
v_add_f32 v20, v20, v17
v_mfma_f32_16x16x32_bf16 v[164:167], a[216:219], v[104:107], v[164:167]
ds_read_b64_tr_b16 a[204:205], v7 offset:96
v_add_f32 v21, v21, v18
v_mfma_f32_16x16x32_bf16 v[168:171], a[216:219], v[108:111], v[168:171]
ds_read_b64_tr_b16 a[206:207], v7 offset:608
v_mfma_f32_16x16x32_bf16 v[172:175], a[216:219], v[112:115], v[172:175]
s_waitcnt lgkmcnt(8)
v_mfma_f32_16x16x32_bf16 v[164:167], a[220:223], v[116:119], v[164:167]
ds_read_b64_tr_b16 a[208:209], v7 offset:128
ds_read_b64_tr_b16 a[210:211], v7 offset:640
v_mfma_f32_16x16x32_bf16 v[168:171], a[220:223], v[120:123], v[168:171]
v_add_u32 v10, 1, v10
v_mfma_f32_16x16x32_bf16 v[172:175], a[220:223], v[124:127], v[172:175]
ds_write_b32 v8, v10
s_waitcnt lgkmcnt(9)
v_mfma_f32_16x16x32_bf16 a[0:3], a[192:195], v[176:179], a[0:3]
ds_read_b64_tr_b16 a[212:213], v7 offset:160
v_mfma_f32_16x16x32_bf16 a[4:7], a[192:195], v[180:183], a[4:7]
ds_read_b64_tr_b16 a[214:215], v7 offset:672
v_mfma_f32_16x16x32_bf16 a[8:11], a[192:195], v[184:187], a[8:11]
s_waitcnt lgkmcnt(9)
v_mfma_f32_16x16x32_bf16 a[12:15], a[196:199], v[176:179], a[12:15]
ds_read_b64_tr_b16 a[216:217], v7 offset:192
v_mfma_f32_16x16x32_bf16 a[16:19], a[196:199], v[180:183], a[16:19]
ds_read_b64_tr_b16 a[218:219], v7 offset:704
v_mfma_f32_16x16x32_bf16 a[20:23], a[196:199], v[184:187], a[20:23]
s_waitcnt lgkmcnt(9)
v_exp_f32 v12, v152
v_mfma_f32_16x16x32_bf16 a[24:27], a[200:203], v[176:179], a[24:27]
ds_read_b64_tr_b16 a[220:221], v7 offset:224
v_mfma_f32_16x16x32_bf16 a[28:31], a[200:203], v[180:183], a[28:31]
ds_read_b64_tr_b16 a[222:223], v7 offset:736
v_mfma_f32_16x16x32_bf16 a[32:35], a[200:203], v[184:187], a[32:35]
s_waitcnt lgkmcnt(9)
v_exp_f32 v13, v153
v_mfma_f32_16x16x32_bf16 a[36:39], a[204:207], v[176:179], a[36:39]
ds_read_b64_tr_b16 a[192:193], v7 offset:256
v_mfma_f32_16x16x32_bf16 a[40:43], a[204:207], v[180:183], a[40:43]
ds_read_b64_tr_b16 a[194:195], v7 offset:768
v_mfma_f32_16x16x32_bf16 a[44:47], a[204:207], v[184:187], a[44:47]
s_waitcnt lgkmcnt(9)
v_exp_f32 v14, v154
v_mfma_f32_16x16x32_bf16 a[48:51], a[208:211], v[176:179], a[48:51]
ds_read_b64_tr_b16 a[196:197], v7 offset:288
v_add_f32 v16, v12, v13
v_mfma_f32_16x16x32_bf16 a[52:55], a[208:211], v[180:183], a[52:55]
ds_read_b64_tr_b16 a[198:199], v7 offset:800
v_cvt_pk_bf16_f32 v188, v12, v13
v_mfma_f32_16x16x32_bf16 a[56:59], a[208:211], v[184:187], a[56:59]
s_waitcnt lgkmcnt(8)
v_exp_f32 v15, v155
v_mfma_f32_16x16x32_bf16 a[60:63], a[212:215], v[176:179], a[60:63]
ds_read_b64_tr_b16 a[200:201], v7 offset:320
v_add_f32 v16, v16, v14
v_mfma_f32_16x16x32_bf16 a[64:67], a[212:215], v[180:183], a[64:67]
ds_read_b64_tr_b16 a[202:203], v7 offset:832
v_mfma_f32_16x16x32_bf16 a[68:71], a[212:215], v[184:187], a[68:71]
s_waitcnt lgkmcnt(8)
v_exp_f32 v12, v164
v_mfma_f32_16x16x32_bf16 a[72:75], a[216:219], v[176:179], a[72:75]
ds_read_b64_tr_b16 a[204:205], v7 offset:352
v_add_f32 v16, v16, v15
v_mfma_f32_16x16x32_bf16 a[76:79], a[216:219], v[180:183], a[76:79]
ds_read_b64_tr_b16 a[206:207], v7 offset:864
v_cvt_pk_bf16_f32 v189, v14, v15
v_mfma_f32_16x16x32_bf16 a[80:83], a[216:219], v[184:187], a[80:83]
s_waitcnt lgkmcnt(8)
v_exp_f32 v13, v165
v_mfma_f32_16x16x32_bf16 a[84:87], a[220:223], v[176:179], a[84:87]
ds_read_b64_tr_b16 a[208:209], v7 offset:384
v_add_f32 v16, v16, v12
v_mfma_f32_16x16x32_bf16 a[88:91], a[220:223], v[180:183], a[88:91]
ds_read_b64_tr_b16 a[210:211], v7 offset:896
v_mfma_f32_16x16x32_bf16 a[92:95], a[220:223], v[184:187], a[92:95]
ds_read_b32 v25, v9
s_waitcnt lgkmcnt(9)
v_mfma_f32_16x16x32_bf16 a[96:99], a[192:195], v[176:179], a[96:99]
ds_read_b64_tr_b16 a[212:213], v7 offset:416
v_mfma_f32_16x16x32_bf16 a[100:103], a[192:195], v[180:183], a[100:103]
ds_read_b64_tr_b16 a[214:215], v7 offset:928
v_mfma_f32_16x16x32_bf16 a[104:107], a[192:195], v[184:187], a[104:107]
s_waitcnt lgkmcnt(9)
v_exp_f32 v14, v166
v_mfma_f32_16x16x32_bf16 a[108:111], a[196:199], v[176:179], a[108:111]
ds_read_b64_tr_b16 a[216:217], v7 offset:448
v_add_f32 v16, v16, v13
v_mfma_f32_16x16x32_bf16 a[112:115], a[196:199], v[180:183], a[112:115]
ds_read_b64_tr_b16 a[218:219], v7 offset:960
v_cvt_pk_bf16_f32 v190, v12, v13
v_mfma_f32_16x16x32_bf16 a[116:119], a[196:199], v[184:187], a[116:119]
s_waitcnt lgkmcnt(9)
v_exp_f32 v15, v167
v_mfma_f32_16x16x32_bf16 a[120:123], a[200:203], v[176:179], a[120:123]
ds_read_b64_tr_b16 a[220:221], v7 offset:480
ds_read_b64_tr_b16 a[222:223], v7 offset:992
s_waitcnt lgkmcnt(6)
v_mfma_f32_16x16x32_bf16 a[124:127], a[200:203], v[180:183], a[124:127]
v_readfirstlane_b32 s39, v25
s_add_u32 s38, s38, 1
v_add_f32 v16, v16, v14
v_mfma_f32_16x16x32_bf16 a[128:131], a[200:203], v[184:187], a[128:131]
s_cmp_ge_u32 s39, s38
s_cbranch_scc0 L_poll41
L_ret42:
v_add_u32 v6, s40, v1
v_mfma_f32_16x16x32_bf16 a[132:135], a[204:207], v[176:179], a[132:135]
ds_read_b128 a[192:195], v6 offset:0
v_add_f32 v16, v16, v15
v_mfma_f32_16x16x32_bf16 a[136:139], a[204:207], v[180:183], a[136:139]
v_cvt_pk_bf16_f32 v191, v14, v15
v_mfma_f32_16x16x32_bf16 a[140:143], a[204:207], v[184:187], a[140:143]
v_exp_f32 v12, v156
v_mfma_f32_16x16x32_bf16 a[144:147], a[208:211], v[176:179], a[144:147]
ds_read_b128 a[196:199], v6 offset:64
v_mfma_f32_16x16x32_bf16 a[148:151], a[208:211], v[180:183], a[148:151]
s_add_u32 s40, s40, 16896
v_exp_f32 v13, v157
v_mfma_f32_16x16x32_bf16 a[152:155], a[208:211], v[184:187], a[152:155]
s_cmp_eq_u32 s40, 152064
s_cselect_b32 s40, 0, s40
s_waitcnt lgkmcnt(6)
v_mfma_f32_16x16x32_bf16 a[156:159], a[212:215], v[176:179], a[156:159]
ds_read_b128 a[200:203], v6 offset:128
v_mfma_f32_16x16x32_bf16 a[160:163], a[212:215], v[180:183], a[160:163]
v_exp_f32 v14, v158
v_mfma_f32_16x16x32_bf16 a[164:167], a[212:215], v[184:187], a[164:167]
s_waitcnt lgkmcnt(5)
v_add_f32 v17, v12, v13
v_cvt_pk_bf16_f32 v192, v12, v13
v_mfma_f32_16x16x32_bf16 a[168:171], a[216:219], v[176:179], a[168:171]
ds_read_b128 a[204:207], v6 offset:192
v_mfma_f32_16x16x32_bf16 a[172:175], a[216:219], v[180:183], a[172:175]
v_exp_f32 v15, v159
v_mfma_f32_16x16x32_bf16 a[176:179], a[216:219], v[184:187], a[176:179]
s_waitcnt lgkmcnt(4)
v_add_f32 v17, v17, v14
v_mfma_f32_16x16x32_bf16 a[180:183], a[220:223], v[176:179], a[180:183]
ds_read_b128 a[208:211], v6 offset:256
v_mfma_f32_16x16x32_bf16 a[184:187], a[220:223], v[180:183], a[184:187]
v_add_u32 v10, 1, v10
v_mfma_f32_16x16x32_bf16 a[188:191], a[220:223], v[184:187], a[188:191]
ds_write_b32 v8, v10
s_waitcnt lgkmcnt(5)
v_exp_f32 v12, v168
v_add_f32 v17, v17, v15
L_mid:
v_mfma_f32_16x16x32_bf16 v[128:131], a[192:195], v[32:35], v[224:227]
ds_read_b128 a[212:215], v6 offset:320
v_cvt_pk_bf16_f32 v193, v14, v15
v_mfma_f32_16x16x32_bf16 v[132:135], a[192:195], v[36:39], v[228:231]
v_exp_f32 v13, v169
v_mfma_f32_16x16x32_bf16 v[136:139], a[192:195], v[40:43], v[232:235]
s_waitcnt lgkmcnt(5)
v_add_f32 v17, v17, v12
v_mfma_f32_16x16x32_bf16 v[128:131], a[196:199], v[44:47], v[128:131]
ds_read_b128 a[216:219], v6 offset:384
v_mfma_f32_16x16x32_bf16 v[132:135], a[196:199], v[48:51], v[132:135]
v_exp_f32 v14, v170
v_mfma_f32_16x16x32_bf16 v[136:139], a[196:199], v[52:55], v[136:139]
s_waitcnt lgkmcnt(5)
v_add_f32 v17, v17, v13
v_mfma_f32_16x16x32_bf16 v[128:131], a[200:203], v[56:59], v[128:131]
ds_read_b128 a[220:223], v6 offset:448
v_cvt_pk_bf16_f32 v194, v12, v13
v_mfma_f32_16x16x32_bf16 v[132:135], a[200:203], v[60:63], v[132:135]
v_exp_f32 v15, v171
v_mfma_f32_16x16x32_bf16 v[136:139], a[200:203], v[64:67], v[136:139]
s_waitcnt lgkmcnt(5)
v_mfma_f32_16x16x32_bf16 v[128:131], a[204:207], v[68:71], v[128:131]
ds_read_b128 a[192:195], v6 offset:512
v_add_f32 v17, v17, v14
v_mfma_f32_16x16x32_bf16 v[132:135], a[204:207], v[72:75], v[132:135]
v_add_f32 v17, v17, v15
v_cvt_pk_bf16_f32 v195, v14, v15
v_mfma_f32_16x16x32_bf16 v[136:139], a[204:207], v[76:79], v[136:139]
s_waitcnt lgkmcnt(5)
v_exp_f32 v12, v160
v_mfma_f32_16x16x32_bf16 v[128:131], a[208:211], v[80:83], v[128:131]
ds_read_b128 a[196:199], v6 offset:576
v_mfma_f32_16x16x32_bf16 v[132:135], a[208:211], v[84:87], v[132:135]
v_exp_f32 v13, v161
v_mfma_f32_16x16x32_bf16 v[136:139], a[208:211], v[88:91], v[136:139]
s_waitcnt lgkmcnt(4)
v_mfma_f32_16x16x32_bf16 v[128:131], a[212:215], v[92:95], v[128:131]
ds_read_b128 a[200:203], v6 offset:640
v_mfma_f32_16x16x32_bf16 v[132:135], a[212:215], v[96:99], v[132:135]
v_exp_f32 v14, v162
v_mfma_f32_16x16x32_bf16 v[136:139], a[212:215], v[100:103], v[136:139]
s_waitcnt lgkmcnt(4)
v_add_f32 v18, v12, v13
v_mfma_f32_16x16x32_bf16 v[128:131], a[216:219], v[104:107], v[128:131]
ds_read_b128 a[204:207], v6 offset:704
v_cvt_pk_bf16_f32 v196, v12, v13
v_mfma_f32_16x16x32_bf16 v[132:135], a[216:219], v[108:111], v[132:135]
v_exp_f32 v15, v163
v_mfma_f32_16x16x32_bf16 v[136:139], a[216:219], v[112:115], v[136:139]
s_waitcnt lgkmcnt(4)
v_add_f32 v18, v18, v14
v_mfma_f32_16x16x32_bf16 v[128:131], a[220:223], v[116:119], v[128:131]
ds_read_b128 a[208:211], v6 offset:768
v_mfma_f32_16x16x32_bf16 v[132:135], a[220:223], v[120:123], v[132:135]
ds_read_b32 v25, v9
v_mfma_f32_16x16x32_bf16 v[136:139], a[220:223], v[124:127], v[136:139]
s_waitcnt lgkmcnt(5)
v_exp_f32 v12, v172
v_mfma_f32_16x16x32_bf16 v[140:143], a[192:195], v[32:35], v[224:227]
ds_read_b128 a[212:215], v6 offset:832
v_add_f32 v18, v18, v15
v_mfma_f32_16x16x32_bf16 v[144:147], a[192:195], v[36:39], v[228:231]
v_cvt_pk_bf16_f32 v197, v14, v15
v_mfma_f32_16x16x32_bf16 v[148:151], a[192:195], v[40:43], v[232:235]
s_waitcnt lgkmcnt(5)
v_exp_f32 v13, v173
v_mfma_f32_16x16x32_bf16 v[140:143], a[196:199], v[44:47], v[140:143]
ds_read_b128 a[216:219], v6 offset:896
v_add_f32 v18, v18, v12
v_mfma_f32_16x16x32_bf16 v[144:147], a[196:199], v[48:51], v[144:147]
v_exp_f32 v14, v174
v_mfma_f32_16x16x32_bf16 v[148:151], a[196:199], v[52:55], v[148:151]
s_waitcnt lgkmcnt(5)
v_add_f32 v18, v18, v13
v_mfma_f32_16x16x32_bf16 v[140:143], a[200:203], v[56:59], v[140:143]
ds_read_b128 a[220:223], v6 offset:960
s_waitcnt lgkmcnt(3)
v_cvt_pk_bf16_f32 v198, v12, v13
v_mfma_f32_16x16x32_bf16 v[144:147], a[200:203], v[60:63], v[144:147]
v_readfirstlane_b32 s39, v25
s_add_u32 s38, s38, 1
v_mfma_f32_16x16x32_bf16 v[148:151], a[200:203], v[64:67], v[148:151]
s_cmp_ge_u32 s39, s38
s_cbranch_scc0 L_poll45
L_ret46:
v_add_u32 v7, s40, v2
v_mfma_f32_16x16x32_bf16 v[140:143], a[204:207], v[68:71], v[140:143]
ds_read_b64_tr_b16 a[192:193], v7 offset:0
v_mfma_f32_16x16x32_bf16 v[144:147], a[204:207], v[72:75], v[144:147]
ds_read_b64_tr_b16 a[194:195], v7 offset:512
v_mfma_f32_16x16x32_bf16 v[148:151], a[204:207], v[76:79], v[148:151]
v_exp_f32 v15, v175
v_mfma_f32_16x16x32_bf16 v[140:143], a[208:211], v[80:83], v[140:143]
ds_read_b64_tr_b16 a[196:197], v7 offset:32
ds_read_b64_tr_b16 a[198:199], v7 offset:544
v_add_f32 v18, v18, v14
v_mfma_f32_16x16x32_bf16 v[144:147], a[208:211], v[84:87], v[144:147]
s_add_u32 s40, s40, 16896
v_add_f32 v18, v18, v15
v_cvt_pk_bf16_f32 v199, v14, v15
v_mfma_f32_16x16x32_bf16 v[148:151], a[208:211], v[88:91], v[148:151]
s_cmp_eq_u32 s40, 152064
s_cselect_b32 s40, 0, s40
s_waitcnt lgkmcnt(6)
v_mfma_f32_16x16x32_bf16 v[140:143], a[212:215], v[92:95], v[140:143]
ds_read_b64_tr_b16 a[200:201], v7 offset:64
v_max3_f32 v28, v16, v17, v18
v_mfma_f32_16x16x32_bf16 v[144:147], a[212:215], v[96:99], v[144:147]
ds_read_b64_tr_b16 a[202:203], v7 offset:576
v_cmp_lt_f32 vcc, s44, v28
s_cbranch_vccnz L_slow43
L_back44:
v_mfma_f32_16x16x32_bf16 v[148:151], a[212:215], v[100:103], v[148:151]
s_waitcnt lgkmcnt(7)
v_add_f32 v19, v19, v16
v_add_f32 v20, v20, v17
v_mfma_f32_16x16x32_bf16 v[140:143], a[216:219], v[104:107], v[140:143]
ds_read_b64_tr_b16 a[204:205], v7 offset:96
v_add_f32 v21, v21, v18
v_mfma_f32_16x16x32_bf16 v[144:147], a[216:219], v[108:111], v[144:147]
ds_read_b64_tr_b16 a[206:207], v7 offset:608
v_mfma_f32_16x16x32_bf16 v[148:151], a[216:219], v[112:115], v[148:151]
s_waitcnt lgkmcnt(8)
v_mfma_f32_16x16x32_bf16 v[140:143], a[220:223], v[116:119], v[140:143]
ds_read_b64_tr_b16 a[208:209], v7 offset:128
ds_read_b64_tr_b16 a[210:211], v7 offset:640
v_mfma_f32_16x16x32_bf16 v[144:147], a[220:223], v[120:123], v[144:147]
v_add_u32 v10, 1, v10
v_mfma_f32_16x16x32_bf16 v[148:151], a[220:223], v[124:127], v[148:151]
ds_write_b32 v8, v10
s_waitcnt lgkmcnt(9)
v_mfma_f32_16x16x32_bf16 a[0:3], a[192:195], v[188:191], a[0:3]
ds_read_b64_tr_b16 a[212:213], v7 offset:160
v_mfma_f32_16x16x32_bf16 a[4:7], a[192:195], v[192:195], a[4:7]
ds_read_b64_tr_b16 a[214:215], v7 offset:672
v_mfma_f32_16x16x32_bf16 a[8:11], a[192:195], v[196:199], a[8:11]
s_waitcnt lgkmcnt(9)
v_mfma_f32_16x16x32_bf16 a[12:15], a[196:199], v[188:191], a[12:15]
ds_read_b64_tr_b16 a[216:217], v7 offset:192
v_mfma_f32_16x16x32_bf16 a[16:19], a[196:199], v[192:195], a[16:19]
ds_read_b64_tr_b16 a[218:219], v7 offset:704
v_mfma_f32_16x16x32_bf16 a[20:23], a[196:199], v[196:199], a[20:23]
s_waitcnt lgkmcnt(9)
v_exp_f32 v12, v128
v_mfma_f32_16x16x32_bf16 a[24:27], a[200:203], v[188:191], a[24:27]
ds_read_b64_tr_b16 a[220:221], v7 offset:224
v_mfma_f32_16x16x32_bf16 a[28:31], a[200:203], v[192:195], a[28:31]
ds_read_b64_tr_b16 a[222:223], v7 offset:736
v_mfma_f32_16x16x32_bf16 a[32:35], a[200:203], v[196:199], a[32:35]
s_waitcnt lgkmcnt(9)
v_exp_f32 v13, v129
v_mfma_f32_16x16x32_bf16 a[36:39], a[204:207], v[188:191], a[36:39]
ds_read_b64_tr_b16 a[192:193], v7 offset:256
v_mfma_f32_16x16x32_bf16 a[40:43], a[204:207], v[192:195], a[40:43]
ds_read_b64_tr_b16 a[194:195], v7 offset:768
v_mfma_f32_16x16x32_bf16 a[44:47], a[204:207], v[196:199], a[44:47]
s_waitcnt lgkmcnt(9)
v_exp_f32 v14, v130
v_mfma_f32_16x16x32_bf16 a[48:51], a[208:211], v[188:191], a[48:51]
ds_read_b64_tr_b16 a[196:197], v7 offset:288
v_add_f32 v16, v12, v13
v_mfma_f32_16x16x32_bf16 a[52:55], a[208:211], v[192:195], a[52:55]
ds_read_b64_tr_b16 a[198:199], v7 offset:800
v_cvt_pk_bf16_f32 v176, v12, v13
v_mfma_f32_16x16x32_bf16 a[56:59], a[208:211], v[196:199], a[56:59]
s_waitcnt lgkmcnt(8)
v_exp_f32 v15, v131
v_mfma_f32_16x16x32_bf16 a[60:63], a[212:215], v[188:191], a[60:63]
ds_read_b64_tr_b16 a[200:201], v7 offset:320
v_add_f32 v16, v16, v14
v_mfma_f32_16x16x32_bf16 a[64:67], a[212:215], v[192:195], a[64:67]
ds_read_b64_tr_b16 a[202:203], v7 offset:832
v_mfma_f32_16x16x32_bf16 a[68:71], a[212:215], v[196:199], a[68:71]
s_waitcnt lgkmcnt(8)
v_exp_f32 v12, v140
v_mfma_f32_16x16x32_bf16 a[72:75], a[216:219], v[188:191], a[72:75]
ds_read_b64_tr_b16 a[204:205], v7 offset:352
v_add_f32 v16, v16, v15
v_mfma_f32_16x16x32_bf16 a[76:79], a[216:219], v[192:195], a[76:79]
ds_read_b64_tr_b16 a[206:207], v7 offset:864
v_cvt_pk_bf16_f32 v177, v14, v15
v_mfma_f32_16x16x32_bf16 a[80:83], a[216:219], v[196:199], a[80:83]
s_waitcnt lgkmcnt(8)
v_exp_f32 v13, v141
v_mfma_f32_16x16x32_bf16 a[84:87], a[220:223], v[188:191], a[84:87]
ds_read_b64_tr_b16 a[208:209], v7 offset:384
v_add_f32 v16, v16, v12
v_mfma_f32_16x16x32_bf16 a[88:91], a[220:223], v[192:195], a[88:91]
ds_read_b64_tr_b16 a[210:211], v7 offset:896
v_mfma_f32_16x16x32_bf16 a[92:95], a[220:223], v[196:199], a[92:95]
ds_read_b32 v25, v9
s_waitcnt lgkmcnt(9)
v_mfma_f32_16x16x32_bf16 a[96:99], a[192:195], v[188:191], a[96:99]
ds_read_b64_tr_b16 a[212:213], v7 offset:416
v_mfma_f32_16x16x32_bf16 a[100:103], a[192:195], v[192:195], a[100:103]
ds_read_b64_tr_b16 a[214:215], v7 offset:928
v_mfma_f32_16x16x32_bf16 a[104:107], a[192:195], v[196:199], a[104:107]
s_waitcnt lgkmcnt(9)
v_exp_f32 v14, v142
v_mfma_f32_16x16x32_bf16 a[108:111], a[196:199], v[188:191], a[108:111]
ds_read_b64_tr_b16 a[216:217], v7 offset:448
v_add_f32 v16, v16, v13
v_mfma_f32_16x16x32_bf16 a[112:115], a[196:199], v[192:195], a[112:115]
ds_read_b64_tr_b16 a[218:219], v7 offset:960
v_cvt_pk_bf16_f32 v178, v12, v13
v_mfma_f32_16x16x32_bf16 a[116:119], a[196:199], v[196:199], a[116:119]
s_waitcnt lgkmcnt(9)
v_exp_f32 v15, v143
v_mfma_f32_16x16x32_bf16 a[120:123], a[200:203], v[188:191], a[120:123]
ds_read_b64_tr_b16 a[220:221], v7 offset:480
ds_read_b64_tr_b16 a[222:223], v7 offset:992
s_waitcnt lgkmcnt(6)
v_mfma_f32_16x16x32_bf16 a[124:127], a[200:203], v[192:195], a[124:127]
v_readfirstlane_b32 s39, v25
s_add_u32 s38, s38, 1
v_add_f32 v16, v16, v14
v_mfma_f32_16x16x32_bf16 a[128:131], a[200:203], v[196:199], a[128:131]
s_cmp_ge_u32 s39, s38
s_cbranch_scc0 L_poll47
L_ret48:
v_add_u32 v6, s40, v1
v_mfma_f32_16x16x32_bf16 a[132:135], a[204:207], v[188:191], a[132:135]
ds_read_b128 a[192:195], v6 offset:0
v_add_f32 v16, v16, v15
v_mfma_f32_16x16x32_bf16 a[136:139], a[204:207], v[192:195], a[136:139]
v_cvt_pk_bf16_f32 v179, v14, v15
v_mfma_f32_16x16x32_bf16 a[140:143], a[204:207], v[196:199], a[140:143]
v_exp_f32 v12, v132
v_mfma_f32_16x16x32_bf16 a[144:147], a[208:211], v[188:191], a[144:147]
ds_read_b128 a[196:199], v6 offset:64
v_mfma_f32_16x16x32_bf16 a[148:151], a[208:211], v[192:195], a[148:151]
s_add_u32 s40, s40, 16896
v_exp_f32 v13, v133
v_mfma_f32_16x16x32_bf16 a[152:155], a[208:211], v[196:199], a[152:155]
s_cmp_eq_u32 s40, 152064
s_cselect_b32 s40, 0, s40
s_waitcnt lgkmcnt(6)
v_mfma_f32_16x16x32_bf16 a[156:159], a[212:215], v[188:191], a[156:159]
ds_read_b128 a[200:203], v6 offset:128
v_mfma_f32_16x16x32_bf16 a[160:163], a[212:215], v[192:195], a[160:163]
v_exp_f32 v14, v134
v_mfma_f32_16x16x32_bf16 a[164:167], a[212:215], v[196:199], a[164:167]
s_waitcnt lgkmcnt(5)
v_add_f32 v17, v12, v13
v_cvt_pk_bf16_f32 v180, v12, v13
v_mfma_f32_16x16x32_bf16 a[168:171], a[216:219], v[188:191], a[168:171]
ds_read_b128 a[204:207], v6 offset:192
v_mfma_f32_16x16x32_bf16 a[172:175], a[216:219], v[192:195], a[172:175]
v_exp_f32 v15, v135
v_mfma_f32_16x16x32_bf16 a[176:179], a[216:219], v[196:199], a[176:179]
s_waitcnt lgkmcnt(4)
v_add_f32 v17, v17, v14
v_mfma_f32_16x16x32_bf16 a[180:183], a[220:223], v[188:191], a[180:183]
ds_read_b128 a[208:211], v6 offset:256
v_mfma_f32_16x16x32_bf16 a[184:187], a[220:223], v[192:195], a[184:187]
v_add_u32 v10, 1, v10
v_mfma_f32_16x16x32_bf16 a[188:191], a[220:223], v[196:199], a[188:191]
ds_write_b32 v8, v10
s_waitcnt lgkmcnt(5)
v_exp_f32 v12, v144
v_add_f32 v17, v17, v15
s_sub_u32 s41, s41, 1
s_cmp_lg_u32 s41, 0
s_cbranch_scc1 L_main
s_cmp_lg_u32 s35, 0
s_cbranch_scc1 L_Ytail
v_mfma_f32_16x16x32_bf16 v[152:155], a[192:195], v[32:35], v[224:227]
ds_read_b128 a[212:215], v6 offset:320
v_cvt_pk_bf16_f32 v181, v14, v15
v_mfma_f32_16x16x32_bf16 v[156:159], a[192:195], v[36:39], v[228:231]
v_exp_f32 v13, v145
v_mfma_f32_16x16x32_bf16 v[160:163], a[192:195], v[40:43], v[232:235]
s_waitcnt lgkmcnt(5)
v_add_f32 v17, v17, v12
v_mov_b32 v214, 153088
L_ng49:
ds_read_b64 v[212:213], v214
s_waitcnt lgkmcnt(0)
v_readfirstlane_b32 s56, v212
v_readfirstlane_b32 s57, v213
s_nop 0
s_cmp_lg_u32 s56, 0
s_cbranch_scc1 L_nk50
s_sleep 1
s_add_u32 s53, s53, 1
s_cmp_lt_u32 s53, 1048576
s_cbranch_scc1 L_ng49
s_endpgm
L_nk50:
v_mfma_f32_16x16x32_bf16 v[152:155], a[196:199], v[44:47], v[152:155]
ds_read_b128 a[216:219], v6 offset:384
v_mfma_f32_16x16x32_bf16 v[156:159], a[196:199], v[48:51], v[156:159]
v_exp_f32 v14, v146
v_mfma_f32_16x16x32_bf16 v[160:163], a[196:199], v[52:55], v[160:163]
s_waitcnt lgkmcnt(5)
v_add_f32 v17, v17, v13
v_mfma_f32_16x16x32_bf16 v[152:155], a[200:203], v[56:59], v[152:155]
ds_read_b128 a[220:223], v6 offset:448
v_cvt_pk_bf16_f32 v182, v12, v13
v_mfma_f32_16x16x32_bf16 v[156:159], a[200:203], v[60:63], v[156:159]
v_exp_f32 v15, v147
v_mfma_f32_16x16x32_bf16 v[160:163], a[200:203], v[64:67], v[160:163]
s_waitcnt lgkmcnt(5)
v_mfma_f32_16x16x32_bf16 v[152:155], a[204:207], v[68:71], v[152:155]
ds_read_b128 a[192:195], v6 offset:512
v_add_f32 v17, v17, v14
v_mfma_f32_16x16x32_bf16 v[156:159], a[204:207], v[72:75], v[156:159]
v_add_f32 v17, v17, v15
v_cvt_pk_bf16_f32 v183, v14, v15
v_mfma_f32_16x16x32_bf16 v[160:163], a[204:207], v[76:79], v[160:163]
s_waitcnt lgkmcnt(5)
v_exp_f32 v12, v136
v_mfma_f32_16x16x32_bf16 v[152:155], a[208:211], v[80:83], v[152:155]
ds_read_b128 a[196:199], v6 offset:576
v_mfma_f32_16x16x32_bf16 v[156:159], a[208:211], v[84:87], v[156:159]
v_exp_f32 v13, v137
v_mfma_f32_16x16x32_bf16 v[160:163], a[208:211], v[88:91], v[160:163]
s_waitcnt lgkmcnt(4)
v_mfma_f32_16x16x32_bf16 v[152:155], a[212:215], v[92:95], v[152:155]
ds_read_b128 a[200:203], v6 offset:640
v_mfma_f32_16x16x32_bf16 v[156:159], a[212:215], v[96:99], v[156:159]
v_exp_f32 v14, v138
v_mfma_f32_16x16x32_bf16 v[160:163], a[212:215], v[100:103], v[160:163]
s_waitcnt lgkmcnt(4)
v_add_f32 v18, v12, v13
v_mfma_f32_16x16x32_bf16 v[152:155], a[216:219], v[104:107], v[152:155]
ds_read_b128 a[204:207], v6 offset:704
v_cvt_pk_bf16_f32 v184, v12, v13
v_mfma_f32_16x16x32_bf16 v[156:159], a[216:219], v[108:111], v[156:159]
v_exp_f32 v15, v139
v_mfma_f32_16x16x32_bf16 v[160:163], a[216:219], v[112:115], v[160:163]
s_waitcnt lgkmcnt(4)
v_add_f32 v18, v18, v14
v_mfma_f32_16x16x32_bf16 v[152:155], a[220:223], v[116:119], v[152:155]
ds_read_b128 a[208:211], v6 offset:768
v_mfma_f32_16x16x32_bf16 v[156:159], a[220:223], v[120:123], v[156:159]
ds_read_b32 v25, v9
v_mfma_f32_16x16x32_bf16 v[160:163], a[220:223], v[124:127], v[160:163]
s_waitcnt lgkmcnt(5)
v_exp_f32 v12, v148
v_mfma_f32_16x16x32_bf16 v[164:167], a[192:195], v[32:35], v[224:227]
ds_read_b128 a[212:215], v6 offset:832
v_add_f32 v18, v18, v15
v_mfma_f32_16x16x32_bf16 v[168:171], a[192:195], v[36:39], v[228:231]
v_cvt_pk_bf16_f32 v185, v14, v15
v_mfma_f32_16x16x32_bf16 v[172:175], a[192:195], v[40:43], v[232:235]
s_waitcnt lgkmcnt(5)
v_exp_f32 v13, v149
v_mfma_f32_16x16x32_bf16 v[164:167], a[196:199], v[44:47], v[164:167]
ds_read_b128 a[216:219], v6 offset:896
v_add_f32 v18, v18, v12
v_mfma_f32_16x16x32_bf16 v[168:171], a[196:199], v[48:51], v[168:171]
v_exp_f32 v14, v150
v_mfma_f32_16x16x32_bf16 v[172:175], a[196:199], v[52:55], v[172:175]
s_waitcnt lgkmcnt(5)
v_add_f32 v18, v18, v13
v_mfma_f32_16x16x32_bf16 v[164:167], a[200:203], v[56:59], v[164:167]
ds_read_b128 a[220:223], v6 offset:960
s_waitcnt lgkmcnt(3)
v_cvt_pk_bf16_f32 v186, v12, v13
v_mfma_f32_16x16x32_bf16 v[168:171], a[200:203], v[60:63], v[168:171]
v_readfirstlane_b32 s39, v25
s_add_u32 s38, s38, 1
v_mfma_f32_16x16x32_bf16 v[172:175], a[200:203], v[64:67], v[172:175]
s_cmp_ge_u32 s39, s38
s_cbranch_scc0 L_poll53
L_ret54:
v_add_u32 v7, s40, v2
v_mfma_f32_16x16x32_bf16 v[164:167], a[204:207], v[68:71], v[164:167]
ds_read_b64_tr_b16 a[192:193], v7 offset:0
v_mfma_f32_16x16x32_bf16 v[168:171], a[204:207], v[72:75], v[168:171]
ds_read_b64_tr_b16 a[194:195], v7 offset:512
v_mfma_f32_16x16x32_bf16 v[172:175], a[204:207], v[76:79], v[172:175]
v_exp_f32 v15, v151
v_mfma_f32_16x16x32_bf16 v[164:167], a[208:211], v[80:83], v[164:167]
ds_read_b64_tr_b16 a[196:197], v7 offset:32
ds_read_b64_tr_b16 a[198:199], v7 offset:544
v_add_f32 v18, v18, v14
v_mfma_f32_16x16x32_bf16 v[168:171], a[208:211], v[84:87], v[168:171]
s_add_u32 s40, s40, 16896
v_add_f32 v18, v18, v15
v_cvt_pk_bf16_f32 v187, v14, v15
v_mfma_f32_16x16x32_bf16 v[172:175], a[208:211], v[88:91], v[172:175]
s_cmp_eq_u32 s40, 152064
s_cselect_b32 s40, 0, s40
s_waitcnt lgkmcnt(6)
v_mfma_f32_16x16x32_bf16 v[164:167], a[212:215], v[92:95], v[164:167]
ds_read_b64_tr_b16 a[200:201], v7 offset:64
v_max3_f32 v28, v16, v17, v18
v_mfma_f32_16x16x32_bf16 v[168:171], a[212:215], v[96:99], v[168:171]
ds_read_b64_tr_b16 a[202:203], v7 offset:576
v_cmp_lt_f32 vcc, s44, v28
s_cbranch_vccnz L_slow51
L_back52:
v_mfma_f32_16x16x32_bf16 v[172:175], a[212:215], v[100:103], v[172:175]
s_waitcnt lgkmcnt(7)
v_add_f32 v19, v19, v16
v_add_f32 v20, v20, v17
v_mfma_f32_16x16x32_bf16 v[164:167], a[216:219], v[104:107], v[164:167]
ds_read_b64_tr_b16 a[204:205], v7 offset:96
v_add_f32 v21, v21, v18
v_mfma_f32_16x16x32_bf16 v[168:171], a[216:219], v[108:111], v[168:171]
ds_read_b64_tr_b16 a[206:207], v7 offset:608
v_mfma_f32_16x16x32_bf16 v[172:175], a[216:219], v[112:115], v[172:175]
s_waitcnt lgkmcnt(8)
v_mfma_f32_16x16x32_bf16 v[164:167], a[220:223], v[116:119], v[164:167]
ds_read_b64_tr_b16 a[208:209], v7 offset:128
ds_read_b64_tr_b16 a[210:211], v7 offset:640
v_mfma_f32_16x16x32_bf16 v[168:171], a[220:223], v[120:123], v[168:171]
v_add_u32 v10, 1, v10
v_mfma_f32_16x16x32_bf16 v[172:175], a[220:223], v[124:127], v[172:175]
ds_write_b32 v8, v10
s_waitcnt lgkmcnt(9)
v_mfma_f32_16x16x32_bf16 a[0:3], a[192:195], v[176:179], a[0:3]
ds_read_b64_tr_b16 a[212:213], v7 offset:160
v_mfma_f32_16x16x32_bf16 a[4:7], a[192:195], v[180:183], a[4:7]
ds_read_b64_tr_b16 a[214:215], v7 offset:672
v_mfma_f32_16x16x32_bf16 a[8:11], a[192:195], v[184:187], a[8:11]
s_waitcnt lgkmcnt(9)
v_mfma_f32_16x16x32_bf16 a[12:15], a[196:199], v[176:179], a[12:15]
ds_read_b64_tr_b16 a[216:217], v7 offset:192
v_exp_f32 v12, v152
v_mfma_f32_16x16x32_bf16 a[16:19], a[196:199], v[180:183], a[16:19]
ds_read_b64_tr_b16 a[218:219], v7 offset:704
v_exp_f32 v13, v153
v_mfma_f32_16x16x32_bf16 a[20:23], a[196:199], v[184:187], a[20:23]
s_waitcnt lgkmcnt(9)
v_exp_f32 v14, v154
v_mfma_f32_16x16x32_bf16 a[24:27], a[200:203], v[176:179], a[24:27]
ds_read_b64_tr_b16 a[220:221], v7 offset:224
v_add_f32 v16, v12, v13
v_cvt_pk_bf16_f32 v188, v12, v13
v_mfma_f32_16x16x32_bf16 a[28:31], a[200:203], v[180:183], a[28:31]
ds_read_b64_tr_b16 a[222:223], v7 offset:736
v_exp_f32 v15, v155
v_mfma_f32_16x16x32_bf16 a[32:35], a[200:203], v[184:187], a[32:35]
s_waitcnt lgkmcnt(9)
v_add_f32 v16, v16, v14
v_mfma_f32_16x16x32_bf16 a[36:39], a[204:207], v[176:179], a[36:39]
ds_read_b64_tr_b16 a[192:193], v7 offset:256
v_exp_f32 v12, v164
v_mfma_f32_16x16x32_bf16 a[40:43], a[204:207], v[180:183], a[40:43]
ds_read_b64_tr_b16 a[194:195], v7 offset:768
v_add_f32 v16, v16, v15
v_cvt_pk_bf16_f32 v189, v14, v15
v_mfma_f32_16x16x32_bf16 a[44:47], a[204:207], v[184:187], a[44:47]
s_waitcnt lgkmcnt(9)
v_exp_f32 v13, v165
v_mfma_f32_16x16x32_bf16 a[48:51], a[208:211], v[176:179], a[48:51]
ds_read_b64_tr_b16 a[196:197], v7 offset:288
v_add_f32 v16, v16, v12
v_mfma_f32_16x16x32_bf16 a[52:55], a[208:211], v[180:183], a[52:55]
ds_read_b64_tr_b16 a[198:199], v7 offset:800
v_exp_f32 v14, v166
v_mfma_f32_16x16x32_bf16 a[56:59], a[208:211], v[184:187], a[56:59]
s_waitcnt lgkmcnt(8)
v_add_f32 v16, v16, v13
v_cvt_pk_bf16_f32 v190, v12, v13
v_mfma_f32_16x16x32_bf16 a[60:63], a[212:215], v[176:179], a[60:63]
ds_read_b64_tr_b16 a[200:201], v7 offset:320
v_exp_f32 v15, v167
v_mfma_f32_16x16x32_bf16 a[64:67], a[212:215], v[180:183], a[64:67]
ds_read_b64_tr_b16 a[202:203], v7 offset:832
v_add_f32 v16, v16, v14
v_add_f32 v16, v16, v15
v_mfma_f32_16x16x32_bf16 a[68:71], a[212:215], v[184:187], a[68:71]
s_waitcnt lgkmcnt(8)
v_cvt_pk_bf16_f32 v191, v14, v15
v_mfma_f32_16x16x32_bf16 a[72:75], a[216:219], v[176:179], a[72:75]
ds_read_b64_tr_b16 a[204:205], v7 offset:352
v_exp_f32 v12, v156
v_mfma_f32_16x16x32_bf16 a[76:79], a[216:219], v[180:183], a[76:79]
ds_read_b64_tr_b16 a[206:207], v7 offset:864
v_exp_f32 v13, v157
v_mfma_f32_16x16x32_bf16 a[80:83], a[216:219], v[184:187], a[80:83]
s_waitcnt lgkmcnt(8)
v_exp_f32 v14, v158
v_mfma_f32_16x16x32_bf16 a[84:87], a[220:223], v[176:179], a[84:87]
ds_read_b64_tr_b16 a[208:209], v7 offset:384
v_add_f32 v17, v12, v13
v_cvt_pk_bf16_f32 v192, v12, v13
v_mfma_f32_16x16x32_bf16 a[88:91], a[220:223], v[180:183], a[88:91]
ds_read_b64_tr_b16 a[210:211], v7 offset:896
v_exp_f32 v15, v159
v_mfma_f32_16x16x32_bf16 a[92:95], a[220:223], v[184:187], a[92:95]
ds_read_b32 v25, v9
s_waitcnt lgkmcnt(9)
v_add_f32 v17, v17, v14
v_mfma_f32_16x16x32_bf16 a[96:99], a[192:195], v[176:179], a[96:99]
ds_read_b64_tr_b16 a[212:213], v7 offset:416
v_exp_f32 v12, v168
v_mfma_f32_16x16x32_bf16 a[100:103], a[192:195], v[180:183], a[100:103]
ds_read_b64_tr_b16 a[214:215], v7 offset:928
v_add_f32 v17, v17, v15
v_cvt_pk_bf16_f32 v193, v14, v15
v_mfma_f32_16x16x32_bf16 a[104:107], a[192:195], v[184:187], a[104:107]
s_waitcnt lgkmcnt(9)
v_exp_f32 v13, v169
v_mfma_f32_16x16x32_bf16 a[108:111], a[196:199], v[176:179], a[108:111]
ds_read_b64_tr_b16 a[216:217], v7 offset:448
v_add_f32 v17, v17, v12
v_mfma_f32_16x16x32_bf16 a[112:115], a[196:199], v[180:183], a[112:115]
ds_read_b64_tr_b16 a[218:219], v7 offset:960
v_exp_f32 v14, v170
v_mfma_f32_16x16x32_bf16 a[116:119], a[196:199], v[184:187], a[116:119]
s_waitcnt lgkmcnt(9)
v_add_f32 v17, v17, v13
v_cvt_pk_bf16_f32 v194, v12, v13
v_mfma_f32_16x16x32_bf16 a[120:123], a[200:203], v[176:179], a[120:123]
ds_read_b64_tr_b16 a[220:221], v7 offset:480
ds_read_b64_tr_b16 a[222:223], v7 offset:992
s_waitcnt lgkmcnt(6)
v_mfma_f32_16x16x32_bf16 a[124:127], a[200:203], v[180:183], a[124:127]
v_readfirstlane_b32 s39, v25
s_add_u32 s38, s38, 1
v_mfma_f32_16x16x32_bf16 a[128:131], a[200:203], v[184:187], a[128:131]
s_cmp_ge_u32 s39, s38
s_cbranch_scc0 L_poll57
L_ret58:
v_add_u32 v7, s40, v2
v_mfma_f32_16x16x32_bf16 a[132:135], a[204:207], v[176:179], a[132:135]
ds_read_b64_tr_b16 a[192:193], v7 offset:0
v_exp_f32 v15, v171
v_mfma_f32_16x16x32_bf16 a[136:139], a[204:207], v[180:183], a[136:139]
ds_read_b64_tr_b16 a[194:195], v7 offset:512
v_add_f32 v17, v17, v14
v_add_f32 v17, v17, v15
v_mfma_f32_16x16x32_bf16 a[140:143], a[204:207], v[184:187], a[140:143]
v_cvt_pk_bf16_f32 v195, v14, v15
v_mfma_f32_16x16x32_bf16 a[144:147], a[208:211], v[176:179], a[144:147]
ds_read_b64_tr_b16 a[196:197], v7 offset:32
ds_read_b64_tr_b16 a[198:199], v7 offset:544
v_exp_f32 v12, v160
v_mfma_f32_16x16x32_bf16 a[148:151], a[208:211], v[180:183], a[148:151]
s_add_u32 s40, s40, 16896
v_exp_f32 v13, v161
v_mfma_f32_16x16x32_bf16 a[152:155], a[208:211], v[184:187], a[152:155]
s_cmp_eq_u32 s40, 152064
s_cselect_b32 s40, 0, s40
s_waitcnt lgkmcnt(8)
v_mfma_f32_16x16x32_bf16 a[156:159], a[212:215], v[176:179], a[156:159]
ds_read_b64_tr_b16 a[200:201], v7 offset:64
v_exp_f32 v14, v162
v_mfma_f32_16x16x32_bf16 a[160:163], a[212:215], v[180:183], a[160:163]
ds_read_b64_tr_b16 a[202:203], v7 offset:576
v_add_f32 v18, v12, v13
v_cvt_pk_bf16_f32 v196, v12, v13
v_mfma_f32_16x16x32_bf16 a[164:167], a[212:215], v[184:187], a[164:167]
s_waitcnt lgkmcnt(8)
v_exp_f32 v15, v163
v_mfma_f32_16x16x32_bf16 a[168:171], a[216:219], v[176:179], a[168:171]
ds_read_b64_tr_b16 a[204:205], v7 offset:96
v_add_f32 v18, v18, v14
v_mfma_f32_16x16x32_bf16 a[172:175], a[216:219], v[180:183], a[172:175]
ds_read_b64_tr_b16 a[206:207], v7 offset:608
v_exp_f32 v12, v172
v_mfma_f32_16x16x32_bf16 a[176:179], a[216:219], v[184:187], a[176:179]
s_waitcnt lgkmcnt(8)
v_add_f32 v18, v18, v15
v_cvt_pk_bf16_f32 v197, v14, v15
v_mfma_f32_16x16x32_bf16 a[180:183], a[220:223], v[176:179], a[180:183]
ds_read_b64_tr_b16 a[208:209], v7 offset:128
ds_read_b64_tr_b16 a[210:211], v7 offset:640
v_exp_f32 v13, v173
v_mfma_f32_16x16x32_bf16 a[184:187], a[220:223], v[180:183], a[184:187]
v_add_u32 v10, 1, v10
v_add_f32 v18, v18, v12
v_mfma_f32_16x16x32_bf16 a[188:191], a[220:223], v[184:187], a[188:191]
ds_write_b32 v8, v10
s_waitcnt lgkmcnt(9)
v_exp_f32 v14, v174
v_add_f32 v18, v18, v13
v_cvt_pk_bf16_f32 v198, v12, v13
v_exp_f32 v15, v175
v_add_f32 v18, v18, v14
v_add_f32 v18, v18, v15
v_cvt_pk_bf16_f32 v199, v14, v15
v_max3_f32 v28, v16, v17, v18
v_cmp_lt_f32 vcc, s44, v28
s_cbranch_vccnz L_slow55
L_back56:
v_add_f32 v19, v19, v16
v_add_f32 v20, v20, v17
v_add_f32 v21, v21, v18
s_nop 1
v_mfma_f32_16x16x32_bf16 a[0:3], a[192:195], v[188:191], a[0:3]
ds_read_b64_tr_b16 a[212:213], v7 offset:160
s_mul_i32 s52, s32, -23040
s_add_u32 s52, s52, s54
v_mfma_f32_16x16x32_bf16 a[4:7], a[192:195], v[192:195], a[4:7]
ds_read_b64_tr_b16 a[214:215], v7 offset:672
s_add_u32 s52, s52, 10559488
buffer_store_dword v224, v216, s[20:23], s52 offen offset:0 sc1
v_mfma_f32_16x16x32_bf16 a[8:11], a[192:195], v[196:199], a[8:11]
s_waitcnt lgkmcnt(9)
buffer_store_dword v19, v216, s[20:23], s52 offen offset:256 sc1
buffer_store_dword v228, v216, s[20:23], s52 offen offset:512 sc1
v_mfma_f32_16x16x32_bf16 a[12:15], a[196:199], v[188:191], a[12:15]
ds_read_b64_tr_b16 a[216:217], v7 offset:192
buffer_store_dword v20, v216, s[20:23], s52 offen offset:768 sc1
buffer_store_dword v232, v216, s[20:23], s52 offen offset:1024 sc1
v_mfma_f32_16x16x32_bf16 a[16:19], a[196:199], v[192:195], a[16:19]
ds_read_b64_tr_b16 a[218:219], v7 offset:704
buffer_store_dword v21, v216, s[20:23], s52 offen offset:1280 sc1
v_mfma_f32_16x16x32_bf16 a[20:23], a[196:199], v[196:199], a[20:23]
s_waitcnt lgkmcnt(9)
v_mfma_f32_16x16x32_bf16 a[24:27], a[200:203], v[188:191], a[24:27]
ds_read_b64_tr_b16 a[220:221], v7 offset:224
v_mfma_f32_16x16x32_bf16 a[28:31], a[200:203], v[192:195], a[28:31]
ds_read_b64_tr_b16 a[222:223], v7 offset:736
v_mfma_f32_16x16x32_bf16 a[32:35], a[200:203], v[196:199], a[32:35]
s_waitcnt lgkmcnt(9)
v_mfma_f32_16x16x32_bf16 a[36:39], a[204:207], v[188:191], a[36:39]
ds_read_b64_tr_b16 a[192:193], v7 offset:256
v_mfma_f32_16x16x32_bf16 a[40:43], a[204:207], v[192:195], a[40:43]
ds_read_b64_tr_b16 a[194:195], v7 offset:768
v_mfma_f32_16x16x32_bf16 a[44:47], a[204:207], v[196:199], a[44:47]
s_waitcnt lgkmcnt(9)
v_mfma_f32_16x16x32_bf16 a[48:51], a[208:211], v[188:191], a[48:51]
ds_read_b64_tr_b16 a[196:197], v7 offset:288
v_accvgpr_read_b32 v12, a0
v_accvgpr_read_b32 v13, a1
v_mfma_f32_16x16x32_bf16 a[52:55], a[208:211], v[192:195], a[52:55]
ds_read_b64_tr_b16 a[198:199], v7 offset:800
v_accvgpr_read_b32 v14, a2
v_accvgpr_read_b32 v15, a3
v_mfma_f32_16x16x32_bf16 a[56:59], a[208:211], v[196:199], a[56:59]
s_waitcnt lgkmcnt(8)
v_cvt_pk_bf16_f32 v32, v12, v13
v_cvt_pk_bf16_f32 v33, v14, v15
v_mfma_f32_16x16x32_bf16 a[60:63], a[212:215], v[188:191], a[60:63]
ds_read_b64_tr_b16 a[200:201], v7 offset:320
v_accvgpr_read_b32 v28, a12
v_accvgpr_read_b32 v29, a13
v_mfma_f32_16x16x32_bf16 a[64:67], a[212:215], v[192:195], a[64:67]
ds_read_b64_tr_b16 a[202:203], v7 offset:832
v_accvgpr_read_b32 v30, a14
v_accvgpr_read_b32 v31, a15
v_mfma_f32_16x16x32_bf16 a[68:71], a[212:215], v[196:199], a[68:71]
s_waitcnt lgkmcnt(8)
v_cvt_pk_bf16_f32 v34, v28, v29
v_cvt_pk_bf16_f32 v35, v30, v31
v_mfma_f32_16x16x32_bf16 a[72:75], a[216:219], v[188:191], a[72:75]
ds_read_b64_tr_b16 a[204:205], v7 offset:352
v_accvgpr_read_b32 v12, a4
v_accvgpr_read_b32 v13, a5
v_mfma_f32_16x16x32_bf16 a[76:79], a[216:219], v[192:195], a[76:79]
ds_read_b64_tr_b16 a[206:207], v7 offset:864
v_accvgpr_read_b32 v14, a6
v_accvgpr_read_b32 v15, a7
v_mfma_f32_16x16x32_bf16 a[80:83], a[216:219], v[196:199], a[80:83]
s_waitcnt lgkmcnt(8)
v_cvt_pk_bf16_f32 v36, v12, v13
v_cvt_pk_bf16_f32 v37, v14, v15
v_mfma_f32_16x16x32_bf16 a[84:87], a[220:223], v[188:191], a[84:87]
ds_read_b64_tr_b16 a[208:209], v7 offset:384
v_accvgpr_read_b32 v28, a16
v_accvgpr_read_b32 v29, a17
v_mfma_f32_16x16x32_bf16 a[88:91], a[220:223], v[192:195], a[88:91]
ds_read_b64_tr_b16 a[210:211], v7 offset:896
v_accvgpr_read_b32 v30, a18
v_accvgpr_read_b32 v31, a19
v_mfma_f32_16x16x32_bf16 a[92:95], a[220:223], v[196:199], a[92:95]
s_waitcnt lgkmcnt(8)
v_cvt_pk_bf16_f32 v38, v28, v29
v_cvt_pk_bf16_f32 v39, v30, v31
v_mfma_f32_16x16x32_bf16 a[96:99], a[192:195], v[188:191], a[96:99]
ds_read_b64_tr_b16 a[212:213], v7 offset:416
v_accvgpr_read_b32 v12, a8
v_accvgpr_read_b32 v13, a9
v_mfma_f32_16x16x32_bf16 a[100:103], a[192:195], v[192:195], a[100:103]
ds_read_b64_tr_b16 a[214:215], v7 offset:928
v_accvgpr_read_b32 v14, a10
v_accvgpr_read_b32 v15, a11
v_mfma_f32_16x16x32_bf16 a[104:107], a[192:195], v[196:199], a[104:107]
s_waitcnt lgkmcnt(8)
v_cvt_pk_bf16_f32 v40, v12, v13
v_cvt_pk_bf16_f32 v41, v14, v15
v_mfma_f32_16x16x32_bf16 a[108:111], a[196:199], v[188:191], a[108:111]
ds_read_b64_tr_b16 a[216:217], v7 offset:448
v_accvgpr_read_b32 v28, a20
v_accvgpr_read_b32 v29, a21
v_mfma_f32_16x16x32_bf16 a[112:115], a[196:199], v[192:195], a[112:115]
ds_read_b64_tr_b16 a[218:219], v7 offset:960
v_accvgpr_read_b32 v30, a22
v_accvgpr_read_b32 v31, a23
v_mfma_f32_16x16x32_bf16 a[116:119], a[196:199], v[196:199], a[116:119]
s_waitcnt lgkmcnt(8)
v_cvt_pk_bf16_f32 v42, v28, v29
v_cvt_pk_bf16_f32 v43, v30, v31
v_mfma_f32_16x16x32_bf16 a[120:123], a[200:203], v[188:191], a[120:123]
ds_read_b64_tr_b16 a[220:221], v7 offset:480
s_add_u32 s51, s54, 10485760
buffer_store_dwordx4 v[32:35], v26, s[20:23], s51 offen offset:0 sc1
v_mfma_f32_16x16x32_bf16 a[124:127], a[200:203], v[192:195], a[124:127]
ds_read_b64_tr_b16 a[222:223], v7 offset:992
buffer_store_dwordx4 v[36:39], v26, s[20:23], s51 offen offset:1024 sc1
buffer_store_dwordx4 v[40:43], v26, s[20:23], s51 offen offset:2048 sc1
v_mfma_f32_16x16x32_bf16 a[128:131], a[200:203], v[196:199], a[128:131]
s_waitcnt lgkmcnt(8)
v_accvgpr_read_b32 v12, a24
v_accvgpr_read_b32 v13, a25
v_mfma_f32_16x16x32_bf16 a[132:135], a[204:207], v[188:191], a[132:135]
v_accvgpr_read_b32 v14, a26
v_accvgpr_read_b32 v15, a27
v_mfma_f32_16x16x32_bf16 a[136:139], a[204:207], v[192:195], a[136:139]
v_cvt_pk_bf16_f32 v44, v12, v13
v_cvt_pk_bf16_f32 v45, v14, v15
v_mfma_f32_16x16x32_bf16 a[140:143], a[204:207], v[196:199], a[140:143]
s_waitcnt lgkmcnt(6)
v_accvgpr_read_b32 v28, a36
v_accvgpr_read_b32 v29, a37
v_mfma_f32_16x16x32_bf16 a[144:147], a[208:211], v[188:191], a[144:147]
v_accvgpr_read_b32 v30, a38
v_accvgpr_read_b32 v31, a39
v_mfma_f32_16x16x32_bf16 a[148:151], a[208:211], v[192:195], a[148:151]
v_cvt_pk_bf16_f32 v46, v28, v29
v_cvt_pk_bf16_f32 v47, v30, v31
v_mfma_f32_16x16x32_bf16 a[152:155], a[208:211], v[196:199], a[152:155]
s_waitcnt lgkmcnt(4)
v_accvgpr_read_b32 v12, a28
v_accvgpr_read_b32 v13, a29
v_mfma_f32_16x16x32_bf16 a[156:159], a[212:215], v[188:191], a[156:159]
v_accvgpr_read_b32 v14, a30
v_accvgpr_read_b32 v15, a31
v_mfma_f32_16x16x32_bf16 a[160:163], a[212:215], v[192:195], a[160:163]
v_cvt_pk_bf16_f32 v48, v12, v13
v_cvt_pk_bf16_f32 v49, v14, v15
v_mfma_f32_16x16x32_bf16 a[164:167], a[212:215], v[196:199], a[164:167]
s_waitcnt lgkmcnt(2)
v_accvgpr_read_b32 v28, a40
v_accvgpr_read_b32 v29, a41
v_mfma_f32_16x16x32_bf16 a[168:171], a[216:219], v[188:191], a[168:171]
v_accvgpr_read_b32 v30, a42
v_accvgpr_read_b32 v31, a43
v_mfma_f32_16x16x32_bf16 a[172:175], a[216:219], v[192:195], a[172:175]
v_cvt_pk_bf16_f32 v50, v28, v29
v_cvt_pk_bf16_f32 v51, v30, v31
v_mfma_f32_16x16x32_bf16 a[176:179], a[216:219], v[196:199], a[176:179]
s_waitcnt lgkmcnt(0)
v_accvgpr_read_b32 v12, a32
v_accvgpr_read_b32 v13, a33
v_mfma_f32_16x16x32_bf16 a[180:183], a[220:223], v[188:191], a[180:183]
v_add_u32 v10, 1, v10
v_accvgpr_read_b32 v14, a34
v_mfma_f32_16x16x32_bf16 a[184:187], a[220:223], v[192:195], a[184:187]
ds_write_b32 v8, v10
v_accvgpr_read_b32 v15, a35
v_cvt_pk_bf16_f32 v52, v12, v13
v_mfma_f32_16x16x32_bf16 a[188:191], a[220:223], v[196:199], a[188:191]
v_cvt_pk_bf16_f32 v53, v14, v15
v_accvgpr_read_b32 v28, a44
v_accvgpr_read_b32 v29, a45
v_accvgpr_read_b32 v30, a46
v_accvgpr_read_b32 v31, a47
v_cvt_pk_bf16_f32 v54, v28, v29
v_cvt_pk_bf16_f32 v55, v30, v31
s_add_u32 s51, s54, 10488832
buffer_store_dwordx4 v[44:47], v26, s[20:23], s51 offen offset:0 sc1
buffer_store_dwordx4 v[48:51], v26, s[20:23], s51 offen offset:1024 sc1
buffer_store_dwordx4 v[52:55], v26, s[20:23], s51 offen offset:2048 sc1
v_accvgpr_read_b32 v12, a48
v_accvgpr_read_b32 v13, a49
v_accvgpr_read_b32 v14, a50
v_accvgpr_read_b32 v15, a51
v_cvt_pk_bf16_f32 v56, v12, v13
v_cvt_pk_bf16_f32 v57, v14, v15
v_accvgpr_read_b32 v28, a60
v_accvgpr_read_b32 v29, a61
v_accvgpr_read_b32 v30, a62
v_accvgpr_read_b32 v31, a63
v_cvt_pk_bf16_f32 v58, v28, v29
v_cvt_pk_bf16_f32 v59, v30, v31
v_accvgpr_read_b32 v12, a52
v_accvgpr_read_b32 v13, a53
v_accvgpr_read_b32 v14, a54
v_accvgpr_read_b32 v15, a55
v_cvt_pk_bf16_f32 v60, v12, v13
v_cvt_pk_bf16_f32 v61, v14, v15
v_accvgpr_read_b32 v28, a64
v_accvgpr_read_b32 v29, a65
v_accvgpr_read_b32 v30, a66
v_accvgpr_read_b32 v31, a67
v_cvt_pk_bf16_f32 v62, v28, v29
v_cvt_pk_bf16_f32 v63, v30, v31
v_accvgpr_read_b32 v12, a56
v_accvgpr_read_b32 v13, a57
v_accvgpr_read_b32 v14, a58
v_accvgpr_read_b32 v15, a59
v_cvt_pk_bf16_f32 v64, v12, v13
v_cvt_pk_bf16_f32 v65, v14, v15
v_accvgpr_read_b32 v28, a68
v_accvgpr_read_b32 v29, a69
v_accvgpr_read_b32 v30, a70
v_accvgpr_read_b32 v31, a71
v_cvt_pk_bf16_f32 v66, v28, v29
v_cvt_pk_bf16_f32 v67, v30, v31
s_add_u32 s51, s54, 10491904
buffer_store_dwordx4 v[56:59], v26, s[20:23], s51 offen offset:0 sc1
buffer_store_dwordx4 v[60:63], v26, s[20:23], s51 offen offset:1024 sc1
buffer_store_dwordx4 v[64:67], v26, s[20:23], s51 offen offset:2048 sc1
v_accvgpr_read_b32 v12, a72
v_accvgpr_read_b32 v13, a73
v_accvgpr_read_b32 v14, a74
v_accvgpr_read_b32 v15, a75
v_cvt_pk_bf16_f32 v68, v12, v13
v_cvt_pk_bf16_f32 v69, v14, v15
v_accvgpr_read_b32 v28, a84
v_accvgpr_read_b32 v29, a85
v_accvgpr_read_b32 v30, a86
v_accvgpr_read_b32 v31, a87
v_cvt_pk_bf16_f32 v70, v28, v29
v_cvt_pk_bf16_f32 v71, v30, v31
v_accvgpr_read_b32 v12, a76
v_accvgpr_read_b32 v13, a77
v_accvgpr_read_b32 v14, a78
v_accvgpr_read_b32 v15, a79
v_cvt_pk_bf16_f32 v72, v12, v13
v_cvt_pk_bf16_f32 v73, v14, v15
v_accvgpr_read_b32 v28, a88
v_accvgpr_read_b32 v29, a89
v_accvgpr_read_b32 v30, a90
v_accvgpr_read_b32 v31, a91
v_cvt_pk_bf16_f32 v74, v28, v29
v_cvt_pk_bf16_f32 v75, v30, v31
v_accvgpr_read_b32 v12, a80
v_accvgpr_read_b32 v13, a81
v_accvgpr_read_b32 v14, a82
v_accvgpr_read_b32 v15, a83
v_cvt_pk_bf16_f32 v76, v12, v13
v_cvt_pk_bf16_f32 v77, v14, v15
v_accvgpr_read_b32 v28, a92
v_accvgpr_read_b32 v29, a93
v_accvgpr_read_b32 v30, a94
v_accvgpr_read_b32 v31, a95
v_cvt_pk_bf16_f32 v78, v28, v29
v_cvt_pk_bf16_f32 v79, v30, v31
s_add_u32 s51, s54, 10494976
buffer_store_dwordx4 v[68:71], v26, s[20:23], s51 offen offset:0 sc1
buffer_store_dwordx4 v[72:75], v26, s[20:23], s51 offen offset:1024 sc1
buffer_store_dwordx4 v[76:79], v26, s[20:23], s51 offen offset:2048 sc1
v_accvgpr_read_b32 v12, a96
v_accvgpr_read_b32 v13, a97
v_accvgpr_read_b32 v14, a98
v_accvgpr_read_b32 v15, a99
v_cvt_pk_bf16_f32 v80, v12, v13
v_cvt_pk_bf16_f32 v81, v14, v15
v_accvgpr_read_b32 v28, a108
v_accvgpr_read_b32 v29, a109
v_accvgpr_read_b32 v30, a110
v_accvgpr_read_b32 v31, a111
v_cvt_pk_bf16_f32 v82, v28, v29
v_cvt_pk_bf16_f32 v83, v30, v31
v_accvgpr_read_b32 v12, a100
v_accvgpr_read_b32 v13, a101
v_accvgpr_read_b32 v14, a102
v_accvgpr_read_b32 v15, a103
v_cvt_pk_bf16_f32 v84, v12, v13
v_cvt_pk_bf16_f32 v85, v14, v15
v_accvgpr_read_b32 v28, a112
v_accvgpr_read_b32 v29, a113
v_accvgpr_read_b32 v30, a114
v_accvgpr_read_b32 v31, a115
v_cvt_pk_bf16_f32 v86, v28, v29
v_cvt_pk_bf16_f32 v87, v30, v31
v_accvgpr_read_b32 v12, a104
v_accvgpr_read_b32 v13, a105
v_accvgpr_read_b32 v14, a106
v_accvgpr_read_b32 v15, a107
v_cvt_pk_bf16_f32 v88, v12, v13
v_cvt_pk_bf16_f32 v89, v14, v15
v_accvgpr_read_b32 v28, a116
v_accvgpr_read_b32 v29, a117
v_accvgpr_read_b32 v30, a118
v_accvgpr_read_b32 v31, a119
v_cvt_pk_bf16_f32 v90, v28, v29
v_cvt_pk_bf16_f32 v91, v30, v31
s_add_u32 s51, s54, 10498048
buffer_store_dwordx4 v[80:83], v26, s[20:23], s51 offen offset:0 sc1
buffer_store_dwordx4 v[84:87], v26, s[20:23], s51 offen offset:1024 sc1
buffer_store_dwordx4 v[88:91], v26, s[20:23], s51 offen offset:2048 sc1
v_accvgpr_read_b32 v12, a120
v_accvgpr_read_b32 v13, a121
v_accvgpr_read_b32 v14, a122
v_accvgpr_read_b32 v15, a123
v_cvt_pk_bf16_f32 v92, v12, v13
v_cvt_pk_bf16_f32 v93, v14, v15
v_accvgpr_read_b32 v28, a132
v_accvgpr_read_b32 v29, a133
v_accvgpr_read_b32 v30, a134
v_accvgpr_read_b32 v31, a135
v_cvt_pk_bf16_f32 v94, v28, v29
v_cvt_pk_bf16_f32 v95, v30, v31
v_accvgpr_read_b32 v12, a124
v_accvgpr_read_b32 v13, a125
v_accvgpr_read_b32 v14, a126
v_accvgpr_read_b32 v15, a127
v_cvt_pk_bf16_f32 v96, v12, v13
v_cvt_pk_bf16_f32 v97, v14, v15
v_accvgpr_read_b32 v28, a136
v_accvgpr_read_b32 v29, a137
v_accvgpr_read_b32 v30, a138
v_accvgpr_read_b32 v31, a139
v_cvt_pk_bf16_f32 v98, v28, v29
v_cvt_pk_bf16_f32 v99, v30, v31
v_accvgpr_read_b32 v12, a128
v_accvgpr_read_b32 v13, a129
v_accvgpr_read_b32 v14, a130
v_accvgpr_read_b32 v15, a131
v_cvt_pk_bf16_f32 v100, v12, v13
v_cvt_pk_bf16_f32 v101, v14, v15
v_accvgpr_read_b32 v28, a140
v_accvgpr_read_b32 v29, a141
v_accvgpr_read_b32 v30, a142
v_accvgpr_read_b32 v31, a143
v_cvt_pk_bf16_f32 v102, v28, v29
v_cvt_pk_bf16_f32 v103, v30, v31
s_add_u32 s51, s54, 10501120
buffer_store_dwordx4 v[92:95], v26, s[20:23], s51 offen offset:0 sc1
buffer_store_dwordx4 v[96:99], v26, s[20:23], s51 offen offset:1024 sc1
buffer_store_dwordx4 v[100:103], v26, s[20:23], s51 offen offset:2048 sc1
s_nop 7
v_accvgpr_read_b32 v12, a144
v_accvgpr_read_b32 v13, a145
v_accvgpr_read_b32 v14, a146
v_accvgpr_read_b32 v15, a147
v_cvt_pk_bf16_f32 v104, v12, v13
v_cvt_pk_bf16_f32 v105, v14, v15
v_accvgpr_read_b32 v28, a156
v_accvgpr_read_b32 v29, a157
v_accvgpr_read_b32 v30, a158
v_accvgpr_read_b32 v31, a159
v_cvt_pk_bf16_f32 v106, v28, v29
v_cvt_pk_bf16_f32 v107, v30, v31
v_accvgpr_read_b32 v12, a148
v_accvgpr_read_b32 v13, a149
v_accvgpr_read_b32 v14, a150
v_accvgpr_read_b32 v15, a151
v_cvt_pk_bf16_f32 v108, v12, v13
v_cvt_pk_bf16_f32 v109, v14, v15
v_accvgpr_read_b32 v28, a160
v_accvgpr_read_b32 v29, a161
v_accvgpr_read_b32 v30, a162
v_accvgpr_read_b32 v31, a163
v_cvt_pk_bf16_f32 v110, v28, v29
v_cvt_pk_bf16_f32 v111, v30, v31
v_accvgpr_read_b32 v12, a152
v_accvgpr_read_b32 v13, a153
v_accvgpr_read_b32 v14, a154
v_accvgpr_read_b32 v15, a155
v_cvt_pk_bf16_f32 v112, v12, v13
v_cvt_pk_bf16_f32 v113, v14, v15
v_accvgpr_read_b32 v28, a164
v_accvgpr_read_b32 v29, a165
v_accvgpr_read_b32 v30, a166
v_accvgpr_read_b32 v31, a167
v_cvt_pk_bf16_f32 v114, v28, v29
v_cvt_pk_bf16_f32 v115, v30, v31
s_add_u32 s51, s54, 10504192
buffer_store_dwordx4 v[104:107], v26, s[20:23], s51 offen offset:0 sc1
buffer_store_dwordx4 v[108:111], v26, s[20:23], s51 offen offset:1024 sc1
buffer_store_dwordx4 v[112:115], v26, s[20:23], s51 offen offset:2048 sc1
v_accvgpr_read_b32 v12, a168
v_accvgpr_read_b32 v13, a169
v_accvgpr_read_b32 v14, a170
v_accvgpr_read_b32 v15, a171
v_cvt_pk_bf16_f32 v116, v12, v13
v_cvt_pk_bf16_f32 v117, v14, v15
v_accvgpr_read_b32 v28, a180
v_accvgpr_read_b32 v29, a181
v_accvgpr_read_b32 v30, a182
v_accvgpr_read_b32 v31, a183
v_cvt_pk_bf16_f32 v118, v28, v29
v_cvt_pk_bf16_f32 v119, v30, v31
v_accvgpr_read_b32 v12, a172
v_accvgpr_read_b32 v13, a173
v_accvgpr_read_b32 v14, a174
v_accvgpr_read_b32 v15, a175
v_cvt_pk_bf16_f32 v120, v12, v13
v_cvt_pk_bf16_f32 v121, v14, v15
v_accvgpr_read_b32 v28, a184
v_accvgpr_read_b32 v29, a185
v_accvgpr_read_b32 v30, a186
v_accvgpr_read_b32 v31, a187
v_cvt_pk_bf16_f32 v122, v28, v29
v_cvt_pk_bf16_f32 v123, v30, v31
v_accvgpr_read_b32 v12, a176
v_accvgpr_read_b32 v13, a177
v_accvgpr_read_b32 v14, a178
v_accvgpr_read_b32 v15, a179
v_cvt_pk_bf16_f32 v124, v12, v13
v_cvt_pk_bf16_f32 v125, v14, v15
v_accvgpr_read_b32 v28, a188
v_accvgpr_read_b32 v29, a189
v_accvgpr_read_b32 v30, a190
v_accvgpr_read_b32 v31, a191
v_cvt_pk_bf16_f32 v126, v28, v29
v_cvt_pk_bf16_f32 v127, v30, v31
s_add_u32 s51, s54, 10507264
buffer_store_dwordx4 v[116:119], v26, s[20:23], s51 offen offset:0 sc1
buffer_store_dwordx4 v[120:123], v26, s[20:23], s51 offen offset:1024 sc1
buffer_store_dwordx4 v[124:127], v26, s[20:23], s51 offen offset:2048 sc1
s_add_u32 s51, s83, 37502976
s_waitcnt vmcnt(0)
s_mov_b64 exec, 1
buffer_store_dwordx2 v[212:213], v217, s[20:23], s51 offen sc1
s_mov_b64 exec, -1
s_branch L_reduce
L_Ytail:
v_mfma_f32_16x16x32_bf16 v[152:155], a[192:195], v[32:35], v[224:227]
ds_read_b128 a[212:215], v6 offset:320
v_cvt_pk_bf16_f32 v181, v14, v15
v_mfma_f32_16x16x32_bf16 v[156:159], a[192:195], v[36:39], v[228:231]
v_exp_f32 v13, v145
v_mfma_f32_16x16x32_bf16 v[160:163], a[192:195], v[40:43], v[232:235]
s_waitcnt lgkmcnt(5)
v_add_f32 v17, v17, v12
v_mov_b32 v214, 153088
L_ng61:
ds_read_b64 v[212:213], v214
s_waitcnt lgkmcnt(0)
v_readfirstlane_b32 s56, v212
v_readfirstlane_b32 s57, v213
s_nop 0
s_cmp_lg_u32 s56, 0
s_cbranch_scc1 L_nk62
s_sleep 1
s_add_u32 s53, s53, 1
s_cmp_lt_u32 s53, 1048576
s_cbranch_scc1 L_ng61
s_endpgm
L_nk62:
v_mfma_f32_16x16x32_bf16 v[152:155], a[196:199], v[44:47], v[152:155]
ds_read_b128 a[216:219], v6 offset:384
v_mfma_f32_16x16x32_bf16 v[156:159], a[196:199], v[48:51], v[156:159]
v_exp_f32 v14, v146
v_mfma_f32_16x16x32_bf16 v[160:163], a[196:199], v[52:55], v[160:163]
s_waitcnt lgkmcnt(5)
v_add_f32 v17, v17, v13
v_mfma_f32_16x16x32_bf16 v[152:155], a[200:203], v[56:59], v[152:155]
ds_read_b128 a[220:223], v6 offset:448
v_cvt_pk_bf16_f32 v182, v12, v13
v_mfma_f32_16x16x32_bf16 v[156:159], a[200:203], v[60:63], v[156:159]
v_exp_f32 v15, v147
s_add_u32 s51, s83, 37502976
buffer_load_dwordx2 v[214:215], v217, s[20:23], s51 offen sc1
v_mfma_f32_16x16x32_bf16 v[160:163], a[200:203], v[64:67], v[160:163]
s_waitcnt lgkmcnt(5)
v_mfma_f32_16x16x32_bf16 v[152:155], a[204:207], v[68:71], v[152:155]
ds_read_b128 a[192:195], v6 offset:512
v_add_f32 v17, v17, v14
v_mfma_f32_16x16x32_bf16 v[156:159], a[204:207], v[72:75], v[156:159]
v_add_f32 v17, v17, v15
v_cvt_pk_bf16_f32 v183, v14, v15
v_mfma_f32_16x16x32_bf16 v[160:163], a[204:207], v[76:79], v[160:163]
s_waitcnt lgkmcnt(5)
v_exp_f32 v12, v136
v_mfma_f32_16x16x32_bf16 v[152:155], a[208:211], v[80:83], v[152:155]
ds_read_b128 a[196:199], v6 offset:576
v_mfma_f32_16x16x32_bf16 v[156:159], a[208:211], v[84:87], v[156:159]
v_exp_f32 v13, v137
v_mfma_f32_16x16x32_bf16 v[160:163], a[208:211], v[88:91], v[160:163]
s_waitcnt lgkmcnt(4)
v_mfma_f32_16x16x32_bf16 v[152:155], a[212:215], v[92:95], v[152:155]
ds_read_b128 a[200:203], v6 offset:640
v_mfma_f32_16x16x32_bf16 v[156:159], a[212:215], v[96:99], v[156:159]
v_exp_f32 v14, v138
v_mfma_f32_16x16x32_bf16 v[160:163], a[212:215], v[100:103], v[160:163]
s_waitcnt lgkmcnt(4)
v_add_f32 v18, v12, v13
v_mfma_f32_16x16x32_bf16 v[152:155], a[216:219], v[104:107], v[152:155]
ds_read_b128 a[204:207], v6 offset:704
v_cvt_pk_bf16_f32 v184, v12, v13
v_mfma_f32_16x16x32_bf16 v[156:159], a[216:219], v[108:111], v[156:159]
v_exp_f32 v15, v139
v_mfma_f32_16x16x32_bf16 v[160:163], a[216:219], v[112:115], v[160:163]
s_waitcnt lgkmcnt(4)
v_add_f32 v18, v18, v14
v_mfma_f32_16x16x32_bf16 v[152:155], a[220:223], v[116:119], v[152:155]
ds_read_b128 a[208:211], v6 offset:768
v_mfma_f32_16x16x32_bf16 v[156:159], a[220:223], v[120:123], v[156:159]
ds_read_b32 v25, v9
v_mfma_f32_16x16x32_bf16 v[160:163], a[220:223], v[124:127], v[160:163]
s_waitcnt lgkmcnt(5)
v_exp_f32 v12, v148
v_mfma_f32_16x16x32_bf16 v[164:167], a[192:195], v[32:35], v[224:227]
ds_read_b128 a[212:215], v6 offset:832
v_add_f32 v18, v18, v15
v_mfma_f32_16x16x32_bf16 v[168:171], a[192:195], v[36:39], v[228:231]
v_cvt_pk_bf16_f32 v185, v14, v15
v_mfma_f32_16x16x32_bf16 v[172:175], a[192:195], v[40:43], v[232:235]
s_waitcnt lgkmcnt(5)
v_exp_f32 v13, v149
v_mfma_f32_16x16x32_bf16 v[164:167], a[196:199], v[44:47], v[164:167]
ds_read_b128 a[216:219], v6 offset:896
v_add_f32 v18, v18, v12
v_mfma_f32_16x16x32_bf16 v[168:171], a[196:199], v[48:51], v[168:171]
v_exp_f32 v14, v150
v_mfma_f32_16x16x32_bf16 v[172:175], a[196:199], v[52:55], v[172:175]
s_waitcnt lgkmcnt(5)
v_add_f32 v18, v18, v13
v_mfma_f32_16x16x32_bf16 v[164:167], a[200:203], v[56:59], v[164:167]
ds_read_b128 a[220:223], v6 offset:960
s_waitcnt lgkmcnt(3)
v_cvt_pk_bf16_f32 v186, v12, v13
v_mfma_f32_16x16x32_bf16 v[168:171], a[200:203], v[60:63], v[168:171]
v_readfirstlane_b32 s39, v25
s_add_u32 s38, s38, 1
v_mfma_f32_16x16x32_bf16 v[172:175], a[200:203], v[64:67], v[172:175]
s_cmp_ge_u32 s39, s38
s_cbranch_scc0 L_poll65
L_ret66:
v_add_u32 v7, s40, v2
v_mfma_f32_16x16x32_bf16 v[164:167], a[204:207], v[68:71], v[164:167]
ds_read_b64_tr_b16 a[192:193], v7 offset:0
v_mfma_f32_16x16x32_bf16 v[168:171], a[204:207], v[72:75], v[168:171]
ds_read_b64_tr_b16 a[194:195], v7 offset:512
v_mfma_f32_16x16x32_bf16 v[172:175], a[204:207], v[76:79], v[172:175]
v_exp_f32 v15, v151
v_mfma_f32_16x16x32_bf16 v[164:167], a[208:211], v[80:83], v[164:167]
ds_read_b64_tr_b16 a[196:197], v7 offset:32
ds_read_b64_tr_b16 a[198:199], v7 offset:544
v_add_f32 v18, v18, v14
v_mfma_f32_16x16x32_bf16 v[168:171], a[208:211], v[84:87], v[168:171]
s_add_u32 s40, s40, 16896
v_add_f32 v18, v18, v15
v_cvt_pk_bf16_f32 v187, v14, v15
v_mfma_f32_16x16x32_bf16 v[172:175], a[208:211], v[88:91], v[172:175]
s_cmp_eq_u32 s40, 152064
s_cselect_b32 s40, 0, s40
s_waitcnt lgkmcnt(6)
v_mfma_f32_16x16x32_bf16 v[164:167], a[212:215], v[92:95], v[164:167]
ds_read_b64_tr_b16 a[200:201], v7 offset:64
v_max3_f32 v28, v16, v17, v18
v_mfma_f32_16x16x32_bf16 v[168:171], a[212:215], v[96:99], v[168:171]
ds_read_b64_tr_b16 a[202:203], v7 offset:576
v_cmp_lt_f32 vcc, s44, v28
s_cbranch_vccnz L_slow63
L_back64:
v_mfma_f32_16x16x32_bf16 v[172:175], a[212:215], v[100:103], v[172:175]
s_waitcnt lgkmcnt(7)
v_add_f32 v19, v19, v16
v_add_f32 v20, v20, v17
v_mfma_f32_16x16x32_bf16 v[164:167], a[216:219], v[104:107], v[164:167]
ds_read_b64_tr_b16 a[204:205], v7 offset:96
v_add_f32 v21, v21, v18
v_mfma_f32_16x16x32_bf16 v[168:171], a[216:219], v[108:111], v[168:171]
ds_read_b64_tr_b16 a[206:207], v7 offset:608
v_mfma_f32_16x16x32_bf16 v[172:175], a[216:219], v[112:115], v[172:175]
s_waitcnt lgkmcnt(8)
v_mfma_f32_16x16x32_bf16 v[164:167], a[220:223], v[116:119], v[164:167]
ds_read_b64_tr_b16 a[208:209], v7 offset:128
ds_read_b64_tr_b16 a[210:211], v7 offset:640
v_mfma_f32_16x16x32_bf16 v[168:171], a[220:223], v[120:123], v[168:171]
v_add_u32 v10, 1, v10
v_mfma_f32_16x16x32_bf16 v[172:175], a[220:223], v[124:127], v[172:175]
ds_write_b32 v8, v10
s_waitcnt lgkmcnt(9)
v_mfma_f32_16x16x32_bf16 a[0:3], a[192:195], v[176:179], a[0:3]
ds_read_b64_tr_b16 a[212:213], v7 offset:160
s_waitcnt vmcnt(0)
v_readfirstlane_b32 s42, v214
v_readfirstlane_b32 s43, v215
s_nop 0
s_cmp_eq_u64 s[42:43], s[56:57]
s_cbranch_scc0 L_op59
L_ok60:
s_mul_i32 s52, s32, -23040
v_mfma_f32_16x16x32_bf16 a[4:7], a[192:195], v[180:183], a[4:7]
ds_read_b64_tr_b16 a[214:215], v7 offset:672
s_add_u32 s52, s52, s54
s_add_u32 s52, s52, 10559488
v_mfma_f32_16x16x32_bf16 a[8:11], a[192:195], v[184:187], a[8:11]
s_waitcnt lgkmcnt(9)
buffer_load_dword v200, v216, s[20:23], s52 offen offset:0 sc1
buffer_load_dword v201, v216, s[20:23], s52 offen offset:256 sc1
v_mfma_f32_16x16x32_bf16 a[12:15], a[196:199], v[176:179], a[12:15]
ds_read_b64_tr_b16 a[216:217], v7 offset:192
buffer_load_dword v202, v216, s[20:23], s52 offen offset:512 sc1
buffer_load_dword v203, v216, s[20:23], s52 offen offset:768 sc1
v_mfma_f32_16x16x32_bf16 a[16:19], a[196:199], v[180:183], a[16:19]
ds_read_b64_tr_b16 a[218:219], v7 offset:704
buffer_load_dword v204, v216, s[20:23], s52 offen offset:1024 sc1
buffer_load_dword v205, v216, s[20:23], s52 offen offset:1280 sc1
v_mfma_f32_16x16x32_bf16 a[20:23], a[196:199], v[184:187], a[20:23]
s_waitcnt lgkmcnt(9)
s_add_u32 s51, s54, 10485760
buffer_load_dwordx4 v[32:35], v26, s[20:23], s51 offen offset:0 sc1
v_mfma_f32_16x16x32_bf16 a[24:27], a[200:203], v[176:179], a[24:27]
ds_read_b64_tr_b16 a[220:221], v7 offset:224
buffer_load_dwordx4 v[36:39], v26, s[20:23], s51 offen offset:1024 sc1
buffer_load_dwordx4 v[40:43], v26, s[20:23], s51 offen offset:2048 sc1
v_mfma_f32_16x16x32_bf16 a[28:31], a[200:203], v[180:183], a[28:31]
ds_read_b64_tr_b16 a[222:223], v7 offset:736
s_add_u32 s51, s54, 10488832
buffer_load_dwordx4 v[44:47], v26, s[20:23], s51 offen offset:0 sc1
v_mfma_f32_16x16x32_bf16 a[32:35], a[200:203], v[184:187], a[32:35]
s_waitcnt lgkmcnt(9)
buffer_load_dwordx4 v[48:51], v26, s[20:23], s51 offen offset:1024 sc1
buffer_load_dwordx4 v[52:55], v26, s[20:23], s51 offen offset:2048 sc1
v_mfma_f32_16x16x32_bf16 a[36:39], a[204:207], v[176:179], a[36:39]
ds_read_b64_tr_b16 a[192:193], v7 offset:256
s_add_u32 s51, s54, 10491904
buffer_load_dwordx4 v[56:59], v26, s[20:23], s51 offen offset:0 sc1
v_mfma_f32_16x16x32_bf16 a[40:43], a[204:207], v[180:183], a[40:43]
ds_read_b64_tr_b16 a[194:195], v7 offset:768
buffer_load_dwordx4 v[60:63], v26, s[20:23], s51 offen offset:1024 sc1
buffer_load_dwordx4 v[64:67], v26, s[20:23], s51 offen offset:2048 sc1
v_mfma_f32_16x16x32_bf16 a[44:47], a[204:207], v[184:187], a[44:47]
s_waitcnt lgkmcnt(9)
s_add_u32 s51, s54, 10494976
buffer_load_dwordx4 v[68:71], v26, s[20:23], s51 offen offset:0 sc1
v_mfma_f32_16x16x32_bf16 a[48:51], a[208:211], v[176:179], a[48:51]
ds_read_b64_tr_b16 a[196:197], v7 offset:288
buffer_load_dwordx4 v[72:75], v26, s[20:23], s51 offen offset:1024 sc1
buffer_load_dwordx4 v[76:79], v26, s[20:23], s51 offen offset:2048 sc1
v_mfma_f32_16x16x32_bf16 a[52:55], a[208:211], v[180:183], a[52:55]
ds_read_b64_tr_b16 a[198:199], v7 offset:800
s_add_u32 s51, s54, 10498048
buffer_load_dwordx4 v[80:83], v26, s[20:23], s51 offen offset:0 sc1
v_mfma_f32_16x16x32_bf16 a[56:59], a[208:211], v[184:187], a[56:59]
s_waitcnt lgkmcnt(8)
buffer_load_dwordx4 v[84:87], v26, s[20:23], s51 offen offset:1024 sc1
buffer_load_dwordx4 v[88:91], v26, s[20:23], s51 offen offset:2048 sc1
v_mfma_f32_16x16x32_bf16 a[60:63], a[212:215], v[176:179], a[60:63]
ds_read_b64_tr_b16 a[200:201], v7 offset:320
s_add_u32 s51, s54, 10501120
buffer_load_dwordx4 v[92:95], v26, s[20:23], s51 offen offset:0 sc1
v_mfma_f32_16x16x32_bf16 a[64:67], a[212:215], v[180:183], a[64:67]
ds_read_b64_tr_b16 a[202:203], v7 offset:832
buffer_load_dwordx4 v[96:99], v26, s[20:23], s51 offen offset:1024 sc1
buffer_load_dwordx4 v[100:103], v26, s[20:23], s51 offen offset:2048 sc1
v_mfma_f32_16x16x32_bf16 a[68:71], a[212:215], v[184:187], a[68:71]
s_waitcnt lgkmcnt(8)
s_add_u32 s51, s54, 10504192
buffer_load_dwordx4 v[104:107], v26, s[20:23], s51 offen offset:0 sc1
v_mfma_f32_16x16x32_bf16 a[72:75], a[216:219], v[176:179], a[72:75]
ds_read_b64_tr_b16 a[204:205], v7 offset:352
buffer_load_dwordx4 v[108:111], v26, s[20:23], s51 offen offset:1024 sc1
buffer_load_dwordx4 v[112:115], v26, s[20:23], s51 offen offset:2048 sc1
v_mfma_f32_16x16x32_bf16 a[76:79], a[216:219], v[180:183], a[76:79]
ds_read_b64_tr_b16 a[206:207], v7 offset:864
s_add_u32 s51, s54, 10507264
buffer_load_dwordx4 v[116:119], v26, s[20:23], s51 offen offset:0 sc1
v_mfma_f32_16x16x32_bf16 a[80:83], a[216:219], v[184:187], a[80:83]
s_waitcnt lgkmcnt(8)
buffer_load_dwordx4 v[120:123], v26, s[20:23], s51 offen offset:1024 sc1
buffer_load_dwordx4 v[124:127], v26, s[20:23], s51 offen offset:2048 sc1
v_mfma_f32_16x16x32_bf16 a[84:87], a[220:223], v[176:179], a[84:87]
ds_read_b64_tr_b16 a[208:209], v7 offset:384
v_exp_f32 v12, v152
v_mfma_f32_16x16x32_bf16 a[88:91], a[220:223], v[180:183], a[88:91]
ds_read_b64_tr_b16 a[210:211], v7 offset:896
v_exp_f32 v13, v153
v_mfma_f32_16x16x32_bf16 a[92:95], a[220:223], v[184:187], a[92:95]
ds_read_b32 v25, v9
s_waitcnt lgkmcnt(9)
v_exp_f32 v14, v154
v_mfma_f32_16x16x32_bf16 a[96:99], a[192:195], v[176:179], a[96:99]
ds_read_b64_tr_b16 a[212:213], v7 offset:416
v_add_f32 v16, v12, v13
v_cvt_pk_bf16_f32 v188, v12, v13
v_mfma_f32_16x16x32_bf16 a[100:103], a[192:195], v[180:183], a[100:103]
ds_read_b64_tr_b16 a[214:215], v7 offset:928
v_exp_f32 v15, v155
v_mfma_f32_16x16x32_bf16 a[104:107], a[192:195], v[184:187], a[104:107]
s_waitcnt lgkmcnt(9)
v_add_f32 v16, v16, v14
v_mfma_f32_16x16x32_bf16 a[108:111], a[196:199], v[176:179], a[108:111]
ds_read_b64_tr_b16 a[216:217], v7 offset:448
v_exp_f32 v12, v164
v_mfma_f32_16x16x32_bf16 a[112:115], a[196:199], v[180:183], a[112:115]
ds_read_b64_tr_b16 a[218:219], v7 offset:960
v_add_f32 v16, v16, v15
v_cvt_pk_bf16_f32 v189, v14, v15
v_mfma_f32_16x16x32_bf16 a[116:119], a[196:199], v[184:187], a[116:119]
s_waitcnt lgkmcnt(9)
v_exp_f32 v13, v165
v_mfma_f32_16x16x32_bf16 a[120:123], a[200:203], v[176:179], a[120:123]
ds_read_b64_tr_b16 a[220:221], v7 offset:480
ds_read_b64_tr_b16 a[222:223], v7 offset:992
s_waitcnt lgkmcnt(6)
v_mfma_f32_16x16x32_bf16 a[124:127], a[200:203], v[180:183], a[124:127]
v_readfirstlane_b32 s39, v25
s_add_u32 s38, s38, 1
v_add_f32 v16, v16, v12
v_mfma_f32_16x16x32_bf16 a[128:131], a[200:203], v[184:187], a[128:131]
s_cmp_ge_u32 s39, s38
s_cbranch_scc0 L_poll69
L_ret70:
v_add_u32 v7, s40, v2
v_mfma_f32_16x16x32_bf16 a[132:135], a[204:207], v[176:179], a[132:135]
ds_read_b64_tr_b16 a[192:193], v7 offset:0
v_exp_f32 v14, v166
v_mfma_f32_16x16x32_bf16 a[136:139], a[204:207], v[180:183], a[136:139]
ds_read_b64_tr_b16 a[194:195], v7 offset:512
v_add_f32 v16, v16, v13
v_cvt_pk_bf16_f32 v190, v12, v13
v_mfma_f32_16x16x32_bf16 a[140:143], a[204:207], v[184:187], a[140:143]
v_exp_f32 v15, v167
v_mfma_f32_16x16x32_bf16 a[144:147], a[208:211], v[176:179], a[144:147]
ds_read_b64_tr_b16 a[196:197], v7 offset:32
ds_read_b64_tr_b16 a[198:199], v7 offset:544
v_add_f32 v16, v16, v14
v_mfma_f32_16x16x32_bf16 a[148:151], a[208:211], v[180:183], a[148:151]
s_add_u32 s40, s40, 16896
v_add_f32 v16, v16, v15
v_cvt_pk_bf16_f32 v191, v14, v15
v_mfma_f32_16x16x32_bf16 a[152:155], a[208:211], v[184:187], a[152:155]
s_cmp_eq_u32 s40, 152064
s_cselect_b32 s40, 0, s40
s_waitcnt lgkmcnt(8)
v_mfma_f32_16x16x32_bf16 a[156:159], a[212:215], v[176:179], a[156:159]
ds_read_b64_tr_b16 a[200:201], v7 offset:64
v_exp_f32 v12, v156
v_mfma_f32_16x16x32_bf16 a[160:163], a[212:215], v[180:183], a[160:163]
ds_read_b64_tr_b16 a[202:203], v7 offset:576
v_exp_f32 v13, v157
v_mfma_f32_16x16x32_bf16 a[164:167], a[212:215], v[184:187], a[164:167]
s_waitcnt lgkmcnt(8)
v_exp_f32 v14, v158
v_mfma_f32_16x16x32_bf16 a[168:171], a[216:219], v[176:179], a[168:171]
ds_read_b64_tr_b16 a[204:205], v7 offset:96
v_add_f32 v17, v12, v13
v_cvt_pk_bf16_f32 v192, v12, v13
v_mfma_f32_16x16x32_bf16 a[172:175], a[216:219], v[180:183], a[172:175]
ds_read_b64_tr_b16 a[206:207], v7 offset:608
v_exp_f32 v15, v159
v_mfma_f32_16x16x32_bf16 a[176:179], a[216:219], v[184:187], a[176:179]
s_waitcnt lgkmcnt(8)
v_add_f32 v17, v17, v14
v_mfma_f32_16x16x32_bf16 a[180:183], a[220:223], v[176:179], a[180:183]
ds_read_b64_tr_b16 a[208:209], v7 offset:128
ds_read_b64_tr_b16 a[210:211], v7 offset:640
v_exp_f32 v12, v168
v_mfma_f32_16x16x32_bf16 a[184:187], a[220:223], v[180:183], a[184:187]
v_add_u32 v10, 1, v10
v_add_f32 v17, v17, v15
v_mfma_f32_16x16x32_bf16 a[188:191], a[220:223], v[184:187], a[188:191]
ds_write_b32 v8, v10
s_waitcnt lgkmcnt(9)
v_cvt_pk_bf16_f32 v193, v14, v15
v_exp_f32 v13, v169
v_add_f32 v17, v17, v12
v_exp_f32 v14, v170
v_add_f32 v17, v17, v13
v_cvt_pk_bf16_f32 v194, v12, v13
v_exp_f32 v15, v171
v_add_f32 v17, v17, v14
v_add_f32 v17, v17, v15
v_cvt_pk_bf16_f32 v195, v14, v15
v_exp_f32 v12, v160
v_exp_f32 v13, v161
v_exp_f32 v14, v162
v_add_f32 v18, v12, v13
v_cvt_pk_bf16_f32 v196, v12, v13
v_exp_f32 v15, v163
v_add_f32 v18, v18, v14
v_exp_f32 v12, v172
v_add_f32 v18, v18, v15
v_cvt_pk_bf16_f32 v197, v14, v15
v_exp_f32 v13, v173
v_add_f32 v18, v18, v12
v_exp_f32 v14, v174
v_add_f32 v18, v18, v13
v_cvt_pk_bf16_f32 v198, v12, v13
v_exp_f32 v15, v175
v_add_f32 v18, v18, v14
v_add_f32 v18, v18, v15
v_cvt_pk_bf16_f32 v199, v14, v15
v_max3_f32 v28, v16, v17, v18
v_cmp_lt_f32 vcc, s44, v28
s_cbranch_vccnz L_slow67
L_back68:
v_add_f32 v19, v19, v16
v_add_f32 v20, v20, v17
v_add_f32 v21, v21, v18
s_nop 1
v_mfma_f32_16x16x32_bf16 a[0:3], a[192:195], v[188:191], a[0:3]
ds_read_b64_tr_b16 a[212:213], v7 offset:160
v_and_b32 v208, 15, v0
v_lshrrev_b32 v209, 4, v0
v_mfma_f32_16x16x32_bf16 a[4:7], a[192:195], v[192:195], a[4:7]
ds_read_b64_tr_b16 a[214:215], v7 offset:672
v_lshlrev_b32 v209, 2, v209
v_sub_u32 v208, v208, v209
v_mfma_f32_16x16x32_bf16 a[8:11], a[192:195], v[196:199], a[8:11]
s_waitcnt lgkmcnt(9)
v_lshlrev_b32 v209, 4, v208
v_mov_b32 v210, 0x3f80
v_mfma_f32_16x16x32_bf16 a[12:15], a[196:199], v[188:191], a[12:15]
ds_read_b64_tr_b16 a[216:217], v7 offset:192
v_mov_b32 v211, 0
v_lshlrev_b64 v[206:207], v209, v[210:211]
v_mfma_f32_16x16x32_bf16 a[16:19], a[196:199], v[192:195], a[16:19]
ds_read_b64_tr_b16 a[218:219], v7 offset:704
v_cmp_gt_u32 s[78:79], 4, v208
s_nop 0
v_mfma_f32_16x16x32_bf16 a[20:23], a[196:199], v[196:199], a[20:23]
s_waitcnt lgkmcnt(9)
v_cndmask_b32 v206, 0, v206, s[78:79]
v_cndmask_b32 v207, 0, v207, s[78:79]
v_mfma_f32_16x16x32_bf16 a[24:27], a[200:203], v[188:191], a[24:27]
ds_read_b64_tr_b16 a[220:221], v7 offset:224
v_mov_b32 v208, 0
v_mov_b32 v209, 0
v_mfma_f32_16x16x32_bf16 a[28:31], a[200:203], v[192:195], a[28:31]
ds_read_b64_tr_b16 a[222:223], v7 offset:736
v_mov_b32 v210, v206
v_mov_b32 v211, v207
v_mfma_f32_16x16x32_bf16 a[32:35], a[200:203], v[196:199], a[32:35]
s_waitcnt lgkmcnt(9)
s_mul_i32 s46, s37, 129024
s_mul_i32 s80, s32, 43008
v_mfma_f32_16x16x32_bf16 a[36:39], a[204:207], v[188:191], a[36:39]
ds_read_b64_tr_b16 a[192:193], v7 offset:256
s_add_u32 s46, s46, s80
s_add_u32 s46, s46, 20971520
v_mfma_f32_16x16x32_bf16 a[40:43], a[204:207], v[192:195], a[40:43]
ds_read_b64_tr_b16 a[194:195], v7 offset:768
v_mfma_f32_16x16x32_bf16 a[44:47], a[204:207], v[196:199], a[44:47]
s_waitcnt lgkmcnt(9)
v_mfma_f32_16x16x32_bf16 a[48:51], a[208:211], v[188:191], a[48:51]
ds_read_b64_tr_b16 a[196:197], v7 offset:288
v_mfma_f32_16x16x32_bf16 a[52:55], a[208:211], v[192:195], a[52:55]
ds_read_b64_tr_b16 a[198:199], v7 offset:800
v_mfma_f32_16x16x32_bf16 a[56:59], a[208:211], v[196:199], a[56:59]
s_waitcnt lgkmcnt(8)
v_mfma_f32_16x16x32_bf16 a[60:63], a[212:215], v[188:191], a[60:63]
ds_read_b64_tr_b16 a[200:201], v7 offset:320
v_mfma_f32_16x16x32_bf16 a[64:67], a[212:215], v[192:195], a[64:67]
ds_read_b64_tr_b16 a[202:203], v7 offset:832
v_mfma_f32_16x16x32_bf16 a[68:71], a[212:215], v[196:199], a[68:71]
s_waitcnt lgkmcnt(8)
v_mfma_f32_16x16x32_bf16 a[72:75], a[216:219], v[188:191], a[72:75]
ds_read_b64_tr_b16 a[204:205], v7 offset:352
v_mfma_f32_16x16x32_bf16 a[76:79], a[216:219], v[192:195], a[76:79]
ds_read_b64_tr_b16 a[206:207], v7 offset:864
v_mfma_f32_16x16x32_bf16 a[80:83], a[216:219], v[196:199], a[80:83]
s_waitcnt lgkmcnt(8)
v_mfma_f32_16x16x32_bf16 a[84:87], a[220:223], v[188:191], a[84:87]
ds_read_b64_tr_b16 a[208:209], v7 offset:384
v_mfma_f32_16x16x32_bf16 a[88:91], a[220:223], v[192:195], a[88:91]
ds_read_b64_tr_b16 a[210:211], v7 offset:896
v_mfma_f32_16x16x32_bf16 a[92:95], a[220:223], v[196:199], a[92:95]
s_waitcnt lgkmcnt(8)
v_mfma_f32_16x16x32_bf16 a[96:99], a[192:195], v[188:191], a[96:99]
ds_read_b64_tr_b16 a[212:213], v7 offset:416
v_mfma_f32_16x16x32_bf16 a[100:103], a[192:195], v[192:195], a[100:103]
ds_read_b64_tr_b16 a[214:215], v7 offset:928
v_mfma_f32_16x16x32_bf16 a[104:107], a[192:195], v[196:199], a[104:107]
s_waitcnt lgkmcnt(8)
v_mfma_f32_16x16x32_bf16 a[108:111], a[196:199], v[188:191], a[108:111]
ds_read_b64_tr_b16 a[216:217], v7 offset:448
v_mfma_f32_16x16x32_bf16 a[112:115], a[196:199], v[192:195], a[112:115]
ds_read_b64_tr_b16 a[218:219], v7 offset:960
v_mfma_f32_16x16x32_bf16 a[116:119], a[196:199], v[196:199], a[116:119]
s_waitcnt lgkmcnt(8)
v_mfma_f32_16x16x32_bf16 a[120:123], a[200:203], v[188:191], a[120:123]
ds_read_b64_tr_b16 a[220:221], v7 offset:480
v_mfma_f32_16x16x32_bf16 a[124:127], a[200:203], v[192:195], a[124:127]
ds_read_b64_tr_b16 a[222:223], v7 offset:992
v_mfma_f32_16x16x32_bf16 a[128:131], a[200:203], v[196:199], a[128:131]
s_waitcnt lgkmcnt(8)
v_mfma_f32_16x16x32_bf16 a[132:135], a[204:207], v[188:191], a[132:135]
v_mfma_f32_16x16x32_bf16 a[136:139], a[204:207], v[192:195], a[136:139]
v_mfma_f32_16x16x32_bf16 a[140:143], a[204:207], v[196:199], a[140:143]
s_waitcnt lgkmcnt(6)
v_mfma_f32_16x16x32_bf16 a[144:147], a[208:211], v[188:191], a[144:147]
s_waitcnt vmcnt(24)
v_cmp_neq_f32 vcc, v200, v224
v_cmp_neq_f32 s[78:79], v202, v228
v_mfma_f32_16x16x32_bf16 a[148:151], a[208:211], v[192:195], a[148:151]
s_or_b64 vcc, vcc, s[78:79]
v_cmp_neq_f32 s[78:79], v204, v232
s_or_b64 s[78:79], vcc, s[78:79]
v_mfma_f32_16x16x32_bf16 a[152:155], a[208:211], v[196:199], a[152:155]
s_waitcnt lgkmcnt(4)
v_mfma_f32_16x16x32_bf16 a[156:159], a[212:215], v[188:191], a[156:159]
v_mfma_f32_16x16x32_bf16 a[160:163], a[212:215], v[192:195], a[160:163]
v_mfma_f32_16x16x32_bf16 a[164:167], a[212:215], v[196:199], a[164:167]
s_waitcnt lgkmcnt(2)
v_mfma_f32_16x16x32_bf16 a[168:171], a[216:219], v[188:191], a[168:171]
v_mfma_f32_16x16x32_bf16 a[172:175], a[216:219], v[192:195], a[172:175]
v_mfma_f32_16x16x32_bf16 a[176:179], a[216:219], v[196:199], a[176:179]
s_waitcnt lgkmcnt(0)
v_mfma_f32_16x16x32_bf16 a[180:183], a[220:223], v[188:191], a[180:183]
v_add_u32 v10, 1, v10
v_mfma_f32_16x16x32_bf16 a[184:187], a[220:223], v[192:195], a[184:187]
ds_write_b32 v8, v10
v_mfma_f32_16x16x32_bf16 a[188:191], a[220:223], v[196:199], a[188:191]
s_cmp_lg_u64 s[78:79], 0
s_cbranch_scc1 L_merge71
L_mback72:
s_waitcnt vmcnt(21)
s_nop 1
v_mfma_f32_16x16x32_bf16 a[0:3], v[206:209], v[32:35], a[0:3]
v_add_f32 v19, v19, v201
v_mov_b32 v22, v19
s_nop 0
v_mfma_f32_16x16x32_bf16 a[4:7], v[206:209], v[36:39], a[4:7]
v_permlane32_swap_b32 v22, v19
s_nop 0
v_mfma_f32_16x16x32_bf16 a[8:11], v[206:209], v[40:43], a[8:11]
v_add_f32 v19, v19, v22
v_mov_b32 v22, v19
s_nop 0
v_mfma_f32_16x16x32_bf16 a[12:15], v[208:211], v[32:35], a[12:15]
v_permlane16_swap_b32 v22, v19
s_nop 0
v_mfma_f32_16x16x32_bf16 a[16:19], v[208:211], v[36:39], a[16:19]
v_add_f32 v19, v19, v22
v_mfma_f32_16x16x32_bf16 a[20:23], v[208:211], v[40:43], a[20:23]
v_rcp_f32 v19, v19
s_waitcnt vmcnt(18)
v_mfma_f32_16x16x32_bf16 a[24:27], v[206:209], v[44:47], a[24:27]
v_add_f32 v20, v20, v203
v_mov_b32 v22, v20
s_nop 0
v_mfma_f32_16x16x32_bf16 a[28:31], v[206:209], v[48:51], a[28:31]
v_permlane32_swap_b32 v22, v20
s_nop 0
v_mfma_f32_16x16x32_bf16 a[32:35], v[206:209], v[52:55], a[32:35]
v_add_f32 v20, v20, v22
v_mov_b32 v22, v20
s_nop 0
v_mfma_f32_16x16x32_bf16 a[36:39], v[208:211], v[44:47], a[36:39]
v_permlane16_swap_b32 v22, v20
s_nop 0
v_mfma_f32_16x16x32_bf16 a[40:43], v[208:211], v[48:51], a[40:43]
v_add_f32 v20, v20, v22
v_mfma_f32_16x16x32_bf16 a[44:47], v[208:211], v[52:55], a[44:47]
v_rcp_f32 v20, v20
s_waitcnt vmcnt(15)
v_mfma_f32_16x16x32_bf16 a[48:51], v[206:209], v[56:59], a[48:51]
v_add_f32 v21, v21, v205
v_mov_b32 v22, v21
s_nop 0
v_mfma_f32_16x16x32_bf16 a[52:55], v[206:209], v[60:63], a[52:55]
v_permlane32_swap_b32 v22, v21
s_nop 0
v_mfma_f32_16x16x32_bf16 a[56:59], v[206:209], v[64:67], a[56:59]
v_add_f32 v21, v21, v22
v_mov_b32 v22, v21
s_nop 0
v_mfma_f32_16x16x32_bf16 a[60:63], v[208:211], v[56:59], a[60:63]
v_permlane16_swap_b32 v22, v21
s_nop 0
v_mfma_f32_16x16x32_bf16 a[64:67], v[208:211], v[60:63], a[64:67]
v_add_f32 v21, v21, v22
v_mfma_f32_16x16x32_bf16 a[68:71], v[208:211], v[64:67], a[68:71]
v_rcp_f32 v21, v21
s_waitcnt vmcnt(12)
v_mfma_f32_16x16x32_bf16 a[72:75], v[206:209], v[68:71], a[72:75]
v_mov_b32 v224, s56
v_mov_b32 v225, s57
v_mfma_f32_16x16x32_bf16 a[76:79], v[206:209], v[72:75], a[76:79]
v_mov_b32 v226, 0
s_mul_i32 s83, s33, 2688
s_lshl_b32 s43, s32, 7
v_mfma_f32_16x16x32_bf16 a[80:83], v[206:209], v[76:79], a[80:83]
s_add_u32 s83, s83, s43
s_lshl_b32 s43, s34, 3
s_add_u32 s83, s83, s43
v_mfma_f32_16x16x32_bf16 a[84:87], v[208:211], v[68:71], a[84:87]
ds_read_b32 v25, v9
s_add_u32 s83, s83, 37519360
v_accvgpr_read_b32 v12, a0
v_mfma_f32_16x16x32_bf16 a[88:91], v[208:211], v[72:75], a[88:91]
v_accvgpr_read_b32 v13, a1
v_accvgpr_read_b32 v14, a2
v_mfma_f32_16x16x32_bf16 a[92:95], v[208:211], v[76:79], a[92:95]
v_accvgpr_read_b32 v15, a3
v_cvt_pk_bf16_f32 v32, v12, v13
s_waitcnt vmcnt(9)
v_mfma_f32_16x16x32_bf16 a[96:99], v[206:209], v[80:83], a[96:99]
v_cvt_pk_bf16_f32 v33, v14, v15
v_accvgpr_read_b32 v28, a12
v_mfma_f32_16x16x32_bf16 a[100:103], v[206:209], v[84:87], a[100:103]
v_accvgpr_read_b32 v29, a13
v_accvgpr_read_b32 v30, a14
v_mfma_f32_16x16x32_bf16 a[104:107], v[206:209], v[88:91], a[104:107]
v_accvgpr_read_b32 v31, a15
v_cvt_pk_bf16_f32 v34, v28, v29
v_mfma_f32_16x16x32_bf16 a[108:111], v[208:211], v[80:83], a[108:111]
v_cvt_pk_bf16_f32 v35, v30, v31
v_accvgpr_read_b32 v12, a4
v_mfma_f32_16x16x32_bf16 a[112:115], v[208:211], v[84:87], a[112:115]
v_accvgpr_read_b32 v13, a5
v_accvgpr_read_b32 v14, a6
v_mfma_f32_16x16x32_bf16 a[116:119], v[208:211], v[88:91], a[116:119]
v_accvgpr_read_b32 v15, a7
v_cvt_pk_bf16_f32 v36, v12, v13
s_waitcnt vmcnt(6)
v_mfma_f32_16x16x32_bf16 a[120:123], v[206:209], v[92:95], a[120:123]
s_waitcnt lgkmcnt(0)
v_readfirstlane_b32 s39, v25
v_cvt_pk_bf16_f32 v37, v14, v15
v_mfma_f32_16x16x32_bf16 a[124:127], v[206:209], v[96:99], a[124:127]
s_add_u32 s38, s38, 1
s_cmp_ge_u32 s39, s38
s_cbranch_scc0 L_poll73
L_ret74:
v_mfma_f32_16x16x32_bf16 a[128:131], v[206:209], v[100:103], a[128:131]
v_add_u32 v6, s40, v4
v_add_u32 v27, s40, v5
v_mfma_f32_16x16x32_bf16 a[132:135], v[208:211], v[92:95], a[132:135]
ds_read_b64_tr_b16 a[192:193], v6 offset:0
v_accvgpr_read_b32 v28, a16
v_accvgpr_read_b32 v29, a17
v_mfma_f32_16x16x32_bf16 a[136:139], v[208:211], v[96:99], a[136:139]
ds_read_b64_tr_b16 a[194:195], v6 offset:2048
v_accvgpr_read_b32 v30, a18
v_accvgpr_read_b32 v31, a19
v_mfma_f32_16x16x32_bf16 a[140:143], v[208:211], v[100:103], a[140:143]
v_cvt_pk_bf16_f32 v38, v28, v29
v_cvt_pk_bf16_f32 v39, v30, v31
s_waitcnt vmcnt(3)
v_mfma_f32_16x16x32_bf16 a[144:147], v[206:209], v[104:107], a[144:147]
ds_read_b64_tr_b16 a[196:197], v27 offset:0
ds_read_b64_tr_b16 a[198:199], v27 offset:2048
v_accvgpr_read_b32 v12, a8
v_mfma_f32_16x16x32_bf16 a[148:151], v[206:209], v[108:111], a[148:151]
s_add_u32 s40, s40, 16896
v_accvgpr_read_b32 v13, a9
v_accvgpr_read_b32 v14, a10
v_mfma_f32_16x16x32_bf16 a[152:155], v[206:209], v[112:115], a[152:155]
s_cmp_eq_u32 s40, 152064
s_cselect_b32 s40, 0, s40
v_accvgpr_read_b32 v15, a11
v_mfma_f32_16x16x32_bf16 a[156:159], v[208:211], v[104:107], a[156:159]
ds_read_b64_tr_b16 a[200:201], v6 offset:512
v_cvt_pk_bf16_f32 v40, v12, v13
v_cvt_pk_bf16_f32 v41, v14, v15
v_mfma_f32_16x16x32_bf16 a[160:163], v[208:211], v[108:111], a[160:163]
ds_read_b64_tr_b16 a[202:203], v6 offset:2560
v_accvgpr_read_b32 v28, a20
v_accvgpr_read_b32 v29, a21
v_mfma_f32_16x16x32_bf16 a[164:167], v[208:211], v[112:115], a[164:167]
v_accvgpr_read_b32 v30, a22
v_accvgpr_read_b32 v31, a23
s_waitcnt vmcnt(0)
v_mfma_f32_16x16x32_bf16 a[168:171], v[206:209], v[116:119], a[168:171]
ds_read_b64_tr_b16 a[204:205], v27 offset:512
v_cvt_pk_bf16_f32 v42, v28, v29
v_cvt_pk_bf16_f32 v43, v30, v31
v_mfma_f32_16x16x32_bf16 a[172:175], v[206:209], v[120:123], a[172:175]
ds_read_b64_tr_b16 a[206:207], v27 offset:2560
v_accvgpr_read_b32 v12, a24
v_accvgpr_read_b32 v13, a25
v_mfma_f32_16x16x32_bf16 a[176:179], v[206:209], v[124:127], a[176:179]
v_accvgpr_read_b32 v14, a26
v_accvgpr_read_b32 v15, a27
v_mfma_f32_16x16x32_bf16 a[180:183], v[208:211], v[116:119], a[180:183]
ds_read_b64_tr_b16 a[208:209], v6 offset:4096
v_cvt_pk_bf16_f32 v44, v12, v13
v_cvt_pk_bf16_f32 v45, v14, v15
v_mfma_f32_16x16x32_bf16 a[184:187], v[208:211], v[120:123], a[184:187]
ds_read_b64_tr_b16 a[210:211], v6 offset:6144
v_accvgpr_read_b32 v28, a36
v_accvgpr_read_b32 v29, a37
v_mfma_f32_16x16x32_bf16 a[188:191], v[208:211], v[124:127], a[188:191]
s_waitcnt lgkmcnt(8)
v_accvgpr_read_b32 v30, a38
v_accvgpr_read_b32 v31, a39
v_mfma_f32_16x16x32_bf16 v[128:131], a[192:195], v[32:35], 0
ds_read_b64_tr_b16 a[212:213], v27 offset:4096
v_cvt_pk_bf16_f32 v46, v28, v29
v_cvt_pk_bf16_f32 v47, v30, v31
v_mfma_f32_16x16x32_bf16 v[132:135], a[192:195], v[36:39], 0
ds_read_b64_tr_b16 a[214:215], v27 offset:6144
v_accvgpr_read_b32 v12, a28
v_accvgpr_read_b32 v13, a29
v_mfma_f32_16x16x32_bf16 v[136:139], a[192:195], v[40:43], 0
s_waitcnt lgkmcnt(8)
v_accvgpr_read_b32 v14, a30
v_accvgpr_read_b32 v15, a31
v_mfma_f32_16x16x32_bf16 v[140:143], a[196:199], v[32:35], 0
ds_read_b64_tr_b16 a[216:217], v6 offset:4608
v_cvt_pk_bf16_f32 v48, v12, v13
v_cvt_pk_bf16_f32 v49, v14, v15
v_mfma_f32_16x16x32_bf16 v[144:147], a[196:199], v[36:39], 0
ds_read_b64_tr_b16 a[218:219], v6 offset:6656
v_accvgpr_read_b32 v28, a40
v_accvgpr_read_b32 v29, a41
v_mfma_f32_16x16x32_bf16 v[148:151], a[196:199], v[40:43], 0
s_waitcnt lgkmcnt(8)
v_accvgpr_read_b32 v30, a42
v_accvgpr_read_b32 v31, a43
v_mfma_f32_16x16x32_bf16 v[152:155], a[200:203], v[32:35], 0
ds_read_b64_tr_b16 a[220:221], v27 offset:4608
v_cvt_pk_bf16_f32 v50, v28, v29
v_cvt_pk_bf16_f32 v51, v30, v31
v_mfma_f32_16x16x32_bf16 v[156:159], a[200:203], v[36:39], 0
ds_read_b64_tr_b16 a[222:223], v27 offset:6656
v_accvgpr_read_b32 v12, a32
v_accvgpr_read_b32 v13, a33
v_mfma_f32_16x16x32_bf16 v[160:163], a[200:203], v[40:43], 0
s_waitcnt lgkmcnt(8)
v_accvgpr_read_b32 v14, a34
v_accvgpr_read_b32 v15, a35
v_mfma_f32_16x16x32_bf16 v[164:167], a[204:207], v[32:35], 0
ds_read_b64_tr_b16 a[192:193], v6 offset:8192
v_cvt_pk_bf16_f32 v52, v12, v13
v_cvt_pk_bf16_f32 v53, v14, v15
v_mfma_f32_16x16x32_bf16 v[168:171], a[204:207], v[36:39], 0
ds_read_b64_tr_b16 a[194:195], v6 offset:10240
v_accvgpr_read_b32 v28, a44
v_accvgpr_read_b32 v29, a45
v_mfma_f32_16x16x32_bf16 v[172:175], a[204:207], v[40:43], 0
s_waitcnt lgkmcnt(8)
v_accvgpr_read_b32 v30, a46
v_accvgpr_read_b32 v31, a47
v_cvt_pk_bf16_f32 v54, v28, v29
v_cvt_pk_bf16_f32 v55, v30, v31
s_nop 1
v_mfma_f32_16x16x32_bf16 v[128:131], a[208:211], v[44:47], v[128:131]
ds_read_b64_tr_b16 a[196:197], v27 offset:8192
v_accvgpr_read_b32 v12, a48
v_accvgpr_read_b32 v13, a49
v_mfma_f32_16x16x32_bf16 v[132:135], a[208:211], v[48:51], v[132:135]
ds_read_b64_tr_b16 a[198:199], v27 offset:10240
v_accvgpr_read_b32 v14, a50
v_accvgpr_read_b32 v15, a51
v_mfma_f32_16x16x32_bf16 v[136:139], a[208:211], v[52:55], v[136:139]
s_waitcnt lgkmcnt(8)
v_cvt_pk_bf16_f32 v56, v12, v13
v_cvt_pk_bf16_f32 v57, v14, v15
v_mfma_f32_16x16x32_bf16 v[140:143], a[212:215], v[44:47], v[140:143]
ds_read_b64_tr_b16 a[200:201], v6 offset:8704
v_accvgpr_read_b32 v28, a60
v_accvgpr_read_b32 v29, a61
v_mfma_f32_16x16x32_bf16 v[144:147], a[212:215], v[48:51], v[144:147]
ds_read_b64_tr_b16 a[202:203], v6 offset:10752
v_accvgpr_read_b32 v30, a62
v_accvgpr_read_b32 v31, a63
v_mfma_f32_16x16x32_bf16 v[148:151], a[212:215], v[52:55], v[148:151]
s_waitcnt lgkmcnt(8)
v_cvt_pk_bf16_f32 v58, v28, v29
v_cvt_pk_bf16_f32 v59, v30, v31
v_mfma_f32_16x16x32_bf16 v[152:155], a[216:219], v[44:47], v[152:155]
ds_read_b64_tr_b16 a[204:205], v27 offset:8704
v_accvgpr_read_b32 v12, a52
v_accvgpr_read_b32 v13, a53
v_mfma_f32_16x16x32_bf16 v[156:159], a[216:219], v[48:51], v[156:159]
ds_read_b64_tr_b16 a[206:207], v27 offset:10752
v_accvgpr_read_b32 v14, a54
v_accvgpr_read_b32 v15, a55
v_mfma_f32_16x16x32_bf16 v[160:163], a[216:219], v[52:55], v[160:163]
s_waitcnt lgkmcnt(8)
v_cvt_pk_bf16_f32 v60, v12, v13
v_cvt_pk_bf16_f32 v61, v14, v15
v_mfma_f32_16x16x32_bf16 v[164:167], a[220:223], v[44:47], v[164:167]
ds_read_b64_tr_b16 a[208:209], v6 offset:12288
v_accvgpr_read_b32 v28, a64
v_accvgpr_read_b32 v29, a65
v_mfma_f32_16x16x32_bf16 v[168:171], a[220:223], v[48:51], v[168:171]
ds_read_b64_tr_b16 a[210:211], v6 offset:14336
v_accvgpr_read_b32 v30, a66
v_accvgpr_read_b32 v31, a67
v_mfma_f32_16x16x32_bf16 v[172:175], a[220:223], v[52:55], v[172:175]
ds_read_b32 v25, v9
s_waitcnt lgkmcnt(9)
v_cvt_pk_bf16_f32 v62, v28, v29
v_cvt_pk_bf16_f32 v63, v30, v31
v_accvgpr_read_b32 v12, a56
v_accvgpr_read_b32 v13, a57
v_accvgpr_read_b32 v14, a58
v_accvgpr_read_b32 v15, a59
v_cvt_pk_bf16_f32 v64, v12, v13
v_cvt_pk_bf16_f32 v65, v14, v15
v_accvgpr_read_b32 v28, a68
v_accvgpr_read_b32 v29, a69
v_accvgpr_read_b32 v30, a70
v_accvgpr_read_b32 v31, a71
v_cvt_pk_bf16_f32 v66, v28, v29
v_cvt_pk_bf16_f32 v67, v30, v31
s_nop 1
v_mfma_f32_16x16x32_bf16 v[128:131], a[192:195], v[56:59], v[128:131]
ds_read_b64_tr_b16 a[212:213], v27 offset:12288
v_accvgpr_read_b32 v12, a72
v_accvgpr_read_b32 v13, a73
v_mfma_f32_16x16x32_bf16 v[132:135], a[192:195], v[60:63], v[132:135]
ds_read_b64_tr_b16 a[214:215], v27 offset:14336
v_accvgpr_read_b32 v14, a74
v_accvgpr_read_b32 v15, a75
v_mfma_f32_16x16x32_bf16 v[136:139], a[192:195], v[64:67], v[136:139]
s_waitcnt lgkmcnt(9)
v_cvt_pk_bf16_f32 v68, v12, v13
v_cvt_pk_bf16_f32 v69, v14, v15
v_mfma_f32_16x16x32_bf16 v[140:143], a[196:199], v[56:59], v[140:143]
ds_read_b64_tr_b16 a[216:217], v6 offset:12800
v_accvgpr_read_b32 v28, a84
v_accvgpr_read_b32 v29, a85
v_mfma_f32_16x16x32_bf16 v[144:147], a[196:199], v[60:63], v[144:147]
ds_read_b64_tr_b16 a[218:219], v6 offset:14848
v_accvgpr_read_b32 v30, a86
v_accvgpr_read_b32 v31, a87
v_mfma_f32_16x16x32_bf16 v[148:151], a[196:199], v[64:67], v[148:151]
s_waitcnt lgkmcnt(9)
v_cvt_pk_bf16_f32 v70, v28, v29
v_cvt_pk_bf16_f32 v71, v30, v31
v_mfma_f32_16x16x32_bf16 v[152:155], a[200:203], v[56:59], v[152:155]
ds_read_b64_tr_b16 a[220:221], v27 offset:12800
ds_read_b64_tr_b16 a[222:223], v27 offset:14848
s_waitcnt lgkmcnt(6)
v_mfma_f32_16x16x32_bf16 v[156:159], a[200:203], v[60:63], v[156:159]
v_readfirstlane_b32 s39, v25
s_add_u32 s38, s38, 1
s_cmp_ge_u32 s39, s38
s_cbranch_scc0 L_poll75
L_ret76:
v_mfma_f32_16x16x32_bf16 v[160:163], a[200:203], v[64:67], v[160:163]
v_add_u32 v6, s40, v4
v_add_u32 v27, s40, v5
v_mfma_f32_16x16x32_bf16 v[164:167], a[204:207], v[56:59], v[164:167]
ds_read_b64_tr_b16 a[192:193], v6 offset:0
v_accvgpr_read_b32 v12, a76
v_accvgpr_read_b32 v13, a77
v_mfma_f32_16x16x32_bf16 v[168:171], a[204:207], v[60:63], v[168:171]
ds_read_b64_tr_b16 a[194:195], v6 offset:2048
v_accvgpr_read_b32 v14, a78
v_accvgpr_read_b32 v15, a79
v_mfma_f32_16x16x32_bf16 v[172:175], a[204:207], v[64:67], v[172:175]
v_cvt_pk_bf16_f32 v72, v12, v13
v_cvt_pk_bf16_f32 v73, v14, v15
v_accvgpr_read_b32 v28, a88
v_accvgpr_read_b32 v29, a89
v_accvgpr_read_b32 v30, a90
v_accvgpr_read_b32 v31, a91
v_cvt_pk_bf16_f32 v74, v28, v29
v_cvt_pk_bf16_f32 v75, v30, v31
v_accvgpr_read_b32 v12, a80
v_accvgpr_read_b32 v13, a81
v_accvgpr_read_b32 v14, a82
v_accvgpr_read_b32 v15, a83
v_cvt_pk_bf16_f32 v76, v12, v13
v_cvt_pk_bf16_f32 v77, v14, v15
v_accvgpr_read_b32 v28, a92
v_accvgpr_read_b32 v29, a93
v_accvgpr_read_b32 v30, a94
v_accvgpr_read_b32 v31, a95
v_cvt_pk_bf16_f32 v78, v28, v29
v_cvt_pk_bf16_f32 v79, v30, v31
s_nop 1
v_mfma_f32_16x16x32_bf16 v[128:131], a[208:211], v[68:71], v[128:131]
ds_read_b64_tr_b16 a[196:197], v27 offset:0
ds_read_b64_tr_b16 a[198:199], v27 offset:2048
v_accvgpr_read_b32 v12, a96
v_mfma_f32_16x16x32_bf16 v[132:135], a[208:211], v[72:75], v[132:135]
s_add_u32 s40, s40, 16896
v_accvgpr_read_b32 v13, a97
v_accvgpr_read_b32 v14, a98
v_mfma_f32_16x16x32_bf16 v[136:139], a[208:211], v[76:79], v[136:139]
s_cmp_eq_u32 s40, 152064
s_cselect_b32 s40, 0, s40
s_waitcnt lgkmcnt(8)
v_mfma_f32_16x16x32_bf16 v[140:143], a[212:215], v[68:71], v[140:143]
ds_read_b64_tr_b16 a[200:201], v6 offset:512
v_accvgpr_read_b32 v15, a99
v_cvt_pk_bf16_f32 v80, v12, v13
v_mfma_f32_16x16x32_bf16 v[144:147], a[212:215], v[72:75], v[144:147]
ds_read_b64_tr_b16 a[202:203], v6 offset:2560
v_cvt_pk_bf16_f32 v81, v14, v15
v_accvgpr_read_b32 v28, a108
v_mfma_f32_16x16x32_bf16 v[148:151], a[212:215], v[76:79], v[148:151]
s_waitcnt lgkmcnt(8)
v_accvgpr_read_b32 v29, a109
v_accvgpr_read_b32 v30, a110
v_mfma_f32_16x16x32_bf16 v[152:155], a[216:219], v[68:71], v[152:155]
ds_read_b64_tr_b16 a[204:205], v27 offset:512
v_accvgpr_read_b32 v31, a111
v_cvt_pk_bf16_f32 v82, v28, v29
v_mfma_f32_16x16x32_bf16 v[156:159], a[216:219], v[72:75], v[156:159]
ds_read_b64_tr_b16 a[206:207], v27 offset:2560
v_cvt_pk_bf16_f32 v83, v30, v31
v_accvgpr_read_b32 v12, a100
v_mfma_f32_16x16x32_bf16 v[160:163], a[216:219], v[76:79], v[160:163]
s_waitcnt lgkmcnt(8)
v_accvgpr_read_b32 v13, a101
v_accvgpr_read_b32 v14, a102
v_mfma_f32_16x16x32_bf16 v[164:167], a[220:223], v[68:71], v[164:167]
ds_read_b64_tr_b16 a[208:209], v6 offset:4096
ds_read_b64_tr_b16 a[210:211], v6 offset:6144
v_accvgpr_read_b32 v15, a103
v_mfma_f32_16x16x32_bf16 v[168:171], a[220:223], v[72:75], v[168:171]
v_add_u32 v10, 1, v10
v_cvt_pk_bf16_f32 v84, v12, v13
v_mfma_f32_16x16x32_bf16 v[172:175], a[220:223], v[76:79], v[172:175]
ds_write_b32 v8, v10
s_waitcnt lgkmcnt(9)
v_cvt_pk_bf16_f32 v85, v14, v15
v_accvgpr_read_b32 v28, a112
v_accvgpr_read_b32 v29, a113
v_accvgpr_read_b32 v30, a114
v_accvgpr_read_b32 v31, a115
v_cvt_pk_bf16_f32 v86, v28, v29
v_cvt_pk_bf16_f32 v87, v30, v31
v_accvgpr_read_b32 v12, a104
v_accvgpr_read_b32 v13, a105
v_accvgpr_read_b32 v14, a106
v_accvgpr_read_b32 v15, a107
v_cvt_pk_bf16_f32 v88, v12, v13
v_cvt_pk_bf16_f32 v89, v14, v15
v_accvgpr_read_b32 v28, a116
v_accvgpr_read_b32 v29, a117
v_accvgpr_read_b32 v30, a118
v_accvgpr_read_b32 v31, a119
v_cvt_pk_bf16_f32 v90, v28, v29
v_cvt_pk_bf16_f32 v91, v30, v31
s_nop 1
v_mfma_f32_16x16x32_bf16 v[128:131], a[192:195], v[80:83], v[128:131]
ds_read_b64_tr_b16 a[212:213], v27 offset:4096
v_accvgpr_read_b32 v12, a120
v_accvgpr_read_b32 v13, a121
v_mfma_f32_16x16x32_bf16 v[132:135], a[192:195], v[84:87], v[132:135]
ds_read_b64_tr_b16 a[214:215], v27 offset:6144
v_accvgpr_read_b32 v14, a122
v_accvgpr_read_b32 v15, a123
v_mfma_f32_16x16x32_bf16 v[136:139], a[192:195], v[88:91], v[136:139]
s_waitcnt lgkmcnt(9)
v_cvt_pk_bf16_f32 v92, v12, v13
v_cvt_pk_bf16_f32 v93, v14, v15
v_mfma_f32_16x16x32_bf16 v[140:143], a[196:199], v[80:83], v[140:143]
ds_read_b64_tr_b16 a[216:217], v6 offset:4608
v_accvgpr_read_b32 v28, a132
v_accvgpr_read_b32 v29, a133
v_mfma_f32_16x16x32_bf16 v[144:147], a[196:199], v[84:87], v[144:147]
ds_read_b64_tr_b16 a[218:219], v6 offset:6656
v_accvgpr_read_b32 v30, a134
v_accvgpr_read_b32 v31, a135
v_mfma_f32_16x16x32_bf16 v[148:151], a[196:199], v[88:91], v[148:151]
s_waitcnt lgkmcnt(9)
v_cvt_pk_bf16_f32 v94, v28, v29
v_cvt_pk_bf16_f32 v95, v30, v31
v_mfma_f32_16x16x32_bf16 v[152:155], a[200:203], v[80:83], v[152:155]
ds_read_b64_tr_b16 a[220:221], v27 offset:4608
v_accvgpr_read_b32 v12, a124
v_accvgpr_read_b32 v13, a125
v_mfma_f32_16x16x32_bf16 v[156:159], a[200:203], v[84:87], v[156:159]
ds_read_b64_tr_b16 a[222:223], v27 offset:6656
v_accvgpr_read_b32 v14, a126
v_accvgpr_read_b32 v15, a127
v_mfma_f32_16x16x32_bf16 v[160:163], a[200:203], v[88:91], v[160:163]
s_waitcnt lgkmcnt(9)
v_cvt_pk_bf16_f32 v96, v12, v13
v_cvt_pk_bf16_f32 v97, v14, v15
v_mfma_f32_16x16x32_bf16 v[164:167], a[204:207], v[80:83], v[164:167]
ds_read_b64_tr_b16 a[192:193], v6 offset:8192
v_accvgpr_read_b32 v28, a136
v_accvgpr_read_b32 v29, a137
v_mfma_f32_16x16x32_bf16 v[168:171], a[204:207], v[84:87], v[168:171]
ds_read_b64_tr_b16 a[194:195], v6 offset:10240
v_accvgpr_read_b32 v30, a138
v_accvgpr_read_b32 v31, a139
v_mfma_f32_16x16x32_bf16 v[172:175], a[204:207], v[88:91], v[172:175]
s_waitcnt lgkmcnt(9)
v_cvt_pk_bf16_f32 v98, v28, v29
v_cvt_pk_bf16_f32 v99, v30, v31
v_accvgpr_read_b32 v12, a128
v_accvgpr_read_b32 v13, a129
v_accvgpr_read_b32 v14, a130
v_accvgpr_read_b32 v15, a131
v_cvt_pk_bf16_f32 v100, v12, v13
v_cvt_pk_bf16_f32 v101, v14, v15
v_accvgpr_read_b32 v28, a140
v_accvgpr_read_b32 v29, a141
v_accvgpr_read_b32 v30, a142
v_accvgpr_read_b32 v31, a143
v_cvt_pk_bf16_f32 v102, v28, v29
v_cvt_pk_bf16_f32 v103, v30, v31
s_nop 1
v_mfma_f32_16x16x32_bf16 v[128:131], a[208:211], v[92:95], v[128:131]
ds_read_b64_tr_b16 a[196:197], v27 offset:8192
v_accvgpr_read_b32 v12, a144
v_accvgpr_read_b32 v13, a145
v_mfma_f32_16x16x32_bf16 v[132:135], a[208:211], v[96:99], v[132:135]
ds_read_b64_tr_b16 a[198:199], v27 offset:10240
v_accvgpr_read_b32 v14, a146
v_accvgpr_read_b32 v15, a147
v_mfma_f32_16x16x32_bf16 v[136:139], a[208:211], v[100:103], v[136:139]
s_waitcnt lgkmcnt(8)
v_cvt_pk_bf16_f32 v104, v12, v13
v_cvt_pk_bf16_f32 v105, v14, v15
v_mfma_f32_16x16x32_bf16 v[140:143], a[212:215], v[92:95], v[140:143]
ds_read_b64_tr_b16 a[200:201], v6 offset:8704
v_accvgpr_read_b32 v28, a156
v_accvgpr_read_b32 v29, a157
v_mfma_f32_16x16x32_bf16 v[144:147], a[212:215], v[96:99], v[144:147]
ds_read_b64_tr_b16 a[202:203], v6 offset:10752
v_accvgpr_read_b32 v30, a158
v_accvgpr_read_b32 v31, a159
v_mfma_f32_16x16x32_bf16 v[148:151], a[212:215], v[100:103], v[148:151]
s_waitcnt lgkmcnt(8)
v_cvt_pk_bf16_f32 v106, v28, v29
v_cvt_pk_bf16_f32 v107, v30, v31
v_mfma_f32_16x16x32_bf16 v[152:155], a[216:219], v[92:95], v[152:155]
ds_read_b64_tr_b16 a[204:205], v27 offset:8704
v_accvgpr_read_b32 v12, a148
v_accvgpr_read_b32 v13, a149
v_mfma_f32_16x16x32_bf16 v[156:159], a[216:219], v[96:99], v[156:159]
ds_read_b64_tr_b16 a[206:207], v27 offset:10752
v_accvgpr_read_b32 v14, a150
v_accvgpr_read_b32 v15, a151
v_mfma_f32_16x16x32_bf16 v[160:163], a[216:219], v[100:103], v[160:163]
s_waitcnt lgkmcnt(8)
v_cvt_pk_bf16_f32 v108, v12, v13
v_cvt_pk_bf16_f32 v109, v14, v15
v_mfma_f32_16x16x32_bf16 v[164:167], a[220:223], v[92:95], v[164:167]
ds_read_b64_tr_b16 a[208:209], v6 offset:12288
v_accvgpr_read_b32 v28, a160
v_accvgpr_read_b32 v29, a161
v_mfma_f32_16x16x32_bf16 v[168:171], a[220:223], v[96:99], v[168:171]
ds_read_b64_tr_b16 a[210:211], v6 offset:14336
v_accvgpr_read_b32 v30, a162
v_accvgpr_read_b32 v31, a163
v_mfma_f32_16x16x32_bf16 v[172:175], a[220:223], v[100:103], v[172:175]
ds_read_b32 v25, v9
s_waitcnt lgkmcnt(9)
v_cvt_pk_bf16_f32 v110, v28, v29
v_cvt_pk_bf16_f32 v111, v30, v31
v_accvgpr_read_b32 v12, a152
v_accvgpr_read_b32 v13, a153
v_accvgpr_read_b32 v14, a154
v_accvgpr_read_b32 v15, a155
v_cvt_pk_bf16_f32 v112, v12, v13
v_cvt_pk_bf16_f32 v113, v14, v15
v_accvgpr_read_b32 v28, a164
v_accvgpr_read_b32 v29, a165
v_accvgpr_read_b32 v30, a166
v_accvgpr_read_b32 v31, a167
v_cvt_pk_bf16_f32 v114, v28, v29
v_cvt_pk_bf16_f32 v115, v30, v31
s_nop 1
v_mfma_f32_16x16x32_bf16 v[128:131], a[192:195], v[104:107], v[128:131]
ds_read_b64_tr_b16 a[212:213], v27 offset:12288
v_accvgpr_read_b32 v12, a168
v_accvgpr_read_b32 v13, a169
v_mfma_f32_16x16x32_bf16 v[132:135], a[192:195], v[108:111], v[132:135]
ds_read_b64_tr_b16 a[214:215], v27 offset:14336
v_accvgpr_read_b32 v14, a170
v_accvgpr_read_b32 v15, a171
v_mfma_f32_16x16x32_bf16 v[136:139], a[192:195], v[112:115], v[136:139]
s_waitcnt lgkmcnt(9)
v_cvt_pk_bf16_f32 v116, v12, v13
v_cvt_pk_bf16_f32 v117, v14, v15
v_mfma_f32_16x16x32_bf16 v[140:143], a[196:199], v[104:107], v[140:143]
ds_read_b64_tr_b16 a[216:217], v6 offset:12800
v_accvgpr_read_b32 v28, a180
v_accvgpr_read_b32 v29, a181
v_mfma_f32_16x16x32_bf16 v[144:147], a[196:199], v[108:111], v[144:147]
ds_read_b64_tr_b16 a[218:219], v6 offset:14848
v_accvgpr_read_b32 v30, a182
v_accvgpr_read_b32 v31, a183
v_mfma_f32_16x16x32_bf16 v[148:151], a[196:199], v[112:115], v[148:151]
s_waitcnt lgkmcnt(9)
v_cvt_pk_bf16_f32 v118, v28, v29
v_cvt_pk_bf16_f32 v119, v30, v31
v_mfma_f32_16x16x32_bf16 v[152:155], a[200:203], v[104:107], v[152:155]
ds_read_b64_tr_b16 a[220:221], v27 offset:12800
ds_read_b64_tr_b16 a[222:223], v27 offset:14848
s_waitcnt lgkmcnt(6)
v_mfma_f32_16x16x32_bf16 v[156:159], a[200:203], v[108:111], v[156:159]
v_readfirstlane_b32 s39, v25
s_add_u32 s38, s38, 1
s_cmp_ge_u32 s39, s38
s_cbranch_scc0 L_poll77
L_ret78:
v_mfma_f32_16x16x32_bf16 v[160:163], a[200:203], v[112:115], v[160:163]
v_add_u32 v6, s40, v4
v_add_u32 v27, s40, v5
v_mfma_f32_16x16x32_bf16 v[164:167], a[204:207], v[104:107], v[164:167]
ds_read_b64_tr_b16 a[192:193], v6 offset:0
v_accvgpr_read_b32 v12, a172
v_accvgpr_read_b32 v13, a173
v_mfma_f32_16x16x32_bf16 v[168:171], a[204:207], v[108:111], v[168:171]
ds_read_b64_tr_b16 a[194:195], v6 offset:2048
v_accvgpr_read_b32 v14, a174
v_accvgpr_read_b32 v15, a175
v_mfma_f32_16x16x32_bf16 v[172:175], a[204:207], v[112:115], v[172:175]
v_cvt_pk_bf16_f32 v120, v12, v13
v_cvt_pk_bf16_f32 v121, v14, v15
v_accvgpr_read_b32 v28, a184
v_accvgpr_read_b32 v29, a185
v_accvgpr_read_b32 v30, a186
v_accvgpr_read_b32 v31, a187
v_cvt_pk_bf16_f32 v122, v28, v29
v_cvt_pk_bf16_f32 v123, v30, v31
v_accvgpr_read_b32 v12, a176
v_accvgpr_read_b32 v13, a177
v_accvgpr_read_b32 v14, a178
v_accvgpr_read_b32 v15, a179
v_cvt_pk_bf16_f32 v124, v12, v13
v_cvt_pk_bf16_f32 v125, v14, v15
v_accvgpr_read_b32 v28, a188
v_accvgpr_read_b32 v29, a189
v_accvgpr_read_b32 v30, a190
v_accvgpr_read_b32 v31, a191
v_cvt_pk_bf16_f32 v126, v28, v29
v_cvt_pk_bf16_f32 v127, v30, v31
s_nop 1
v_mfma_f32_16x16x32_bf16 v[128:131], a[208:211], v[116:119], v[128:131]
ds_read_b64_tr_b16 a[196:197], v27 offset:0
ds_read_b64_tr_b16 a[198:199], v27 offset:2048
v_mfma_f32_16x16x32_bf16 v[132:135], a[208:211], v[120:123], v[132:135]
s_add_u32 s40, s40, 16896
v_mfma_f32_16x16x32_bf16 v[136:139], a[208:211], v[124:127], v[136:139]
s_cmp_eq_u32 s40, 152064
s_cselect_b32 s40, 0, s40
s_waitcnt lgkmcnt(8)
v_mfma_f32_16x16x32_bf16 v[140:143], a[212:215], v[116:119], v[140:143]
ds_read_b64_tr_b16 a[200:201], v6 offset:512
v_mfma_f32_16x16x32_bf16 v[144:147], a[212:215], v[120:123], v[144:147]
ds_read_b64_tr_b16 a[202:203], v6 offset:2560
v_mfma_f32_16x16x32_bf16 v[148:151], a[212:215], v[124:127], v[148:151]
s_waitcnt lgkmcnt(8)
v_mfma_f32_16x16x32_bf16 v[152:155], a[216:219], v[116:119], v[152:155]
ds_read_b64_tr_b16 a[204:205], v27 offset:512
v_mfma_f32_16x16x32_bf16 v[156:159], a[216:219], v[120:123], v[156:159]
ds_read_b64_tr_b16 a[206:207], v27 offset:2560
v_mfma_f32_16x16x32_bf16 v[160:163], a[216:219], v[124:127], v[160:163]
s_waitcnt lgkmcnt(8)
v_mfma_f32_16x16x32_bf16 v[164:167], a[220:223], v[116:119], v[164:167]
ds_read_b64_tr_b16 a[208:209], v6 offset:4096
ds_read_b64_tr_b16 a[210:211], v6 offset:6144
v_mfma_f32_16x16x32_bf16 v[168:171], a[220:223], v[120:123], v[168:171]
v_add_u32 v10, 1, v10
v_mfma_f32_16x16x32_bf16 v[172:175], a[220:223], v[124:127], v[172:175]
ds_write_b32 v8, v10
s_waitcnt lgkmcnt(9)
v_mfma_f32_16x16x32_bf16 v[176:179], a[192:195], v[32:35], 0
ds_read_b64_tr_b16 a[212:213], v27 offset:4096
v_mfma_f32_16x16x32_bf16 v[180:183], a[192:195], v[36:39], 0
ds_read_b64_tr_b16 a[214:215], v27 offset:6144
v_mfma_f32_16x16x32_bf16 v[184:187], a[192:195], v[40:43], 0
s_waitcnt lgkmcnt(9)
v_mfma_f32_16x16x32_bf16 v[188:191], a[196:199], v[32:35], 0
ds_read_b64_tr_b16 a[216:217], v6 offset:4608
v_mfma_f32_16x16x32_bf16 v[192:195], a[196:199], v[36:39], 0
ds_read_b64_tr_b16 a[218:219], v6 offset:6656
v_mfma_f32_16x16x32_bf16 v[196:199], a[196:199], v[40:43], 0
s_waitcnt lgkmcnt(9)
v_mfma_f32_16x16x32_bf16 v[200:203], a[200:203], v[32:35], 0
ds_read_b64_tr_b16 a[220:221], v27 offset:4608
v_mfma_f32_16x16x32_bf16 v[204:207], a[200:203], v[36:39], 0
ds_read_b64_tr_b16 a[222:223], v27 offset:6656
v_mfma_f32_16x16x32_bf16 v[208:211], a[200:203], v[40:43], 0
s_waitcnt lgkmcnt(9)
v_mfma_f32_16x16x32_bf16 v[212:215], a[204:207], v[32:35], 0
ds_read_b64_tr_b16 a[192:193], v6 offset:8192
s_add_u32 s42, s46, 0
v_mul_f32 v128, v19, v128
v_mfma_f32_16x16x32_bf16 v[216:219], a[204:207], v[36:39], 0
ds_read_b64_tr_b16 a[194:195], v6 offset:10240
v_mul_f32 v129, v19, v129
v_mfma_f32_16x16x32_bf16 v[220:223], a[204:207], v[40:43], 0
s_waitcnt lgkmcnt(9)
v_mul_f32 v130, v19, v130
v_mul_f32 v131, v19, v131
v_mfma_f32_16x16x32_bf16 v[176:179], a[208:211], v[44:47], v[176:179]
ds_read_b64_tr_b16 a[196:197], v27 offset:8192
v_cvt_pk_bf16_f32 v236, v128, v129
v_mfma_f32_16x16x32_bf16 v[180:183], a[208:211], v[48:51], v[180:183]
ds_read_b64_tr_b16 a[198:199], v27 offset:10240
v_cvt_pk_bf16_f32 v237, v130, v131
v_mfma_f32_16x16x32_bf16 v[184:187], a[208:211], v[52:55], v[184:187]
s_waitcnt lgkmcnt(8)
v_mul_f32 v140, v19, v140
v_mul_f32 v141, v19, v141
v_mfma_f32_16x16x32_bf16 v[188:191], a[212:215], v[44:47], v[188:191]
ds_read_b64_tr_b16 a[200:201], v6 offset:8704
v_mul_f32 v142, v19, v142
v_mfma_f32_16x16x32_bf16 v[192:195], a[212:215], v[48:51], v[192:195]
ds_read_b64_tr_b16 a[202:203], v6 offset:10752
v_mul_f32 v143, v19, v143
v_mfma_f32_16x16x32_bf16 v[196:199], a[212:215], v[52:55], v[196:199]
s_waitcnt lgkmcnt(8)
v_cvt_pk_bf16_f32 v238, v140, v141
v_cvt_pk_bf16_f32 v239, v142, v143
v_mfma_f32_16x16x32_bf16 v[200:203], a[216:219], v[44:47], v[200:203]
ds_read_b64_tr_b16 a[204:205], v27 offset:8704
buffer_store_dwordx4 v[236:239], v26, s[20:23], s42 offen offset:0 sc1
v_mul_f32 v152, v19, v152
v_mfma_f32_16x16x32_bf16 v[204:207], a[216:219], v[48:51], v[204:207]
ds_read_b64_tr_b16 a[206:207], v27 offset:10752
v_mul_f32 v153, v19, v153
v_mfma_f32_16x16x32_bf16 v[208:211], a[216:219], v[52:55], v[208:211]
s_waitcnt lgkmcnt(8)
v_mul_f32 v154, v19, v154
v_mul_f32 v155, v19, v155
v_mfma_f32_16x16x32_bf16 v[212:215], a[220:223], v[44:47], v[212:215]
ds_read_b64_tr_b16 a[208:209], v6 offset:12288
v_cvt_pk_bf16_f32 v240, v152, v153
v_mfma_f32_16x16x32_bf16 v[216:219], a[220:223], v[48:51], v[216:219]
ds_read_b64_tr_b16 a[210:211], v6 offset:14336
v_cvt_pk_bf16_f32 v241, v154, v155
v_mfma_f32_16x16x32_bf16 v[220:223], a[220:223], v[52:55], v[220:223]
ds_read_b32 v25, v9
s_waitcnt lgkmcnt(9)
v_mul_f32 v164, v19, v164
v_mfma_f32_16x16x32_bf16 v[176:179], a[192:195], v[56:59], v[176:179]
ds_read_b64_tr_b16 a[212:213], v27 offset:12288
v_mul_f32 v165, v19, v165
v_mfma_f32_16x16x32_bf16 v[180:183], a[192:195], v[60:63], v[180:183]
ds_read_b64_tr_b16 a[214:215], v27 offset:14336
v_mul_f32 v166, v19, v166
v_mfma_f32_16x16x32_bf16 v[184:187], a[192:195], v[64:67], v[184:187]
s_waitcnt lgkmcnt(9)
v_mul_f32 v167, v19, v167
v_cvt_pk_bf16_f32 v242, v164, v165
v_mfma_f32_16x16x32_bf16 v[188:191], a[196:199], v[56:59], v[188:191]
ds_read_b64_tr_b16 a[216:217], v6 offset:12800
v_cvt_pk_bf16_f32 v243, v166, v167
buffer_store_dwordx4 v[240:243], v26, s[20:23], s42 offen offset:1024 sc1
v_mfma_f32_16x16x32_bf16 v[192:195], a[196:199], v[60:63], v[192:195]
ds_read_b64_tr_b16 a[218:219], v6 offset:14848
s_add_u32 s42, s42, 14336
v_mul_f32 v132, v20, v132
v_mfma_f32_16x16x32_bf16 v[196:199], a[196:199], v[64:67], v[196:199]
s_waitcnt lgkmcnt(9)
v_mul_f32 v133, v20, v133
v_mul_f32 v134, v20, v134
v_mfma_f32_16x16x32_bf16 v[200:203], a[200:203], v[56:59], v[200:203]
ds_read_b64_tr_b16 a[220:221], v27 offset:12800
ds_read_b64_tr_b16 a[222:223], v27 offset:14848
s_waitcnt lgkmcnt(6)
v_mfma_f32_16x16x32_bf16 v[204:207], a[200:203], v[60:63], v[204:207]
v_readfirstlane_b32 s39, v25
s_add_u32 s38, s38, 1
s_cmp_ge_u32 s39, s38
s_cbranch_scc0 L_poll79
L_ret80:
v_mfma_f32_16x16x32_bf16 v[208:211], a[200:203], v[64:67], v[208:211]
v_add_u32 v6, s40, v4
v_add_u32 v27, s40, v5
v_mfma_f32_16x16x32_bf16 v[212:215], a[204:207], v[56:59], v[212:215]
ds_read_b64_tr_b16 a[192:193], v6 offset:0
v_mul_f32 v135, v20, v135
v_mfma_f32_16x16x32_bf16 v[216:219], a[204:207], v[60:63], v[216:219]
ds_read_b64_tr_b16 a[194:195], v6 offset:2048
v_cvt_pk_bf16_f32 v244, v132, v133
v_mfma_f32_16x16x32_bf16 v[220:223], a[204:207], v[64:67], v[220:223]
v_cvt_pk_bf16_f32 v245, v134, v135
v_mul_f32 v144, v20, v144
v_mfma_f32_16x16x32_bf16 v[176:179], a[208:211], v[68:71], v[176:179]
ds_read_b64_tr_b16 a[196:197], v27 offset:0
ds_read_b64_tr_b16 a[198:199], v27 offset:2048
v_mul_f32 v145, v20, v145
v_mfma_f32_16x16x32_bf16 v[180:183], a[208:211], v[72:75], v[180:183]
s_add_u32 s40, s40, 16896
v_mul_f32 v146, v20, v146
v_mul_f32 v147, v20, v147
v_mfma_f32_16x16x32_bf16 v[184:187], a[208:211], v[76:79], v[184:187]
s_cmp_eq_u32 s40, 152064
s_cselect_b32 s40, 0, s40
s_waitcnt lgkmcnt(8)
v_mfma_f32_16x16x32_bf16 v[188:191], a[212:215], v[68:71], v[188:191]
ds_read_b64_tr_b16 a[200:201], v6 offset:512
v_cvt_pk_bf16_f32 v246, v144, v145
v_mfma_f32_16x16x32_bf16 v[192:195], a[212:215], v[72:75], v[192:195]
ds_read_b64_tr_b16 a[202:203], v6 offset:2560
v_cvt_pk_bf16_f32 v247, v146, v147
buffer_store_dwordx4 v[244:247], v26, s[20:23], s42 offen offset:0 sc1
v_mfma_f32_16x16x32_bf16 v[196:199], a[212:215], v[76:79], v[196:199]
s_waitcnt lgkmcnt(8)
v_mul_f32 v156, v20, v156
v_mul_f32 v157, v20, v157
v_mfma_f32_16x16x32_bf16 v[200:203], a[216:219], v[68:71], v[200:203]
ds_read_b64_tr_b16 a[204:205], v27 offset:512
v_mul_f32 v158, v20, v158
v_mfma_f32_16x16x32_bf16 v[204:207], a[216:219], v[72:75], v[204:207]
ds_read_b64_tr_b16 a[206:207], v27 offset:2560
v_mul_f32 v159, v20, v159
v_mfma_f32_16x16x32_bf16 v[208:211], a[216:219], v[76:79], v[208:211]
s_waitcnt lgkmcnt(8)
v_cvt_pk_bf16_f32 v248, v156, v157
v_cvt_pk_bf16_f32 v249, v158, v159
v_mfma_f32_16x16x32_bf16 v[212:215], a[220:223], v[68:71], v[212:215]
ds_read_b64_tr_b16 a[208:209], v6 offset:4096
ds_read_b64_tr_b16 a[210:211], v6 offset:6144
v_mul_f32 v168, v20, v168
v_mfma_f32_16x16x32_bf16 v[216:219], a[220:223], v[72:75], v[216:219]
v_add_u32 v10, 1, v10
v_mul_f32 v169, v20, v169
v_mfma_f32_16x16x32_bf16 v[220:223], a[220:223], v[76:79], v[220:223]
ds_write_b32 v8, v10
s_waitcnt lgkmcnt(9)
v_mul_f32 v170, v20, v170
v_mfma_f32_16x16x32_bf16 v[176:179], a[192:195], v[80:83], v[176:179]
ds_read_b64_tr_b16 a[212:213], v27 offset:4096
v_mul_f32 v171, v20, v171
v_mfma_f32_16x16x32_bf16 v[180:183], a[192:195], v[84:87], v[180:183]
ds_read_b64_tr_b16 a[214:215], v27 offset:6144
v_cvt_pk_bf16_f32 v250, v168, v169
v_mfma_f32_16x16x32_bf16 v[184:187], a[192:195], v[88:91], v[184:187]
s_waitcnt lgkmcnt(9)
v_cvt_pk_bf16_f32 v251, v170, v171
buffer_store_dwordx4 v[248:251], v26, s[20:23], s42 offen offset:1024 sc1
v_mfma_f32_16x16x32_bf16 v[188:191], a[196:199], v[80:83], v[188:191]
ds_read_b64_tr_b16 a[216:217], v6 offset:4608
s_add_u32 s42, s42, 14336
v_mul_f32 v136, v21, v136
v_mfma_f32_16x16x32_bf16 v[192:195], a[196:199], v[84:87], v[192:195]
ds_read_b64_tr_b16 a[218:219], v6 offset:6656
v_mul_f32 v137, v21, v137
v_mfma_f32_16x16x32_bf16 v[196:199], a[196:199], v[88:91], v[196:199]
s_waitcnt lgkmcnt(9)
v_mul_f32 v138, v21, v138
v_mul_f32 v139, v21, v139
v_mfma_f32_16x16x32_bf16 v[200:203], a[200:203], v[80:83], v[200:203]
ds_read_b64_tr_b16 a[220:221], v27 offset:4608
v_cvt_pk_bf16_f32 v252, v136, v137
v_mfma_f32_16x16x32_bf16 v[204:207], a[200:203], v[84:87], v[204:207]
ds_read_b64_tr_b16 a[222:223], v27 offset:6656
v_cvt_pk_bf16_f32 v253, v138, v139
v_mfma_f32_16x16x32_bf16 v[208:211], a[200:203], v[88:91], v[208:211]
s_waitcnt lgkmcnt(9)
v_mul_f32 v148, v21, v148
v_mul_f32 v149, v21, v149
v_mfma_f32_16x16x32_bf16 v[212:215], a[204:207], v[80:83], v[212:215]
ds_read_b64_tr_b16 a[192:193], v6 offset:8192
v_mul_f32 v150, v21, v150
v_mfma_f32_16x16x32_bf16 v[216:219], a[204:207], v[84:87], v[216:219]
ds_read_b64_tr_b16 a[194:195], v6 offset:10240
v_mul_f32 v151, v21, v151
v_mfma_f32_16x16x32_bf16 v[220:223], a[204:207], v[88:91], v[220:223]
s_waitcnt lgkmcnt(9)
v_cvt_pk_bf16_f32 v254, v148, v149
v_cvt_pk_bf16_f32 v255, v150, v151
v_mfma_f32_16x16x32_bf16 v[176:179], a[208:211], v[92:95], v[176:179]
ds_read_b64_tr_b16 a[196:197], v27 offset:8192
buffer_store_dwordx4 v[252:255], v26, s[20:23], s42 offen offset:0 sc1
v_mul_f32 v160, v21, v160
v_mfma_f32_16x16x32_bf16 v[180:183], a[208:211], v[96:99], v[180:183]
ds_read_b64_tr_b16 a[198:199], v27 offset:10240
v_mul_f32 v161, v21, v161
v_mfma_f32_16x16x32_bf16 v[184:187], a[208:211], v[100:103], v[184:187]
s_waitcnt lgkmcnt(8)
v_mul_f32 v162, v21, v162
v_mul_f32 v163, v21, v163
v_mfma_f32_16x16x32_bf16 v[188:191], a[212:215], v[92:95], v[188:191]
ds_read_b64_tr_b16 a[200:201], v6 offset:8704
v_cvt_pk_bf16_f32 v236, v160, v161
v_mfma_f32_16x16x32_bf16 v[192:195], a[212:215], v[96:99], v[192:195]
ds_read_b64_tr_b16 a[202:203], v6 offset:10752
v_cvt_pk_bf16_f32 v237, v162, v163
v_mfma_f32_16x16x32_bf16 v[196:199], a[212:215], v[100:103], v[196:199]
s_waitcnt lgkmcnt(8)
v_mul_f32 v172, v21, v172
v_mul_f32 v173, v21, v173
v_mfma_f32_16x16x32_bf16 v[200:203], a[216:219], v[92:95], v[200:203]
ds_read_b64_tr_b16 a[204:205], v27 offset:8704
v_mul_f32 v174, v21, v174
v_mfma_f32_16x16x32_bf16 v[204:207], a[216:219], v[96:99], v[204:207]
ds_read_b64_tr_b16 a[206:207], v27 offset:10752
v_mul_f32 v175, v21, v175
v_mfma_f32_16x16x32_bf16 v[208:211], a[216:219], v[100:103], v[208:211]
s_waitcnt lgkmcnt(8)
v_cvt_pk_bf16_f32 v238, v172, v173
v_cvt_pk_bf16_f32 v239, v174, v175
v_mfma_f32_16x16x32_bf16 v[212:215], a[220:223], v[92:95], v[212:215]
ds_read_b64_tr_b16 a[208:209], v6 offset:12288
buffer_store_dwordx4 v[236:239], v26, s[20:23], s42 offen offset:1024 sc1
v_mfma_f32_16x16x32_bf16 v[216:219], a[220:223], v[96:99], v[216:219]
ds_read_b64_tr_b16 a[210:211], v6 offset:14336
v_mfma_f32_16x16x32_bf16 v[220:223], a[220:223], v[100:103], v[220:223]
ds_read_b32 v25, v9
s_waitcnt lgkmcnt(9)
v_mfma_f32_16x16x32_bf16 v[176:179], a[192:195], v[104:107], v[176:179]
ds_read_b64_tr_b16 a[212:213], v27 offset:12288
v_mfma_f32_16x16x32_bf16 v[180:183], a[192:195], v[108:111], v[180:183]
ds_read_b64_tr_b16 a[214:215], v27 offset:14336
v_mfma_f32_16x16x32_bf16 v[184:187], a[192:195], v[112:115], v[184:187]
s_waitcnt lgkmcnt(9)
v_mfma_f32_16x16x32_bf16 v[188:191], a[196:199], v[104:107], v[188:191]
ds_read_b64_tr_b16 a[216:217], v6 offset:12800
v_mfma_f32_16x16x32_bf16 v[192:195], a[196:199], v[108:111], v[192:195]
ds_read_b64_tr_b16 a[218:219], v6 offset:14848
v_mfma_f32_16x16x32_bf16 v[196:199], a[196:199], v[112:115], v[196:199]
s_waitcnt lgkmcnt(9)
v_mfma_f32_16x16x32_bf16 v[200:203], a[200:203], v[104:107], v[200:203]
ds_read_b64_tr_b16 a[220:221], v27 offset:12800
ds_read_b64_tr_b16 a[222:223], v27 offset:14848
s_waitcnt lgkmcnt(6)
v_mfma_f32_16x16x32_bf16 v[204:207], a[200:203], v[108:111], v[204:207]
v_readfirstlane_b32 s39, v25
s_add_u32 s38, s38, 1
s_cmp_ge_u32 s39, s38
s_cbranch_scc0 L_poll81
L_ret82:
v_mfma_f32_16x16x32_bf16 v[208:211], a[200:203], v[112:115], v[208:211]
v_add_u32 v6, s40, v4
v_add_u32 v27, s40, v5
v_mfma_f32_16x16x32_bf16 v[212:215], a[204:207], v[104:107], v[212:215]
ds_read_b64_tr_b16 a[192:193], v6 offset:0
v_mfma_f32_16x16x32_bf16 v[216:219], a[204:207], v[108:111], v[216:219]
ds_read_b64_tr_b16 a[194:195], v6 offset:2048
v_mfma_f32_16x16x32_bf16 v[220:223], a[204:207], v[112:115], v[220:223]
v_mfma_f32_16x16x32_bf16 v[176:179], a[208:211], v[116:119], v[176:179]
ds_read_b64_tr_b16 a[196:197], v27 offset:0
ds_read_b64_tr_b16 a[198:199], v27 offset:2048
v_mfma_f32_16x16x32_bf16 v[180:183], a[208:211], v[120:123], v[180:183]
s_add_u32 s40, s40, 16896
v_mfma_f32_16x16x32_bf16 v[184:187], a[208:211], v[124:127], v[184:187]
s_cmp_eq_u32 s40, 152064
s_cselect_b32 s40, 0, s40
s_waitcnt lgkmcnt(8)
v_mfma_f32_16x16x32_bf16 v[188:191], a[212:215], v[116:119], v[188:191]
ds_read_b64_tr_b16 a[200:201], v6 offset:512
v_mfma_f32_16x16x32_bf16 v[192:195], a[212:215], v[120:123], v[192:195]
ds_read_b64_tr_b16 a[202:203], v6 offset:2560
v_mfma_f32_16x16x32_bf16 v[196:199], a[212:215], v[124:127], v[196:199]
s_waitcnt lgkmcnt(8)
v_mfma_f32_16x16x32_bf16 v[200:203], a[216:219], v[116:119], v[200:203]
ds_read_b64_tr_b16 a[204:205], v27 offset:512
v_mfma_f32_16x16x32_bf16 v[204:207], a[216:219], v[120:123], v[204:207]
ds_read_b64_tr_b16 a[206:207], v27 offset:2560
v_mfma_f32_16x16x32_bf16 v[208:211], a[216:219], v[124:127], v[208:211]
s_waitcnt lgkmcnt(8)
v_mfma_f32_16x16x32_bf16 v[212:215], a[220:223], v[116:119], v[212:215]
ds_read_b64_tr_b16 a[208:209], v6 offset:4096
ds_read_b64_tr_b16 a[210:211], v6 offset:6144
v_mfma_f32_16x16x32_bf16 v[216:219], a[220:223], v[120:123], v[216:219]
v_add_u32 v10, 1, v10
v_mfma_f32_16x16x32_bf16 v[220:223], a[220:223], v[124:127], v[220:223]
ds_write_b32 v8, v10
s_waitcnt lgkmcnt(9)
v_mfma_f32_16x16x32_bf16 v[128:131], a[192:195], v[32:35], 0
ds_read_b64_tr_b16 a[212:213], v27 offset:4096
v_mfma_f32_16x16x32_bf16 v[132:135], a[192:195], v[36:39], 0
ds_read_b64_tr_b16 a[214:215], v27 offset:6144
v_mfma_f32_16x16x32_bf16 v[136:139], a[192:195], v[40:43], 0
s_waitcnt lgkmcnt(9)
v_mfma_f32_16x16x32_bf16 v[140:143], a[196:199], v[32:35], 0
ds_read_b64_tr_b16 a[216:217], v6 offset:4608
v_mfma_f32_16x16x32_bf16 v[144:147], a[196:199], v[36:39], 0
ds_read_b64_tr_b16 a[218:219], v6 offset:6656
v_mfma_f32_16x16x32_bf16 v[148:151], a[196:199], v[40:43], 0
s_waitcnt lgkmcnt(9)
v_mfma_f32_16x16x32_bf16 v[152:155], a[200:203], v[32:35], 0
ds_read_b64_tr_b16 a[220:221], v27 offset:4608
v_mfma_f32_16x16x32_bf16 v[156:159], a[200:203], v[36:39], 0
ds_read_b64_tr_b16 a[222:223], v27 offset:6656
v_mfma_f32_16x16x32_bf16 v[160:163], a[200:203], v[40:43], 0
s_waitcnt lgkmcnt(9)
v_mfma_f32_16x16x32_bf16 v[164:167], a[204:207], v[32:35], 0
ds_read_b64_tr_b16 a[192:193], v6 offset:8192
s_add_u32 s42, s46, 2048
v_mul_f32 v176, v19, v176
v_mfma_f32_16x16x32_bf16 v[168:171], a[204:207], v[36:39], 0
ds_read_b64_tr_b16 a[194:195], v6 offset:10240
v_mul_f32 v177, v19, v177
v_mfma_f32_16x16x32_bf16 v[172:175], a[204:207], v[40:43], 0
s_waitcnt lgkmcnt(9)
v_mul_f32 v178, v19, v178
v_mul_f32 v179, v19, v179
v_mfma_f32_16x16x32_bf16 v[128:131], a[208:211], v[44:47], v[128:131]
ds_read_b64_tr_b16 a[196:197], v27 offset:8192
v_cvt_pk_bf16_f32 v240, v176, v177
v_mfma_f32_16x16x32_bf16 v[132:135], a[208:211], v[48:51], v[132:135]
ds_read_b64_tr_b16 a[198:199], v27 offset:10240
v_cvt_pk_bf16_f32 v241, v178, v179
v_mfma_f32_16x16x32_bf16 v[136:139], a[208:211], v[52:55], v[136:139]
s_waitcnt lgkmcnt(8)
v_mul_f32 v188, v19, v188
v_mul_f32 v189, v19, v189
v_mfma_f32_16x16x32_bf16 v[140:143], a[212:215], v[44:47], v[140:143]
ds_read_b64_tr_b16 a[200:201], v6 offset:8704
v_mul_f32 v190, v19, v190
v_mfma_f32_16x16x32_bf16 v[144:147], a[212:215], v[48:51], v[144:147]
ds_read_b64_tr_b16 a[202:203], v6 offset:10752
v_mul_f32 v191, v19, v191
v_mfma_f32_16x16x32_bf16 v[148:151], a[212:215], v[52:55], v[148:151]
s_waitcnt lgkmcnt(8)
v_cvt_pk_bf16_f32 v242, v188, v189
v_cvt_pk_bf16_f32 v243, v190, v191
v_mfma_f32_16x16x32_bf16 v[152:155], a[216:219], v[44:47], v[152:155]
ds_read_b64_tr_b16 a[204:205], v27 offset:8704
buffer_store_dwordx4 v[240:243], v26, s[20:23], s42 offen offset:0 sc1
v_mul_f32 v200, v19, v200
v_mfma_f32_16x16x32_bf16 v[156:159], a[216:219], v[48:51], v[156:159]
ds_read_b64_tr_b16 a[206:207], v27 offset:10752
v_mul_f32 v201, v19, v201
v_mfma_f32_16x16x32_bf16 v[160:163], a[216:219], v[52:55], v[160:163]
s_waitcnt lgkmcnt(8)
v_mul_f32 v202, v19, v202
v_mul_f32 v203, v19, v203
v_mfma_f32_16x16x32_bf16 v[164:167], a[220:223], v[44:47], v[164:167]
ds_read_b64_tr_b16 a[208:209], v6 offset:12288
v_cvt_pk_bf16_f32 v244, v200, v201
v_mfma_f32_16x16x32_bf16 v[168:171], a[220:223], v[48:51], v[168:171]
ds_read_b64_tr_b16 a[210:211], v6 offset:14336
v_cvt_pk_bf16_f32 v245, v202, v203
v_mfma_f32_16x16x32_bf16 v[172:175], a[220:223], v[52:55], v[172:175]
ds_read_b32 v25, v9
s_waitcnt lgkmcnt(9)
v_mul_f32 v212, v19, v212
v_mfma_f32_16x16x32_bf16 v[128:131], a[192:195], v[56:59], v[128:131]
ds_read_b64_tr_b16 a[212:213], v27 offset:12288
v_mul_f32 v213, v19, v213
v_mfma_f32_16x16x32_bf16 v[132:135], a[192:195], v[60:63], v[132:135]
ds_read_b64_tr_b16 a[214:215], v27 offset:14336
v_mul_f32 v214, v19, v214
v_mfma_f32_16x16x32_bf16 v[136:139], a[192:195], v[64:67], v[136:139]
s_waitcnt lgkmcnt(9)
v_mul_f32 v215, v19, v215
v_cvt_pk_bf16_f32 v246, v212, v213
v_mfma_f32_16x16x32_bf16 v[140:143], a[196:199], v[56:59], v[140:143]
ds_read_b64_tr_b16 a[216:217], v6 offset:12800
v_cvt_pk_bf16_f32 v247, v214, v215
buffer_store_dwordx4 v[244:247], v26, s[20:23], s42 offen offset:1024 sc1
v_mfma_f32_16x16x32_bf16 v[144:147], a[196:199], v[60:63], v[144:147]
ds_read_b64_tr_b16 a[218:219], v6 offset:14848
s_add_u32 s42, s42, 14336
v_mul_f32 v180, v20, v180
v_mfma_f32_16x16x32_bf16 v[148:151], a[196:199], v[64:67], v[148:151]
s_waitcnt lgkmcnt(9)
v_mul_f32 v181, v20, v181
v_mul_f32 v182, v20, v182
v_mfma_f32_16x16x32_bf16 v[152:155], a[200:203], v[56:59], v[152:155]
ds_read_b64_tr_b16 a[220:221], v27 offset:12800
ds_read_b64_tr_b16 a[222:223], v27 offset:14848
s_waitcnt lgkmcnt(6)
v_mfma_f32_16x16x32_bf16 v[156:159], a[200:203], v[60:63], v[156:159]
v_readfirstlane_b32 s39, v25
s_add_u32 s38, s38, 1
s_cmp_ge_u32 s39, s38
s_cbranch_scc0 L_poll83
L_ret84:
v_mfma_f32_16x16x32_bf16 v[160:163], a[200:203], v[64:67], v[160:163]
v_add_u32 v6, s40, v4
v_add_u32 v27, s40, v5
v_mfma_f32_16x16x32_bf16 v[164:167], a[204:207], v[56:59], v[164:167]
ds_read_b64_tr_b16 a[192:193], v6 offset:0
v_mul_f32 v183, v20, v183
v_mfma_f32_16x16x32_bf16 v[168:171], a[204:207], v[60:63], v[168:171]
ds_read_b64_tr_b16 a[194:195], v6 offset:2048
v_cvt_pk_bf16_f32 v248, v180, v181
v_mfma_f32_16x16x32_bf16 v[172:175], a[204:207], v[64:67], v[172:175]
v_cvt_pk_bf16_f32 v249, v182, v183
v_mul_f32 v192, v20, v192
v_mfma_f32_16x16x32_bf16 v[128:131], a[208:211], v[68:71], v[128:131]
ds_read_b64_tr_b16 a[196:197], v27 offset:0
ds_read_b64_tr_b16 a[198:199], v27 offset:2048
v_mul_f32 v193, v20, v193
v_mfma_f32_16x16x32_bf16 v[132:135], a[208:211], v[72:75], v[132:135]
s_add_u32 s40, s40, 16896
v_mul_f32 v194, v20, v194
v_mul_f32 v195, v20, v195
v_mfma_f32_16x16x32_bf16 v[136:139], a[208:211], v[76:79], v[136:139]
s_cmp_eq_u32 s40, 152064
s_cselect_b32 s40, 0, s40
s_waitcnt lgkmcnt(8)
v_mfma_f32_16x16x32_bf16 v[140:143], a[212:215], v[68:71], v[140:143]
ds_read_b64_tr_b16 a[200:201], v6 offset:512
v_cvt_pk_bf16_f32 v250, v192, v193
v_mfma_f32_16x16x32_bf16 v[144:147], a[212:215], v[72:75], v[144:147]
ds_read_b64_tr_b16 a[202:203], v6 offset:2560
v_cvt_pk_bf16_f32 v251, v194, v195
buffer_store_dwordx4 v[248:251], v26, s[20:23], s42 offen offset:0 sc1
v_mfma_f32_16x16x32_bf16 v[148:151], a[212:215], v[76:79], v[148:151]
s_waitcnt lgkmcnt(8)
v_mul_f32 v204, v20, v204
v_mul_f32 v205, v20, v205
v_mfma_f32_16x16x32_bf16 v[152:155], a[216:219], v[68:71], v[152:155]
ds_read_b64_tr_b16 a[204:205], v27 offset:512
v_mul_f32 v206, v20, v206
v_mfma_f32_16x16x32_bf16 v[156:159], a[216:219], v[72:75], v[156:159]
ds_read_b64_tr_b16 a[206:207], v27 offset:2560
v_mul_f32 v207, v20, v207
v_mfma_f32_16x16x32_bf16 v[160:163], a[216:219], v[76:79], v[160:163]
s_waitcnt lgkmcnt(8)
v_cvt_pk_bf16_f32 v252, v204, v205
v_cvt_pk_bf16_f32 v253, v206, v207
v_mfma_f32_16x16x32_bf16 v[164:167], a[220:223], v[68:71], v[164:167]
ds_read_b64_tr_b16 a[208:209], v6 offset:4096
ds_read_b64_tr_b16 a[210:211], v6 offset:6144
v_mul_f32 v216, v20, v216
v_mfma_f32_16x16x32_bf16 v[168:171], a[220:223], v[72:75], v[168:171]
v_add_u32 v10, 1, v10
v_mul_f32 v217, v20, v217
v_mfma_f32_16x16x32_bf16 v[172:175], a[220:223], v[76:79], v[172:175]
ds_write_b32 v8, v10
s_waitcnt lgkmcnt(9)
v_mul_f32 v218, v20, v218
v_mfma_f32_16x16x32_bf16 v[128:131], a[192:195], v[80:83], v[128:131]
ds_read_b64_tr_b16 a[212:213], v27 offset:4096
v_mul_f32 v219, v20, v219
v_mfma_f32_16x16x32_bf16 v[132:135], a[192:195], v[84:87], v[132:135]
ds_read_b64_tr_b16 a[214:215], v27 offset:6144
v_cvt_pk_bf16_f32 v254, v216, v217
v_mfma_f32_16x16x32_bf16 v[136:139], a[192:195], v[88:91], v[136:139]
s_waitcnt lgkmcnt(9)
v_cvt_pk_bf16_f32 v255, v218, v219
buffer_store_dwordx4 v[252:255], v26, s[20:23], s42 offen offset:1024 sc1
v_mfma_f32_16x16x32_bf16 v[140:143], a[196:199], v[80:83], v[140:143]
ds_read_b64_tr_b16 a[216:217], v6 offset:4608
s_add_u32 s42, s42, 14336
v_mul_f32 v184, v21, v184
v_mfma_f32_16x16x32_bf16 v[144:147], a[196:199], v[84:87], v[144:147]
ds_read_b64_tr_b16 a[218:219], v6 offset:6656
v_mul_f32 v185, v21, v185
v_mfma_f32_16x16x32_bf16 v[148:151], a[196:199], v[88:91], v[148:151]
s_waitcnt lgkmcnt(9)
v_mul_f32 v186, v21, v186
v_mul_f32 v187, v21, v187
v_mfma_f32_16x16x32_bf16 v[152:155], a[200:203], v[80:83], v[152:155]
ds_read_b64_tr_b16 a[220:221], v27 offset:4608
v_cvt_pk_bf16_f32 v236, v184, v185
v_mfma_f32_16x16x32_bf16 v[156:159], a[200:203], v[84:87], v[156:159]
ds_read_b64_tr_b16 a[222:223], v27 offset:6656
v_cvt_pk_bf16_f32 v237, v186, v187
v_mfma_f32_16x16x32_bf16 v[160:163], a[200:203], v[88:91], v[160:163]
s_waitcnt lgkmcnt(9)
v_mul_f32 v196, v21, v196
v_mul_f32 v197, v21, v197
v_mfma_f32_16x16x32_bf16 v[164:167], a[204:207], v[80:83], v[164:167]
ds_read_b64_tr_b16 a[192:193], v6 offset:8192
v_mul_f32 v198, v21, v198
v_mfma_f32_16x16x32_bf16 v[168:171], a[204:207], v[84:87], v[168:171]
ds_read_b64_tr_b16 a[194:195], v6 offset:10240
v_mul_f32 v199, v21, v199
v_mfma_f32_16x16x32_bf16 v[172:175], a[204:207], v[88:91], v[172:175]
s_waitcnt lgkmcnt(9)
v_cvt_pk_bf16_f32 v238, v196, v197
v_cvt_pk_bf16_f32 v239, v198, v199
v_mfma_f32_16x16x32_bf16 v[128:131], a[208:211], v[92:95], v[128:131]
ds_read_b64_tr_b16 a[196:197], v27 offset:8192
buffer_store_dwordx4 v[236:239], v26, s[20:23], s42 offen offset:0 sc1
v_mul_f32 v208, v21, v208
v_mfma_f32_16x16x32_bf16 v[132:135], a[208:211], v[96:99], v[132:135]
ds_read_b64_tr_b16 a[198:199], v27 offset:10240
v_mul_f32 v209, v21, v209
v_mfma_f32_16x16x32_bf16 v[136:139], a[208:211], v[100:103], v[136:139]
s_waitcnt lgkmcnt(8)
v_mul_f32 v210, v21, v210
v_mul_f32 v211, v21, v211
v_mfma_f32_16x16x32_bf16 v[140:143], a[212:215], v[92:95], v[140:143]
ds_read_b64_tr_b16 a[200:201], v6 offset:8704
v_cvt_pk_bf16_f32 v240, v208, v209
v_mfma_f32_16x16x32_bf16 v[144:147], a[212:215], v[96:99], v[144:147]
ds_read_b64_tr_b16 a[202:203], v6 offset:10752
v_cvt_pk_bf16_f32 v241, v210, v211
v_mfma_f32_16x16x32_bf16 v[148:151], a[212:215], v[100:103], v[148:151]
s_waitcnt lgkmcnt(8)
v_mul_f32 v220, v21, v220
v_mul_f32 v221, v21, v221
v_mfma_f32_16x16x32_bf16 v[152:155], a[216:219], v[92:95], v[152:155]
ds_read_b64_tr_b16 a[204:205], v27 offset:8704
v_mul_f32 v222, v21, v222
v_mfma_f32_16x16x32_bf16 v[156:159], a[216:219], v[96:99], v[156:159]
ds_read_b64_tr_b16 a[206:207], v27 offset:10752
v_mul_f32 v223, v21, v223
v_mfma_f32_16x16x32_bf16 v[160:163], a[216:219], v[100:103], v[160:163]
s_waitcnt lgkmcnt(8)
v_cvt_pk_bf16_f32 v242, v220, v221
v_cvt_pk_bf16_f32 v243, v222, v223
v_mfma_f32_16x16x32_bf16 v[164:167], a[220:223], v[92:95], v[164:167]
ds_read_b64_tr_b16 a[208:209], v6 offset:12288
buffer_store_dwordx4 v[240:243], v26, s[20:23], s42 offen offset:1024 sc1
s_waitcnt vmcnt(6)
s_mov_b64 exec, 1
buffer_store_dwordx2 v[224:225], v226, s[20:23], s83 offen offset:0 sc1
s_mov_b64 exec, -1
v_mfma_f32_16x16x32_bf16 v[168:171], a[220:223], v[96:99], v[168:171]
ds_read_b64_tr_b16 a[210:211], v6 offset:14336
v_mfma_f32_16x16x32_bf16 v[172:175], a[220:223], v[100:103], v[172:175]
ds_read_b32 v25, v9
s_waitcnt lgkmcnt(9)
v_mfma_f32_16x16x32_bf16 v[128:131], a[192:195], v[104:107], v[128:131]
ds_read_b64_tr_b16 a[212:213], v27 offset:12288
v_mfma_f32_16x16x32_bf16 v[132:135], a[192:195], v[108:111], v[132:135]
ds_read_b64_tr_b16 a[214:215], v27 offset:14336
v_mfma_f32_16x16x32_bf16 v[136:139], a[192:195], v[112:115], v[136:139]
s_waitcnt lgkmcnt(9)
v_mfma_f32_16x16x32_bf16 v[140:143], a[196:199], v[104:107], v[140:143]
ds_read_b64_tr_b16 a[216:217], v6 offset:12800
v_mfma_f32_16x16x32_bf16 v[144:147], a[196:199], v[108:111], v[144:147]
ds_read_b64_tr_b16 a[218:219], v6 offset:14848
v_mfma_f32_16x16x32_bf16 v[148:151], a[196:199], v[112:115], v[148:151]
s_waitcnt lgkmcnt(9)
v_mfma_f32_16x16x32_bf16 v[152:155], a[200:203], v[104:107], v[152:155]
ds_read_b64_tr_b16 a[220:221], v27 offset:12800
ds_read_b64_tr_b16 a[222:223], v27 offset:14848
s_waitcnt lgkmcnt(6)
v_mfma_f32_16x16x32_bf16 v[156:159], a[200:203], v[108:111], v[156:159]
v_readfirstlane_b32 s39, v25
s_add_u32 s38, s38, 1
s_cmp_ge_u32 s39, s38
s_cbranch_scc0 L_poll85
L_ret86:
v_mfma_f32_16x16x32_bf16 v[160:163], a[200:203], v[112:115], v[160:163]
v_add_u32 v6, s40, v4
v_add_u32 v27, s40, v5
v_mfma_f32_16x16x32_bf16 v[164:167], a[204:207], v[104:107], v[164:167]
ds_read_b64_tr_b16 a[192:193], v6 offset:0
v_mfma_f32_16x16x32_bf16 v[168:171], a[204:207], v[108:111], v[168:171]
ds_read_b64_tr_b16 a[194:195], v6 offset:2048
v_mfma_f32_16x16x32_bf16 v[172:175], a[204:207], v[112:115], v[172:175]
v_mfma_f32_16x16x32_bf16 v[128:131], a[208:211], v[116:119], v[128:131]
ds_read_b64_tr_b16 a[196:197], v27 offset:0
ds_read_b64_tr_b16 a[198:199], v27 offset:2048
v_mfma_f32_16x16x32_bf16 v[132:135], a[208:211], v[120:123], v[132:135]
s_add_u32 s40, s40, 16896
v_mfma_f32_16x16x32_bf16 v[136:139], a[208:211], v[124:127], v[136:139]
s_cmp_eq_u32 s40, 152064
s_cselect_b32 s40, 0, s40
s_waitcnt lgkmcnt(8)
v_mfma_f32_16x16x32_bf16 v[140:143], a[212:215], v[116:119], v[140:143]
ds_read_b64_tr_b16 a[200:201], v6 offset:512
v_mfma_f32_16x16x32_bf16 v[144:147], a[212:215], v[120:123], v[144:147]
ds_read_b64_tr_b16 a[202:203], v6 offset:2560
v_mfma_f32_16x16x32_bf16 v[148:151], a[212:215], v[124:127], v[148:151]
s_waitcnt lgkmcnt(8)
v_mfma_f32_16x16x32_bf16 v[152:155], a[216:219], v[116:119], v[152:155]
ds_read_b64_tr_b16 a[204:205], v27 offset:512
v_mfma_f32_16x16x32_bf16 v[156:159], a[216:219], v[120:123], v[156:159]
ds_read_b64_tr_b16 a[206:207], v27 offset:2560
v_mfma_f32_16x16x32_bf16 v[160:163], a[216:219], v[124:127], v[160:163]
s_waitcnt lgkmcnt(8)
v_mfma_f32_16x16x32_bf16 v[164:167], a[220:223], v[116:119], v[164:167]
ds_read_b64_tr_b16 a[208:209], v6 offset:4096
ds_read_b64_tr_b16 a[210:211], v6 offset:6144
v_mfma_f32_16x16x32_bf16 v[168:171], a[220:223], v[120:123], v[168:171]
v_add_u32 v10, 1, v10
v_mfma_f32_16x16x32_bf16 v[172:175], a[220:223], v[124:127], v[172:175]
ds_write_b32 v8, v10
s_waitcnt lgkmcnt(9)
v_mfma_f32_16x16x32_bf16 v[176:179], a[192:195], v[32:35], 0
ds_read_b64_tr_b16 a[212:213], v27 offset:4096
v_mfma_f32_16x16x32_bf16 v[180:183], a[192:195], v[36:39], 0
ds_read_b64_tr_b16 a[214:215], v27 offset:6144
v_mfma_f32_16x16x32_bf16 v[184:187], a[192:195], v[40:43], 0
s_waitcnt lgkmcnt(9)
v_mfma_f32_16x16x32_bf16 v[188:191], a[196:199], v[32:35], 0
ds_read_b64_tr_b16 a[216:217], v6 offset:4608
v_mfma_f32_16x16x32_bf16 v[192:195], a[196:199], v[36:39], 0
ds_read_b64_tr_b16 a[218:219], v6 offset:6656
v_mfma_f32_16x16x32_bf16 v[196:199], a[196:199], v[40:43], 0
s_waitcnt lgkmcnt(9)
v_mfma_f32_16x16x32_bf16 v[200:203], a[200:203], v[32:35], 0
ds_read_b64_tr_b16 a[220:221], v27 offset:4608
v_mfma_f32_16x16x32_bf16 v[204:207], a[200:203], v[36:39], 0
ds_read_b64_tr_b16 a[222:223], v27 offset:6656
v_mfma_f32_16x16x32_bf16 v[208:211], a[200:203], v[40:43], 0
s_waitcnt lgkmcnt(9)
v_mfma_f32_16x16x32_bf16 v[212:215], a[204:207], v[32:35], 0
ds_read_b64_tr_b16 a[192:193], v6 offset:8192
s_add_u32 s42, s46, 4096
v_mul_f32 v128, v19, v128
v_mfma_f32_16x16x32_bf16 v[216:219], a[204:207], v[36:39], 0
ds_read_b64_tr_b16 a[194:195], v6 offset:10240
v_mul_f32 v129, v19, v129
v_mfma_f32_16x16x32_bf16 v[220:223], a[204:207], v[40:43], 0
s_waitcnt lgkmcnt(9)
v_mul_f32 v130, v19, v130
v_mul_f32 v131, v19, v131
v_mfma_f32_16x16x32_bf16 v[176:179], a[208:211], v[44:47], v[176:179]
ds_read_b64_tr_b16 a[196:197], v27 offset:8192
v_cvt_pk_bf16_f32 v244, v128, v129
v_mfma_f32_16x16x32_bf16 v[180:183], a[208:211], v[48:51], v[180:183]
ds_read_b64_tr_b16 a[198:199], v27 offset:10240
v_cvt_pk_bf16_f32 v245, v130, v131
v_mfma_f32_16x16x32_bf16 v[184:187], a[208:211], v[52:55], v[184:187]
s_waitcnt lgkmcnt(8)
v_mul_f32 v140, v19, v140
v_mul_f32 v141, v19, v141
v_mfma_f32_16x16x32_bf16 v[188:191], a[212:215], v[44:47], v[188:191]
ds_read_b64_tr_b16 a[200:201], v6 offset:8704
v_mul_f32 v142, v19, v142
v_mfma_f32_16x16x32_bf16 v[192:195], a[212:215], v[48:51], v[192:195]
ds_read_b64_tr_b16 a[202:203], v6 offset:10752
v_mul_f32 v143, v19, v143
v_mfma_f32_16x16x32_bf16 v[196:199], a[212:215], v[52:55], v[196:199]
s_waitcnt lgkmcnt(8)
v_cvt_pk_bf16_f32 v246, v140, v141
v_cvt_pk_bf16_f32 v247, v142, v143
v_mfma_f32_16x16x32_bf16 v[200:203], a[216:219], v[44:47], v[200:203]
ds_read_b64_tr_b16 a[204:205], v27 offset:8704
buffer_store_dwordx4 v[244:247], v26, s[20:23], s42 offen offset:0 sc1
v_mul_f32 v152, v19, v152
v_mfma_f32_16x16x32_bf16 v[204:207], a[216:219], v[48:51], v[204:207]
ds_read_b64_tr_b16 a[206:207], v27 offset:10752
v_mul_f32 v153, v19, v153
v_mfma_f32_16x16x32_bf16 v[208:211], a[216:219], v[52:55], v[208:211]
s_waitcnt lgkmcnt(8)
v_mul_f32 v154, v19, v154
v_mul_f32 v155, v19, v155
v_mfma_f32_16x16x32_bf16 v[212:215], a[220:223], v[44:47], v[212:215]
ds_read_b64_tr_b16 a[208:209], v6 offset:12288
v_cvt_pk_bf16_f32 v248, v152, v153
v_mfma_f32_16x16x32_bf16 v[216:219], a[220:223], v[48:51], v[216:219]
ds_read_b64_tr_b16 a[210:211], v6 offset:14336
v_cvt_pk_bf16_f32 v249, v154, v155
v_mfma_f32_16x16x32_bf16 v[220:223], a[220:223], v[52:55], v[220:223]
ds_read_b32 v25, v9
s_waitcnt lgkmcnt(9)
v_mul_f32 v164, v19, v164
v_mfma_f32_16x16x32_bf16 v[176:179], a[192:195], v[56:59], v[176:179]
ds_read_b64_tr_b16 a[212:213], v27 offset:12288
v_mul_f32 v165, v19, v165
v_mfma_f32_16x16x32_bf16 v[180:183], a[192:195], v[60:63], v[180:183]
ds_read_b64_tr_b16 a[214:215], v27 offset:14336
v_mul_f32 v166, v19, v166
v_mfma_f32_16x16x32_bf16 v[184:187], a[192:195], v[64:67], v[184:187]
s_waitcnt lgkmcnt(9)
v_mul_f32 v167, v19, v167
v_cvt_pk_bf16_f32 v250, v164, v165
v_mfma_f32_16x16x32_bf16 v[188:191], a[196:199], v[56:59], v[188:191]
ds_read_b64_tr_b16 a[216:217], v6 offset:12800
v_cvt_pk_bf16_f32 v251, v166, v167
buffer_store_dwordx4 v[248:251], v26, s[20:23], s42 offen offset:1024 sc1
v_mfma_f32_16x16x32_bf16 v[192:195], a[196:199], v[60:63], v[192:195]
ds_read_b64_tr_b16 a[218:219], v6 offset:14848
s_add_u32 s42, s42, 14336
v_mul_f32 v132, v20, v132
v_mfma_f32_16x16x32_bf16 v[196:199], a[196:199], v[64:67], v[196:199]
s_waitcnt lgkmcnt(9)
v_mul_f32 v133, v20, v133
v_mul_f32 v134, v20, v134
v_mfma_f32_16x16x32_bf16 v[200:203], a[200:203], v[56:59], v[200:203]
ds_read_b64_tr_b16 a[220:221], v27 offset:12800
ds_read_b64_tr_b16 a[222:223], v27 offset:14848
s_waitcnt lgkmcnt(6)
v_mfma_f32_16x16x32_bf16 v[204:207], a[200:203], v[60:63], v[204:207]
v_readfirstlane_b32 s39, v25
s_add_u32 s38, s38, 1
s_cmp_ge_u32 s39, s38
s_cbranch_scc0 L_poll87
L_ret88:
v_mfma_f32_16x16x32_bf16 v[208:211], a[200:203], v[64:67], v[208:211]
v_add_u32 v6, s40, v4
v_add_u32 v27, s40, v5
v_mfma_f32_16x16x32_bf16 v[212:215], a[204:207], v[56:59], v[212:215]
ds_read_b64_tr_b16 a[192:193], v6 offset:0
v_mul_f32 v135, v20, v135
v_mfma_f32_16x16x32_bf16 v[216:219], a[204:207], v[60:63], v[216:219]
ds_read_b64_tr_b16 a[194:195], v6 offset:2048
v_cvt_pk_bf16_f32 v252, v132, v133
v_mfma_f32_16x16x32_bf16 v[220:223], a[204:207], v[64:67], v[220:223]
v_cvt_pk_bf16_f32 v253, v134, v135
v_mul_f32 v144, v20, v144
v_mfma_f32_16x16x32_bf16 v[176:179], a[208:211], v[68:71], v[176:179]
ds_read_b64_tr_b16 a[196:197], v27 offset:0
ds_read_b64_tr_b16 a[198:199], v27 offset:2048
v_mul_f32 v145, v20, v145
v_mfma_f32_16x16x32_bf16 v[180:183], a[208:211], v[72:75], v[180:183]
s_add_u32 s40, s40, 16896
v_mul_f32 v146, v20, v146
v_mul_f32 v147, v20, v147
v_mfma_f32_16x16x32_bf16 v[184:187], a[208:211], v[76:79], v[184:187]
s_cmp_eq_u32 s40, 152064
s_cselect_b32 s40, 0, s40
s_waitcnt lgkmcnt(8)
v_mfma_f32_16x16x32_bf16 v[188:191], a[212:215], v[68:71], v[188:191]
ds_read_b64_tr_b16 a[200:201], v6 offset:512
v_cvt_pk_bf16_f32 v254, v144, v145
v_mfma_f32_16x16x32_bf16 v[192:195], a[212:215], v[72:75], v[192:195]
ds_read_b64_tr_b16 a[202:203], v6 offset:2560
v_cvt_pk_bf16_f32 v255, v146, v147
buffer_store_dwordx4 v[252:255], v26, s[20:23], s42 offen offset:0 sc1
v_mfma_f32_16x16x32_bf16 v[196:199], a[212:215], v[76:79], v[196:199]
s_waitcnt lgkmcnt(8)
v_mul_f32 v156, v20, v156
v_mul_f32 v157, v20, v157
v_mfma_f32_16x16x32_bf16 v[200:203], a[216:219], v[68:71], v[200:203]
ds_read_b64_tr_b16 a[204:205], v27 offset:512
v_mul_f32 v158, v20, v158
v_mfma_f32_16x16x32_bf16 v[204:207], a[216:219], v[72:75], v[204:207]
ds_read_b64_tr_b16 a[206:207], v27 offset:2560
v_mul_f32 v159, v20, v159
v_mfma_f32_16x16x32_bf16 v[208:211], a[216:219], v[76:79], v[208:211]
s_waitcnt lgkmcnt(8)
v_cvt_pk_bf16_f32 v236, v156, v157
v_cvt_pk_bf16_f32 v237, v158, v159
v_mfma_f32_16x16x32_bf16 v[212:215], a[220:223], v[68:71], v[212:215]
ds_read_b64_tr_b16 a[208:209], v6 offset:4096
ds_read_b64_tr_b16 a[210:211], v6 offset:6144
v_mul_f32 v168, v20, v168
v_mfma_f32_16x16x32_bf16 v[216:219], a[220:223], v[72:75], v[216:219]
v_add_u32 v10, 1, v10
v_mul_f32 v169, v20, v169
v_mfma_f32_16x16x32_bf16 v[220:223], a[220:223], v[76:79], v[220:223]
ds_write_b32 v8, v10
s_waitcnt lgkmcnt(9)
v_mul_f32 v170, v20, v170
v_mfma_f32_16x16x32_bf16 v[176:179], a[192:195], v[80:83], v[176:179]
ds_read_b64_tr_b16 a[212:213], v27 offset:4096
v_mul_f32 v171, v20, v171
v_mfma_f32_16x16x32_bf16 v[180:183], a[192:195], v[84:87], v[180:183]
ds_read_b64_tr_b16 a[214:215], v27 offset:6144
v_cvt_pk_bf16_f32 v238, v168, v169
v_mfma_f32_16x16x32_bf16 v[184:187], a[192:195], v[88:91], v[184:187]
s_waitcnt lgkmcnt(9)
v_cvt_pk_bf16_f32 v239, v170, v171
buffer_store_dwordx4 v[236:239], v26, s[20:23], s42 offen offset:1024 sc1
v_mfma_f32_16x16x32_bf16 v[188:191], a[196:199], v[80:83], v[188:191]
ds_read_b64_tr_b16 a[216:217], v6 offset:4608
s_add_u32 s42, s42, 14336
v_mul_f32 v136, v21, v136
v_mfma_f32_16x16x32_bf16 v[192:195], a[196:199], v[84:87], v[192:195]
ds_read_b64_tr_b16 a[218:219], v6 offset:6656
v_mul_f32 v137, v21, v137
v_mfma_f32_16x16x32_bf16 v[196:199], a[196:199], v[88:91], v[196:199]
s_waitcnt lgkmcnt(9)
v_mul_f32 v138, v21, v138
v_mul_f32 v139, v21, v139
v_mfma_f32_16x16x32_bf16 v[200:203], a[200:203], v[80:83], v[200:203]
ds_read_b64_tr_b16 a[220:221], v27 offset:4608
v_cvt_pk_bf16_f32 v240, v136, v137
v_mfma_f32_16x16x32_bf16 v[204:207], a[200:203], v[84:87], v[204:207]
ds_read_b64_tr_b16 a[222:223], v27 offset:6656
v_cvt_pk_bf16_f32 v241, v138, v139
v_mfma_f32_16x16x32_bf16 v[208:211], a[200:203], v[88:91], v[208:211]
s_waitcnt lgkmcnt(9)
v_mul_f32 v148, v21, v148
v_mul_f32 v149, v21, v149
v_mfma_f32_16x16x32_bf16 v[212:215], a[204:207], v[80:83], v[212:215]
ds_read_b64_tr_b16 a[192:193], v6 offset:8192
v_mul_f32 v150, v21, v150
v_mfma_f32_16x16x32_bf16 v[216:219], a[204:207], v[84:87], v[216:219]
ds_read_b64_tr_b16 a[194:195], v6 offset:10240
v_mul_f32 v151, v21, v151
v_mfma_f32_16x16x32_bf16 v[220:223], a[204:207], v[88:91], v[220:223]
s_waitcnt lgkmcnt(9)
v_cvt_pk_bf16_f32 v242, v148, v149
v_cvt_pk_bf16_f32 v243, v150, v151
v_mfma_f32_16x16x32_bf16 v[176:179], a[208:211], v[92:95], v[176:179]
ds_read_b64_tr_b16 a[196:197], v27 offset:8192
buffer_store_dwordx4 v[240:243], v26, s[20:23], s42 offen offset:0 sc1
v_mul_f32 v160, v21, v160
v_mfma_f32_16x16x32_bf16 v[180:183], a[208:211], v[96:99], v[180:183]
ds_read_b64_tr_b16 a[198:199], v27 offset:10240
v_mul_f32 v161, v21, v161
v_mfma_f32_16x16x32_bf16 v[184:187], a[208:211], v[100:103], v[184:187]
s_waitcnt lgkmcnt(8)
v_mul_f32 v162, v21, v162
v_mul_f32 v163, v21, v163
v_mfma_f32_16x16x32_bf16 v[188:191], a[212:215], v[92:95], v[188:191]
ds_read_b64_tr_b16 a[200:201], v6 offset:8704
v_cvt_pk_bf16_f32 v244, v160, v161
v_mfma_f32_16x16x32_bf16 v[192:195], a[212:215], v[96:99], v[192:195]
ds_read_b64_tr_b16 a[202:203], v6 offset:10752
v_cvt_pk_bf16_f32 v245, v162, v163
v_mfma_f32_16x16x32_bf16 v[196:199], a[212:215], v[100:103], v[196:199]
s_waitcnt lgkmcnt(8)
v_mul_f32 v172, v21, v172
v_mul_f32 v173, v21, v173
v_mfma_f32_16x16x32_bf16 v[200:203], a[216:219], v[92:95], v[200:203]
ds_read_b64_tr_b16 a[204:205], v27 offset:8704
v_mul_f32 v174, v21, v174
v_mfma_f32_16x16x32_bf16 v[204:207], a[216:219], v[96:99], v[204:207]
ds_read_b64_tr_b16 a[206:207], v27 offset:10752
v_mul_f32 v175, v21, v175
v_mfma_f32_16x16x32_bf16 v[208:211], a[216:219], v[100:103], v[208:211]
s_waitcnt lgkmcnt(8)
v_cvt_pk_bf16_f32 v246, v172, v173
v_cvt_pk_bf16_f32 v247, v174, v175
v_mfma_f32_16x16x32_bf16 v[212:215], a[220:223], v[92:95], v[212:215]
ds_read_b64_tr_b16 a[208:209], v6 offset:12288
buffer_store_dwordx4 v[244:247], v26, s[20:23], s42 offen offset:1024 sc1
s_waitcnt vmcnt(6)
s_mov_b64 exec, 1
buffer_store_dwordx2 v[224:225], v226, s[20:23], s83 offen offset:384 sc1
s_mov_b64 exec, -1
v_mfma_f32_16x16x32_bf16 v[216:219], a[220:223], v[96:99], v[216:219]
ds_read_b64_tr_b16 a[210:211], v6 offset:14336
v_mfma_f32_16x16x32_bf16 v[220:223], a[220:223], v[100:103], v[220:223]
ds_read_b32 v25, v9
s_waitcnt lgkmcnt(9)
v_mfma_f32_16x16x32_bf16 v[176:179], a[192:195], v[104:107], v[176:179]
ds_read_b64_tr_b16 a[212:213], v27 offset:12288
v_mfma_f32_16x16x32_bf16 v[180:183], a[192:195], v[108:111], v[180:183]
ds_read_b64_tr_b16 a[214:215], v27 offset:14336
v_mfma_f32_16x16x32_bf16 v[184:187], a[192:195], v[112:115], v[184:187]
s_waitcnt lgkmcnt(9)
v_mfma_f32_16x16x32_bf16 v[188:191], a[196:199], v[104:107], v[188:191]
ds_read_b64_tr_b16 a[216:217], v6 offset:12800
v_mfma_f32_16x16x32_bf16 v[192:195], a[196:199], v[108:111], v[192:195]
ds_read_b64_tr_b16 a[218:219], v6 offset:14848
v_mfma_f32_16x16x32_bf16 v[196:199], a[196:199], v[112:115], v[196:199]
s_waitcnt lgkmcnt(9)
v_mfma_f32_16x16x32_bf16 v[200:203], a[200:203], v[104:107], v[200:203]
ds_read_b64_tr_b16 a[220:221], v27 offset:12800
ds_read_b64_tr_b16 a[222:223], v27 offset:14848
s_waitcnt lgkmcnt(6)
v_mfma_f32_16x16x32_bf16 v[204:207], a[200:203], v[108:111], v[204:207]
v_readfirstlane_b32 s39, v25
s_add_u32 s38, s38, 1
s_cmp_ge_u32 s39, s38
s_cbranch_scc0 L_poll89
L_ret90:
v_mfma_f32_16x16x32_bf16 v[208:211], a[200:203], v[112:115], v[208:211]
v_add_u32 v6, s40, v4
v_add_u32 v27, s40, v5
v_mfma_f32_16x16x32_bf16 v[212:215], a[204:207], v[104:107], v[212:215]
ds_read_b64_tr_b16 a[192:193], v6 offset:0
v_mfma_f32_16x16x32_bf16 v[216:219], a[204:207], v[108:111], v[216:219]
ds_read_b64_tr_b16 a[194:195], v6 offset:2048
v_mfma_f32_16x16x32_bf16 v[220:223], a[204:207], v[112:115], v[220:223]
v_mfma_f32_16x16x32_bf16 v[176:179], a[208:211], v[116:119], v[176:179]
ds_read_b64_tr_b16 a[196:197], v27 offset:0
ds_read_b64_tr_b16 a[198:199], v27 offset:2048
v_mfma_f32_16x16x32_bf16 v[180:183], a[208:211], v[120:123], v[180:183]
s_add_u32 s40, s40, 16896
v_mfma_f32_16x16x32_bf16 v[184:187], a[208:211], v[124:127], v[184:187]
s_cmp_eq_u32 s40, 152064
s_cselect_b32 s40, 0, s40
s_waitcnt lgkmcnt(8)
v_mfma_f32_16x16x32_bf16 v[188:191], a[212:215], v[116:119], v[188:191]
ds_read_b64_tr_b16 a[200:201], v6 offset:512
v_mfma_f32_16x16x32_bf16 v[192:195], a[212:215], v[120:123], v[192:195]
ds_read_b64_tr_b16 a[202:203], v6 offset:2560
v_mfma_f32_16x16x32_bf16 v[196:199], a[212:215], v[124:127], v[196:199]
s_waitcnt lgkmcnt(8)
v_mfma_f32_16x16x32_bf16 v[200:203], a[216:219], v[116:119], v[200:203]
ds_read_b64_tr_b16 a[204:205], v27 offset:512
v_mfma_f32_16x16x32_bf16 v[204:207], a[216:219], v[120:123], v[204:207]
ds_read_b64_tr_b16 a[206:207], v27 offset:2560
v_mfma_f32_16x16x32_bf16 v[208:211], a[216:219], v[124:127], v[208:211]
s_waitcnt lgkmcnt(8)
v_mfma_f32_16x16x32_bf16 v[212:215], a[220:223], v[116:119], v[212:215]
ds_read_b64_tr_b16 a[208:209], v6 offset:4096
ds_read_b64_tr_b16 a[210:211], v6 offset:6144
v_mfma_f32_16x16x32_bf16 v[216:219], a[220:223], v[120:123], v[216:219]
v_add_u32 v10, 1, v10
v_mfma_f32_16x16x32_bf16 v[220:223], a[220:223], v[124:127], v[220:223]
ds_write_b32 v8, v10
s_waitcnt lgkmcnt(9)
v_mfma_f32_16x16x32_bf16 v[128:131], a[192:195], v[32:35], 0
ds_read_b64_tr_b16 a[212:213], v27 offset:4096
v_mfma_f32_16x16x32_bf16 v[132:135], a[192:195], v[36:39], 0
ds_read_b64_tr_b16 a[214:215], v27 offset:6144
v_mfma_f32_16x16x32_bf16 v[136:139], a[192:195], v[40:43], 0
s_waitcnt lgkmcnt(9)
v_mfma_f32_16x16x32_bf16 v[140:143], a[196:199], v[32:35], 0
ds_read_b64_tr_b16 a[216:217], v6 offset:4608
v_mfma_f32_16x16x32_bf16 v[144:147], a[196:199], v[36:39], 0
ds_read_b64_tr_b16 a[218:219], v6 offset:6656
v_mfma_f32_16x16x32_bf16 v[148:151], a[196:199], v[40:43], 0
s_waitcnt lgkmcnt(9)
v_mfma_f32_16x16x32_bf16 v[152:155], a[200:203], v[32:35], 0
ds_read_b64_tr_b16 a[220:221], v27 offset:4608
v_mfma_f32_16x16x32_bf16 v[156:159], a[200:203], v[36:39], 0
ds_read_b64_tr_b16 a[222:223], v27 offset:6656
v_mfma_f32_16x16x32_bf16 v[160:163], a[200:203], v[40:43], 0
s_waitcnt lgkmcnt(9)
v_mfma_f32_16x16x32_bf16 v[164:167], a[204:207], v[32:35], 0
ds_read_b64_tr_b16 a[192:193], v6 offset:8192
s_add_u32 s42, s46, 6144
v_mul_f32 v176, v19, v176
v_mfma_f32_16x16x32_bf16 v[168:171], a[204:207], v[36:39], 0
ds_read_b64_tr_b16 a[194:195], v6 offset:10240
v_mul_f32 v177, v19, v177
v_mfma_f32_16x16x32_bf16 v[172:175], a[204:207], v[40:43], 0
s_waitcnt lgkmcnt(9)
v_mul_f32 v178, v19, v178
v_mul_f32 v179, v19, v179
v_mfma_f32_16x16x32_bf16 v[128:131], a[208:211], v[44:47], v[128:131]
ds_read_b64_tr_b16 a[196:197], v27 offset:8192
v_cvt_pk_bf16_f32 v248, v176, v177
v_mfma_f32_16x16x32_bf16 v[132:135], a[208:211], v[48:51], v[132:135]
ds_read_b64_tr_b16 a[198:199], v27 offset:10240
v_cvt_pk_bf16_f32 v249, v178, v179
v_mfma_f32_16x16x32_bf16 v[136:139], a[208:211], v[52:55], v[136:139]
s_waitcnt lgkmcnt(8)
v_mul_f32 v188, v19, v188
v_mul_f32 v189, v19, v189
v_mfma_f32_16x16x32_bf16 v[140:143], a[212:215], v[44:47], v[140:143]
ds_read_b64_tr_b16 a[200:201], v6 offset:8704
v_mul_f32 v190, v19, v190
v_mfma_f32_16x16x32_bf16 v[144:147], a[212:215], v[48:51], v[144:147]
ds_read_b64_tr_b16 a[202:203], v6 offset:10752
v_mul_f32 v191, v19, v191
v_mfma_f32_16x16x32_bf16 v[148:151], a[212:215], v[52:55], v[148:151]
s_waitcnt lgkmcnt(8)
v_cvt_pk_bf16_f32 v250, v188, v189
v_cvt_pk_bf16_f32 v251, v190, v191
v_mfma_f32_16x16x32_bf16 v[152:155], a[216:219], v[44:47], v[152:155]
ds_read_b64_tr_b16 a[204:205], v27 offset:8704
buffer_store_dwordx4 v[248:251], v26, s[20:23], s42 offen offset:0 sc1
v_mul_f32 v200, v19, v200
v_mfma_f32_16x16x32_bf16 v[156:159], a[216:219], v[48:51], v[156:159]
ds_read_b64_tr_b16 a[206:207], v27 offset:10752
v_mul_f32 v201, v19, v201
v_mfma_f32_16x16x32_bf16 v[160:163], a[216:219], v[52:55], v[160:163]
s_waitcnt lgkmcnt(8)
v_mul_f32 v202, v19, v202
v_mul_f32 v203, v19, v203
v_mfma_f32_16x16x32_bf16 v[164:167], a[220:223], v[44:47], v[164:167]
ds_read_b64_tr_b16 a[208:209], v6 offset:12288
v_cvt_pk_bf16_f32 v252, v200, v201
v_mfma_f32_16x16x32_bf16 v[168:171], a[220:223], v[48:51], v[168:171]
ds_read_b64_tr_b16 a[210:211], v6 offset:14336
v_cvt_pk_bf16_f32 v253, v202, v203
v_mfma_f32_16x16x32_bf16 v[172:175], a[220:223], v[52:55], v[172:175]
ds_read_b32 v25, v9
s_waitcnt lgkmcnt(9)
v_mul_f32 v212, v19, v212
v_mfma_f32_16x16x32_bf16 v[128:131], a[192:195], v[56:59], v[128:131]
ds_read_b64_tr_b16 a[212:213], v27 offset:12288
v_mul_f32 v213, v19, v213
v_mfma_f32_16x16x32_bf16 v[132:135], a[192:195], v[60:63], v[132:135]
ds_read_b64_tr_b16 a[214:215], v27 offset:14336
v_mul_f32 v214, v19, v214
v_mfma_f32_16x16x32_bf16 v[136:139], a[192:195], v[64:67], v[136:139]
s_waitcnt lgkmcnt(9)
v_mul_f32 v215, v19, v215
v_cvt_pk_bf16_f32 v254, v212, v213
v_mfma_f32_16x16x32_bf16 v[140:143], a[196:199], v[56:59], v[140:143]
ds_read_b64_tr_b16 a[216:217], v6 offset:12800
v_cvt_pk_bf16_f32 v255, v214, v215
buffer_store_dwordx4 v[252:255], v26, s[20:23], s42 offen offset:1024 sc1
v_mfma_f32_16x16x32_bf16 v[144:147], a[196:199], v[60:63], v[144:147]
ds_read_b64_tr_b16 a[218:219], v6 offset:14848
s_add_u32 s42, s42, 14336
v_mul_f32 v180, v20, v180
v_mfma_f32_16x16x32_bf16 v[148:151], a[196:199], v[64:67], v[148:151]
s_waitcnt lgkmcnt(9)
v_mul_f32 v181, v20, v181
v_mul_f32 v182, v20, v182
v_mfma_f32_16x16x32_bf16 v[152:155], a[200:203], v[56:59], v[152:155]
ds_read_b64_tr_b16 a[220:221], v27 offset:12800
ds_read_b64_tr_b16 a[222:223], v27 offset:14848
s_waitcnt lgkmcnt(6)
v_mfma_f32_16x16x32_bf16 v[156:159], a[200:203], v[60:63], v[156:159]
v_readfirstlane_b32 s39, v25
s_add_u32 s38, s38, 1
s_cmp_ge_u32 s39, s38
s_cbranch_scc0 L_poll91
L_ret92:
v_mfma_f32_16x16x32_bf16 v[160:163], a[200:203], v[64:67], v[160:163]
v_add_u32 v6, s40, v4
v_add_u32 v27, s40, v5
v_mfma_f32_16x16x32_bf16 v[164:167], a[204:207], v[56:59], v[164:167]
ds_read_b64_tr_b16 a[192:193], v6 offset:0
v_mul_f32 v183, v20, v183
v_mfma_f32_16x16x32_bf16 v[168:171], a[204:207], v[60:63], v[168:171]
ds_read_b64_tr_b16 a[194:195], v6 offset:2048
v_cvt_pk_bf16_f32 v236, v180, v181
v_mfma_f32_16x16x32_bf16 v[172:175], a[204:207], v[64:67], v[172:175]
v_cvt_pk_bf16_f32 v237, v182, v183
v_mul_f32 v192, v20, v192
v_mfma_f32_16x16x32_bf16 v[128:131], a[208:211], v[68:71], v[128:131]
ds_read_b64_tr_b16 a[196:197], v27 offset:0
ds_read_b64_tr_b16 a[198:199], v27 offset:2048
v_mul_f32 v193, v20, v193
v_mfma_f32_16x16x32_bf16 v[132:135], a[208:211], v[72:75], v[132:135]
s_add_u32 s40, s40, 16896
v_mul_f32 v194, v20, v194
v_mul_f32 v195, v20, v195
v_mfma_f32_16x16x32_bf16 v[136:139], a[208:211], v[76:79], v[136:139]
s_cmp_eq_u32 s40, 152064
s_cselect_b32 s40, 0, s40
s_waitcnt lgkmcnt(8)
v_mfma_f32_16x16x32_bf16 v[140:143], a[212:215], v[68:71], v[140:143]
ds_read_b64_tr_b16 a[200:201], v6 offset:512
v_cvt_pk_bf16_f32 v238, v192, v193
v_mfma_f32_16x16x32_bf16 v[144:147], a[212:215], v[72:75], v[144:147]
ds_read_b64_tr_b16 a[202:203], v6 offset:2560
v_cvt_pk_bf16_f32 v239, v194, v195
buffer_store_dwordx4 v[236:239], v26, s[20:23], s42 offen offset:0 sc1
v_mfma_f32_16x16x32_bf16 v[148:151], a[212:215], v[76:79], v[148:151]
s_waitcnt lgkmcnt(8)
v_mul_f32 v204, v20, v204
v_mul_f32 v205, v20, v205
v_mfma_f32_16x16x32_bf16 v[152:155], a[216:219], v[68:71], v[152:155]
ds_read_b64_tr_b16 a[204:205], v27 offset:512
v_mul_f32 v206, v20, v206
v_mfma_f32_16x16x32_bf16 v[156:159], a[216:219], v[72:75], v[156:159]
ds_read_b64_tr_b16 a[206:207], v27 offset:2560
v_mul_f32 v207, v20, v207
v_mfma_f32_16x16x32_bf16 v[160:163], a[216:219], v[76:79], v[160:163]
s_waitcnt lgkmcnt(8)
v_cvt_pk_bf16_f32 v240, v204, v205
v_cvt_pk_bf16_f32 v241, v206, v207
v_mfma_f32_16x16x32_bf16 v[164:167], a[220:223], v[68:71], v[164:167]
ds_read_b64_tr_b16 a[208:209], v6 offset:4096
ds_read_b64_tr_b16 a[210:211], v6 offset:6144
v_mul_f32 v216, v20, v216
v_mfma_f32_16x16x32_bf16 v[168:171], a[220:223], v[72:75], v[168:171]
v_add_u32 v10, 1, v10
v_mul_f32 v217, v20, v217
v_mfma_f32_16x16x32_bf16 v[172:175], a[220:223], v[76:79], v[172:175]
ds_write_b32 v8, v10
s_waitcnt lgkmcnt(9)
v_mul_f32 v218, v20, v218
v_mfma_f32_16x16x32_bf16 v[128:131], a[192:195], v[80:83], v[128:131]
ds_read_b64_tr_b16 a[212:213], v27 offset:4096
v_mul_f32 v219, v20, v219
v_mfma_f32_16x16x32_bf16 v[132:135], a[192:195], v[84:87], v[132:135]
ds_read_b64_tr_b16 a[214:215], v27 offset:6144
v_cvt_pk_bf16_f32 v242, v216, v217
v_mfma_f32_16x16x32_bf16 v[136:139], a[192:195], v[88:91], v[136:139]
s_waitcnt lgkmcnt(9)
v_cvt_pk_bf16_f32 v243, v218, v219
buffer_store_dwordx4 v[240:243], v26, s[20:23], s42 offen offset:1024 sc1
v_mfma_f32_16x16x32_bf16 v[140:143], a[196:199], v[80:83], v[140:143]
ds_read_b64_tr_b16 a[216:217], v6 offset:4608
s_add_u32 s42, s42, 14336
v_mul_f32 v184, v21, v184
v_mfma_f32_16x16x32_bf16 v[144:147], a[196:199], v[84:87], v[144:147]
ds_read_b64_tr_b16 a[218:219], v6 offset:6656
v_mul_f32 v185, v21, v185
v_mfma_f32_16x16x32_bf16 v[148:151], a[196:199], v[88:91], v[148:151]
s_waitcnt lgkmcnt(9)
v_mul_f32 v186, v21, v186
v_mul_f32 v187, v21, v187
v_mfma_f32_16x16x32_bf16 v[152:155], a[200:203], v[80:83], v[152:155]
ds_read_b64_tr_b16 a[220:221], v27 offset:4608
v_cvt_pk_bf16_f32 v244, v184, v185
v_mfma_f32_16x16x32_bf16 v[156:159], a[200:203], v[84:87], v[156:159]
ds_read_b64_tr_b16 a[222:223], v27 offset:6656
v_cvt_pk_bf16_f32 v245, v186, v187
v_mfma_f32_16x16x32_bf16 v[160:163], a[200:203], v[88:91], v[160:163]
s_waitcnt lgkmcnt(9)
v_mul_f32 v196, v21, v196
v_mul_f32 v197, v21, v197
v_mfma_f32_16x16x32_bf16 v[164:167], a[204:207], v[80:83], v[164:167]
ds_read_b64_tr_b16 a[192:193], v6 offset:8192
v_mul_f32 v198, v21, v198
v_mfma_f32_16x16x32_bf16 v[168:171], a[204:207], v[84:87], v[168:171]
ds_read_b64_tr_b16 a[194:195], v6 offset:10240
v_mul_f32 v199, v21, v199
v_mfma_f32_16x16x32_bf16 v[172:175], a[204:207], v[88:91], v[172:175]
s_waitcnt lgkmcnt(9)
v_cvt_pk_bf16_f32 v246, v196, v197
v_cvt_pk_bf16_f32 v247, v198, v199
v_mfma_f32_16x16x32_bf16 v[128:131], a[208:211], v[92:95], v[128:131]
ds_read_b64_tr_b16 a[196:197], v27 offset:8192
buffer_store_dwordx4 v[244:247], v26, s[20:23], s42 offen offset:0 sc1
v_mul_f32 v208, v21, v208
v_mfma_f32_16x16x32_bf16 v[132:135], a[208:211], v[96:99], v[132:135]
ds_read_b64_tr_b16 a[198:199], v27 offset:10240
v_mul_f32 v209, v21, v209
v_mfma_f32_16x16x32_bf16 v[136:139], a[208:211], v[100:103], v[136:139]
s_waitcnt lgkmcnt(8)
v_mul_f32 v210, v21, v210
v_mul_f32 v211, v21, v211
v_mfma_f32_16x16x32_bf16 v[140:143], a[212:215], v[92:95], v[140:143]
ds_read_b64_tr_b16 a[200:201], v6 offset:8704
v_cvt_pk_bf16_f32 v248, v208, v209
v_mfma_f32_16x16x32_bf16 v[144:147], a[212:215], v[96:99], v[144:147]
ds_read_b64_tr_b16 a[202:203], v6 offset:10752
v_cvt_pk_bf16_f32 v249, v210, v211
v_mfma_f32_16x16x32_bf16 v[148:151], a[212:215], v[100:103], v[148:151]
s_waitcnt lgkmcnt(8)
v_mul_f32 v220, v21, v220
v_mul_f32 v221, v21, v221
v_mfma_f32_16x16x32_bf16 v[152:155], a[216:219], v[92:95], v[152:155]
ds_read_b64_tr_b16 a[204:205], v27 offset:8704
v_mul_f32 v222, v21, v222
v_mfma_f32_16x16x32_bf16 v[156:159], a[216:219], v[96:99], v[156:159]
ds_read_b64_tr_b16 a[206:207], v27 offset:10752
v_mul_f32 v223, v21, v223
v_mfma_f32_16x16x32_bf16 v[160:163], a[216:219], v[100:103], v[160:163]
s_waitcnt lgkmcnt(8)
v_cvt_pk_bf16_f32 v250, v220, v221
v_cvt_pk_bf16_f32 v251, v222, v223
v_mfma_f32_16x16x32_bf16 v[164:167], a[220:223], v[92:95], v[164:167]
ds_read_b64_tr_b16 a[208:209], v6 offset:12288
buffer_store_dwordx4 v[248:251], v26, s[20:23], s42 offen offset:1024 sc1
s_waitcnt vmcnt(6)
s_mov_b64 exec, 1
buffer_store_dwordx2 v[224:225], v226, s[20:23], s83 offen offset:768 sc1
s_mov_b64 exec, -1
v_mfma_f32_16x16x32_bf16 v[168:171], a[220:223], v[96:99], v[168:171]
ds_read_b64_tr_b16 a[210:211], v6 offset:14336
v_mfma_f32_16x16x32_bf16 v[172:175], a[220:223], v[100:103], v[172:175]
ds_read_b32 v25, v9
s_waitcnt lgkmcnt(9)
v_mfma_f32_16x16x32_bf16 v[128:131], a[192:195], v[104:107], v[128:131]
ds_read_b64_tr_b16 a[212:213], v27 offset:12288
v_mfma_f32_16x16x32_bf16 v[132:135], a[192:195], v[108:111], v[132:135]
ds_read_b64_tr_b16 a[214:215], v27 offset:14336
v_mfma_f32_16x16x32_bf16 v[136:139], a[192:195], v[112:115], v[136:139]
s_waitcnt lgkmcnt(9)
v_mfma_f32_16x16x32_bf16 v[140:143], a[196:199], v[104:107], v[140:143]
ds_read_b64_tr_b16 a[216:217], v6 offset:12800
v_mfma_f32_16x16x32_bf16 v[144:147], a[196:199], v[108:111], v[144:147]
ds_read_b64_tr_b16 a[218:219], v6 offset:14848
v_mfma_f32_16x16x32_bf16 v[148:151], a[196:199], v[112:115], v[148:151]
s_waitcnt lgkmcnt(9)
v_mfma_f32_16x16x32_bf16 v[152:155], a[200:203], v[104:107], v[152:155]
ds_read_b64_tr_b16 a[220:221], v27 offset:12800
ds_read_b64_tr_b16 a[222:223], v27 offset:14848
s_waitcnt lgkmcnt(6)
v_mfma_f32_16x16x32_bf16 v[156:159], a[200:203], v[108:111], v[156:159]
v_readfirstlane_b32 s39, v25
s_add_u32 s38, s38, 1
s_cmp_ge_u32 s39, s38
s_cbranch_scc0 L_poll93
L_ret94:
v_mfma_f32_16x16x32_bf16 v[160:163], a[200:203], v[112:115], v[160:163]
v_add_u32 v6, s40, v4
v_add_u32 v27, s40, v5
v_mfma_f32_16x16x32_bf16 v[164:167], a[204:207], v[104:107], v[164:167]
ds_read_b64_tr_b16 a[192:193], v6 offset:0
v_mfma_f32_16x16x32_bf16 v[168:171], a[204:207], v[108:111], v[168:171]
ds_read_b64_tr_b16 a[194:195], v6 offset:2048
v_mfma_f32_16x16x32_bf16 v[172:175], a[204:207], v[112:115], v[172:175]
v_mfma_f32_16x16x32_bf16 v[128:131], a[208:211], v[116:119], v[128:131]
ds_read_b64_tr_b16 a[196:197], v27 offset:0
ds_read_b64_tr_b16 a[198:199], v27 offset:2048
v_mfma_f32_16x16x32_bf16 v[132:135], a[208:211], v[120:123], v[132:135]
s_add_u32 s40, s40, 16896
v_mfma_f32_16x16x32_bf16 v[136:139], a[208:211], v[124:127], v[136:139]
s_cmp_eq_u32 s40, 152064
s_cselect_b32 s40, 0, s40
s_waitcnt lgkmcnt(8)
v_mfma_f32_16x16x32_bf16 v[140:143], a[212:215], v[116:119], v[140:143]
ds_read_b64_tr_b16 a[200:201], v6 offset:512
v_mfma_f32_16x16x32_bf16 v[144:147], a[212:215], v[120:123], v[144:147]
ds_read_b64_tr_b16 a[202:203], v6 offset:2560
v_mfma_f32_16x16x32_bf16 v[148:151], a[212:215], v[124:127], v[148:151]
s_waitcnt lgkmcnt(8)
v_mfma_f32_16x16x32_bf16 v[152:155], a[216:219], v[116:119], v[152:155]
ds_read_b64_tr_b16 a[204:205], v27 offset:512
v_mfma_f32_16x16x32_bf16 v[156:159], a[216:219], v[120:123], v[156:159]
ds_read_b64_tr_b16 a[206:207], v27 offset:2560
v_mfma_f32_16x16x32_bf16 v[160:163], a[216:219], v[124:127], v[160:163]
s_waitcnt lgkmcnt(8)
v_mfma_f32_16x16x32_bf16 v[164:167], a[220:223], v[116:119], v[164:167]
ds_read_b64_tr_b16 a[208:209], v6 offset:4096
ds_read_b64_tr_b16 a[210:211], v6 offset:6144
v_mfma_f32_16x16x32_bf16 v[168:171], a[220:223], v[120:123], v[168:171]
v_add_u32 v10, 1, v10
v_mfma_f32_16x16x32_bf16 v[172:175], a[220:223], v[124:127], v[172:175]
ds_write_b32 v8, v10
s_waitcnt lgkmcnt(9)
v_mfma_f32_16x16x32_bf16 v[176:179], a[192:195], v[32:35], 0
ds_read_b64_tr_b16 a[212:213], v27 offset:4096
v_mfma_f32_16x16x32_bf16 v[180:183], a[192:195], v[36:39], 0
ds_read_b64_tr_b16 a[214:215], v27 offset:6144
v_mfma_f32_16x16x32_bf16 v[184:187], a[192:195], v[40:43], 0
s_waitcnt lgkmcnt(9)
v_mfma_f32_16x16x32_bf16 v[188:191], a[196:199], v[32:35], 0
ds_read_b64_tr_b16 a[216:217], v6 offset:4608
v_mfma_f32_16x16x32_bf16 v[192:195], a[196:199], v[36:39], 0
ds_read_b64_tr_b16 a[218:219], v6 offset:6656
v_mfma_f32_16x16x32_bf16 v[196:199], a[196:199], v[40:43], 0
s_waitcnt lgkmcnt(9)
v_mfma_f32_16x16x32_bf16 v[200:203], a[200:203], v[32:35], 0
ds_read_b64_tr_b16 a[220:221], v27 offset:4608
v_mfma_f32_16x16x32_bf16 v[204:207], a[200:203], v[36:39], 0
ds_read_b64_tr_b16 a[222:223], v27 offset:6656
v_mfma_f32_16x16x32_bf16 v[208:211], a[200:203], v[40:43], 0
s_waitcnt lgkmcnt(9)
v_mfma_f32_16x16x32_bf16 v[212:215], a[204:207], v[32:35], 0
ds_read_b64_tr_b16 a[192:193], v6 offset:8192
s_add_u32 s42, s46, 8192
v_mul_f32 v128, v19, v128
v_mfma_f32_16x16x32_bf16 v[216:219], a[204:207], v[36:39], 0
ds_read_b64_tr_b16 a[194:195], v6 offset:10240
v_mul_f32 v129, v19, v129
v_mfma_f32_16x16x32_bf16 v[220:223], a[204:207], v[40:43], 0
s_waitcnt lgkmcnt(9)
v_mul_f32 v130, v19, v130
v_mul_f32 v131, v19, v131
v_mfma_f32_16x16x32_bf16 v[176:179], a[208:211], v[44:47], v[176:179]
ds_read_b64_tr_b16 a[196:197], v27 offset:8192
v_cvt_pk_bf16_f32 v252, v128, v129
v_mfma_f32_16x16x32_bf16 v[180:183], a[208:211], v[48:51], v[180:183]
ds_read_b64_tr_b16 a[198:199], v27 offset:10240
v_cvt_pk_bf16_f32 v253, v130, v131
v_mfma_f32_16x16x32_bf16 v[184:187], a[208:211], v[52:55], v[184:187]
s_waitcnt lgkmcnt(8)
v_mul_f32 v140, v19, v140
v_mul_f32 v141, v19, v141
v_mfma_f32_16x16x32_bf16 v[188:191], a[212:215], v[44:47], v[188:191]
ds_read_b64_tr_b16 a[200:201], v6 offset:8704
v_mul_f32 v142, v19, v142
v_mfma_f32_16x16x32_bf16 v[192:195], a[212:215], v[48:51], v[192:195]
ds_read_b64_tr_b16 a[202:203], v6 offset:10752
v_mul_f32 v143, v19, v143
v_mfma_f32_16x16x32_bf16 v[196:199], a[212:215], v[52:55], v[196:199]
s_waitcnt lgkmcnt(8)
v_cvt_pk_bf16_f32 v254, v140, v141
v_cvt_pk_bf16_f32 v255, v142, v143
v_mfma_f32_16x16x32_bf16 v[200:203], a[216:219], v[44:47], v[200:203]
ds_read_b64_tr_b16 a[204:205], v27 offset:8704
buffer_store_dwordx4 v[252:255], v26, s[20:23], s42 offen offset:0 sc1
v_mul_f32 v152, v19, v152
v_mfma_f32_16x16x32_bf16 v[204:207], a[216:219], v[48:51], v[204:207]
ds_read_b64_tr_b16 a[206:207], v27 offset:10752
v_mul_f32 v153, v19, v153
v_mfma_f32_16x16x32_bf16 v[208:211], a[216:219], v[52:55], v[208:211]
s_waitcnt lgkmcnt(8)
v_mul_f32 v154, v19, v154
v_mul_f32 v155, v19, v155
v_mfma_f32_16x16x32_bf16 v[212:215], a[220:223], v[44:47], v[212:215]
ds_read_b64_tr_b16 a[208:209], v6 offset:12288
v_cvt_pk_bf16_f32 v236, v152, v153
v_mfma_f32_16x16x32_bf16 v[216:219], a[220:223], v[48:51], v[216:219]
ds_read_b64_tr_b16 a[210:211], v6 offset:14336
v_cvt_pk_bf16_f32 v237, v154, v155
v_mfma_f32_16x16x32_bf16 v[220:223], a[220:223], v[52:55], v[220:223]
ds_read_b32 v25, v9
s_waitcnt lgkmcnt(9)
v_mul_f32 v164, v19, v164
v_mfma_f32_16x16x32_bf16 v[176:179], a[192:195], v[56:59], v[176:179]
ds_read_b64_tr_b16 a[212:213], v27 offset:12288
v_mul_f32 v165, v19, v165
v_mfma_f32_16x16x32_bf16 v[180:183], a[192:195], v[60:63], v[180:183]
ds_read_b64_tr_b16 a[214:215], v27 offset:14336
v_mul_f32 v166, v19, v166
v_mfma_f32_16x16x32_bf16 v[184:187], a[192:195], v[64:67], v[184:187]
s_waitcnt lgkmcnt(9)
v_mul_f32 v167, v19, v167
v_cvt_pk_bf16_f32 v238, v164, v165
v_mfma_f32_16x16x32_bf16 v[188:191], a[196:199], v[56:59], v[188:191]
ds_read_b64_tr_b16 a[216:217], v6 offset:12800
v_cvt_pk_bf16_f32 v239, v166, v167
buffer_store_dwordx4 v[236:239], v26, s[20:23], s42 offen offset:1024 sc1
v_mfma_f32_16x16x32_bf16 v[192:195], a[196:199], v[60:63], v[192:195]
ds_read_b64_tr_b16 a[218:219], v6 offset:14848
s_add_u32 s42, s42, 14336
v_mul_f32 v132, v20, v132
v_mfma_f32_16x16x32_bf16 v[196:199], a[196:199], v[64:67], v[196:199]
s_waitcnt lgkmcnt(9)
v_mul_f32 v133, v20, v133
v_mul_f32 v134, v20, v134
v_mfma_f32_16x16x32_bf16 v[200:203], a[200:203], v[56:59], v[200:203]
ds_read_b64_tr_b16 a[220:221], v27 offset:12800
ds_read_b64_tr_b16 a[222:223], v27 offset:14848
s_waitcnt lgkmcnt(6)
v_mfma_f32_16x16x32_bf16 v[204:207], a[200:203], v[60:63], v[204:207]
v_readfirstlane_b32 s39, v25
s_add_u32 s38, s38, 1
s_cmp_ge_u32 s39, s38
s_cbranch_scc0 L_poll95
L_ret96:
v_mfma_f32_16x16x32_bf16 v[208:211], a[200:203], v[64:67], v[208:211]
v_add_u32 v6, s40, v4
v_add_u32 v27, s40, v5
v_mfma_f32_16x16x32_bf16 v[212:215], a[204:207], v[56:59], v[212:215]
ds_read_b64_tr_b16 a[192:193], v6 offset:0
v_mul_f32 v135, v20, v135
v_mfma_f32_16x16x32_bf16 v[216:219], a[204:207], v[60:63], v[216:219]
ds_read_b64_tr_b16 a[194:195], v6 offset:2048
v_cvt_pk_bf16_f32 v240, v132, v133
v_mfma_f32_16x16x32_bf16 v[220:223], a[204:207], v[64:67], v[220:223]
v_cvt_pk_bf16_f32 v241, v134, v135
v_mul_f32 v144, v20, v144
v_mfma_f32_16x16x32_bf16 v[176:179], a[208:211], v[68:71], v[176:179]
ds_read_b64_tr_b16 a[196:197], v27 offset:0
ds_read_b64_tr_b16 a[198:199], v27 offset:2048
v_mul_f32 v145, v20, v145
v_mfma_f32_16x16x32_bf16 v[180:183], a[208:211], v[72:75], v[180:183]
s_add_u32 s40, s40, 16896
v_mul_f32 v146, v20, v146
v_mul_f32 v147, v20, v147
v_mfma_f32_16x16x32_bf16 v[184:187], a[208:211], v[76:79], v[184:187]
s_cmp_eq_u32 s40, 152064
s_cselect_b32 s40, 0, s40
s_waitcnt lgkmcnt(8)
v_mfma_f32_16x16x32_bf16 v[188:191], a[212:215], v[68:71], v[188:191]
ds_read_b64_tr_b16 a[200:201], v6 offset:512
v_cvt_pk_bf16_f32 v242, v144, v145
v_mfma_f32_16x16x32_bf16 v[192:195], a[212:215], v[72:75], v[192:195]
ds_read_b64_tr_b16 a[202:203], v6 offset:2560
v_cvt_pk_bf16_f32 v243, v146, v147
buffer_store_dwordx4 v[240:243], v26, s[20:23], s42 offen offset:0 sc1
v_mfma_f32_16x16x32_bf16 v[196:199], a[212:215], v[76:79], v[196:199]
s_waitcnt lgkmcnt(8)
v_mul_f32 v156, v20, v156
v_mul_f32 v157, v20, v157
v_mfma_f32_16x16x32_bf16 v[200:203], a[216:219], v[68:71], v[200:203]
ds_read_b64_tr_b16 a[204:205], v27 offset:512
v_mul_f32 v158, v20, v158
v_mfma_f32_16x16x32_bf16 v[204:207], a[216:219], v[72:75], v[204:207]
ds_read_b64_tr_b16 a[206:207], v27 offset:2560
v_mul_f32 v159, v20, v159
v_mfma_f32_16x16x32_bf16 v[208:211], a[216:219], v[76:79], v[208:211]
s_waitcnt lgkmcnt(8)
v_cvt_pk_bf16_f32 v244, v156, v157
v_cvt_pk_bf16_f32 v245, v158, v159
v_mfma_f32_16x16x32_bf16 v[212:215], a[220:223], v[68:71], v[212:215]
ds_read_b64_tr_b16 a[208:209], v6 offset:4096
ds_read_b64_tr_b16 a[210:211], v6 offset:6144
v_mul_f32 v168, v20, v168
v_mfma_f32_16x16x32_bf16 v[216:219], a[220:223], v[72:75], v[216:219]
v_add_u32 v10, 1, v10
v_mul_f32 v169, v20, v169
v_mfma_f32_16x16x32_bf16 v[220:223], a[220:223], v[76:79], v[220:223]
ds_write_b32 v8, v10
s_waitcnt lgkmcnt(9)
v_mul_f32 v170, v20, v170
v_mfma_f32_16x16x32_bf16 v[176:179], a[192:195], v[80:83], v[176:179]
ds_read_b64_tr_b16 a[212:213], v27 offset:4096
v_mul_f32 v171, v20, v171
v_mfma_f32_16x16x32_bf16 v[180:183], a[192:195], v[84:87], v[180:183]
ds_read_b64_tr_b16 a[214:215], v27 offset:6144
v_cvt_pk_bf16_f32 v246, v168, v169
v_mfma_f32_16x16x32_bf16 v[184:187], a[192:195], v[88:91], v[184:187]
s_waitcnt lgkmcnt(9)
v_cvt_pk_bf16_f32 v247, v170, v171
buffer_store_dwordx4 v[244:247], v26, s[20:23], s42 offen offset:1024 sc1
v_mfma_f32_16x16x32_bf16 v[188:191], a[196:199], v[80:83], v[188:191]
ds_read_b64_tr_b16 a[216:217], v6 offset:4608
s_add_u32 s42, s42, 14336
v_mul_f32 v136, v21, v136
v_mfma_f32_16x16x32_bf16 v[192:195], a[196:199], v[84:87], v[192:195]
ds_read_b64_tr_b16 a[218:219], v6 offset:6656
v_mul_f32 v137, v21, v137
v_mfma_f32_16x16x32_bf16 v[196:199], a[196:199], v[88:91], v[196:199]
s_waitcnt lgkmcnt(9)
v_mul_f32 v138, v21, v138
v_mul_f32 v139, v21, v139
v_mfma_f32_16x16x32_bf16 v[200:203], a[200:203], v[80:83], v[200:203]
ds_read_b64_tr_b16 a[220:221], v27 offset:4608
v_cvt_pk_bf16_f32 v248, v136, v137
v_mfma_f32_16x16x32_bf16 v[204:207], a[200:203], v[84:87], v[204:207]
ds_read_b64_tr_b16 a[222:223], v27 offset:6656
v_cvt_pk_bf16_f32 v249, v138, v139
v_mfma_f32_16x16x32_bf16 v[208:211], a[200:203], v[88:91], v[208:211]
s_waitcnt lgkmcnt(9)
v_mul_f32 v148, v21, v148
v_mul_f32 v149, v21, v149
v_mfma_f32_16x16x32_bf16 v[212:215], a[204:207], v[80:83], v[212:215]
ds_read_b64_tr_b16 a[192:193], v6 offset:8192
v_mul_f32 v150, v21, v150
v_mfma_f32_16x16x32_bf16 v[216:219], a[204:207], v[84:87], v[216:219]
ds_read_b64_tr_b16 a[194:195], v6 offset:10240
v_mul_f32 v151, v21, v151
v_mfma_f32_16x16x32_bf16 v[220:223], a[204:207], v[88:91], v[220:223]
s_waitcnt lgkmcnt(9)
v_cvt_pk_bf16_f32 v250, v148, v149
v_cvt_pk_bf16_f32 v251, v150, v151
v_mfma_f32_16x16x32_bf16 v[176:179], a[208:211], v[92:95], v[176:179]
ds_read_b64_tr_b16 a[196:197], v27 offset:8192
buffer_store_dwordx4 v[248:251], v26, s[20:23], s42 offen offset:0 sc1
v_mul_f32 v160, v21, v160
v_mfma_f32_16x16x32_bf16 v[180:183], a[208:211], v[96:99], v[180:183]
ds_read_b64_tr_b16 a[198:199], v27 offset:10240
v_mul_f32 v161, v21, v161
v_mfma_f32_16x16x32_bf16 v[184:187], a[208:211], v[100:103], v[184:187]
s_waitcnt lgkmcnt(8)
v_mul_f32 v162, v21, v162
v_mul_f32 v163, v21, v163
v_mfma_f32_16x16x32_bf16 v[188:191], a[212:215], v[92:95], v[188:191]
ds_read_b64_tr_b16 a[200:201], v6 offset:8704
v_cvt_pk_bf16_f32 v252, v160, v161
v_mfma_f32_16x16x32_bf16 v[192:195], a[212:215], v[96:99], v[192:195]
ds_read_b64_tr_b16 a[202:203], v6 offset:10752
v_cvt_pk_bf16_f32 v253, v162, v163
v_mfma_f32_16x16x32_bf16 v[196:199], a[212:215], v[100:103], v[196:199]
s_waitcnt lgkmcnt(8)
v_mul_f32 v172, v21, v172
v_mul_f32 v173, v21, v173
v_mfma_f32_16x16x32_bf16 v[200:203], a[216:219], v[92:95], v[200:203]
ds_read_b64_tr_b16 a[204:205], v27 offset:8704
v_mul_f32 v174, v21, v174
v_mfma_f32_16x16x32_bf16 v[204:207], a[216:219], v[96:99], v[204:207]
ds_read_b64_tr_b16 a[206:207], v27 offset:10752
v_mul_f32 v175, v21, v175
v_mfma_f32_16x16x32_bf16 v[208:211], a[216:219], v[100:103], v[208:211]
s_waitcnt lgkmcnt(8)
v_cvt_pk_bf16_f32 v254, v172, v173
v_cvt_pk_bf16_f32 v255, v174, v175
v_mfma_f32_16x16x32_bf16 v[212:215], a[220:223], v[92:95], v[212:215]
ds_read_b64_tr_b16 a[208:209], v6 offset:12288
buffer_store_dwordx4 v[252:255], v26, s[20:23], s42 offen offset:1024 sc1
s_waitcnt vmcnt(6)
s_mov_b64 exec, 1
buffer_store_dwordx2 v[224:225], v226, s[20:23], s83 offen offset:1152 sc1
s_mov_b64 exec, -1
v_mfma_f32_16x16x32_bf16 v[216:219], a[220:223], v[96:99], v[216:219]
ds_read_b64_tr_b16 a[210:211], v6 offset:14336
v_mfma_f32_16x16x32_bf16 v[220:223], a[220:223], v[100:103], v[220:223]
ds_read_b32 v25, v9
s_waitcnt lgkmcnt(9)
v_mfma_f32_16x16x32_bf16 v[176:179], a[192:195], v[104:107], v[176:179]
ds_read_b64_tr_b16 a[212:213], v27 offset:12288
v_mfma_f32_16x16x32_bf16 v[180:183], a[192:195], v[108:111], v[180:183]
ds_read_b64_tr_b16 a[214:215], v27 offset:14336
v_mfma_f32_16x16x32_bf16 v[184:187], a[192:195], v[112:115], v[184:187]
s_waitcnt lgkmcnt(9)
v_mfma_f32_16x16x32_bf16 v[188:191], a[196:199], v[104:107], v[188:191]
ds_read_b64_tr_b16 a[216:217], v6 offset:12800
v_mfma_f32_16x16x32_bf16 v[192:195], a[196:199], v[108:111], v[192:195]
ds_read_b64_tr_b16 a[218:219], v6 offset:14848
v_mfma_f32_16x16x32_bf16 v[196:199], a[196:199], v[112:115], v[196:199]
s_waitcnt lgkmcnt(9)
v_mfma_f32_16x16x32_bf16 v[200:203], a[200:203], v[104:107], v[200:203]
ds_read_b64_tr_b16 a[220:221], v27 offset:12800
ds_read_b64_tr_b16 a[222:223], v27 offset:14848
s_waitcnt lgkmcnt(6)
v_mfma_f32_16x16x32_bf16 v[204:207], a[200:203], v[108:111], v[204:207]
v_readfirstlane_b32 s39, v25
s_add_u32 s38, s38, 1
s_cmp_ge_u32 s39, s38
s_cbranch_scc0 L_poll97
L_ret98:
v_mfma_f32_16x16x32_bf16 v[208:211], a[200:203], v[112:115], v[208:211]
v_add_u32 v6, s40, v4
v_add_u32 v27, s40, v5
v_mfma_f32_16x16x32_bf16 v[212:215], a[204:207], v[104:107], v[212:215]
ds_read_b64_tr_b16 a[192:193], v6 offset:0
v_mfma_f32_16x16x32_bf16 v[216:219], a[204:207], v[108:111], v[216:219]
ds_read_b64_tr_b16 a[194:195], v6 offset:2048
v_mfma_f32_16x16x32_bf16 v[220:223], a[204:207], v[112:115], v[220:223]
v_mfma_f32_16x16x32_bf16 v[176:179], a[208:211], v[116:119], v[176:179]
ds_read_b64_tr_b16 a[196:197], v27 offset:0
ds_read_b64_tr_b16 a[198:199], v27 offset:2048
v_mfma_f32_16x16x32_bf16 v[180:183], a[208:211], v[120:123], v[180:183]
s_add_u32 s40, s40, 16896
v_mfma_f32_16x16x32_bf16 v[184:187], a[208:211], v[124:127], v[184:187]
s_cmp_eq_u32 s40, 152064
s_cselect_b32 s40, 0, s40
s_waitcnt lgkmcnt(8)
v_mfma_f32_16x16x32_bf16 v[188:191], a[212:215], v[116:119], v[188:191]
ds_read_b64_tr_b16 a[200:201], v6 offset:512
v_mfma_f32_16x16x32_bf16 v[192:195], a[212:215], v[120:123], v[192:195]
ds_read_b64_tr_b16 a[202:203], v6 offset:2560
v_mfma_f32_16x16x32_bf16 v[196:199], a[212:215], v[124:127], v[196:199]
s_waitcnt lgkmcnt(8)
v_mfma_f32_16x16x32_bf16 v[200:203], a[216:219], v[116:119], v[200:203]
ds_read_b64_tr_b16 a[204:205], v27 offset:512
v_mfma_f32_16x16x32_bf16 v[204:207], a[216:219], v[120:123], v[204:207]
ds_read_b64_tr_b16 a[206:207], v27 offset:2560
v_mfma_f32_16x16x32_bf16 v[208:211], a[216:219], v[124:127], v[208:211]
s_waitcnt lgkmcnt(8)
v_mfma_f32_16x16x32_bf16 v[212:215], a[220:223], v[116:119], v[212:215]
ds_read_b64_tr_b16 a[208:209], v6 offset:4096
ds_read_b64_tr_b16 a[210:211], v6 offset:6144
v_mfma_f32_16x16x32_bf16 v[216:219], a[220:223], v[120:123], v[216:219]
v_add_u32 v10, 1, v10
v_mfma_f32_16x16x32_bf16 v[220:223], a[220:223], v[124:127], v[220:223]
ds_write_b32 v8, v10
s_waitcnt lgkmcnt(9)
v_mfma_f32_16x16x32_bf16 v[128:131], a[192:195], v[32:35], 0
ds_read_b64_tr_b16 a[212:213], v27 offset:4096
v_mfma_f32_16x16x32_bf16 v[132:135], a[192:195], v[36:39], 0
ds_read_b64_tr_b16 a[214:215], v27 offset:6144
v_mfma_f32_16x16x32_bf16 v[136:139], a[192:195], v[40:43], 0
s_waitcnt lgkmcnt(9)
v_mfma_f32_16x16x32_bf16 v[140:143], a[196:199], v[32:35], 0
ds_read_b64_tr_b16 a[216:217], v6 offset:4608
v_mfma_f32_16x16x32_bf16 v[144:147], a[196:199], v[36:39], 0
ds_read_b64_tr_b16 a[218:219], v6 offset:6656
v_mfma_f32_16x16x32_bf16 v[148:151], a[196:199], v[40:43], 0
s_waitcnt lgkmcnt(9)
v_mfma_f32_16x16x32_bf16 v[152:155], a[200:203], v[32:35], 0
ds_read_b64_tr_b16 a[220:221], v27 offset:4608
v_mfma_f32_16x16x32_bf16 v[156:159], a[200:203], v[36:39], 0
ds_read_b64_tr_b16 a[222:223], v27 offset:6656
v_mfma_f32_16x16x32_bf16 v[160:163], a[200:203], v[40:43], 0
s_waitcnt lgkmcnt(9)
v_mfma_f32_16x16x32_bf16 v[164:167], a[204:207], v[32:35], 0
ds_read_b64_tr_b16 a[192:193], v6 offset:8192
s_add_u32 s42, s46, 10240
v_mul_f32 v176, v19, v176
v_mfma_f32_16x16x32_bf16 v[168:171], a[204:207], v[36:39], 0
ds_read_b64_tr_b16 a[194:195], v6 offset:10240
v_mul_f32 v177, v19, v177
v_mfma_f32_16x16x32_bf16 v[172:175], a[204:207], v[40:43], 0
s_waitcnt lgkmcnt(9)
v_mul_f32 v178, v19, v178
v_mul_f32 v179, v19, v179
v_mfma_f32_16x16x32_bf16 v[128:131], a[208:211], v[44:47], v[128:131]
ds_read_b64_tr_b16 a[196:197], v27 offset:8192
v_cvt_pk_bf16_f32 v236, v176, v177
v_mfma_f32_16x16x32_bf16 v[132:135], a[208:211], v[48:51], v[132:135]
ds_read_b64_tr_b16 a[198:199], v27 offset:10240
v_cvt_pk_bf16_f32 v237, v178, v179
v_mfma_f32_16x16x32_bf16 v[136:139], a[208:211], v[52:55], v[136:139]
s_waitcnt lgkmcnt(8)
v_mul_f32 v188, v19, v188
v_mul_f32 v189, v19, v189
v_mfma_f32_16x16x32_bf16 v[140:143], a[212:215], v[44:47], v[140:143]
ds_read_b64_tr_b16 a[200:201], v6 offset:8704
v_mul_f32 v190, v19, v190
v_mfma_f32_16x16x32_bf16 v[144:147], a[212:215], v[48:51], v[144:147]
ds_read_b64_tr_b16 a[202:203], v6 offset:10752
v_mul_f32 v191, v19, v191
v_mfma_f32_16x16x32_bf16 v[148:151], a[212:215], v[52:55], v[148:151]
s_waitcnt lgkmcnt(8)
v_cvt_pk_bf16_f32 v238, v188, v189
v_cvt_pk_bf16_f32 v239, v190, v191
v_mfma_f32_16x16x32_bf16 v[152:155], a[216:219], v[44:47], v[152:155]
ds_read_b64_tr_b16 a[204:205], v27 offset:8704
buffer_store_dwordx4 v[236:239], v26, s[20:23], s42 offen offset:0 sc1
v_mul_f32 v200, v19, v200
v_mfma_f32_16x16x32_bf16 v[156:159], a[216:219], v[48:51], v[156:159]
ds_read_b64_tr_b16 a[206:207], v27 offset:10752
v_mul_f32 v201, v19, v201
v_mfma_f32_16x16x32_bf16 v[160:163], a[216:219], v[52:55], v[160:163]
s_waitcnt lgkmcnt(8)
v_mul_f32 v202, v19, v202
v_mul_f32 v203, v19, v203
v_mfma_f32_16x16x32_bf16 v[164:167], a[220:223], v[44:47], v[164:167]
ds_read_b64_tr_b16 a[208:209], v6 offset:12288
v_cvt_pk_bf16_f32 v240, v200, v201
v_mfma_f32_16x16x32_bf16 v[168:171], a[220:223], v[48:51], v[168:171]
ds_read_b64_tr_b16 a[210:211], v6 offset:14336
v_cvt_pk_bf16_f32 v241, v202, v203
v_mfma_f32_16x16x32_bf16 v[172:175], a[220:223], v[52:55], v[172:175]
ds_read_b32 v25, v9
s_waitcnt lgkmcnt(9)
v_mul_f32 v212, v19, v212
v_mfma_f32_16x16x32_bf16 v[128:131], a[192:195], v[56:59], v[128:131]
ds_read_b64_tr_b16 a[212:213], v27 offset:12288
v_mul_f32 v213, v19, v213
v_mfma_f32_16x16x32_bf16 v[132:135], a[192:195], v[60:63], v[132:135]
ds_read_b64_tr_b16 a[214:215], v27 offset:14336
v_mul_f32 v214, v19, v214
v_mfma_f32_16x16x32_bf16 v[136:139], a[192:195], v[64:67], v[136:139]
s_waitcnt lgkmcnt(9)
v_mul_f32 v215, v19, v215
v_cvt_pk_bf16_f32 v242, v212, v213
v_mfma_f32_16x16x32_bf16 v[140:143], a[196:199], v[56:59], v[140:143]
ds_read_b64_tr_b16 a[216:217], v6 offset:12800
v_cvt_pk_bf16_f32 v243, v214, v215
buffer_store_dwordx4 v[240:243], v26, s[20:23], s42 offen offset:1024 sc1
v_mfma_f32_16x16x32_bf16 v[144:147], a[196:199], v[60:63], v[144:147]
ds_read_b64_tr_b16 a[218:219], v6 offset:14848
s_add_u32 s42, s42, 14336
v_mul_f32 v180, v20, v180
v_mfma_f32_16x16x32_bf16 v[148:151], a[196:199], v[64:67], v[148:151]
s_waitcnt lgkmcnt(9)
v_mul_f32 v181, v20, v181
v_mul_f32 v182, v20, v182
v_mfma_f32_16x16x32_bf16 v[152:155], a[200:203], v[56:59], v[152:155]
ds_read_b64_tr_b16 a[220:221], v27 offset:12800
ds_read_b64_tr_b16 a[222:223], v27 offset:14848
s_waitcnt lgkmcnt(6)
v_mfma_f32_16x16x32_bf16 v[156:159], a[200:203], v[60:63], v[156:159]
v_readfirstlane_b32 s39, v25
s_add_u32 s38, s38, 1
s_cmp_ge_u32 s39, s38
s_cbranch_scc0 L_poll99
L_ret100:
v_mfma_f32_16x16x32_bf16 v[160:163], a[200:203], v[64:67], v[160:163]
v_add_u32 v6, s40, v4
v_add_u32 v27, s40, v5
v_mfma_f32_16x16x32_bf16 v[164:167], a[204:207], v[56:59], v[164:167]
ds_read_b64_tr_b16 a[192:193], v6 offset:0
v_mul_f32 v183, v20, v183
v_mfma_f32_16x16x32_bf16 v[168:171], a[204:207], v[60:63], v[168:171]
ds_read_b64_tr_b16 a[194:195], v6 offset:2048
v_cvt_pk_bf16_f32 v244, v180, v181
v_mfma_f32_16x16x32_bf16 v[172:175], a[204:207], v[64:67], v[172:175]
v_cvt_pk_bf16_f32 v245, v182, v183
v_mul_f32 v192, v20, v192
v_mfma_f32_16x16x32_bf16 v[128:131], a[208:211], v[68:71], v[128:131]
ds_read_b64_tr_b16 a[196:197], v27 offset:0
ds_read_b64_tr_b16 a[198:199], v27 offset:2048
v_mul_f32 v193, v20, v193
v_mfma_f32_16x16x32_bf16 v[132:135], a[208:211], v[72:75], v[132:135]
s_add_u32 s40, s40, 16896
v_mul_f32 v194, v20, v194
v_mul_f32 v195, v20, v195
v_mfma_f32_16x16x32_bf16 v[136:139], a[208:211], v[76:79], v[136:139]
s_cmp_eq_u32 s40, 152064
s_cselect_b32 s40, 0, s40
s_waitcnt lgkmcnt(8)
v_mfma_f32_16x16x32_bf16 v[140:143], a[212:215], v[68:71], v[140:143]
ds_read_b64_tr_b16 a[200:201], v6 offset:512
v_cvt_pk_bf16_f32 v246, v192, v193
v_mfma_f32_16x16x32_bf16 v[144:147], a[212:215], v[72:75], v[144:147]
ds_read_b64_tr_b16 a[202:203], v6 offset:2560
v_cvt_pk_bf16_f32 v247, v194, v195
buffer_store_dwordx4 v[244:247], v26, s[20:23], s42 offen offset:0 sc1
v_mfma_f32_16x16x32_bf16 v[148:151], a[212:215], v[76:79], v[148:151]
s_waitcnt lgkmcnt(8)
v_mul_f32 v204, v20, v204
v_mul_f32 v205, v20, v205
v_mfma_f32_16x16x32_bf16 v[152:155], a[216:219], v[68:71], v[152:155]
ds_read_b64_tr_b16 a[204:205], v27 offset:512
v_mul_f32 v206, v20, v206
v_mfma_f32_16x16x32_bf16 v[156:159], a[216:219], v[72:75], v[156:159]
ds_read_b64_tr_b16 a[206:207], v27 offset:2560
v_mul_f32 v207, v20, v207
v_mfma_f32_16x16x32_bf16 v[160:163], a[216:219], v[76:79], v[160:163]
s_waitcnt lgkmcnt(8)
v_cvt_pk_bf16_f32 v248, v204, v205
v_cvt_pk_bf16_f32 v249, v206, v207
v_mfma_f32_16x16x32_bf16 v[164:167], a[220:223], v[68:71], v[164:167]
ds_read_b64_tr_b16 a[208:209], v6 offset:4096
ds_read_b64_tr_b16 a[210:211], v6 offset:6144
v_mul_f32 v216, v20, v216
v_mfma_f32_16x16x32_bf16 v[168:171], a[220:223], v[72:75], v[168:171]
v_add_u32 v10, 1, v10
v_mul_f32 v217, v20, v217
v_mfma_f32_16x16x32_bf16 v[172:175], a[220:223], v[76:79], v[172:175]
ds_write_b32 v8, v10
s_waitcnt lgkmcnt(9)
v_mul_f32 v218, v20, v218
v_mfma_f32_16x16x32_bf16 v[128:131], a[192:195], v[80:83], v[128:131]
ds_read_b64_tr_b16 a[212:213], v27 offset:4096
v_mul_f32 v219, v20, v219
v_mfma_f32_16x16x32_bf16 v[132:135], a[192:195], v[84:87], v[132:135]
ds_read_b64_tr_b16 a[214:215], v27 offset:6144
v_cvt_pk_bf16_f32 v250, v216, v217
v_mfma_f32_16x16x32_bf16 v[136:139], a[192:195], v[88:91], v[136:139]
s_waitcnt lgkmcnt(9)
v_cvt_pk_bf16_f32 v251, v218, v219
buffer_store_dwordx4 v[248:251], v26, s[20:23], s42 offen offset:1024 sc1
v_mfma_f32_16x16x32_bf16 v[140:143], a[196:199], v[80:83], v[140:143]
ds_read_b64_tr_b16 a[216:217], v6 offset:4608
s_add_u32 s42, s42, 14336
v_mul_f32 v184, v21, v184
v_mfma_f32_16x16x32_bf16 v[144:147], a[196:199], v[84:87], v[144:147]
ds_read_b64_tr_b16 a[218:219], v6 offset:6656
v_mul_f32 v185, v21, v185
v_mfma_f32_16x16x32_bf16 v[148:151], a[196:199], v[88:91], v[148:151]
s_waitcnt lgkmcnt(9)
v_mul_f32 v186, v21, v186
v_mul_f32 v187, v21, v187
v_mfma_f32_16x16x32_bf16 v[152:155], a[200:203], v[80:83], v[152:155]
ds_read_b64_tr_b16 a[220:221], v27 offset:4608
v_cvt_pk_bf16_f32 v252, v184, v185
v_mfma_f32_16x16x32_bf16 v[156:159], a[200:203], v[84:87], v[156:159]
ds_read_b64_tr_b16 a[222:223], v27 offset:6656
v_cvt_pk_bf16_f32 v253, v186, v187
v_mfma_f32_16x16x32_bf16 v[160:163], a[200:203], v[88:91], v[160:163]
s_waitcnt lgkmcnt(9)
v_mul_f32 v196, v21, v196
v_mul_f32 v197, v21, v197
v_mfma_f32_16x16x32_bf16 v[164:167], a[204:207], v[80:83], v[164:167]
ds_read_b64_tr_b16 a[192:193], v6 offset:8192
v_mul_f32 v198, v21, v198
v_mfma_f32_16x16x32_bf16 v[168:171], a[204:207], v[84:87], v[168:171]
ds_read_b64_tr_b16 a[194:195], v6 offset:10240
v_mul_f32 v199, v21, v199
v_mfma_f32_16x16x32_bf16 v[172:175], a[204:207], v[88:91], v[172:175]
s_waitcnt lgkmcnt(9)
v_cvt_pk_bf16_f32 v254, v196, v197
v_cvt_pk_bf16_f32 v255, v198, v199
v_mfma_f32_16x16x32_bf16 v[128:131], a[208:211], v[92:95], v[128:131]
ds_read_b64_tr_b16 a[196:197], v27 offset:8192
buffer_store_dwordx4 v[252:255], v26, s[20:23], s42 offen offset:0 sc1
v_mul_f32 v208, v21, v208
v_mfma_f32_16x16x32_bf16 v[132:135], a[208:211], v[96:99], v[132:135]
ds_read_b64_tr_b16 a[198:199], v27 offset:10240
v_mul_f32 v209, v21, v209
v_mfma_f32_16x16x32_bf16 v[136:139], a[208:211], v[100:103], v[136:139]
s_waitcnt lgkmcnt(8)
v_mul_f32 v210, v21, v210
v_mul_f32 v211, v21, v211
v_mfma_f32_16x16x32_bf16 v[140:143], a[212:215], v[92:95], v[140:143]
ds_read_b64_tr_b16 a[200:201], v6 offset:8704
v_cvt_pk_bf16_f32 v236, v208, v209
v_mfma_f32_16x16x32_bf16 v[144:147], a[212:215], v[96:99], v[144:147]
ds_read_b64_tr_b16 a[202:203], v6 offset:10752
v_cvt_pk_bf16_f32 v237, v210, v211
v_mfma_f32_16x16x32_bf16 v[148:151], a[212:215], v[100:103], v[148:151]
s_waitcnt lgkmcnt(8)
v_mul_f32 v220, v21, v220
v_mul_f32 v221, v21, v221
v_mfma_f32_16x16x32_bf16 v[152:155], a[216:219], v[92:95], v[152:155]
ds_read_b64_tr_b16 a[204:205], v27 offset:8704
v_mul_f32 v222, v21, v222
v_mfma_f32_16x16x32_bf16 v[156:159], a[216:219], v[96:99], v[156:159]
ds_read_b64_tr_b16 a[206:207], v27 offset:10752
v_mul_f32 v223, v21, v223
v_mfma_f32_16x16x32_bf16 v[160:163], a[216:219], v[100:103], v[160:163]
s_waitcnt lgkmcnt(8)
v_cvt_pk_bf16_f32 v238, v220, v221
v_cvt_pk_bf16_f32 v239, v222, v223
v_mfma_f32_16x16x32_bf16 v[164:167], a[220:223], v[92:95], v[164:167]
ds_read_b64_tr_b16 a[208:209], v6 offset:12288
buffer_store_dwordx4 v[236:239], v26, s[20:23], s42 offen offset:1024 sc1
s_waitcnt vmcnt(6)
s_mov_b64 exec, 1
buffer_store_dwordx2 v[224:225], v226, s[20:23], s83 offen offset:1536 sc1
s_mov_b64 exec, -1
v_mfma_f32_16x16x32_bf16 v[168:171], a[220:223], v[96:99], v[168:171]
ds_read_b64_tr_b16 a[210:211], v6 offset:14336
v_mfma_f32_16x16x32_bf16 v[172:175], a[220:223], v[100:103], v[172:175]
s_waitcnt lgkmcnt(8)
v_mfma_f32_16x16x32_bf16 v[128:131], a[192:195], v[104:107], v[128:131]
ds_read_b64_tr_b16 a[212:213], v27 offset:12288
v_mfma_f32_16x16x32_bf16 v[132:135], a[192:195], v[108:111], v[132:135]
ds_read_b64_tr_b16 a[214:215], v27 offset:14336
v_mfma_f32_16x16x32_bf16 v[136:139], a[192:195], v[112:115], v[136:139]
s_waitcnt lgkmcnt(8)
v_mfma_f32_16x16x32_bf16 v[140:143], a[196:199], v[104:107], v[140:143]
ds_read_b64_tr_b16 a[216:217], v6 offset:12800
v_mfma_f32_16x16x32_bf16 v[144:147], a[196:199], v[108:111], v[144:147]
ds_read_b64_tr_b16 a[218:219], v6 offset:14848
v_mfma_f32_16x16x32_bf16 v[148:151], a[196:199], v[112:115], v[148:151]
s_waitcnt lgkmcnt(8)
v_mfma_f32_16x16x32_bf16 v[152:155], a[200:203], v[104:107], v[152:155]
ds_read_b64_tr_b16 a[220:221], v27 offset:12800
v_mfma_f32_16x16x32_bf16 v[156:159], a[200:203], v[108:111], v[156:159]
ds_read_b64_tr_b16 a[222:223], v27 offset:14848
v_mfma_f32_16x16x32_bf16 v[160:163], a[200:203], v[112:115], v[160:163]
s_waitcnt lgkmcnt(8)
v_mfma_f32_16x16x32_bf16 v[164:167], a[204:207], v[104:107], v[164:167]
v_mfma_f32_16x16x32_bf16 v[168:171], a[204:207], v[108:111], v[168:171]
v_mfma_f32_16x16x32_bf16 v[172:175], a[204:207], v[112:115], v[172:175]
s_waitcnt lgkmcnt(6)
v_mfma_f32_16x16x32_bf16 v[128:131], a[208:211], v[116:119], v[128:131]
v_mfma_f32_16x16x32_bf16 v[132:135], a[208:211], v[120:123], v[132:135]
v_mfma_f32_16x16x32_bf16 v[136:139], a[208:211], v[124:127], v[136:139]
s_waitcnt lgkmcnt(4)
v_mfma_f32_16x16x32_bf16 v[140:143], a[212:215], v[116:119], v[140:143]
v_mfma_f32_16x16x32_bf16 v[144:147], a[212:215], v[120:123], v[144:147]
v_mfma_f32_16x16x32_bf16 v[148:151], a[212:215], v[124:127], v[148:151]
s_waitcnt lgkmcnt(2)
v_mfma_f32_16x16x32_bf16 v[152:155], a[216:219], v[116:119], v[152:155]
v_mfma_f32_16x16x32_bf16 v[156:159], a[216:219], v[120:123], v[156:159]
v_mfma_f32_16x16x32_bf16 v[160:163], a[216:219], v[124:127], v[160:163]
s_waitcnt lgkmcnt(0)
v_mfma_f32_16x16x32_bf16 v[164:167], a[220:223], v[116:119], v[164:167]
v_add_u32 v10, 1, v10
v_mfma_f32_16x16x32_bf16 v[168:171], a[220:223], v[120:123], v[168:171]
ds_write_b32 v8, v10
v_mfma_f32_16x16x32_bf16 v[172:175], a[220:223], v[124:127], v[172:175]
s_nop 7
s_add_u32 s42, s46, 12288
v_mul_f32 v128, v19, v128
v_mul_f32 v129, v19, v129
v_mul_f32 v130, v19, v130
v_mul_f32 v131, v19, v131
v_cvt_pk_bf16_f32 v240, v128, v129
v_cvt_pk_bf16_f32 v241, v130, v131
v_mul_f32 v140, v19, v140
v_mul_f32 v141, v19, v141
v_mul_f32 v142, v19, v142
v_mul_f32 v143, v19, v143
v_cvt_pk_bf16_f32 v242, v140, v141
v_cvt_pk_bf16_f32 v243, v142, v143
buffer_store_dwordx4 v[240:243], v26, s[20:23], s42 offen offset:0 sc1
v_mul_f32 v152, v19, v152
v_mul_f32 v153, v19, v153
v_mul_f32 v154, v19, v154
v_mul_f32 v155, v19, v155
v_cvt_pk_bf16_f32 v244, v152, v153
v_cvt_pk_bf16_f32 v245, v154, v155
v_mul_f32 v164, v19, v164
v_mul_f32 v165, v19, v165
v_mul_f32 v166, v19, v166
v_mul_f32 v167, v19, v167
v_cvt_pk_bf16_f32 v246, v164, v165
v_cvt_pk_bf16_f32 v247, v166, v167
buffer_store_dwordx4 v[244:247], v26, s[20:23], s42 offen offset:1024 sc1
s_add_u32 s42, s42, 14336
v_mul_f32 v132, v20, v132
v_mul_f32 v133, v20, v133
v_mul_f32 v134, v20, v134
v_mul_f32 v135, v20, v135
v_cvt_pk_bf16_f32 v248, v132, v133
v_cvt_pk_bf16_f32 v249, v134, v135
v_mul_f32 v144, v20, v144
v_mul_f32 v145, v20, v145
v_mul_f32 v146, v20, v146
v_mul_f32 v147, v20, v147
v_cvt_pk_bf16_f32 v250, v144, v145
v_cvt_pk_bf16_f32 v251, v146, v147
buffer_store_dwordx4 v[248:251], v26, s[20:23], s42 offen offset:0 sc1
v_mul_f32 v156, v20, v156
v_mul_f32 v157, v20, v157
v_mul_f32 v158, v20, v158
v_mul_f32 v159, v20, v159
v_cvt_pk_bf16_f32 v252, v156, v157
v_cvt_pk_bf16_f32 v253, v158, v159
v_mul_f32 v168, v20, v168
v_mul_f32 v169, v20, v169
v_mul_f32 v170, v20, v170
v_mul_f32 v171, v20, v171
v_cvt_pk_bf16_f32 v254, v168, v169
v_cvt_pk_bf16_f32 v255, v170, v171
buffer_store_dwordx4 v[252:255], v26, s[20:23], s42 offen offset:1024 sc1
s_add_u32 s42, s42, 14336
v_mul_f32 v136, v21, v136
v_mul_f32 v137, v21, v137
v_mul_f32 v138, v21, v138
v_mul_f32 v139, v21, v139
v_cvt_pk_bf16_f32 v236, v136, v137
v_cvt_pk_bf16_f32 v237, v138, v139
v_mul_f32 v148, v21, v148
v_mul_f32 v149, v21, v149
v_mul_f32 v150, v21, v150
v_mul_f32 v151, v21, v151
v_cvt_pk_bf16_f32 v238, v148, v149
v_cvt_pk_bf16_f32 v239, v150, v151
buffer_store_dwordx4 v[236:239], v26, s[20:23], s42 offen offset:0 sc1
v_mul_f32 v160, v21, v160
v_mul_f32 v161, v21, v161
v_mul_f32 v162, v21, v162
v_mul_f32 v163, v21, v163
v_cvt_pk_bf16_f32 v240, v160, v161
v_cvt_pk_bf16_f32 v241, v162, v163
v_mul_f32 v172, v21, v172
v_mul_f32 v173, v21, v173
v_mul_f32 v174, v21, v174
v_mul_f32 v175, v21, v175
v_cvt_pk_bf16_f32 v242, v172, v173
v_cvt_pk_bf16_f32 v243, v174, v175
buffer_store_dwordx4 v[240:243], v26, s[20:23], s42 offen offset:1024 sc1
s_waitcnt vmcnt(6)
s_mov_b64 exec, 1
buffer_store_dwordx2 v[224:225], v226, s[20:23], s83 offen offset:1920 sc1
s_mov_b64 exec, -1
s_waitcnt vmcnt(1)
s_mov_b64 exec, 1
buffer_store_dwordx2 v[224:225], v226, s[20:23], s83 offen offset:2304 sc1
s_mov_b64 exec, -1
s_endpgm
L_reduce:
v_lshlrev_b32 v5, 4, v0
s_lshl_b32 s42, s33, 2
s_add_u32 s42, s42, s32
s_mul_i32 s42, s42, 7168
buffer_load_dwordx4 v[32:35], v5, s[88:91], s42 offen
s_add_u32 s42, s42, 1024
buffer_load_dwordx4 v[36:39], v5, s[88:91], s42 offen
s_add_u32 s42, s42, 1024
buffer_load_dwordx4 v[40:43], v5, s[88:91], s42 offen
s_add_u32 s42, s42, 1024
buffer_load_dwordx4 v[44:47], v5, s[88:91], s42 offen
s_add_u32 s42, s42, 1024
buffer_load_dwordx4 v[48:51], v5, s[88:91], s42 offen
s_add_u32 s42, s42, 1024
buffer_load_dwordx4 v[52:55], v5, s[88:91], s42 offen
s_add_u32 s42, s42, 1024
buffer_load_dwordx4 v[56:59], v5, s[88:91], s42 offen
s_add_u32 s42, s42, 1024
v_mov_b32 v4, 153088
L_ng101:
ds_read_b64 v[2:3], v4
s_waitcnt lgkmcnt(0)
v_readfirstlane_b32 s56, v2
v_readfirstlane_b32 s57, v3
s_nop 0
s_cmp_lg_u32 s56, 0
s_cbranch_scc1 L_nk102
s_sleep 1
s_add_u32 s53, s53, 1
s_cmp_lt_u32 s53, 1048576
s_cbranch_scc1 L_ng101
s_endpgm
L_nk102:
s_lshl_b32 s41, s32, 4
s_add_u32 s41, s41, s34
v_and_b32 v3, 15, v0
v_lshlrev_b32 v4, 3, v3
v_lshlrev_b32 v5, 4, v0
v_mul_u32_u24 v6, 896, v3
v_lshrrev_b32 v7, 4, v0
v_lshl_add_u32 v6, v7, 3, v6
L_rpiece:
s_mul_i32 s45, s41, 3641
s_lshr_b32 s45, s45, 16
s_mul_i32 s42, s45, 18
s_sub_u32 s42, s41, s42
s_lshr_b32 s43, s42, 1
s_and_b32 s42, s42, 1
s_mul_i32 s51, s43, 11
s_lshr_b32 s51, s51, 5
s_mul_i32 s83, s33, 7
s_add_u32 s83, s83, s45
s_mul_i32 s83, s83, 3
s_add_u32 s83, s83, s51
s_lshl_b32 s83, s83, 7
s_add_u32 s83, s83, 37519360
s_lshl_b32 s45, s45, 1
s_add_u32 s45, s45, s42
s_mul_i32 s51, s43, 14
s_add_u32 s51, s51, s45
s_lshl_b32 s51, s51, 10
s_mul_i32 s52, s33, 2064384
s_add_u32 s51, s51, s52
s_add_u32 s51, s51, 20971520
s_mul_i32 s52, s33, 129024
s_mul_i32 s43, s43, 14336
s_add_u32 s52, s52, s43
s_lshl_b32 s45, s45, 6
s_add_u32 s52, s52, s45
L_rpoll:
buffer_load_dwordx2 v[8:9], v4, s[20:23], s83 offen sc1
s_waitcnt vmcnt(0)
v_cmp_ne_u64 vcc, s[56:57], v[8:9]
s_cbranch_vccz L_rgo
s_cmp_ge_u32 s41, 64
s_cbranch_scc1 L_rp2
s_sleep 24
L_rp2:
s_sleep 2
s_add_u32 s53, s53, 1
s_cmp_lt_u32 s53, 1048576
s_cbranch_scc1 L_rpoll
s_endpgm
L_rgo:
s_cmp_lg_u32 s41, 0
s_cbranch_scc1 L_rgo2
s_lshl_b32 s42, s33, 7
s_add_u32 s42, s42, 37540864
s_mov_b64 exec, 1
buffer_store_dwordx2 v[8:9], v4, s[20:23], s42 offen sc1
s_mov_b64 exec, -1
s_waitcnt vmcnt(0)
L_rgo2:
buffer_load_dwordx4 v[32:35], v5, s[20:23], s51 offen sc1
s_add_u32 s51, s51, 129024
buffer_load_dwordx4 v[36:39], v5, s[20:23], s51 offen sc1
s_add_u32 s51, s51, 129024
buffer_load_dwordx4 v[40:43], v5, s[20:23], s51 offen sc1
s_add_u32 s51, s51, 129024
buffer_load_dwordx4 v[44:47], v5, s[20:23], s51 offen sc1
s_add_u32 s51, s51, 129024
buffer_load_dwordx4 v[48:51], v5, s[20:23], s51 offen sc1
s_add_u32 s51, s51, 129024
buffer_load_dwordx4 v[52:55], v5, s[20:23], s51 offen sc1
s_add_u32 s51, s51, 129024
buffer_load_dwordx4 v[56:59], v5, s[20:23], s51 offen sc1
s_add_u32 s51, s51, 129024
buffer_load_dwordx4 v[60:63], v5, s[20:23], s51 offen sc1
s_add_u32 s51, s51, 129024
buffer_load_dwordx4 v[64:67], v5, s[20:23], s51 offen sc1
s_add_u32 s51, s51, 129024
buffer_load_dwordx4 v[68:71], v5, s[20:23], s51 offen sc1
s_add_u32 s51, s51, 129024
buffer_load_dwordx4 v[72:75], v5, s[20:23], s51 offen sc1
s_add_u32 s51, s51, 129024
buffer_load_dwordx4 v[76:79], v5, s[20:23], s51 offen sc1
s_add_u32 s51, s51, 129024
buffer_load_dwordx4 v[80:83], v5, s[20:23], s51 offen sc1
s_add_u32 s51, s51, 129024
buffer_load_dwordx4 v[84:87], v5, s[20:23], s51 offen sc1
s_add_u32 s51, s51, 129024
buffer_load_dwordx4 v[88:91], v5, s[20:23], s51 offen sc1
s_add_u32 s51, s51, 129024
buffer_load_dwordx4 v[92:95], v5, s[20:23], s51 offen sc1
s_waitcnt vmcnt(15)
v_lshlrev_b32 v16, 16, v32
v_and_b32 v17, 0xffff0000, v32
v_lshlrev_b32 v18, 16, v33
v_and_b32 v19, 0xffff0000, v33
v_lshlrev_b32 v20, 16, v34
v_and_b32 v21, 0xffff0000, v34
v_lshlrev_b32 v22, 16, v35
v_and_b32 v23, 0xffff0000, v35
s_waitcnt vmcnt(14)
v_lshlrev_b32 v10, 16, v36
v_and_b32 v11, 0xffff0000, v36
v_add_f32 v16, v16, v10
v_add_f32 v17, v17, v11
v_lshlrev_b32 v10, 16, v37
v_and_b32 v11, 0xffff0000, v37
v_add_f32 v18, v18, v10
v_add_f32 v19, v19, v11
v_lshlrev_b32 v10, 16, v38
v_and_b32 v11, 0xffff0000, v38
v_add_f32 v20, v20, v10
v_add_f32 v21, v21, v11
v_lshlrev_b32 v10, 16, v39
v_and_b32 v11, 0xffff0000, v39
v_add_f32 v22, v22, v10
v_add_f32 v23, v23, v11
s_waitcnt vmcnt(13)
v_lshlrev_b32 v10, 16, v40
v_and_b32 v11, 0xffff0000, v40
v_add_f32 v16, v16, v10
v_add_f32 v17, v17, v11
v_lshlrev_b32 v10, 16, v41
v_and_b32 v11, 0xffff0000, v41
v_add_f32 v18, v18, v10
v_add_f32 v19, v19, v11
v_lshlrev_b32 v10, 16, v42
v_and_b32 v11, 0xffff0000, v42
v_add_f32 v20, v20, v10
v_add_f32 v21, v21, v11
v_lshlrev_b32 v10, 16, v43
v_and_b32 v11, 0xffff0000, v43
v_add_f32 v22, v22, v10
v_add_f32 v23, v23, v11
s_waitcnt vmcnt(12)
v_lshlrev_b32 v10, 16, v44
v_and_b32 v11, 0xffff0000, v44
v_add_f32 v16, v16, v10
v_add_f32 v17, v17, v11
v_lshlrev_b32 v10, 16, v45
v_and_b32 v11, 0xffff0000, v45
v_add_f32 v18, v18, v10
v_add_f32 v19, v19, v11
v_lshlrev_b32 v10, 16, v46
v_and_b32 v11, 0xffff0000, v46
v_add_f32 v20, v20, v10
v_add_f32 v21, v21, v11
v_lshlrev_b32 v10, 16, v47
v_and_b32 v11, 0xffff0000, v47
v_add_f32 v22, v22, v10
v_add_f32 v23, v23, v11
s_waitcnt vmcnt(11)
v_lshlrev_b32 v10, 16, v48
v_and_b32 v11, 0xffff0000, v48
v_add_f32 v16, v16, v10
v_add_f32 v17, v17, v11
v_lshlrev_b32 v10, 16, v49
v_and_b32 v11, 0xffff0000, v49
v_add_f32 v18, v18, v10
v_add_f32 v19, v19, v11
v_lshlrev_b32 v10, 16, v50
v_and_b32 v11, 0xffff0000, v50
v_add_f32 v20, v20, v10
v_add_f32 v21, v21, v11
v_lshlrev_b32 v10, 16, v51
v_and_b32 v11, 0xffff0000, v51
v_add_f32 v22, v22, v10
v_add_f32 v23, v23, v11
s_waitcnt vmcnt(10)
v_lshlrev_b32 v10, 16, v52
v_and_b32 v11, 0xffff0000, v52
v_add_f32 v16, v16, v10
v_add_f32 v17, v17, v11
v_lshlrev_b32 v10, 16, v53
v_and_b32 v11, 0xffff0000, v53
v_add_f32 v18, v18, v10
v_add_f32 v19, v19, v11
v_lshlrev_b32 v10, 16, v54
v_and_b32 v11, 0xffff0000, v54
v_add_f32 v20, v20, v10
v_add_f32 v21, v21, v11
v_lshlrev_b32 v10, 16, v55
v_and_b32 v11, 0xffff0000, v55
v_add_f32 v22, v22, v10
v_add_f32 v23, v23, v11
s_waitcnt vmcnt(9)
v_lshlrev_b32 v10, 16, v56
v_and_b32 v11, 0xffff0000, v56
v_add_f32 v16, v16, v10
v_add_f32 v17, v17, v11
v_lshlrev_b32 v10, 16, v57
v_and_b32 v11, 0xffff0000, v57
v_add_f32 v18, v18, v10
v_add_f32 v19, v19, v11
v_lshlrev_b32 v10, 16, v58
v_and_b32 v11, 0xffff0000, v58
v_add_f32 v20, v20, v10
v_add_f32 v21, v21, v11
v_lshlrev_b32 v10, 16, v59
v_and_b32 v11, 0xffff0000, v59
v_add_f32 v22, v22, v10
v_add_f32 v23, v23, v11
s_waitcnt vmcnt(8)
v_lshlrev_b32 v10, 16, v60
v_and_b32 v11, 0xffff0000, v60
v_add_f32 v16, v16, v10
v_add_f32 v17, v17, v11
v_lshlrev_b32 v10, 16, v61
v_and_b32 v11, 0xffff0000, v61
v_add_f32 v18, v18, v10
v_add_f32 v19, v19, v11
v_lshlrev_b32 v10, 16, v62
v_and_b32 v11, 0xffff0000, v62
v_add_f32 v20, v20, v10
v_add_f32 v21, v21, v11
v_lshlrev_b32 v10, 16, v63
v_and_b32 v11, 0xffff0000, v63
v_add_f32 v22, v22, v10
v_add_f32 v23, v23, v11
s_waitcnt vmcnt(7)
v_lshlrev_b32 v10, 16, v64
v_and_b32 v11, 0xffff0000, v64
v_add_f32 v16, v16, v10
v_add_f32 v17, v17, v11
v_lshlrev_b32 v10, 16, v65
v_and_b32 v11, 0xffff0000, v65
v_add_f32 v18, v18, v10
v_add_f32 v19, v19, v11
v_lshlrev_b32 v10, 16, v66
v_and_b32 v11, 0xffff0000, v66
v_add_f32 v20, v20, v10
v_add_f32 v21, v21, v11
v_lshlrev_b32 v10, 16, v67
v_and_b32 v11, 0xffff0000, v67
v_add_f32 v22, v22, v10
v_add_f32 v23, v23, v11
s_waitcnt vmcnt(6)
v_lshlrev_b32 v10, 16, v68
v_and_b32 v11, 0xffff0000, v68
v_add_f32 v16, v16, v10
v_add_f32 v17, v17, v11
v_lshlrev_b32 v10, 16, v69
v_and_b32 v11, 0xffff0000, v69
v_add_f32 v18, v18, v10
v_add_f32 v19, v19, v11
v_lshlrev_b32 v10, 16, v70
v_and_b32 v11, 0xffff0000, v70
v_add_f32 v20, v20, v10
v_add_f32 v21, v21, v11
v_lshlrev_b32 v10, 16, v71
v_and_b32 v11, 0xffff0000, v71
v_add_f32 v22, v22, v10
v_add_f32 v23, v23, v11
s_waitcnt vmcnt(5)
v_lshlrev_b32 v10, 16, v72
v_and_b32 v11, 0xffff0000, v72
v_add_f32 v16, v16, v10
v_add_f32 v17, v17, v11
v_lshlrev_b32 v10, 16, v73
v_and_b32 v11, 0xffff0000, v73
v_add_f32 v18, v18, v10
v_add_f32 v19, v19, v11
v_lshlrev_b32 v10, 16, v74
v_and_b32 v11, 0xffff0000, v74
v_add_f32 v20, v20, v10
v_add_f32 v21, v21, v11
v_lshlrev_b32 v10, 16, v75
v_and_b32 v11, 0xffff0000, v75
v_add_f32 v22, v22, v10
v_add_f32 v23, v23, v11
s_waitcnt vmcnt(4)
v_lshlrev_b32 v10, 16, v76
v_and_b32 v11, 0xffff0000, v76
v_add_f32 v16, v16, v10
v_add_f32 v17, v17, v11
v_lshlrev_b32 v10, 16, v77
v_and_b32 v11, 0xffff0000, v77
v_add_f32 v18, v18, v10
v_add_f32 v19, v19, v11
v_lshlrev_b32 v10, 16, v78
v_and_b32 v11, 0xffff0000, v78
v_add_f32 v20, v20, v10
v_add_f32 v21, v21, v11
v_lshlrev_b32 v10, 16, v79
v_and_b32 v11, 0xffff0000, v79
v_add_f32 v22, v22, v10
v_add_f32 v23, v23, v11
s_waitcnt vmcnt(3)
v_lshlrev_b32 v10, 16, v80
v_and_b32 v11, 0xffff0000, v80
v_add_f32 v16, v16, v10
v_add_f32 v17, v17, v11
v_lshlrev_b32 v10, 16, v81
v_and_b32 v11, 0xffff0000, v81
v_add_f32 v18, v18, v10
v_add_f32 v19, v19, v11
v_lshlrev_b32 v10, 16, v82
v_and_b32 v11, 0xffff0000, v82
v_add_f32 v20, v20, v10
v_add_f32 v21, v21, v11
v_lshlrev_b32 v10, 16, v83
v_and_b32 v11, 0xffff0000, v83
v_add_f32 v22, v22, v10
v_add_f32 v23, v23, v11
s_waitcnt vmcnt(2)
v_lshlrev_b32 v10, 16, v84
v_and_b32 v11, 0xffff0000, v84
v_add_f32 v16, v16, v10
v_add_f32 v17, v17, v11
v_lshlrev_b32 v10, 16, v85
v_and_b32 v11, 0xffff0000, v85
v_add_f32 v18, v18, v10
v_add_f32 v19, v19, v11
v_lshlrev_b32 v10, 16, v86
v_and_b32 v11, 0xffff0000, v86
v_add_f32 v20, v20, v10
v_add_f32 v21, v21, v11
v_lshlrev_b32 v10, 16, v87
v_and_b32 v11, 0xffff0000, v87
v_add_f32 v22, v22, v10
v_add_f32 v23, v23, v11
s_waitcnt vmcnt(1)
v_lshlrev_b32 v10, 16, v88
v_and_b32 v11, 0xffff0000, v88
v_add_f32 v16, v16, v10
v_add_f32 v17, v17, v11
v_lshlrev_b32 v10, 16, v89
v_and_b32 v11, 0xffff0000, v89
v_add_f32 v18, v18, v10
v_add_f32 v19, v19, v11
v_lshlrev_b32 v10, 16, v90
v_and_b32 v11, 0xffff0000, v90
v_add_f32 v20, v20, v10
v_add_f32 v21, v21, v11
v_lshlrev_b32 v10, 16, v91
v_and_b32 v11, 0xffff0000, v91
v_add_f32 v22, v22, v10
v_add_f32 v23, v23, v11
s_waitcnt vmcnt(0)
v_lshlrev_b32 v10, 16, v92
v_and_b32 v11, 0xffff0000, v92
v_add_f32 v16, v16, v10
v_add_f32 v17, v17, v11
v_lshlrev_b32 v10, 16, v93
v_and_b32 v11, 0xffff0000, v93
v_add_f32 v18, v18, v10
v_add_f32 v19, v19, v11
v_lshlrev_b32 v10, 16, v94
v_and_b32 v11, 0xffff0000, v94
v_add_f32 v20, v20, v10
v_add_f32 v21, v21, v11
v_lshlrev_b32 v10, 16, v95
v_and_b32 v11, 0xffff0000, v95
v_add_f32 v22, v22, v10
v_add_f32 v23, v23, v11
v_cvt_pk_bf16_f32 v12, v16, v17
v_cvt_pk_bf16_f32 v13, v18, v19
v_cvt_pk_bf16_f32 v14, v20, v21
v_cvt_pk_bf16_f32 v15, v22, v23
buffer_store_dwordx2 v[12:13], v6, s[28:31], s52 offen
buffer_store_dwordx2 v[14:15], v6, s[28:31], s52 offen offset:32
s_add_u32 s41, s41, 64
s_cmp_lt_u32 s41, 126
s_cbranch_scc1 L_rpiece
s_endpgm
L_loader:
v_lshlrev_b32 v10, 4, v0
v_add_u32 v10, 152064, v10
v_mov_b32 v4, 0
v_mov_b32 v5, 0
v_mov_b32 v6, 0
v_mov_b32 v7, 0
ds_write_b128 v10, v[4:7]
ds_write_b128 v10, v[4:7] offset:256
v_lshrrev_b32 v10, 5, v0
v_and_b32 v11, 31, v0
v_lshlrev_b32 v11, 4, v11
v_lshl_add_u32 v20, v10, 13, v11
v_and_b32 v11, 15, v0
v_lshlrev_b32 v11, 4, v11
v_lshl_add_u32 v24, v10, 18, v11
v_bfe_u32 v11, v0, 4, 1
v_lshl_add_u32 v24, v11, 15, v24
v_add_u32 v25, 7136, v24
v_add_u32 v21, 992, v20
v_add_u32 v26, 14272, v24
v_add_u32 v22, 1984, v20
v_add_u32 v27, 21408, v24
v_add_u32 v23, 2976, v20
v_lshlrev_b32 v12, 2, v0
v_add_u32 v8, 152064, v12
v_min_u32 v12, 2, v0
v_lshlrev_b32 v12, 8, v12
v_add_u32 v9, 152320, v12
v_mov_b32 v13, 0
s_mov_b32 s49, 0
s_waitcnt lgkmcnt(0)
s_barrier
v_lshlrev_b32 v15, 4, v0
s_cmp_lg_u32 s35, 0
s_cbranch_scc1 L_lY
s_lshl_b32 s50, s36, 19
s_sub_i32 s43, s38, 8
s_waitcnt lgkmcnt(0)
v_cmp_gt_i32 vcc, s43, v13
s_cbranch_vccz L_lg103
s_call_b64 s[84:85], L_lfull
L_lg103:
s_add_u32 m0, s40, 0
s_add_u32 s48, s50, 0
s_waitcnt vmcnt(26)
buffer_load_dwordx4 v24, s[12:15], s48 offen offset:0 lds
buffer_load_dwordx4 v25, s[12:15], s48 offen offset:1056 lds
s_waitcnt vmcnt(26)
buffer_load_dwordx4 v26, s[12:15], s48 offen offset:2112 lds
buffer_load_dwordx4 v27, s[12:15], s48 offen offset:3168 lds
s_add_u32 m0, s40, 4224
s_add_u32 s48, s50, 65536
s_waitcnt vmcnt(26)
buffer_load_dwordx4 v24, s[12:15], s48 offen offset:0 lds
buffer_load_dwordx4 v25, s[12:15], s48 offen offset:1056 lds
s_waitcnt vmcnt(26)
buffer_load_dwordx4 v26, s[12:15], s48 offen offset:2112 lds
buffer_load_dwordx4 v27, s[12:15], s48 offen offset:3168 lds
s_add_u32 m0, s40, 8448
s_add_u32 s48, s50, 131072
s_waitcnt vmcnt(26)
buffer_load_dwordx4 v24, s[12:15], s48 offen offset:0 lds
buffer_load_dwordx4 v25, s[12:15], s48 offen offset:1056 lds
s_waitcnt vmcnt(26)
buffer_load_dwordx4 v26, s[12:15], s48 offen offset:2112 lds
buffer_load_dwordx4 v27, s[12:15], s48 offen offset:3168 lds
s_add_u32 m0, s40, 12672
s_add_u32 s48, s50, 196608
s_waitcnt vmcnt(26)
ds_read_b32 v13, v9
buffer_load_dwordx4 v24, s[12:15], s48 offen offset:0 lds
buffer_load_dwordx4 v25, s[12:15], s48 offen offset:1056 lds
s_waitcnt vmcnt(26)
buffer_load_dwordx4 v26, s[12:15], s48 offen offset:2112 lds
buffer_load_dwordx4 v27, s[12:15], s48 offen offset:3168 lds
s_add_u32 s38, s38, 1
s_add_u32 s40, s40, 16896
s_cmp_eq_u32 s40, 152064
s_cselect_b32 s40, 0, s40
s_add_u32 s50, s50, 524288
s_cmp_eq_u32 s50, 3670016
s_cselect_b32 s50, 0, s50
s_sub_i32 s43, s38, 8
s_waitcnt lgkmcnt(0)
v_cmp_gt_i32 vcc, s43, v13
s_cbranch_vccz L_lg104
s_call_b64 s[84:85], L_lfull
L_lg104:
s_add_u32 m0, s40, 0
s_add_u32 s48, s50, 0
s_waitcnt vmcnt(26)
buffer_load_dwordx4 v24, s[12:15], s48 offen offset:0 lds
buffer_load_dwordx4 v25, s[12:15], s48 offen offset:1056 lds
s_waitcnt vmcnt(26)
buffer_load_dwordx4 v26, s[12:15], s48 offen offset:2112 lds
buffer_load_dwordx4 v27, s[12:15], s48 offen offset:3168 lds
s_add_u32 m0, s40, 4224
s_add_u32 s48, s50, 65536
s_waitcnt vmcnt(26)
buffer_load_dwordx4 v24, s[12:15], s48 offen offset:0 lds
buffer_load_dwordx4 v25, s[12:15], s48 offen offset:1056 lds
s_waitcnt vmcnt(26)
buffer_load_dwordx4 v26, s[12:15], s48 offen offset:2112 lds
buffer_load_dwordx4 v27, s[12:15], s48 offen offset:3168 lds
s_add_u32 m0, s40, 8448
s_add_u32 s48, s50, 131072
s_waitcnt vmcnt(26)
buffer_load_dwordx4 v24, s[12:15], s48 offen offset:0 lds
buffer_load_dwordx4 v25, s[12:15], s48 offen offset:1056 lds
s_waitcnt vmcnt(26)
buffer_load_dwordx4 v26, s[12:15], s48 offen offset:2112 lds
buffer_load_dwordx4 v27, s[12:15], s48 offen offset:3168 lds
s_add_u32 m0, s40, 12672
s_add_u32 s48, s50, 196608
s_waitcnt vmcnt(26)
ds_read_b32 v13, v9
buffer_load_dwordx4 v24, s[12:15], s48 offen offset:0 lds
buffer_load_dwordx4 v25, s[12:15], s48 offen offset:1056 lds
s_waitcnt vmcnt(26)
buffer_load_dwordx4 v26, s[12:15], s48 offen offset:2112 lds
buffer_load_dwordx4 v27, s[12:15], s48 offen offset:3168 lds
s_add_u32 s38, s38, 1
s_add_u32 s40, s40, 16896
s_cmp_eq_u32 s40, 152064
s_cselect_b32 s40, 0, s40
s_add_u32 s50, s50, 524288
s_cmp_eq_u32 s50, 3670016
s_cselect_b32 s50, 0, s50
s_sub_i32 s43, s38, 8
s_waitcnt lgkmcnt(0)
v_cmp_gt_i32 vcc, s43, v13
s_cbranch_vccz L_lg105
s_call_b64 s[84:85], L_lfull
L_lg105:
s_add_u32 m0, s40, 0
s_add_u32 s48, s50, 0
s_waitcnt vmcnt(26)
buffer_load_dwordx4 v24, s[12:15], s48 offen offset:0 lds
buffer_load_dwordx4 v25, s[12:15], s48 offen offset:1056 lds
s_waitcnt vmcnt(26)
buffer_load_dwordx4 v26, s[12:15], s48 offen offset:2112 lds
buffer_load_dwordx4 v27, s[12:15], s48 offen offset:3168 lds
s_add_u32 m0, s40, 4224
s_add_u32 s48, s50, 65536
s_waitcnt vmcnt(26)
buffer_load_dwordx4 v24, s[12:15], s48 offen offset:0 lds
buffer_load_dwordx4 v25, s[12:15], s48 offen offset:1056 lds
s_waitcnt vmcnt(26)
buffer_load_dwordx4 v26, s[12:15], s48 offen offset:2112 lds
buffer_load_dwordx4 v27, s[12:15], s48 offen offset:3168 lds
s_add_u32 m0, s40, 8448
s_add_u32 s48, s50, 131072
s_waitcnt vmcnt(26)
buffer_load_dwordx4 v24, s[12:15], s48 offen offset:0 lds
buffer_load_dwordx4 v25, s[12:15], s48 offen offset:1056 lds
s_waitcnt vmcnt(26)
s_max_i32 s49, s49, 1
v_mov_b32 v12, s49
ds_write_b32 v8, v12
buffer_load_dwordx4 v26, s[12:15], s48 offen offset:2112 lds
buffer_load_dwordx4 v27, s[12:15], s48 offen offset:3168 lds
s_add_u32 m0, s40, 12672
s_add_u32 s48, s50, 196608
s_waitcnt vmcnt(26)
ds_read_b32 v13, v9
buffer_load_dwordx4 v24, s[12:15], s48 offen offset:0 lds
buffer_load_dwordx4 v25, s[12:15], s48 offen offset:1056 lds
s_waitcnt vmcnt(26)
buffer_load_dwordx4 v26, s[12:15], s48 offen offset:2112 lds
buffer_load_dwordx4 v27, s[12:15], s48 offen offset:3168 lds
s_add_u32 s38, s38, 1
s_add_u32 s40, s40, 16896
s_cmp_eq_u32 s40, 152064
s_cselect_b32 s40, 0, s40
s_add_u32 s50, s50, 524288
s_cmp_eq_u32 s50, 3670016
s_cselect_b32 s50, 0, s50
s_sub_i32 s43, s38, 8
s_waitcnt lgkmcnt(0)
v_cmp_gt_i32 vcc, s43, v13
s_cbranch_vccz L_lg106
s_call_b64 s[84:85], L_lfull
L_lg106:
s_add_u32 m0, s40, 0
s_add_u32 s48, s50, 0
s_waitcnt vmcnt(26)
buffer_load_dwordx4 v24, s[12:15], s48 offen offset:0 lds
buffer_load_dwordx4 v25, s[12:15], s48 offen offset:1056 lds
s_waitcnt vmcnt(26)
buffer_load_dwordx4 v26, s[12:15], s48 offen offset:2112 lds
buffer_load_dwordx4 v27, s[12:15], s48 offen offset:3168 lds
s_add_u32 m0, s40, 4224
s_add_u32 s48, s50, 65536
s_waitcnt vmcnt(26)
buffer_load_dwordx4 v24, s[12:15], s48 offen offset:0 lds
buffer_load_dwordx4 v25, s[12:15], s48 offen offset:1056 lds
s_waitcnt vmcnt(26)
buffer_load_dwordx4 v26, s[12:15], s48 offen offset:2112 lds
buffer_load_dwordx4 v27, s[12:15], s48 offen offset:3168 lds
s_add_u32 m0, s40, 8448
s_add_u32 s48, s50, 131072
s_waitcnt vmcnt(26)
buffer_load_dwordx4 v24, s[12:15], s48 offen offset:0 lds
buffer_load_dwordx4 v25, s[12:15], s48 offen offset:1056 lds
s_waitcnt vmcnt(26)
s_max_i32 s49, s49, 2
v_mov_b32 v12, s49
ds_write_b32 v8, v12
buffer_load_dwordx4 v26, s[12:15], s48 offen offset:2112 lds
buffer_load_dwordx4 v27, s[12:15], s48 offen offset:3168 lds
s_add_u32 m0, s40, 12672
s_add_u32 s48, s50, 196608
s_waitcnt vmcnt(26)
ds_read_b32 v13, v9
buffer_load_dwordx4 v24, s[12:15], s48 offen offset:0 lds
buffer_load_dwordx4 v25, s[12:15], s48 offen offset:1056 lds
s_waitcnt vmcnt(26)
buffer_load_dwordx4 v26, s[12:15], s48 offen offset:2112 lds
buffer_load_dwordx4 v27, s[12:15], s48 offen offset:3168 lds
s_add_u32 s38, s38, 1
s_add_u32 s40, s40, 16896
s_cmp_eq_u32 s40, 152064
s_cselect_b32 s40, 0, s40
s_add_u32 s50, s50, 524288
s_cmp_eq_u32 s50, 3670016
s_cselect_b32 s50, 0, s50
s_sub_i32 s43, s38, 8
s_waitcnt lgkmcnt(0)
v_cmp_gt_i32 vcc, s43, v13
s_cbranch_vccz L_lg107
s_call_b64 s[84:85], L_lfull
L_lg107:
s_add_u32 m0, s40, 0
s_add_u32 s48, s50, 0
s_waitcnt vmcnt(26)
buffer_load_dwordx4 v24, s[12:15], s48 offen offset:0 lds
buffer_load_dwordx4 v25, s[12:15], s48 offen offset:1056 lds
s_waitcnt vmcnt(26)
buffer_load_dwordx4 v26, s[12:15], s48 offen offset:2112 lds
buffer_load_dwordx4 v27, s[12:15], s48 offen offset:3168 lds
s_add_u32 m0, s40, 4224
s_add_u32 s48, s50, 65536
s_waitcnt vmcnt(26)
buffer_load_dwordx4 v24, s[12:15], s48 offen offset:0 lds
buffer_load_dwordx4 v25, s[12:15], s48 offen offset:1056 lds
s_waitcnt vmcnt(26)
buffer_load_dwordx4 v26, s[12:15], s48 offen offset:2112 lds
buffer_load_dwordx4 v27, s[12:15], s48 offen offset:3168 lds
s_add_u32 m0, s40, 8448
s_add_u32 s48, s50, 131072
s_waitcnt vmcnt(26)
buffer_load_dwordx4 v24, s[12:15], s48 offen offset:0 lds
buffer_load_dwordx4 v25, s[12:15], s48 offen offset:1056 lds
s_waitcnt vmcnt(26)
s_max_i32 s49, s49, 3
v_mov_b32 v12, s49
ds_write_b32 v8, v12
buffer_load_dwordx4 v26, s[12:15], s48 offen offset:2112 lds
buffer_load_dwordx4 v27, s[12:15], s48 offen offset:3168 lds
s_add_u32 m0, s40, 12672
s_add_u32 s48, s50, 196608
s_waitcnt vmcnt(26)
ds_read_b32 v13, v9
buffer_load_dwordx4 v24, s[12:15], s48 offen offset:0 lds
buffer_load_dwordx4 v25, s[12:15], s48 offen offset:1056 lds
s_waitcnt vmcnt(26)
buffer_load_dwordx4 v26, s[12:15], s48 offen offset:2112 lds
buffer_load_dwordx4 v27, s[12:15], s48 offen offset:3168 lds
s_add_u32 s38, s38, 1
s_add_u32 s40, s40, 16896
s_cmp_eq_u32 s40, 152064
s_cselect_b32 s40, 0, s40
s_add_u32 s50, s50, 524288
s_cmp_eq_u32 s50, 3670016
s_cselect_b32 s50, 0, s50
s_mov_b32 s48, 65536
s_waitcnt vmcnt(26)
buffer_load_dwordx4 v[32:35], v20, s[8:11], s48 offen offset:0 nt
buffer_load_dwordx4 v[36:39], v21, s[8:11], s48 offen offset:1056 nt
s_waitcnt vmcnt(26)
buffer_load_dwordx4 v[40:43], v22, s[8:11], s48 offen offset:2112 nt
buffer_load_dwordx4 v[44:47], v23, s[8:11], s48 offen offset:3168 nt
s_mov_b32 s48, 66048
s_waitcnt vmcnt(26)
buffer_load_dwordx4 v[48:51], v20, s[8:11], s48 offen offset:0 nt
buffer_load_dwordx4 v[52:55], v21, s[8:11], s48 offen offset:1056 nt
s_waitcnt vmcnt(26)
buffer_load_dwordx4 v[56:59], v22, s[8:11], s48 offen offset:2112 nt
buffer_load_dwordx4 v[60:63], v23, s[8:11], s48 offen offset:3168 nt
s_mov_b32 s48, 66560
s_waitcnt vmcnt(26)
buffer_load_dwordx4 v[64:67], v20, s[8:11], s48 offen offset:0 nt
buffer_load_dwordx4 v[68:71], v21, s[8:11], s48 offen offset:1056 nt
s_waitcnt vmcnt(26)
s_max_i32 s49, s49, 4
v_mov_b32 v12, s49
ds_write_b32 v8, v12
buffer_load_dwordx4 v[72:75], v22, s[8:11], s48 offen offset:2112 nt
buffer_load_dwordx4 v[76:79], v23, s[8:11], s48 offen offset:3168 nt
s_mov_b32 s48, 67072
s_waitcnt vmcnt(26)
buffer_load_dwordx4 v[80:83], v20, s[8:11], s48 offen offset:0 nt
buffer_load_dwordx4 v[84:87], v21, s[8:11], s48 offen offset:1056 nt
s_waitcnt vmcnt(26)
buffer_load_dwordx4 v[88:91], v22, s[8:11], s48 offen offset:2112 nt
buffer_load_dwordx4 v[92:95], v23, s[8:11], s48 offen offset:3168 nt
ds_read_b32 v13, v9
s_add_u32 s38, s38, 4
s_mov_b32 s40, 0
s_sub_i32 s43, s38, 8
s_waitcnt lgkmcnt(0)
v_cmp_gt_i32 vcc, s43, v13
s_cbranch_vccz L_lg108
s_call_b64 s[84:85], L_lfull
L_lg108:
s_add_u32 m0, s40, 0
s_add_u32 s48, s50, 0
s_waitcnt vmcnt(26)
buffer_load_dwordx4 v24, s[12:15], s48 offen offset:0 lds
buffer_load_dwordx4 v25, s[12:15], s48 offen offset:1056 lds
s_waitcnt vmcnt(26)
buffer_load_dwordx4 v26, s[12:15], s48 offen offset:2112 lds
buffer_load_dwordx4 v27, s[12:15], s48 offen offset:3168 lds
s_add_u32 m0, s40, 4224
s_add_u32 s48, s50, 65536
s_waitcnt vmcnt(26)
buffer_load_dwordx4 v24, s[12:15], s48 offen offset:0 lds
buffer_load_dwordx4 v25, s[12:15], s48 offen offset:1056 lds
s_waitcnt vmcnt(26)
buffer_load_dwordx4 v26, s[12:15], s48 offen offset:2112 lds
buffer_load_dwordx4 v27, s[12:15], s48 offen offset:3168 lds
s_add_u32 m0, s40, 8448
s_add_u32 s48, s50, 131072
s_waitcnt vmcnt(26)
buffer_load_dwordx4 v24, s[12:15], s48 offen offset:0 lds
buffer_load_dwordx4 v25, s[12:15], s48 offen offset:1056 lds
s_waitcnt vmcnt(26)
s_max_i32 s49, s49, 9
v_mov_b32 v12, s49
ds_write_b32 v8, v12
buffer_load_dwordx4 v26, s[12:15], s48 offen offset:2112 lds
buffer_load_dwordx4 v27, s[12:15], s48 offen offset:3168 lds
s_add_u32 m0, s40, 12672
s_add_u32 s48, s50, 196608
s_waitcnt vmcnt(26)
ds_read_b32 v13, v9
buffer_load_dwordx4 v24, s[12:15], s48 offen offset:0 lds
buffer_load_dwordx4 v25, s[12:15], s48 offen offset:1056 lds
s_waitcnt vmcnt(26)
buffer_load_dwordx4 v26, s[12:15], s48 offen offset:2112 lds
buffer_load_dwordx4 v27, s[12:15], s48 offen offset:3168 lds
s_add_u32 s38, s38, 1
s_add_u32 s40, s40, 16896
s_cmp_eq_u32 s40, 152064
s_cselect_b32 s40, 0, s40
s_add_u32 s50, s50, 524288
s_cmp_eq_u32 s50, 3670016
s_cselect_b32 s50, 0, s50
s_mov_b32 s48, 98304
s_waitcnt vmcnt(26)
buffer_load_dwordx4 v[96:99], v20, s[8:11], s48 offen offset:0 nt
buffer_load_dwordx4 v[100:103], v21, s[8:11], s48 offen offset:1056 nt
s_waitcnt vmcnt(26)
buffer_load_dwordx4 v[104:107], v22, s[8:11], s48 offen offset:2112 nt
buffer_load_dwordx4 v[108:111], v23, s[8:11], s48 offen offset:3168 nt
s_mov_b32 s48, 98816
s_waitcnt vmcnt(26)
buffer_load_dwordx4 v[112:115], v20, s[8:11], s48 offen offset:0 nt
buffer_load_dwordx4 v[116:119], v21, s[8:11], s48 offen offset:1056 nt
s_waitcnt vmcnt(26)
buffer_load_dwordx4 v[120:123], v22, s[8:11], s48 offen offset:2112 nt
buffer_load_dwordx4 v[124:127], v23, s[8:11], s48 offen offset:3168 nt
s_mov_b32 s48, 99328
s_waitcnt vmcnt(26)
buffer_load_dwordx4 v[128:131], v20, s[8:11], s48 offen offset:0 nt
buffer_load_dwordx4 v[132:135], v21, s[8:11], s48 offen offset:1056 nt
s_waitcnt vmcnt(26)
buffer_load_dwordx4 v[136:139], v22, s[8:11], s48 offen offset:2112 nt
buffer_load_dwordx4 v[140:143], v23, s[8:11], s48 offen offset:3168 nt
s_mov_b32 s48, 99840
s_waitcnt vmcnt(26)
buffer_load_dwordx4 v[144:147], v20, s[8:11], s48 offen offset:0 nt
buffer_load_dwordx4 v[148:151], v21, s[8:11], s48 offen offset:1056 nt
s_waitcnt vmcnt(26)
buffer_load_dwordx4 v[152:155], v22, s[8:11], s48 offen offset:2112 nt
buffer_load_dwordx4 v[156:159], v23, s[8:11], s48 offen offset:3168 nt
ds_read_b32 v13, v9
s_sub_i32 s43, s38, 8
s_waitcnt lgkmcnt(0)
v_cmp_gt_i32 vcc, s43, v13
s_cbranch_vccz L_lg109
s_call_b64 s[84:85], L_lfull
L_lg109:
s_add_u32 m0, s40, 0
s_add_u32 s48, s50, 0
s_waitcnt vmcnt(26)
buffer_load_dwordx4 v24, s[12:15], s48 offen offset:0 lds
buffer_load_dwordx4 v25, s[12:15], s48 offen offset:1056 lds
s_waitcnt vmcnt(26)
buffer_load_dwordx4 v26, s[12:15], s48 offen offset:2112 lds
buffer_load_dwordx4 v27, s[12:15], s48 offen offset:3168 lds
s_add_u32 m0, s40, 4224
s_add_u32 s48, s50, 65536
s_waitcnt vmcnt(26)
buffer_load_dwordx4 v24, s[12:15], s48 offen offset:0 lds
buffer_load_dwordx4 v25, s[12:15], s48 offen offset:1056 lds
s_waitcnt vmcnt(26)
buffer_load_dwordx4 v26, s[12:15], s48 offen offset:2112 lds
buffer_load_dwordx4 v27, s[12:15], s48 offen offset:3168 lds
s_add_u32 m0, s40, 8448
s_add_u32 s48, s50, 131072
s_waitcnt vmcnt(26)
buffer_load_dwordx4 v24, s[12:15], s48 offen offset:0 lds
buffer_load_dwordx4 v25, s[12:15], s48 offen offset:1056 lds
s_waitcnt vmcnt(26)
s_max_i32 s49, s49, 10
v_mov_b32 v12, s49
ds_write_b32 v8, v12
buffer_load_dwordx4 v26, s[12:15], s48 offen offset:2112 lds
buffer_load_dwordx4 v27, s[12:15], s48 offen offset:3168 lds
s_add_u32 m0, s40, 12672
s_add_u32 s48, s50, 196608
s_waitcnt vmcnt(26)
ds_read_b32 v13, v9
buffer_load_dwordx4 v24, s[12:15], s48 offen offset:0 lds
buffer_load_dwordx4 v25, s[12:15], s48 offen offset:1056 lds
s_waitcnt vmcnt(26)
buffer_load_dwordx4 v26, s[12:15], s48 offen offset:2112 lds
buffer_load_dwordx4 v27, s[12:15], s48 offen offset:3168 lds
s_add_u32 s38, s38, 1
s_add_u32 s40, s40, 16896
s_cmp_eq_u32 s40, 152064
s_cselect_b32 s40, 0, s40
s_add_u32 s50, s50, 524288
s_cmp_eq_u32 s50, 3670016
s_cselect_b32 s50, 0, s50
s_add_u32 s50, s50, 256
s_mov_b32 s48, 131072
s_waitcnt vmcnt(26)
buffer_load_dwordx4 v[160:163], v20, s[8:11], s48 offen offset:0 nt
buffer_load_dwordx4 v[164:167], v21, s[8:11], s48 offen offset:1056 nt
s_waitcnt vmcnt(26)
buffer_load_dwordx4 v[168:171], v22, s[8:11], s48 offen offset:2112 nt
buffer_load_dwordx4 v[172:175], v23, s[8:11], s48 offen offset:3168 nt
s_mov_b32 s48, 131584
s_waitcnt vmcnt(26)
buffer_load_dwordx4 v[176:179], v20, s[8:11], s48 offen offset:0 nt
buffer_load_dwordx4 v[180:183], v21, s[8:11], s48 offen offset:1056 nt
s_waitcnt vmcnt(26)
buffer_load_dwordx4 v[184:187], v22, s[8:11], s48 offen offset:2112 nt
buffer_load_dwordx4 v[188:191], v23, s[8:11], s48 offen offset:3168 nt
s_mov_b32 s48, 132096
s_waitcnt vmcnt(26)
buffer_load_dwordx4 v[192:195], v20, s[8:11], s48 offen offset:0 nt
buffer_load_dwordx4 v[196:199], v21, s[8:11], s48 offen offset:1056 nt
s_waitcnt vmcnt(26)
buffer_load_dwordx4 v[200:203], v22, s[8:11], s48 offen offset:2112 nt
buffer_load_dwordx4 v[204:207], v23, s[8:11], s48 offen offset:3168 nt
s_mov_b32 s48, 132608
s_waitcnt vmcnt(26)
buffer_load_dwordx4 v[208:211], v20, s[8:11], s48 offen offset:0 nt
buffer_load_dwordx4 v[212:215], v21, s[8:11], s48 offen offset:1056 nt
s_waitcnt vmcnt(26)
buffer_load_dwordx4 v[216:219], v22, s[8:11], s48 offen offset:2112 nt
buffer_load_dwordx4 v[220:223], v23, s[8:11], s48 offen offset:3168 nt
ds_read_b32 v13, v9
s_sub_i32 s43, s38, 8
s_waitcnt lgkmcnt(0)
v_cmp_gt_i32 vcc, s43, v13
s_cbranch_vccz L_lg110
s_call_b64 s[84:85], L_lfull
L_lg110:
s_add_u32 m0, s40, 0
s_add_u32 s48, s50, 0
s_waitcnt vmcnt(26)
buffer_load_dwordx4 v24, s[12:15], s48 offen offset:0 lds
buffer_load_dwordx4 v25, s[12:15], s48 offen offset:1056 lds
s_waitcnt vmcnt(26)
buffer_load_dwordx4 v26, s[12:15], s48 offen offset:2112 lds
buffer_load_dwordx4 v27, s[12:15], s48 offen offset:3168 lds
s_add_u32 m0, s40, 4224
s_add_u32 s48, s50, 65536
s_waitcnt vmcnt(26)
buffer_load_dwordx4 v24, s[12:15], s48 offen offset:0 lds
buffer_load_dwordx4 v25, s[12:15], s48 offen offset:1056 lds
s_waitcnt vmcnt(26)
buffer_load_dwordx4 v26, s[12:15], s48 offen offset:2112 lds
buffer_load_dwordx4 v27, s[12:15], s48 offen offset:3168 lds
s_add_u32 m0, s40, 8448
s_add_u32 s48, s50, 131072
s_waitcnt vmcnt(26)
buffer_load_dwordx4 v24, s[12:15], s48 offen offset:0 lds
buffer_load_dwordx4 v25, s[12:15], s48 offen offset:1056 lds
s_waitcnt vmcnt(26)
s_max_i32 s49, s49, 11
v_mov_b32 v12, s49
ds_write_b32 v8, v12
buffer_load_dwordx4 v26, s[12:15], s48 offen offset:2112 lds
buffer_load_dwordx4 v27, s[12:15], s48 offen offset:3168 lds
s_add_u32 m0, s40, 12672
s_add_u32 s48, s50, 196608
s_waitcnt vmcnt(26)
ds_read_b32 v13, v9
buffer_load_dwordx4 v24, s[12:15], s48 offen offset:0 lds
buffer_load_dwordx4 v25, s[12:15], s48 offen offset:1056 lds
s_waitcnt vmcnt(26)
buffer_load_dwordx4 v26, s[12:15], s48 offen offset:2112 lds
buffer_load_dwordx4 v27, s[12:15], s48 offen offset:3168 lds
s_add_u32 s38, s38, 1
s_add_u32 s40, s40, 16896
s_cmp_eq_u32 s40, 152064
s_cselect_b32 s40, 0, s40
s_add_u32 s50, s50, 524288
s_cmp_eq_u32 s50, 3670272
s_cselect_b32 s50, 256, s50
s_mov_b32 s48, 163840
s_waitcnt vmcnt(26)
buffer_load_dwordx4 a[0:3], v20, s[8:11], s48 offen offset:0 nt
buffer_load_dwordx4 a[4:7], v21, s[8:11], s48 offen offset:1056 nt
s_waitcnt vmcnt(26)
buffer_load_dwordx4 a[8:11], v22, s[8:11], s48 offen offset:2112 nt
buffer_load_dwordx4 a[12:15], v23, s[8:11], s48 offen offset:3168 nt
s_mov_b32 s48, 164352
s_waitcnt vmcnt(26)
buffer_load_dwordx4 a[16:19], v20, s[8:11], s48 offen offset:0 nt
buffer_load_dwordx4 a[20:23], v21, s[8:11], s48 offen offset:1056 nt
s_waitcnt vmcnt(26)
buffer_load_dwordx4 a[24:27], v22, s[8:11], s48 offen offset:2112 nt
buffer_load_dwordx4 a[28:31], v23, s[8:11], s48 offen offset:3168 nt
s_mov_b32 s48, 164864
s_waitcnt vmcnt(26)
buffer_load_dwordx4 a[32:35], v20, s[8:11], s48 offen offset:0 nt
buffer_load_dwordx4 a[36:39], v21, s[8:11], s48 offen offset:1056 nt
s_waitcnt vmcnt(26)
buffer_load_dwordx4 a[40:43], v22, s[8:11], s48 offen offset:2112 nt
buffer_load_dwordx4 a[44:47], v23, s[8:11], s48 offen offset:3168 nt
s_mov_b32 s48, 165376
s_waitcnt vmcnt(26)
buffer_load_dwordx4 a[48:51], v20, s[8:11], s48 offen offset:0 nt
buffer_load_dwordx4 a[52:55], v21, s[8:11], s48 offen offset:1056 nt
s_waitcnt vmcnt(26)
buffer_load_dwordx4 a[56:59], v22, s[8:11], s48 offen offset:2112 nt
buffer_load_dwordx4 a[60:63], v23, s[8:11], s48 offen offset:3168 nt
ds_read_b32 v13, v9
s_sub_i32 s43, s38, 8
s_waitcnt lgkmcnt(0)
v_cmp_gt_i32 vcc, s43, v13
s_cbranch_vccz L_lg111
s_call_b64 s[84:85], L_lfull
L_lg111:
s_add_u32 m0, s40, 0
s_add_u32 s48, s50, 0
s_waitcnt vmcnt(26)
buffer_load_dwordx4 v24, s[12:15], s48 offen offset:0 lds
buffer_load_dwordx4 v25, s[12:15], s48 offen offset:1056 lds
s_waitcnt vmcnt(26)
buffer_load_dwordx4 v26, s[12:15], s48 offen offset:2112 lds
buffer_load_dwordx4 v27, s[12:15], s48 offen offset:3168 lds
s_add_u32 m0, s40, 4224
s_add_u32 s48, s50, 65536
s_waitcnt vmcnt(26)
buffer_load_dwordx4 v24, s[12:15], s48 offen offset:0 lds
buffer_load_dwordx4 v25, s[12:15], s48 offen offset:1056 lds
s_waitcnt vmcnt(26)
buffer_load_dwordx4 v26, s[12:15], s48 offen offset:2112 lds
buffer_load_dwordx4 v27, s[12:15], s48 offen offset:3168 lds
s_add_u32 m0, s40, 8448
s_add_u32 s48, s50, 131072
s_waitcnt vmcnt(26)
buffer_load_dwordx4 v24, s[12:15], s48 offen offset:0 lds
buffer_load_dwordx4 v25, s[12:15], s48 offen offset:1056 lds
s_waitcnt vmcnt(26)
s_max_i32 s49, s49, 12
v_mov_b32 v12, s49
ds_write_b32 v8, v12
buffer_load_dwordx4 v26, s[12:15], s48 offen offset:2112 lds
buffer_load_dwordx4 v27, s[12:15], s48 offen offset:3168 lds
s_add_u32 m0, s40, 12672
s_add_u32 s48, s50, 196608
s_waitcnt vmcnt(26)
ds_read_b32 v13, v9
buffer_load_dwordx4 v24, s[12:15], s48 offen offset:0 lds
buffer_load_dwordx4 v25, s[12:15], s48 offen offset:1056 lds
s_waitcnt vmcnt(26)
buffer_load_dwordx4 v26, s[12:15], s48 offen offset:2112 lds
buffer_load_dwordx4 v27, s[12:15], s48 offen offset:3168 lds
s_add_u32 s38, s38, 1
s_add_u32 s40, s40, 16896
s_cmp_eq_u32 s40, 152064
s_cselect_b32 s40, 0, s40
s_add_u32 s50, s50, 524288
s_cmp_eq_u32 s50, 3670272
s_cselect_b32 s50, 256, s50
s_mov_b32 s48, 196608
s_waitcnt vmcnt(26)
buffer_load_dwordx4 a[64:67], v20, s[8:11], s48 offen offset:0 nt
buffer_load_dwordx4 a[68:71], v21, s[8:11], s48 offen offset:1056 nt
s_waitcnt vmcnt(26)
buffer_load_dwordx4 a[72:75], v22, s[8:11], s48 offen offset:2112 nt
buffer_load_dwordx4 a[76:79], v23, s[8:11], s48 offen offset:3168 nt
s_mov_b32 s48, 197120
s_waitcnt vmcnt(26)
buffer_load_dwordx4 a[80:83], v20, s[8:11], s48 offen offset:0 nt
buffer_load_dwordx4 a[84:87], v21, s[8:11], s48 offen offset:1056 nt
s_waitcnt vmcnt(26)
buffer_load_dwordx4 a[88:91], v22, s[8:11], s48 offen offset:2112 nt
buffer_load_dwordx4 a[92:95], v23, s[8:11], s48 offen offset:3168 nt
s_mov_b32 s48, 197632
s_waitcnt vmcnt(26)
buffer_load_dwordx4 a[96:99], v20, s[8:11], s48 offen offset:0 nt
buffer_load_dwordx4 a[100:103], v21, s[8:11], s48 offen offset:1056 nt
s_waitcnt vmcnt(26)
buffer_load_dwordx4 a[104:107], v22, s[8:11], s48 offen offset:2112 nt
buffer_load_dwordx4 a[108:111], v23, s[8:11], s48 offen offset:3168 nt
s_mov_b32 s48, 198144
s_waitcnt vmcnt(26)
buffer_load_dwordx4 a[112:115], v20, s[8:11], s48 offen offset:0 nt
buffer_load_dwordx4 a[116:119], v21, s[8:11], s48 offen offset:1056 nt
s_waitcnt vmcnt(26)
buffer_load_dwordx4 a[120:123], v22, s[8:11], s48 offen offset:2112 nt
buffer_load_dwordx4 a[124:127], v23, s[8:11], s48 offen offset:3168 nt
ds_read_b32 v13, v9
s_sub_i32 s43, s38, 8
s_waitcnt lgkmcnt(0)
v_cmp_gt_i32 vcc, s43, v13
s_cbranch_vccz L_lg112
s_call_b64 s[84:85], L_lfull
L_lg112:
s_add_u32 m0, s40, 0
s_add_u32 s48, s50, 0
s_waitcnt vmcnt(26)
buffer_load_dwordx4 v24, s[12:15], s48 offen offset:0 lds
buffer_load_dwordx4 v25, s[12:15], s48 offen offset:1056 lds
s_waitcnt vmcnt(26)
buffer_load_dwordx4 v26, s[12:15], s48 offen offset:2112 lds
buffer_load_dwordx4 v27, s[12:15], s48 offen offset:3168 lds
s_add_u32 m0, s40, 4224
s_add_u32 s48, s50, 65536
s_waitcnt vmcnt(26)
buffer_load_dwordx4 v24, s[12:15], s48 offen offset:0 lds
buffer_load_dwordx4 v25, s[12:15], s48 offen offset:1056 lds
s_waitcnt vmcnt(26)
buffer_load_dwordx4 v26, s[12:15], s48 offen offset:2112 lds
buffer_load_dwordx4 v27, s[12:15], s48 offen offset:3168 lds
s_add_u32 m0, s40, 8448
s_add_u32 s48, s50, 131072
s_waitcnt vmcnt(26)
buffer_load_dwordx4 v24, s[12:15], s48 offen offset:0 lds
buffer_load_dwordx4 v25, s[12:15], s48 offen offset:1056 lds
s_waitcnt vmcnt(26)
s_max_i32 s49, s49, 13
v_mov_b32 v12, s49
ds_write_b32 v8, v12
buffer_load_dwordx4 v26, s[12:15], s48 offen offset:2112 lds
buffer_load_dwordx4 v27, s[12:15], s48 offen offset:3168 lds
s_add_u32 m0, s40, 12672
s_add_u32 s48, s50, 196608
s_waitcnt vmcnt(26)
ds_read_b32 v13, v9
buffer_load_dwordx4 v24, s[12:15], s48 offen offset:0 lds
buffer_load_dwordx4 v25, s[12:15], s48 offen offset:1056 lds
s_waitcnt vmcnt(26)
buffer_load_dwordx4 v26, s[12:15], s48 offen offset:2112 lds
buffer_load_dwordx4 v27, s[12:15], s48 offen offset:3168 lds
s_add_u32 s38, s38, 1
s_add_u32 s40, s40, 16896
s_cmp_eq_u32 s40, 152064
s_cselect_b32 s40, 0, s40
s_add_u32 s50, s50, 524288
s_cmp_eq_u32 s50, 3670272
s_cselect_b32 s50, 256, s50
s_sub_i32 s43, s38, 8
s_waitcnt lgkmcnt(0)
v_cmp_gt_i32 vcc, s43, v13
s_cbranch_vccz L_lg113
s_call_b64 s[84:85], L_lfull
L_lg113:
s_add_u32 m0, s40, 0
s_add_u32 s48, s50, 0
s_waitcnt vmcnt(26)
buffer_load_dwordx4 v24, s[12:15], s48 offen offset:0 lds
buffer_load_dwordx4 v25, s[12:15], s48 offen offset:1056 lds
s_waitcnt vmcnt(26)
buffer_load_dwordx4 v26, s[12:15], s48 offen offset:2112 lds
buffer_load_dwordx4 v27, s[12:15], s48 offen offset:3168 lds
s_add_u32 m0, s40, 4224
s_add_u32 s48, s50, 65536
s_waitcnt vmcnt(26)
buffer_load_dwordx4 v24, s[12:15], s48 offen offset:0 lds
buffer_load_dwordx4 v25, s[12:15], s48 offen offset:1056 lds
s_waitcnt vmcnt(26)
buffer_load_dwordx4 v26, s[12:15], s48 offen offset:2112 lds
buffer_load_dwordx4 v27, s[12:15], s48 offen offset:3168 lds
s_add_u32 m0, s40, 8448
s_add_u32 s48, s50, 131072
s_waitcnt vmcnt(26)
buffer_load_dwordx4 v24, s[12:15], s48 offen offset:0 lds
buffer_load_dwordx4 v25, s[12:15], s48 offen offset:1056 lds
s_waitcnt vmcnt(26)
buffer_load_dwordx4 v26, s[12:15], s48 offen offset:2112 lds
buffer_load_dwordx4 v27, s[12:15], s48 offen offset:3168 lds
s_add_u32 m0, s40, 12672
s_add_u32 s48, s50, 196608
s_waitcnt vmcnt(26)
ds_read_b32 v13, v9
buffer_load_dwordx4 v24, s[12:15], s48 offen offset:0 lds
buffer_load_dwordx4 v25, s[12:15], s48 offen offset:1056 lds
s_waitcnt vmcnt(26)
buffer_load_dwordx4 v26, s[12:15], s48 offen offset:2112 lds
buffer_load_dwordx4 v27, s[12:15], s48 offen offset:3168 lds
s_add_u32 s38, s38, 1
s_add_u32 s40, s40, 16896
s_cmp_eq_u32 s40, 152064
s_cselect_b32 s40, 0, s40
s_add_u32 s50, s50, 524288
s_cmp_eq_u32 s50, 3670272
s_cselect_b32 s50, 256, s50
s_sub_i32 s43, s38, 8
s_waitcnt lgkmcnt(0)
v_cmp_gt_i32 vcc, s43, v13
s_cbranch_vccz L_lg114
s_call_b64 s[84:85], L_lfull
L_lg114:
s_add_u32 m0, s40, 0
s_add_u32 s48, s50, 0
s_waitcnt vmcnt(26)
buffer_load_dwordx4 v24, s[12:15], s48 offen offset:0 lds
buffer_load_dwordx4 v25, s[12:15], s48 offen offset:1056 lds
s_waitcnt vmcnt(26)
buffer_load_dwordx4 v26, s[12:15], s48 offen offset:2112 lds
buffer_load_dwordx4 v27, s[12:15], s48 offen offset:3168 lds
s_add_u32 m0, s40, 4224
s_add_u32 s48, s50, 65536
s_waitcnt vmcnt(26)
buffer_load_dwordx4 v24, s[12:15], s48 offen offset:0 lds
buffer_load_dwordx4 v25, s[12:15], s48 offen offset:1056 lds
s_waitcnt vmcnt(26)
buffer_load_dwordx4 v26, s[12:15], s48 offen offset:2112 lds
buffer_load_dwordx4 v27, s[12:15], s48 offen offset:3168 lds
s_add_u32 m0, s40, 8448
s_add_u32 s48, s50, 131072
s_waitcnt vmcnt(26)
buffer_load_dwordx4 v24, s[12:15], s48 offen offset:0 lds
buffer_load_dwordx4 v25, s[12:15], s48 offen offset:1056 lds
s_waitcnt vmcnt(26)
s_max_i32 s49, s49, 14
v_mov_b32 v12, s49
ds_write_b32 v8, v12
buffer_load_dwordx4 v26, s[12:15], s48 offen offset:2112 lds
buffer_load_dwordx4 v27, s[12:15], s48 offen offset:3168 lds
s_add_u32 m0, s40, 12672
s_add_u32 s48, s50, 196608
s_waitcnt vmcnt(26)
ds_read_b32 v13, v9
buffer_load_dwordx4 v24, s[12:15], s48 offen offset:0 lds
buffer_load_dwordx4 v25, s[12:15], s48 offen offset:1056 lds
s_waitcnt vmcnt(26)
buffer_load_dwordx4 v26, s[12:15], s48 offen offset:2112 lds
buffer_load_dwordx4 v27, s[12:15], s48 offen offset:3168 lds
s_add_u32 s38, s38, 1
s_add_u32 s40, s40, 16896
s_cmp_eq_u32 s40, 152064
s_cselect_b32 s40, 0, s40
s_add_u32 s50, s50, 524288
s_cmp_eq_u32 s50, 3670272
s_cselect_b32 s50, 256, s50
s_sub_i32 s43, s38, 8
s_waitcnt lgkmcnt(0)
v_cmp_gt_i32 vcc, s43, v13
s_cbranch_vccz L_lg115
s_call_b64 s[84:85], L_lfull
L_lg115:
s_add_u32 m0, s40, 0
s_add_u32 s48, s50, 0
s_waitcnt vmcnt(26)
buffer_load_dwordx4 v24, s[12:15], s48 offen offset:0 lds
buffer_load_dwordx4 v25, s[12:15], s48 offen offset:1056 lds
s_waitcnt vmcnt(26)
buffer_load_dwordx4 v26, s[12:15], s48 offen offset:2112 lds
buffer_load_dwordx4 v27, s[12:15], s48 offen offset:3168 lds
s_add_u32 m0, s40, 4224
s_add_u32 s48, s50, 65536
s_waitcnt vmcnt(26)
buffer_load_dwordx4 v24, s[12:15], s48 offen offset:0 lds
buffer_load_dwordx4 v25, s[12:15], s48 offen offset:1056 lds
s_waitcnt vmcnt(26)
buffer_load_dwordx4 v26, s[12:15], s48 offen offset:2112 lds
buffer_load_dwordx4 v27, s[12:15], s48 offen offset:3168 lds
s_add_u32 m0, s40, 8448
s_add_u32 s48, s50, 131072
s_waitcnt vmcnt(26)
buffer_load_dwordx4 v24, s[12:15], s48 offen offset:0 lds
buffer_load_dwordx4 v25, s[12:15], s48 offen offset:1056 lds
s_waitcnt vmcnt(26)
s_max_i32 s49, s49, 15
v_mov_b32 v12, s49
ds_write_b32 v8, v12
buffer_load_dwordx4 v26, s[12:15], s48 offen offset:2112 lds
buffer_load_dwordx4 v27, s[12:15], s48 offen offset:3168 lds
s_add_u32 m0, s40, 12672
s_add_u32 s48, s50, 196608
s_waitcnt vmcnt(26)
ds_read_b32 v13, v9
buffer_load_dwordx4 v24, s[12:15], s48 offen offset:0 lds
buffer_load_dwordx4 v25, s[12:15], s48 offen offset:1056 lds
s_waitcnt vmcnt(26)
buffer_load_dwordx4 v26, s[12:15], s48 offen offset:2112 lds
buffer_load_dwordx4 v27, s[12:15], s48 offen offset:3168 lds
s_add_u32 s38, s38, 1
s_add_u32 s40, s40, 16896
s_cmp_eq_u32 s40, 152064
s_cselect_b32 s40, 0, s40
s_add_u32 s50, s50, 524288
s_cmp_eq_u32 s50, 3670272
s_cselect_b32 s50, 256, s50
s_sub_i32 s43, s38, 8
s_waitcnt lgkmcnt(0)
v_cmp_gt_i32 vcc, s43, v13
s_cbranch_vccz L_lg116
s_call_b64 s[84:85], L_lfull
L_lg116:
s_add_u32 m0, s40, 0
s_add_u32 s48, s50, 0
s_waitcnt vmcnt(26)
buffer_load_dwordx4 v24, s[12:15], s48 offen offset:0 lds
buffer_load_dwordx4 v25, s[12:15], s48 offen offset:1056 lds
s_waitcnt vmcnt(26)
buffer_load_dwordx4 v26, s[12:15], s48 offen offset:2112 lds
buffer_load_dwordx4 v27, s[12:15], s48 offen offset:3168 lds
s_add_u32 m0, s40, 4224
s_add_u32 s48, s50, 65536
s_waitcnt vmcnt(26)
buffer_load_dwordx4 v24, s[12:15], s48 offen offset:0 lds
buffer_load_dwordx4 v25, s[12:15], s48 offen offset:1056 lds
s_waitcnt vmcnt(26)
buffer_load_dwordx4 v26, s[12:15], s48 offen offset:2112 lds
buffer_load_dwordx4 v27, s[12:15], s48 offen offset:3168 lds
s_add_u32 m0, s40, 8448
s_add_u32 s48, s50, 131072
s_waitcnt vmcnt(26)
buffer_load_dwordx4 v24, s[12:15], s48 offen offset:0 lds
buffer_load_dwordx4 v25, s[12:15], s48 offen offset:1056 lds
s_waitcnt vmcnt(26)
s_max_i32 s49, s49, 16
v_mov_b32 v12, s49
ds_write_b32 v8, v12
buffer_load_dwordx4 v26, s[12:15], s48 offen offset:2112 lds
buffer_load_dwordx4 v27, s[12:15], s48 offen offset:3168 lds
s_add_u32 m0, s40, 12672
s_add_u32 s48, s50, 196608
s_waitcnt vmcnt(26)
ds_read_b32 v13, v9
buffer_load_dwordx4 v24, s[12:15], s48 offen offset:0 lds
buffer_load_dwordx4 v25, s[12:15], s48 offen offset:1056 lds
s_waitcnt vmcnt(26)
buffer_load_dwordx4 v26, s[12:15], s48 offen offset:2112 lds
buffer_load_dwordx4 v27, s[12:15], s48 offen offset:3168 lds
s_add_u32 s38, s38, 1
s_add_u32 s40, s40, 16896
s_cmp_eq_u32 s40, 152064
s_cselect_b32 s40, 0, s40
s_add_u32 s50, s50, 524288
s_cmp_eq_u32 s50, 3670272
s_cselect_b32 s50, 256, s50
s_mov_b32 s50, 0
s_sub_i32 s43, s38, 8
s_waitcnt lgkmcnt(0)
v_cmp_gt_i32 vcc, s43, v13
s_cbranch_vccz L_lg117
s_call_b64 s[84:85], L_lfull
L_lg117:
s_add_u32 m0, s40, 0
s_add_u32 s48, s50, 0
s_waitcnt vmcnt(30)
buffer_load_dwordx4 v20, s[96:99], s48 offen offset:0 nt lds
buffer_load_dwordx4 v21, s[96:99], s48 offen offset:1056 nt lds
s_waitcnt vmcnt(30)
buffer_load_dwordx4 v22, s[96:99], s48 offen offset:2112 nt lds
buffer_load_dwordx4 v23, s[96:99], s48 offen offset:3168 nt lds
s_add_u32 m0, s40, 4224
s_add_u32 s48, s50, 512
s_waitcnt vmcnt(30)
buffer_load_dwordx4 v20, s[96:99], s48 offen offset:0 nt lds
buffer_load_dwordx4 v21, s[96:99], s48 offen offset:1056 nt lds
s_waitcnt vmcnt(30)
buffer_load_dwordx4 v22, s[96:99], s48 offen offset:2112 nt lds
buffer_load_dwordx4 v23, s[96:99], s48 offen offset:3168 nt lds
s_add_u32 m0, s40, 8448
s_add_u32 s48, s50, 1024
s_waitcnt vmcnt(30)
buffer_load_dwordx4 v20, s[96:99], s48 offen offset:0 nt lds
buffer_load_dwordx4 v21, s[96:99], s48 offen offset:1056 nt lds
s_waitcnt vmcnt(30)
buffer_load_dwordx4 v22, s[96:99], s48 offen offset:2112 nt lds
buffer_load_dwordx4 v23, s[96:99], s48 offen offset:3168 nt lds
s_add_u32 m0, s40, 12672
s_add_u32 s48, s50, 1536
s_waitcnt vmcnt(30)
ds_read_b32 v13, v9
buffer_load_dwordx4 v20, s[96:99], s48 offen offset:0 nt lds
buffer_load_dwordx4 v21, s[96:99], s48 offen offset:1056 nt lds
s_waitcnt vmcnt(30)
s_max_i32 s49, s49, 17
v_mov_b32 v12, s49
ds_write_b32 v8, v12
buffer_load_dwordx4 v22, s[96:99], s48 offen offset:2112 nt lds
buffer_load_dwordx4 v23, s[96:99], s48 offen offset:3168 nt lds
s_add_u32 s38, s38, 1
s_add_u32 s40, s40, 16896
s_cmp_eq_u32 s40, 152064
s_cselect_b32 s40, 0, s40
s_sub_i32 s43, s38, 8
s_waitcnt lgkmcnt(0)
v_cmp_gt_i32 vcc, s43, v13
s_cbranch_vccz L_lg118
s_call_b64 s[84:85], L_lfull
L_lg118:
s_add_u32 m0, s40, 0
s_add_u32 s48, s50, 0
s_waitcnt vmcnt(30)
buffer_load_dwordx4 v20, s[4:7], s48 offen offset:0 nt lds
buffer_load_dwordx4 v21, s[4:7], s48 offen offset:1056 nt lds
s_waitcnt vmcnt(30)
buffer_load_dwordx4 v22, s[4:7], s48 offen offset:2112 nt lds
buffer_load_dwordx4 v23, s[4:7], s48 offen offset:3168 nt lds
s_add_u32 m0, s40, 4224
s_add_u32 s48, s50, 512
s_waitcnt vmcnt(30)
buffer_load_dwordx4 v20, s[4:7], s48 offen offset:0 nt lds
buffer_load_dwordx4 v21, s[4:7], s48 offen offset:1056 nt lds
s_waitcnt vmcnt(30)
buffer_load_dwordx4 v22, s[4:7], s48 offen offset:2112 nt lds
buffer_load_dwordx4 v23, s[4:7], s48 offen offset:3168 nt lds
s_add_u32 m0, s40, 8448
s_add_u32 s48, s50, 1024
s_waitcnt vmcnt(30)
buffer_load_dwordx4 v20, s[4:7], s48 offen offset:0 nt lds
buffer_load_dwordx4 v21, s[4:7], s48 offen offset:1056 nt lds
s_waitcnt vmcnt(30)
buffer_load_dwordx4 v22, s[4:7], s48 offen offset:2112 nt lds
buffer_load_dwordx4 v23, s[4:7], s48 offen offset:3168 nt lds
s_add_u32 m0, s40, 12672
s_add_u32 s48, s50, 1536
s_waitcnt vmcnt(30)
ds_read_b32 v13, v9
buffer_load_dwordx4 v20, s[4:7], s48 offen offset:0 nt lds
buffer_load_dwordx4 v21, s[4:7], s48 offen offset:1056 nt lds
s_waitcnt vmcnt(30)
s_max_i32 s49, s49, 18
v_mov_b32 v12, s49
ds_write_b32 v8, v12
buffer_load_dwordx4 v22, s[4:7], s48 offen offset:2112 nt lds
buffer_load_dwordx4 v23, s[4:7], s48 offen offset:3168 nt lds
s_add_u32 s38, s38, 1
s_add_u32 s40, s40, 16896
s_cmp_eq_u32 s40, 152064
s_cselect_b32 s40, 0, s40
s_sub_i32 s43, s38, 8
s_waitcnt lgkmcnt(0)
v_cmp_gt_i32 vcc, s43, v13
s_cbranch_vccz L_lg119
s_call_b64 s[84:85], L_lfull
L_lg119:
s_add_u32 m0, s40, 0
s_add_u32 s48, s50, 16384
s_waitcnt vmcnt(30)
buffer_load_dwordx4 v20, s[4:7], s48 offen offset:0 nt lds
buffer_load_dwordx4 v21, s[4:7], s48 offen offset:1056 nt lds
s_waitcnt vmcnt(30)
buffer_load_dwordx4 v22, s[4:7], s48 offen offset:2112 nt lds
buffer_load_dwordx4 v23, s[4:7], s48 offen offset:3168 nt lds
s_add_u32 m0, s40, 4224
s_add_u32 s48, s50, 16896
s_waitcnt vmcnt(30)
buffer_load_dwordx4 v20, s[4:7], s48 offen offset:0 nt lds
buffer_load_dwordx4 v21, s[4:7], s48 offen offset:1056 nt lds
s_waitcnt vmcnt(30)
buffer_load_dwordx4 v22, s[4:7], s48 offen offset:2112 nt lds
buffer_load_dwordx4 v23, s[4:7], s48 offen offset:3168 nt lds
s_add_u32 m0, s40, 8448
s_add_u32 s48, s50, 17408
s_waitcnt vmcnt(30)
buffer_load_dwordx4 v20, s[4:7], s48 offen offset:0 nt lds
buffer_load_dwordx4 v21, s[4:7], s48 offen offset:1056 nt lds
s_waitcnt vmcnt(30)
buffer_load_dwordx4 v22, s[4:7], s48 offen offset:2112 nt lds
buffer_load_dwordx4 v23, s[4:7], s48 offen offset:3168 nt lds
s_add_u32 m0, s40, 12672
s_add_u32 s48, s50, 17920
s_waitcnt vmcnt(30)
ds_read_b32 v13, v9
buffer_load_dwordx4 v20, s[4:7], s48 offen offset:0 nt lds
buffer_load_dwordx4 v21, s[4:7], s48 offen offset:1056 nt lds
s_waitcnt vmcnt(30)
s_max_i32 s49, s49, 19
v_mov_b32 v12, s49
ds_write_b32 v8, v12
buffer_load_dwordx4 v22, s[4:7], s48 offen offset:2112 nt lds
buffer_load_dwordx4 v23, s[4:7], s48 offen offset:3168 nt lds
s_add_u32 s38, s38, 1
s_add_u32 s40, s40, 16896
s_cmp_eq_u32 s40, 152064
s_cselect_b32 s40, 0, s40
s_sub_i32 s43, s38, 8
s_waitcnt lgkmcnt(0)
v_cmp_gt_i32 vcc, s43, v13
s_cbranch_vccz L_lg120
s_call_b64 s[84:85], L_lfull
L_lg120:
s_add_u32 m0, s40, 0
s_add_u32 s48, s50, 0
s_waitcnt vmcnt(30)
buffer_load_dwordx4 v20, s[8:11], s48 offen offset:0 nt lds
buffer_load_dwordx4 v21, s[8:11], s48 offen offset:1056 nt lds
s_waitcnt vmcnt(30)
buffer_load_dwordx4 v22, s[8:11], s48 offen offset:2112 nt lds
buffer_load_dwordx4 v23, s[8:11], s48 offen offset:3168 nt lds
s_add_u32 m0, s40, 4224
s_add_u32 s48, s50, 512
s_waitcnt vmcnt(30)
buffer_load_dwordx4 v20, s[8:11], s48 offen offset:0 nt lds
buffer_load_dwordx4 v21, s[8:11], s48 offen offset:1056 nt lds
s_waitcnt vmcnt(30)
buffer_load_dwordx4 v22, s[8:11], s48 offen offset:2112 nt lds
buffer_load_dwordx4 v23, s[8:11], s48 offen offset:3168 nt lds
s_add_u32 m0, s40, 8448
s_add_u32 s48, s50, 1024
s_waitcnt vmcnt(30)
buffer_load_dwordx4 v20, s[8:11], s48 offen offset:0 nt lds
buffer_load_dwordx4 v21, s[8:11], s48 offen offset:1056 nt lds
s_waitcnt vmcnt(30)
buffer_load_dwordx4 v22, s[8:11], s48 offen offset:2112 nt lds
buffer_load_dwordx4 v23, s[8:11], s48 offen offset:3168 nt lds
s_add_u32 m0, s40, 12672
s_add_u32 s48, s50, 1536
s_waitcnt vmcnt(30)
ds_read_b32 v13, v9
buffer_load_dwordx4 v20, s[8:11], s48 offen offset:0 nt lds
buffer_load_dwordx4 v21, s[8:11], s48 offen offset:1056 nt lds
s_waitcnt vmcnt(30)
s_max_i32 s49, s49, 20
v_mov_b32 v12, s49
ds_write_b32 v8, v12
buffer_load_dwordx4 v22, s[8:11], s48 offen offset:2112 nt lds
buffer_load_dwordx4 v23, s[8:11], s48 offen offset:3168 nt lds
s_add_u32 s38, s38, 1
s_add_u32 s40, s40, 16896
s_cmp_eq_u32 s40, 152064
s_cselect_b32 s40, 0, s40
s_add_u32 s50, s50, 16384
s_sub_i32 s43, s38, 8
s_waitcnt lgkmcnt(0)
v_cmp_gt_i32 vcc, s43, v13
s_cbranch_vccz L_lg121
s_call_b64 s[84:85], L_lfull
L_lg121:
s_add_u32 m0, s40, 0
s_add_u32 s48, s50, 16384
s_waitcnt vmcnt(30)
buffer_load_dwordx4 v20, s[4:7], s48 offen offset:0 nt lds
buffer_load_dwordx4 v21, s[4:7], s48 offen offset:1056 nt lds
s_waitcnt vmcnt(30)
buffer_load_dwordx4 v22, s[4:7], s48 offen offset:2112 nt lds
buffer_load_dwordx4 v23, s[4:7], s48 offen offset:3168 nt lds
s_add_u32 m0, s40, 4224
s_add_u32 s48, s50, 16896
s_waitcnt vmcnt(30)
buffer_load_dwordx4 v20, s[4:7], s48 offen offset:0 nt lds
buffer_load_dwordx4 v21, s[4:7], s48 offen offset:1056 nt lds
s_waitcnt vmcnt(30)
buffer_load_dwordx4 v22, s[4:7], s48 offen offset:2112 nt lds
buffer_load_dwordx4 v23, s[4:7], s48 offen offset:3168 nt lds
s_add_u32 m0, s40, 8448
s_add_u32 s48, s50, 17408
s_waitcnt vmcnt(30)
buffer_load_dwordx4 v20, s[4:7], s48 offen offset:0 nt lds
buffer_load_dwordx4 v21, s[4:7], s48 offen offset:1056 nt lds
s_waitcnt vmcnt(30)
buffer_load_dwordx4 v22, s[4:7], s48 offen offset:2112 nt lds
buffer_load_dwordx4 v23, s[4:7], s48 offen offset:3168 nt lds
s_add_u32 m0, s40, 12672
s_add_u32 s48, s50, 17920
s_waitcnt vmcnt(30)
ds_read_b32 v13, v9
buffer_load_dwordx4 v20, s[4:7], s48 offen offset:0 nt lds
buffer_load_dwordx4 v21, s[4:7], s48 offen offset:1056 nt lds
s_waitcnt vmcnt(30)
s_max_i32 s49, s49, 21
v_mov_b32 v12, s49
ds_write_b32 v8, v12
buffer_load_dwordx4 v22, s[4:7], s48 offen offset:2112 nt lds
buffer_load_dwordx4 v23, s[4:7], s48 offen offset:3168 nt lds
s_add_u32 s38, s38, 1
s_add_u32 s40, s40, 16896
s_cmp_eq_u32 s40, 152064
s_cselect_b32 s40, 0, s40
s_sub_i32 s43, s38, 8
s_waitcnt lgkmcnt(0)
v_cmp_gt_i32 vcc, s43, v13
s_cbranch_vccz L_lg122
s_call_b64 s[84:85], L_lfull
L_lg122:
s_add_u32 m0, s40, 0
s_add_u32 s48, s50, 0
s_waitcnt vmcnt(30)
buffer_load_dwordx4 v20, s[8:11], s48 offen offset:0 nt lds
buffer_load_dwordx4 v21, s[8:11], s48 offen offset:1056 nt lds
s_waitcnt vmcnt(30)
buffer_load_dwordx4 v22, s[8:11], s48 offen offset:2112 nt lds
buffer_load_dwordx4 v23, s[8:11], s48 offen offset:3168 nt lds
s_add_u32 m0, s40, 4224
s_add_u32 s48, s50, 512
s_waitcnt vmcnt(30)
buffer_load_dwordx4 v20, s[8:11], s48 offen offset:0 nt lds
buffer_load_dwordx4 v21, s[8:11], s48 offen offset:1056 nt lds
s_waitcnt vmcnt(30)
buffer_load_dwordx4 v22, s[8:11], s48 offen offset:2112 nt lds
buffer_load_dwordx4 v23, s[8:11], s48 offen offset:3168 nt lds
s_add_u32 m0, s40, 8448
s_add_u32 s48, s50, 1024
s_waitcnt vmcnt(30)
buffer_load_dwordx4 v20, s[8:11], s48 offen offset:0 nt lds
buffer_load_dwordx4 v21, s[8:11], s48 offen offset:1056 nt lds
s_waitcnt vmcnt(30)
buffer_load_dwordx4 v22, s[8:11], s48 offen offset:2112 nt lds
buffer_load_dwordx4 v23, s[8:11], s48 offen offset:3168 nt lds
s_add_u32 m0, s40, 12672
s_add_u32 s48, s50, 1536
s_waitcnt vmcnt(30)
ds_read_b32 v13, v9
buffer_load_dwordx4 v20, s[8:11], s48 offen offset:0 nt lds
buffer_load_dwordx4 v21, s[8:11], s48 offen offset:1056 nt lds
s_waitcnt vmcnt(30)
s_max_i32 s49, s49, 22
v_mov_b32 v12, s49
ds_write_b32 v8, v12
buffer_load_dwordx4 v22, s[8:11], s48 offen offset:2112 nt lds
buffer_load_dwordx4 v23, s[8:11], s48 offen offset:3168 nt lds
s_add_u32 s38, s38, 1
s_add_u32 s40, s40, 16896
s_cmp_eq_u32 s40, 152064
s_cselect_b32 s40, 0, s40
s_add_u32 s50, s50, 16384
s_sub_i32 s43, s38, 8
s_waitcnt lgkmcnt(0)
v_cmp_gt_i32 vcc, s43, v13
s_cbranch_vccz L_lg123
s_call_b64 s[84:85], L_lfull
L_lg123:
s_add_u32 m0, s40, 0
s_add_u32 s48, s50, 16384
s_waitcnt vmcnt(30)
buffer_load_dwordx4 v20, s[4:7], s48 offen offset:0 nt lds
buffer_load_dwordx4 v21, s[4:7], s48 offen offset:1056 nt lds
s_waitcnt vmcnt(30)
buffer_load_dwordx4 v22, s[4:7], s48 offen offset:2112 nt lds
buffer_load_dwordx4 v23, s[4:7], s48 offen offset:3168 nt lds
s_add_u32 m0, s40, 4224
s_add_u32 s48, s50, 16896
s_waitcnt vmcnt(30)
buffer_load_dwordx4 v20, s[4:7], s48 offen offset:0 nt lds
buffer_load_dwordx4 v21, s[4:7], s48 offen offset:1056 nt lds
s_waitcnt vmcnt(30)
buffer_load_dwordx4 v22, s[4:7], s48 offen offset:2112 nt lds
buffer_load_dwordx4 v23, s[4:7], s48 offen offset:3168 nt lds
s_add_u32 m0, s40, 8448
s_add_u32 s48, s50, 17408
s_waitcnt vmcnt(30)
buffer_load_dwordx4 v20, s[4:7], s48 offen offset:0 nt lds
buffer_load_dwordx4 v21, s[4:7], s48 offen offset:1056 nt lds
s_waitcnt vmcnt(30)
buffer_load_dwordx4 v22, s[4:7], s48 offen offset:2112 nt lds
buffer_load_dwordx4 v23, s[4:7], s48 offen offset:3168 nt lds
s_add_u32 m0, s40, 12672
s_add_u32 s48, s50, 17920
s_waitcnt vmcnt(30)
ds_read_b32 v13, v9
buffer_load_dwordx4 v20, s[4:7], s48 offen offset:0 nt lds
buffer_load_dwordx4 v21, s[4:7], s48 offen offset:1056 nt lds
s_waitcnt vmcnt(30)
s_max_i32 s49, s49, 23
v_mov_b32 v12, s49
ds_write_b32 v8, v12
buffer_load_dwordx4 v22, s[4:7], s48 offen offset:2112 nt lds
buffer_load_dwordx4 v23, s[4:7], s48 offen offset:3168 nt lds
s_add_u32 s38, s38, 1
s_add_u32 s40, s40, 16896
s_cmp_eq_u32 s40, 152064
s_cselect_b32 s40, 0, s40
s_sub_i32 s43, s38, 8
s_waitcnt lgkmcnt(0)
v_cmp_gt_i32 vcc, s43, v13
s_cbranch_vccz L_lg124
s_call_b64 s[84:85], L_lfull
L_lg124:
s_add_u32 m0, s40, 0
s_add_u32 s48, s50, 0
s_waitcnt vmcnt(30)
buffer_load_dwordx4 v20, s[8:11], s48 offen offset:0 nt lds
buffer_load_dwordx4 v21, s[8:11], s48 offen offset:1056 nt lds
s_waitcnt vmcnt(30)
buffer_load_dwordx4 v22, s[8:11], s48 offen offset:2112 nt lds
buffer_load_dwordx4 v23, s[8:11], s48 offen offset:3168 nt lds
s_add_u32 m0, s40, 4224
s_add_u32 s48, s50, 512
s_waitcnt vmcnt(30)
buffer_load_dwordx4 v20, s[8:11], s48 offen offset:0 nt lds
buffer_load_dwordx4 v21, s[8:11], s48 offen offset:1056 nt lds
s_waitcnt vmcnt(30)
buffer_load_dwordx4 v22, s[8:11], s48 offen offset:2112 nt lds
buffer_load_dwordx4 v23, s[8:11], s48 offen offset:3168 nt lds
s_add_u32 m0, s40, 8448
s_add_u32 s48, s50, 1024
s_waitcnt vmcnt(30)
buffer_load_dwordx4 v20, s[8:11], s48 offen offset:0 nt lds
buffer_load_dwordx4 v21, s[8:11], s48 offen offset:1056 nt lds
s_waitcnt vmcnt(30)
buffer_load_dwordx4 v22, s[8:11], s48 offen offset:2112 nt lds
buffer_load_dwordx4 v23, s[8:11], s48 offen offset:3168 nt lds
s_add_u32 m0, s40, 12672
s_add_u32 s48, s50, 1536
s_waitcnt vmcnt(30)
ds_read_b32 v13, v9
buffer_load_dwordx4 v20, s[8:11], s48 offen offset:0 nt lds
buffer_load_dwordx4 v21, s[8:11], s48 offen offset:1056 nt lds
s_waitcnt vmcnt(30)
s_max_i32 s49, s49, 24
v_mov_b32 v12, s49
ds_write_b32 v8, v12
buffer_load_dwordx4 v22, s[8:11], s48 offen offset:2112 nt lds
buffer_load_dwordx4 v23, s[8:11], s48 offen offset:3168 nt lds
s_add_u32 s38, s38, 1
s_add_u32 s40, s40, 16896
s_cmp_eq_u32 s40, 152064
s_cselect_b32 s40, 0, s40
s_add_u32 s50, s50, 16384
s_sub_i32 s43, s38, 8
s_waitcnt lgkmcnt(0)
v_cmp_gt_i32 vcc, s43, v13
s_cbranch_vccz L_lg125
s_call_b64 s[84:85], L_lfull
L_lg125:
s_add_u32 m0, s40, 0
s_add_u32 s48, s50, 16384
s_waitcnt vmcnt(30)
buffer_load_dwordx4 v20, s[4:7], s48 offen offset:0 nt lds
buffer_load_dwordx4 v21, s[4:7], s48 offen offset:1056 nt lds
s_waitcnt vmcnt(30)
buffer_load_dwordx4 v22, s[4:7], s48 offen offset:2112 nt lds
buffer_load_dwordx4 v23, s[4:7], s48 offen offset:3168 nt lds
s_add_u32 m0, s40, 4224
s_add_u32 s48, s50, 16896
s_waitcnt vmcnt(30)
buffer_load_dwordx4 v20, s[4:7], s48 offen offset:0 nt lds
buffer_load_dwordx4 v21, s[4:7], s48 offen offset:1056 nt lds
s_waitcnt vmcnt(30)
buffer_load_dwordx4 v22, s[4:7], s48 offen offset:2112 nt lds
buffer_load_dwordx4 v23, s[4:7], s48 offen offset:3168 nt lds
s_add_u32 m0, s40, 8448
s_add_u32 s48, s50, 17408
s_waitcnt vmcnt(30)
buffer_load_dwordx4 v20, s[4:7], s48 offen offset:0 nt lds
buffer_load_dwordx4 v21, s[4:7], s48 offen offset:1056 nt lds
s_waitcnt vmcnt(30)
buffer_load_dwordx4 v22, s[4:7], s48 offen offset:2112 nt lds
buffer_load_dwordx4 v23, s[4:7], s48 offen offset:3168 nt lds
s_add_u32 m0, s40, 12672
s_add_u32 s48, s50, 17920
s_waitcnt vmcnt(30)
ds_read_b32 v13, v9
buffer_load_dwordx4 v20, s[4:7], s48 offen offset:0 nt lds
buffer_load_dwordx4 v21, s[4:7], s48 offen offset:1056 nt lds
s_waitcnt vmcnt(30)
s_max_i32 s49, s49, 25
v_mov_b32 v12, s49
ds_write_b32 v8, v12
buffer_load_dwordx4 v22, s[4:7], s48 offen offset:2112 nt lds
buffer_load_dwordx4 v23, s[4:7], s48 offen offset:3168 nt lds
s_add_u32 s38, s38, 1
s_add_u32 s40, s40, 16896
s_cmp_eq_u32 s40, 152064
s_cselect_b32 s40, 0, s40
s_sub_i32 s43, s38, 8
s_waitcnt lgkmcnt(0)
v_cmp_gt_i32 vcc, s43, v13
s_cbranch_vccz L_lg126
s_call_b64 s[84:85], L_lfull
L_lg126:
s_add_u32 m0, s40, 0
s_add_u32 s48, s50, 0
s_waitcnt vmcnt(30)
buffer_load_dwordx4 v20, s[8:11], s48 offen offset:0 nt lds
buffer_load_dwordx4 v21, s[8:11], s48 offen offset:1056 nt lds
s_waitcnt vmcnt(30)
buffer_load_dwordx4 v22, s[8:11], s48 offen offset:2112 nt lds
buffer_load_dwordx4 v23, s[8:11], s48 offen offset:3168 nt lds
s_add_u32 m0, s40, 4224
s_add_u32 s48, s50, 512
s_waitcnt vmcnt(30)
buffer_load_dwordx4 v20, s[8:11], s48 offen offset:0 nt lds
buffer_load_dwordx4 v21, s[8:11], s48 offen offset:1056 nt lds
s_waitcnt vmcnt(30)
buffer_load_dwordx4 v22, s[8:11], s48 offen offset:2112 nt lds
buffer_load_dwordx4 v23, s[8:11], s48 offen offset:3168 nt lds
s_add_u32 m0, s40, 8448
s_add_u32 s48, s50, 1024
s_waitcnt vmcnt(30)
buffer_load_dwordx4 v20, s[8:11], s48 offen offset:0 nt lds
buffer_load_dwordx4 v21, s[8:11], s48 offen offset:1056 nt lds
s_waitcnt vmcnt(30)
buffer_load_dwordx4 v22, s[8:11], s48 offen offset:2112 nt lds
buffer_load_dwordx4 v23, s[8:11], s48 offen offset:3168 nt lds
s_add_u32 m0, s40, 12672
s_add_u32 s48, s50, 1536
s_waitcnt vmcnt(30)
ds_read_b32 v13, v9
buffer_load_dwordx4 v20, s[8:11], s48 offen offset:0 nt lds
buffer_load_dwordx4 v21, s[8:11], s48 offen offset:1056 nt lds
s_waitcnt vmcnt(30)
s_max_i32 s49, s49, 26
v_mov_b32 v12, s49
ds_write_b32 v8, v12
buffer_load_dwordx4 v22, s[8:11], s48 offen offset:2112 nt lds
buffer_load_dwordx4 v23, s[8:11], s48 offen offset:3168 nt lds
s_add_u32 s38, s38, 1
s_add_u32 s40, s40, 16896
s_cmp_eq_u32 s40, 152064
s_cselect_b32 s40, 0, s40
s_add_u32 s50, s50, 16384
s_sub_i32 s43, s38, 8
s_waitcnt lgkmcnt(0)
v_cmp_gt_i32 vcc, s43, v13
s_cbranch_vccz L_lg127
s_call_b64 s[84:85], L_lfull
L_lg127:
s_add_u32 m0, s40, 0
s_add_u32 s48, s50, 16384
s_waitcnt vmcnt(22)
buffer_load_dwordx4 v20, s[4:7], s48 offen offset:0 nt lds
buffer_load_dwordx4 v21, s[4:7], s48 offen offset:1056 nt lds
s_waitcnt vmcnt(22)
buffer_load_dwordx4 v22, s[4:7], s48 offen offset:2112 nt lds
buffer_load_dwordx4 v23, s[4:7], s48 offen offset:3168 nt lds
s_add_u32 m0, s40, 4224
s_add_u32 s48, s50, 16896
s_waitcnt vmcnt(22)
buffer_load_dwordx4 v20, s[4:7], s48 offen offset:0 nt lds
buffer_load_dwordx4 v21, s[4:7], s48 offen offset:1056 nt lds
s_waitcnt vmcnt(22)
s_sub_i32 s42, s38, 1
s_max_i32 s49, s49, s42
v_mov_b32 v12, s49
ds_write_b32 v8, v12
buffer_load_dwordx4 v22, s[4:7], s48 offen offset:2112 nt lds
buffer_load_dwordx4 v23, s[4:7], s48 offen offset:3168 nt lds
s_add_u32 m0, s40, 8448
s_add_u32 s48, s50, 17408
s_waitcnt vmcnt(22)
buffer_load_dwordx4 v20, s[4:7], s48 offen offset:0 nt lds
buffer_load_dwordx4 v21, s[4:7], s48 offen offset:1056 nt lds
s_waitcnt vmcnt(22)
buffer_load_dwordx4 v22, s[4:7], s48 offen offset:2112 nt lds
buffer_load_dwordx4 v23, s[4:7], s48 offen offset:3168 nt lds
s_add_u32 m0, s40, 12672
s_add_u32 s48, s50, 17920
s_waitcnt vmcnt(22)
ds_read_b32 v13, v9
buffer_load_dwordx4 v20, s[4:7], s48 offen offset:0 nt lds
buffer_load_dwordx4 v21, s[4:7], s48 offen offset:1056 nt lds
s_waitcnt vmcnt(22)
buffer_load_dwordx4 v22, s[4:7], s48 offen offset:2112 nt lds
buffer_load_dwordx4 v23, s[4:7], s48 offen offset:3168 nt lds
s_add_u32 s38, s38, 1
s_add_u32 s40, s40, 16896
s_cmp_eq_u32 s40, 152064
s_cselect_b32 s40, 0, s40
s_waitcnt vmcnt(32)
s_sub_i32 s43, s38, 8
s_waitcnt lgkmcnt(0)
v_cmp_gt_i32 vcc, s43, v13
s_cbranch_vccz L_lg128
s_call_b64 s[84:85], L_lfull
L_lg128:
v_add_u32 v16, s40, v15
ds_write_b128 v16, v[32:35] offset:0
ds_write_b128 v16, v[36:39] offset:1056
ds_write_b128 v16, v[40:43] offset:2112
ds_write_b128 v16, v[44:47] offset:3168
ds_write_b128 v16, v[48:51] offset:4224
ds_write_b128 v16, v[52:55] offset:5280
ds_write_b128 v16, v[56:59] offset:6336
ds_write_b128 v16, v[60:63] offset:7392
s_waitcnt lgkmcnt(4)
ds_write_b128 v16, v[64:67] offset:8448
ds_write_b128 v16, v[68:71] offset:9504
ds_write_b128 v16, v[72:75] offset:10560
ds_write_b128 v16, v[76:79] offset:11616
ds_write_b128 v16, v[80:83] offset:12672
ds_write_b128 v16, v[84:87] offset:13728
ds_write_b128 v16, v[88:91] offset:14784
ds_write_b128 v16, v[92:95] offset:15840
s_waitcnt lgkmcnt(4)
ds_read_b32 v13, v9
s_add_u32 s38, s38, 1
s_add_u32 s40, s40, 16896
s_cmp_eq_u32 s40, 152064
s_cselect_b32 s40, 0, s40
s_add_u32 s50, s50, 16384
s_sub_i32 s43, s38, 8
s_waitcnt lgkmcnt(0)
v_cmp_gt_i32 vcc, s43, v13
s_cbranch_vccz L_lg129
s_call_b64 s[84:85], L_lfull
L_lg129:
s_add_u32 m0, s40, 0
s_add_u32 s48, s50, 16384
s_waitcnt vmcnt(22)
buffer_load_dwordx4 v20, s[4:7], s48 offen offset:0 nt lds
buffer_load_dwordx4 v21, s[4:7], s48 offen offset:1056 nt lds
s_waitcnt vmcnt(22)
buffer_load_dwordx4 v22, s[4:7], s48 offen offset:2112 nt lds
buffer_load_dwordx4 v23, s[4:7], s48 offen offset:3168 nt lds
s_add_u32 m0, s40, 4224
s_add_u32 s48, s50, 16896
s_waitcnt vmcnt(22)
buffer_load_dwordx4 v20, s[4:7], s48 offen offset:0 nt lds
buffer_load_dwordx4 v21, s[4:7], s48 offen offset:1056 nt lds
s_waitcnt vmcnt(22)
s_sub_i32 s42, s38, 2
s_max_i32 s49, s49, s42
v_mov_b32 v12, s49
ds_write_b32 v8, v12
buffer_load_dwordx4 v22, s[4:7], s48 offen offset:2112 nt lds
buffer_load_dwordx4 v23, s[4:7], s48 offen offset:3168 nt lds
s_add_u32 m0, s40, 8448
s_add_u32 s48, s50, 17408
s_waitcnt vmcnt(22)
buffer_load_dwordx4 v20, s[4:7], s48 offen offset:0 nt lds
buffer_load_dwordx4 v21, s[4:7], s48 offen offset:1056 nt lds
s_waitcnt vmcnt(22)
buffer_load_dwordx4 v22, s[4:7], s48 offen offset:2112 nt lds
buffer_load_dwordx4 v23, s[4:7], s48 offen offset:3168 nt lds
s_add_u32 m0, s40, 12672
s_add_u32 s48, s50, 17920
s_waitcnt vmcnt(22)
ds_read_b32 v13, v9
buffer_load_dwordx4 v20, s[4:7], s48 offen offset:0 nt lds
buffer_load_dwordx4 v21, s[4:7], s48 offen offset:1056 nt lds
s_waitcnt vmcnt(22)
buffer_load_dwordx4 v22, s[4:7], s48 offen offset:2112 nt lds
buffer_load_dwordx4 v23, s[4:7], s48 offen offset:3168 nt lds
s_add_u32 s38, s38, 1
s_add_u32 s40, s40, 16896
s_cmp_eq_u32 s40, 152064
s_cselect_b32 s40, 0, s40
s_sub_i32 s43, s38, 8
s_waitcnt lgkmcnt(0)
v_cmp_gt_i32 vcc, s43, v13
s_cbranch_vccz L_lg130
s_call_b64 s[84:85], L_lfull
L_lg130:
s_add_u32 m0, s40, 0
s_add_u32 s48, s50, 0
s_waitcnt vmcnt(22)
buffer_load_dwordx4 v20, s[8:11], s48 offen offset:0 nt lds
buffer_load_dwordx4 v21, s[8:11], s48 offen offset:1056 nt lds
s_waitcnt vmcnt(22)
buffer_load_dwordx4 v22, s[8:11], s48 offen offset:2112 nt lds
buffer_load_dwordx4 v23, s[8:11], s48 offen offset:3168 nt lds
s_add_u32 m0, s40, 4224
s_add_u32 s48, s50, 512
s_waitcnt vmcnt(22)
buffer_load_dwordx4 v20, s[8:11], s48 offen offset:0 nt lds
buffer_load_dwordx4 v21, s[8:11], s48 offen offset:1056 nt lds
s_waitcnt vmcnt(22)
s_sub_i32 s42, s38, 1
s_max_i32 s49, s49, s42
v_mov_b32 v12, s49
ds_write_b32 v8, v12
buffer_load_dwordx4 v22, s[8:11], s48 offen offset:2112 nt lds
buffer_load_dwordx4 v23, s[8:11], s48 offen offset:3168 nt lds
s_add_u32 m0, s40, 8448
s_add_u32 s48, s50, 1024
s_waitcnt vmcnt(22)
buffer_load_dwordx4 v20, s[8:11], s48 offen offset:0 nt lds
buffer_load_dwordx4 v21, s[8:11], s48 offen offset:1056 nt lds
s_waitcnt vmcnt(22)
buffer_load_dwordx4 v22, s[8:11], s48 offen offset:2112 nt lds
buffer_load_dwordx4 v23, s[8:11], s48 offen offset:3168 nt lds
s_add_u32 m0, s40, 12672
s_add_u32 s48, s50, 1536
s_waitcnt vmcnt(22)
ds_read_b32 v13, v9
buffer_load_dwordx4 v20, s[8:11], s48 offen offset:0 nt lds
buffer_load_dwordx4 v21, s[8:11], s48 offen offset:1056 nt lds
s_waitcnt vmcnt(22)
buffer_load_dwordx4 v22, s[8:11], s48 offen offset:2112 nt lds
buffer_load_dwordx4 v23, s[8:11], s48 offen offset:3168 nt lds
s_add_u32 s38, s38, 1
s_add_u32 s40, s40, 16896
s_cmp_eq_u32 s40, 152064
s_cselect_b32 s40, 0, s40
s_add_u32 s50, s50, 16384
s_sub_i32 s43, s38, 8
s_waitcnt lgkmcnt(0)
v_cmp_gt_i32 vcc, s43, v13
s_cbranch_vccz L_lg131
s_call_b64 s[84:85], L_lfull
L_lg131:
s_add_u32 m0, s40, 0
s_add_u32 s48, s50, 16384
s_waitcnt vmcnt(22)
buffer_load_dwordx4 v20, s[4:7], s48 offen offset:0 nt lds
buffer_load_dwordx4 v21, s[4:7], s48 offen offset:1056 nt lds
s_waitcnt vmcnt(22)
buffer_load_dwordx4 v22, s[4:7], s48 offen offset:2112 nt lds
buffer_load_dwordx4 v23, s[4:7], s48 offen offset:3168 nt lds
s_add_u32 m0, s40, 4224
s_add_u32 s48, s50, 16896
s_waitcnt vmcnt(22)
buffer_load_dwordx4 v20, s[4:7], s48 offen offset:0 nt lds
buffer_load_dwordx4 v21, s[4:7], s48 offen offset:1056 nt lds
s_waitcnt vmcnt(22)
s_sub_i32 s42, s38, 1
s_max_i32 s49, s49, s42
v_mov_b32 v12, s49
ds_write_b32 v8, v12
buffer_load_dwordx4 v22, s[4:7], s48 offen offset:2112 nt lds
buffer_load_dwordx4 v23, s[4:7], s48 offen offset:3168 nt lds
s_add_u32 m0, s40, 8448
s_add_u32 s48, s50, 17408
s_waitcnt vmcnt(22)
buffer_load_dwordx4 v20, s[4:7], s48 offen offset:0 nt lds
buffer_load_dwordx4 v21, s[4:7], s48 offen offset:1056 nt lds
s_waitcnt vmcnt(22)
buffer_load_dwordx4 v22, s[4:7], s48 offen offset:2112 nt lds
buffer_load_dwordx4 v23, s[4:7], s48 offen offset:3168 nt lds
s_add_u32 m0, s40, 12672
s_add_u32 s48, s50, 17920
s_waitcnt vmcnt(22)
ds_read_b32 v13, v9
buffer_load_dwordx4 v20, s[4:7], s48 offen offset:0 nt lds
buffer_load_dwordx4 v21, s[4:7], s48 offen offset:1056 nt lds
s_waitcnt vmcnt(22)
buffer_load_dwordx4 v22, s[4:7], s48 offen offset:2112 nt lds
buffer_load_dwordx4 v23, s[4:7], s48 offen offset:3168 nt lds
s_add_u32 s38, s38, 1
s_add_u32 s40, s40, 16896
s_cmp_eq_u32 s40, 152064
s_cselect_b32 s40, 0, s40
s_sub_i32 s43, s38, 8
s_waitcnt lgkmcnt(0)
v_cmp_gt_i32 vcc, s43, v13
s_cbranch_vccz L_lg132
s_call_b64 s[84:85], L_lfull
L_lg132:
v_add_u32 v16, s40, v15
ds_write_b128 v16, v[96:99] offset:0
ds_write_b128 v16, v[100:103] offset:1056
ds_write_b128 v16, v[104:107] offset:2112
ds_write_b128 v16, v[108:111] offset:3168
ds_write_b128 v16, v[112:115] offset:4224
ds_write_b128 v16, v[116:119] offset:5280
ds_write_b128 v16, v[120:123] offset:6336
ds_write_b128 v16, v[124:127] offset:7392
s_waitcnt lgkmcnt(4)
ds_write_b128 v16, v[128:131] offset:8448
ds_write_b128 v16, v[132:135] offset:9504
ds_write_b128 v16, v[136:139] offset:10560
ds_write_b128 v16, v[140:143] offset:11616
ds_write_b128 v16, v[144:147] offset:12672
ds_write_b128 v16, v[148:151] offset:13728
ds_write_b128 v16, v[152:155] offset:14784
ds_write_b128 v16, v[156:159] offset:15840
s_waitcnt lgkmcnt(4)
ds_read_b32 v13, v9
s_add_u32 s38, s38, 1
s_add_u32 s40, s40, 16896
s_cmp_eq_u32 s40, 152064
s_cselect_b32 s40, 0, s40
s_add_u32 s50, s50, 16384
s_sub_i32 s43, s38, 8
s_waitcnt lgkmcnt(0)
v_cmp_gt_i32 vcc, s43, v13
s_cbranch_vccz L_lg133
s_call_b64 s[84:85], L_lfull
L_lg133:
s_add_u32 m0, s40, 0
s_add_u32 s48, s50, 16384
s_waitcnt vmcnt(22)
buffer_load_dwordx4 v20, s[4:7], s48 offen offset:0 nt lds
buffer_load_dwordx4 v21, s[4:7], s48 offen offset:1056 nt lds
s_waitcnt vmcnt(22)
buffer_load_dwordx4 v22, s[4:7], s48 offen offset:2112 nt lds
buffer_load_dwordx4 v23, s[4:7], s48 offen offset:3168 nt lds
s_add_u32 m0, s40, 4224
s_add_u32 s48, s50, 16896
s_waitcnt vmcnt(22)
buffer_load_dwordx4 v20, s[4:7], s48 offen offset:0 nt lds
buffer_load_dwordx4 v21, s[4:7], s48 offen offset:1056 nt lds
s_waitcnt vmcnt(22)
s_sub_i32 s42, s38, 2
s_max_i32 s49, s49, s42
v_mov_b32 v12, s49
ds_write_b32 v8, v12
buffer_load_dwordx4 v22, s[4:7], s48 offen offset:2112 nt lds
buffer_load_dwordx4 v23, s[4:7], s48 offen offset:3168 nt lds
s_add_u32 m0, s40, 8448
s_add_u32 s48, s50, 17408
s_waitcnt vmcnt(22)
buffer_load_dwordx4 v20, s[4:7], s48 offen offset:0 nt lds
buffer_load_dwordx4 v21, s[4:7], s48 offen offset:1056 nt lds
s_waitcnt vmcnt(22)
buffer_load_dwordx4 v22, s[4:7], s48 offen offset:2112 nt lds
buffer_load_dwordx4 v23, s[4:7], s48 offen offset:3168 nt lds
s_add_u32 m0, s40, 12672
s_add_u32 s48, s50, 17920
s_waitcnt vmcnt(22)
ds_read_b32 v13, v9
buffer_load_dwordx4 v20, s[4:7], s48 offen offset:0 nt lds
buffer_load_dwordx4 v21, s[4:7], s48 offen offset:1056 nt lds
s_waitcnt vmcnt(22)
buffer_load_dwordx4 v22, s[4:7], s48 offen offset:2112 nt lds
buffer_load_dwordx4 v23, s[4:7], s48 offen offset:3168 nt lds
s_add_u32 s38, s38, 1
s_add_u32 s40, s40, 16896
s_cmp_eq_u32 s40, 152064
s_cselect_b32 s40, 0, s40
s_sub_i32 s43, s38, 8
s_waitcnt lgkmcnt(0)
v_cmp_gt_i32 vcc, s43, v13
s_cbranch_vccz L_lg134
s_call_b64 s[84:85], L_lfull
L_lg134:
s_add_u32 m0, s40, 0
s_add_u32 s48, s50, 0
s_waitcnt vmcnt(22)
buffer_load_dwordx4 v20, s[8:11], s48 offen offset:0 nt lds
buffer_load_dwordx4 v21, s[8:11], s48 offen offset:1056 nt lds
s_waitcnt vmcnt(22)
buffer_load_dwordx4 v22, s[8:11], s48 offen offset:2112 nt lds
buffer_load_dwordx4 v23, s[8:11], s48 offen offset:3168 nt lds
s_add_u32 m0, s40, 4224
s_add_u32 s48, s50, 512
s_waitcnt vmcnt(22)
buffer_load_dwordx4 v20, s[8:11], s48 offen offset:0 nt lds
buffer_load_dwordx4 v21, s[8:11], s48 offen offset:1056 nt lds
s_waitcnt vmcnt(22)
s_sub_i32 s42, s38, 1
s_max_i32 s49, s49, s42
v_mov_b32 v12, s49
ds_write_b32 v8, v12
buffer_load_dwordx4 v22, s[8:11], s48 offen offset:2112 nt lds
buffer_load_dwordx4 v23, s[8:11], s48 offen offset:3168 nt lds
s_add_u32 m0, s40, 8448
s_add_u32 s48, s50, 1024
s_waitcnt vmcnt(22)
buffer_load_dwordx4 v20, s[8:11], s48 offen offset:0 nt lds
buffer_load_dwordx4 v21, s[8:11], s48 offen offset:1056 nt lds
s_waitcnt vmcnt(22)
buffer_load_dwordx4 v22, s[8:11], s48 offen offset:2112 nt lds
buffer_load_dwordx4 v23, s[8:11], s48 offen offset:3168 nt lds
s_add_u32 m0, s40, 12672
s_add_u32 s48, s50, 1536
s_waitcnt vmcnt(22)
ds_read_b32 v13, v9
buffer_load_dwordx4 v20, s[8:11], s48 offen offset:0 nt lds
buffer_load_dwordx4 v21, s[8:11], s48 offen offset:1056 nt lds
s_waitcnt vmcnt(22)
buffer_load_dwordx4 v22, s[8:11], s48 offen offset:2112 nt lds
buffer_load_dwordx4 v23, s[8:11], s48 offen offset:3168 nt lds
s_add_u32 s38, s38, 1
s_add_u32 s40, s40, 16896
s_cmp_eq_u32 s40, 152064
s_cselect_b32 s40, 0, s40
s_add_u32 s50, s50, 16384
s_sub_i32 s43, s38, 8
s_waitcnt lgkmcnt(0)
v_cmp_gt_i32 vcc, s43, v13
s_cbranch_vccz L_lg135
s_call_b64 s[84:85], L_lfull
L_lg135:
s_add_u32 m0, s40, 0
s_add_u32 s48, s50, 16384
s_waitcnt vmcnt(22)
buffer_load_dwordx4 v20, s[4:7], s48 offen offset:0 nt lds
buffer_load_dwordx4 v21, s[4:7], s48 offen offset:1056 nt lds
s_waitcnt vmcnt(22)
buffer_load_dwordx4 v22, s[4:7], s48 offen offset:2112 nt lds
buffer_load_dwordx4 v23, s[4:7], s48 offen offset:3168 nt lds
s_add_u32 m0, s40, 4224
s_add_u32 s48, s50, 16896
s_waitcnt vmcnt(22)
buffer_load_dwordx4 v20, s[4:7], s48 offen offset:0 nt lds
buffer_load_dwordx4 v21, s[4:7], s48 offen offset:1056 nt lds
s_waitcnt vmcnt(22)
s_sub_i32 s42, s38, 1
s_max_i32 s49, s49, s42
v_mov_b32 v12, s49
ds_write_b32 v8, v12
buffer_load_dwordx4 v22, s[4:7], s48 offen offset:2112 nt lds
buffer_load_dwordx4 v23, s[4:7], s48 offen offset:3168 nt lds
s_add_u32 m0, s40, 8448
s_add_u32 s48, s50, 17408
s_waitcnt vmcnt(22)
buffer_load_dwordx4 v20, s[4:7], s48 offen offset:0 nt lds
buffer_load_dwordx4 v21, s[4:7], s48 offen offset:1056 nt lds
s_waitcnt vmcnt(22)
buffer_load_dwordx4 v22, s[4:7], s48 offen offset:2112 nt lds
buffer_load_dwordx4 v23, s[4:7], s48 offen offset:3168 nt lds
s_add_u32 m0, s40, 12672
s_add_u32 s48, s50, 17920
s_waitcnt vmcnt(22)
ds_read_b32 v13, v9
buffer_load_dwordx4 v20, s[4:7], s48 offen offset:0 nt lds
buffer_load_dwordx4 v21, s[4:7], s48 offen offset:1056 nt lds
s_waitcnt vmcnt(22)
buffer_load_dwordx4 v22, s[4:7], s48 offen offset:2112 nt lds
buffer_load_dwordx4 v23, s[4:7], s48 offen offset:3168 nt lds
s_add_u32 s38, s38, 1
s_add_u32 s40, s40, 16896
s_cmp_eq_u32 s40, 152064
s_cselect_b32 s40, 0, s40
s_sub_i32 s43, s38, 8
s_waitcnt lgkmcnt(0)
v_cmp_gt_i32 vcc, s43, v13
s_cbranch_vccz L_lg136
s_call_b64 s[84:85], L_lfull
L_lg136:
v_add_u32 v16, s40, v15
ds_write_b128 v16, v[160:163] offset:0
ds_write_b128 v16, v[164:167] offset:1056
ds_write_b128 v16, v[168:171] offset:2112
ds_write_b128 v16, v[172:175] offset:3168
ds_write_b128 v16, v[176:179] offset:4224
ds_write_b128 v16, v[180:183] offset:5280
ds_write_b128 v16, v[184:187] offset:6336
ds_write_b128 v16, v[188:191] offset:7392
s_waitcnt lgkmcnt(4)
ds_write_b128 v16, v[192:195] offset:8448
ds_write_b128 v16, v[196:199] offset:9504
ds_write_b128 v16, v[200:203] offset:10560
ds_write_b128 v16, v[204:207] offset:11616
ds_write_b128 v16, v[208:211] offset:12672
ds_write_b128 v16, v[212:215] offset:13728
ds_write_b128 v16, v[216:219] offset:14784
ds_write_b128 v16, v[220:223] offset:15840
s_waitcnt lgkmcnt(4)
ds_read_b32 v13, v9
s_add_u32 s38, s38, 1
s_add_u32 s40, s40, 16896
s_cmp_eq_u32 s40, 152064
s_cselect_b32 s40, 0, s40
s_add_u32 s50, s50, 16384
s_sub_i32 s43, s38, 8
s_waitcnt lgkmcnt(0)
v_cmp_gt_i32 vcc, s43, v13
s_cbranch_vccz L_lg137
s_call_b64 s[84:85], L_lfull
L_lg137:
s_add_u32 m0, s40, 0
s_add_u32 s48, s50, 16384
s_waitcnt vmcnt(22)
buffer_load_dwordx4 v20, s[4:7], s48 offen offset:0 nt lds
buffer_load_dwordx4 v21, s[4:7], s48 offen offset:1056 nt lds
s_waitcnt vmcnt(22)
buffer_load_dwordx4 v22, s[4:7], s48 offen offset:2112 nt lds
buffer_load_dwordx4 v23, s[4:7], s48 offen offset:3168 nt lds
s_add_u32 m0, s40, 4224
s_add_u32 s48, s50, 16896
s_waitcnt vmcnt(22)
buffer_load_dwordx4 v20, s[4:7], s48 offen offset:0 nt lds
buffer_load_dwordx4 v21, s[4:7], s48 offen offset:1056 nt lds
s_waitcnt vmcnt(22)
s_sub_i32 s42, s38, 2
s_max_i32 s49, s49, s42
v_mov_b32 v12, s49
ds_write_b32 v8, v12
buffer_load_dwordx4 v22, s[4:7], s48 offen offset:2112 nt lds
buffer_load_dwordx4 v23, s[4:7], s48 offen offset:3168 nt lds
s_add_u32 m0, s40, 8448
s_add_u32 s48, s50, 17408
s_waitcnt vmcnt(22)
buffer_load_dwordx4 v20, s[4:7], s48 offen offset:0 nt lds
buffer_load_dwordx4 v21, s[4:7], s48 offen offset:1056 nt lds
s_waitcnt vmcnt(22)
buffer_load_dwordx4 v22, s[4:7], s48 offen offset:2112 nt lds
buffer_load_dwordx4 v23, s[4:7], s48 offen offset:3168 nt lds
s_add_u32 m0, s40, 12672
s_add_u32 s48, s50, 17920
s_waitcnt vmcnt(22)
ds_read_b32 v13, v9
buffer_load_dwordx4 v20, s[4:7], s48 offen offset:0 nt lds
buffer_load_dwordx4 v21, s[4:7], s48 offen offset:1056 nt lds
s_waitcnt vmcnt(22)
buffer_load_dwordx4 v22, s[4:7], s48 offen offset:2112 nt lds
buffer_load_dwordx4 v23, s[4:7], s48 offen offset:3168 nt lds
s_add_u32 s38, s38, 1
s_add_u32 s40, s40, 16896
s_cmp_eq_u32 s40, 152064
s_cselect_b32 s40, 0, s40
s_sub_i32 s43, s38, 8
s_waitcnt lgkmcnt(0)
v_cmp_gt_i32 vcc, s43, v13
s_cbranch_vccz L_lg138
s_call_b64 s[84:85], L_lfull
L_lg138:
s_add_u32 m0, s40, 0
s_add_u32 s48, s50, 0
s_waitcnt vmcnt(22)
buffer_load_dwordx4 v20, s[8:11], s48 offen offset:0 nt lds
buffer_load_dwordx4 v21, s[8:11], s48 offen offset:1056 nt lds
s_waitcnt vmcnt(22)
buffer_load_dwordx4 v22, s[8:11], s48 offen offset:2112 nt lds
buffer_load_dwordx4 v23, s[8:11], s48 offen offset:3168 nt lds
s_add_u32 m0, s40, 4224
s_add_u32 s48, s50, 512
s_waitcnt vmcnt(22)
buffer_load_dwordx4 v20, s[8:11], s48 offen offset:0 nt lds
buffer_load_dwordx4 v21, s[8:11], s48 offen offset:1056 nt lds
s_waitcnt vmcnt(22)
s_sub_i32 s42, s38, 1
s_max_i32 s49, s49, s42
v_mov_b32 v12, s49
ds_write_b32 v8, v12
buffer_load_dwordx4 v22, s[8:11], s48 offen offset:2112 nt lds
buffer_load_dwordx4 v23, s[8:11], s48 offen offset:3168 nt lds
s_add_u32 m0, s40, 8448
s_add_u32 s48, s50, 1024
s_waitcnt vmcnt(22)
buffer_load_dwordx4 v20, s[8:11], s48 offen offset:0 nt lds
buffer_load_dwordx4 v21, s[8:11], s48 offen offset:1056 nt lds
s_waitcnt vmcnt(22)
buffer_load_dwordx4 v22, s[8:11], s48 offen offset:2112 nt lds
buffer_load_dwordx4 v23, s[8:11], s48 offen offset:3168 nt lds
s_add_u32 m0, s40, 12672
s_add_u32 s48, s50, 1536
s_waitcnt vmcnt(22)
ds_read_b32 v13, v9
buffer_load_dwordx4 v20, s[8:11], s48 offen offset:0 nt lds
buffer_load_dwordx4 v21, s[8:11], s48 offen offset:1056 nt lds
s_waitcnt vmcnt(22)
buffer_load_dwordx4 v22, s[8:11], s48 offen offset:2112 nt lds
buffer_load_dwordx4 v23, s[8:11], s48 offen offset:3168 nt lds
s_add_u32 s38, s38, 1
s_add_u32 s40, s40, 16896
s_cmp_eq_u32 s40, 152064
s_cselect_b32 s40, 0, s40
s_add_u32 s50, s50, 16384
s_sub_i32 s43, s38, 8
s_waitcnt lgkmcnt(0)
v_cmp_gt_i32 vcc, s43, v13
s_cbranch_vccz L_lg139
s_call_b64 s[84:85], L_lfull
L_lg139:
s_add_u32 m0, s40, 0
s_add_u32 s48, s50, 16384
s_waitcnt vmcnt(22)
buffer_load_dwordx4 v20, s[4:7], s48 offen offset:0 nt lds
buffer_load_dwordx4 v21, s[4:7], s48 offen offset:1056 nt lds
s_waitcnt vmcnt(22)
buffer_load_dwordx4 v22, s[4:7], s48 offen offset:2112 nt lds
buffer_load_dwordx4 v23, s[4:7], s48 offen offset:3168 nt lds
s_add_u32 m0, s40, 4224
s_add_u32 s48, s50, 16896
s_waitcnt vmcnt(22)
buffer_load_dwordx4 v20, s[4:7], s48 offen offset:0 nt lds
buffer_load_dwordx4 v21, s[4:7], s48 offen offset:1056 nt lds
s_waitcnt vmcnt(22)
s_sub_i32 s42, s38, 1
s_max_i32 s49, s49, s42
v_mov_b32 v12, s49
ds_write_b32 v8, v12
buffer_load_dwordx4 v22, s[4:7], s48 offen offset:2112 nt lds
buffer_load_dwordx4 v23, s[4:7], s48 offen offset:3168 nt lds
s_add_u32 m0, s40, 8448
s_add_u32 s48, s50, 17408
s_waitcnt vmcnt(22)
buffer_load_dwordx4 v20, s[4:7], s48 offen offset:0 nt lds
buffer_load_dwordx4 v21, s[4:7], s48 offen offset:1056 nt lds
s_waitcnt vmcnt(22)
buffer_load_dwordx4 v22, s[4:7], s48 offen offset:2112 nt lds
buffer_load_dwordx4 v23, s[4:7], s48 offen offset:3168 nt lds
s_add_u32 m0, s40, 12672
s_add_u32 s48, s50, 17920
s_waitcnt vmcnt(22)
ds_read_b32 v13, v9
buffer_load_dwordx4 v20, s[4:7], s48 offen offset:0 nt lds
buffer_load_dwordx4 v21, s[4:7], s48 offen offset:1056 nt lds
s_waitcnt vmcnt(22)
buffer_load_dwordx4 v22, s[4:7], s48 offen offset:2112 nt lds
buffer_load_dwordx4 v23, s[4:7], s48 offen offset:3168 nt lds
s_add_u32 s38, s38, 1
s_add_u32 s40, s40, 16896
s_cmp_eq_u32 s40, 152064
s_cselect_b32 s40, 0, s40
s_sub_i32 s43, s38, 8
s_waitcnt lgkmcnt(0)
v_cmp_gt_i32 vcc, s43, v13
s_cbranch_vccz L_lg140
s_call_b64 s[84:85], L_lfull
L_lg140:
v_add_u32 v16, s40, v15
ds_write_b128 v16, a[0:3] offset:0
ds_write_b128 v16, a[4:7] offset:1056
ds_write_b128 v16, a[8:11] offset:2112
ds_write_b128 v16, a[12:15] offset:3168
ds_write_b128 v16, a[16:19] offset:4224
ds_write_b128 v16, a[20:23] offset:5280
ds_write_b128 v16, a[24:27] offset:6336
ds_write_b128 v16, a[28:31] offset:7392
s_waitcnt lgkmcnt(4)
ds_write_b128 v16, a[32:35] offset:8448
ds_write_b128 v16, a[36:39] offset:9504
ds_write_b128 v16, a[40:43] offset:10560
ds_write_b128 v16, a[44:47] offset:11616
ds_write_b128 v16, a[48:51] offset:12672
ds_write_b128 v16, a[52:55] offset:13728
ds_write_b128 v16, a[56:59] offset:14784
ds_write_b128 v16, a[60:63] offset:15840
s_waitcnt lgkmcnt(4)
ds_read_b32 v13, v9
s_add_u32 s38, s38, 1
s_add_u32 s40, s40, 16896
s_cmp_eq_u32 s40, 152064
s_cselect_b32 s40, 0, s40
s_add_u32 s50, s50, 16384
s_sub_i32 s43, s38, 8
s_waitcnt lgkmcnt(0)
v_cmp_gt_i32 vcc, s43, v13
s_cbranch_vccz L_lg141
s_call_b64 s[84:85], L_lfull
L_lg141:
s_add_u32 m0, s40, 0
s_add_u32 s48, s50, 16384
s_waitcnt vmcnt(22)
buffer_load_dwordx4 v20, s[4:7], s48 offen offset:0 nt lds
buffer_load_dwordx4 v21, s[4:7], s48 offen offset:1056 nt lds
s_waitcnt vmcnt(22)
buffer_load_dwordx4 v22, s[4:7], s48 offen offset:2112 nt lds
buffer_load_dwordx4 v23, s[4:7], s48 offen offset:3168 nt lds
s_add_u32 m0, s40, 4224
s_add_u32 s48, s50, 16896
s_waitcnt vmcnt(22)
buffer_load_dwordx4 v20, s[4:7], s48 offen offset:0 nt lds
buffer_load_dwordx4 v21, s[4:7], s48 offen offset:1056 nt lds
s_waitcnt vmcnt(22)
s_sub_i32 s42, s38, 2
s_max_i32 s49, s49, s42
v_mov_b32 v12, s49
ds_write_b32 v8, v12
buffer_load_dwordx4 v22, s[4:7], s48 offen offset:2112 nt lds
buffer_load_dwordx4 v23, s[4:7], s48 offen offset:3168 nt lds
s_add_u32 m0, s40, 8448
s_add_u32 s48, s50, 17408
s_waitcnt vmcnt(22)
buffer_load_dwordx4 v20, s[4:7], s48 offen offset:0 nt lds
buffer_load_dwordx4 v21, s[4:7], s48 offen offset:1056 nt lds
s_waitcnt vmcnt(22)
buffer_load_dwordx4 v22, s[4:7], s48 offen offset:2112 nt lds
buffer_load_dwordx4 v23, s[4:7], s48 offen offset:3168 nt lds
s_add_u32 m0, s40, 12672
s_add_u32 s48, s50, 17920
s_waitcnt vmcnt(22)
ds_read_b32 v13, v9
buffer_load_dwordx4 v20, s[4:7], s48 offen offset:0 nt lds
buffer_load_dwordx4 v21, s[4:7], s48 offen offset:1056 nt lds
s_waitcnt vmcnt(22)
buffer_load_dwordx4 v22, s[4:7], s48 offen offset:2112 nt lds
buffer_load_dwordx4 v23, s[4:7], s48 offen offset:3168 nt lds
s_add_u32 s38, s38, 1
s_add_u32 s40, s40, 16896
s_cmp_eq_u32 s40, 152064
s_cselect_b32 s40, 0, s40
s_sub_i32 s43, s38, 8
s_waitcnt lgkmcnt(0)
v_cmp_gt_i32 vcc, s43, v13
s_cbranch_vccz L_lg142
s_call_b64 s[84:85], L_lfull
L_lg142:
s_add_u32 m0, s40, 0
s_add_u32 s48, s50, 0
s_waitcnt vmcnt(22)
buffer_load_dwordx4 v20, s[8:11], s48 offen offset:0 nt lds
buffer_load_dwordx4 v21, s[8:11], s48 offen offset:1056 nt lds
s_waitcnt vmcnt(22)
buffer_load_dwordx4 v22, s[8:11], s48 offen offset:2112 nt lds
buffer_load_dwordx4 v23, s[8:11], s48 offen offset:3168 nt lds
s_add_u32 m0, s40, 4224
s_add_u32 s48, s50, 512
s_waitcnt vmcnt(22)
buffer_load_dwordx4 v20, s[8:11], s48 offen offset:0 nt lds
buffer_load_dwordx4 v21, s[8:11], s48 offen offset:1056 nt lds
s_waitcnt vmcnt(22)
s_sub_i32 s42, s38, 1
s_max_i32 s49, s49, s42
v_mov_b32 v12, s49
ds_write_b32 v8, v12
buffer_load_dwordx4 v22, s[8:11], s48 offen offset:2112 nt lds
buffer_load_dwordx4 v23, s[8:11], s48 offen offset:3168 nt lds
s_add_u32 m0, s40, 8448
s_add_u32 s48, s50, 1024
s_waitcnt vmcnt(22)
buffer_load_dwordx4 v20, s[8:11], s48 offen offset:0 nt lds
buffer_load_dwordx4 v21, s[8:11], s48 offen offset:1056 nt lds
s_waitcnt vmcnt(22)
buffer_load_dwordx4 v22, s[8:11], s48 offen offset:2112 nt lds
buffer_load_dwordx4 v23, s[8:11], s48 offen offset:3168 nt lds
s_add_u32 m0, s40, 12672
s_add_u32 s48, s50, 1536
s_waitcnt vmcnt(22)
ds_read_b32 v13, v9
buffer_load_dwordx4 v20, s[8:11], s48 offen offset:0 nt lds
buffer_load_dwordx4 v21, s[8:11], s48 offen offset:1056 nt lds
s_waitcnt vmcnt(22)
buffer_load_dwordx4 v22, s[8:11], s48 offen offset:2112 nt lds
buffer_load_dwordx4 v23, s[8:11], s48 offen offset:3168 nt lds
s_add_u32 s38, s38, 1
s_add_u32 s40, s40, 16896
s_cmp_eq_u32 s40, 152064
s_cselect_b32 s40, 0, s40
s_add_u32 s50, s50, 16384
s_sub_i32 s43, s38, 8
s_waitcnt lgkmcnt(0)
v_cmp_gt_i32 vcc, s43, v13
s_cbranch_vccz L_lg143
s_call_b64 s[84:85], L_lfull
L_lg143:
s_add_u32 m0, s40, 0
s_add_u32 s48, s50, 16384
s_waitcnt vmcnt(22)
buffer_load_dwordx4 v20, s[4:7], s48 offen offset:0 nt lds
buffer_load_dwordx4 v21, s[4:7], s48 offen offset:1056 nt lds
s_waitcnt vmcnt(22)
buffer_load_dwordx4 v22, s[4:7], s48 offen offset:2112 nt lds
buffer_load_dwordx4 v23, s[4:7], s48 offen offset:3168 nt lds
s_add_u32 m0, s40, 4224
s_add_u32 s48, s50, 16896
s_waitcnt vmcnt(22)
buffer_load_dwordx4 v20, s[4:7], s48 offen offset:0 nt lds
buffer_load_dwordx4 v21, s[4:7], s48 offen offset:1056 nt lds
s_waitcnt vmcnt(22)
s_sub_i32 s42, s38, 1
s_max_i32 s49, s49, s42
v_mov_b32 v12, s49
ds_write_b32 v8, v12
buffer_load_dwordx4 v22, s[4:7], s48 offen offset:2112 nt lds
buffer_load_dwordx4 v23, s[4:7], s48 offen offset:3168 nt lds
s_add_u32 m0, s40, 8448
s_add_u32 s48, s50, 17408
s_waitcnt vmcnt(22)
buffer_load_dwordx4 v20, s[4:7], s48 offen offset:0 nt lds
buffer_load_dwordx4 v21, s[4:7], s48 offen offset:1056 nt lds
s_waitcnt vmcnt(22)
buffer_load_dwordx4 v22, s[4:7], s48 offen offset:2112 nt lds
buffer_load_dwordx4 v23, s[4:7], s48 offen offset:3168 nt lds
s_add_u32 m0, s40, 12672
s_add_u32 s48, s50, 17920
s_waitcnt vmcnt(22)
ds_read_b32 v13, v9
buffer_load_dwordx4 v20, s[4:7], s48 offen offset:0 nt lds
buffer_load_dwordx4 v21, s[4:7], s48 offen offset:1056 nt lds
s_waitcnt vmcnt(22)
buffer_load_dwordx4 v22, s[4:7], s48 offen offset:2112 nt lds
buffer_load_dwordx4 v23, s[4:7], s48 offen offset:3168 nt lds
s_add_u32 s38, s38, 1
s_add_u32 s40, s40, 16896
s_cmp_eq_u32 s40, 152064
s_cselect_b32 s40, 0, s40
s_sub_i32 s43, s38, 8
s_waitcnt lgkmcnt(0)
v_cmp_gt_i32 vcc, s43, v13
s_cbranch_vccz L_lg144
s_call_b64 s[84:85], L_lfull
L_lg144:
v_add_u32 v16, s40, v15
ds_write_b128 v16, a[64:67] offset:0
ds_write_b128 v16, a[68:71] offset:1056
ds_write_b128 v16, a[72:75] offset:2112
ds_write_b128 v16, a[76:79] offset:3168
ds_write_b128 v16, a[80:83] offset:4224
ds_write_b128 v16, a[84:87] offset:5280
ds_write_b128 v16, a[88:91] offset:6336
ds_write_b128 v16, a[92:95] offset:7392
s_waitcnt lgkmcnt(4)
ds_write_b128 v16, a[96:99] offset:8448
ds_write_b128 v16, a[100:103] offset:9504
ds_write_b128 v16, a[104:107] offset:10560
ds_write_b128 v16, a[108:111] offset:11616
ds_write_b128 v16, a[112:115] offset:12672
ds_write_b128 v16, a[116:119] offset:13728
ds_write_b128 v16, a[120:123] offset:14784
ds_write_b128 v16, a[124:127] offset:15840
s_waitcnt lgkmcnt(4)
ds_read_b32 v13, v9
s_add_u32 s38, s38, 1
s_add_u32 s40, s40, 16896
s_cmp_eq_u32 s40, 152064
s_cselect_b32 s40, 0, s40
s_add_u32 s50, s50, 16384
s_sub_i32 s43, s38, 8
s_waitcnt lgkmcnt(0)
v_cmp_gt_i32 vcc, s43, v13
s_cbranch_vccz L_lg145
s_call_b64 s[84:85], L_lfull
L_lg145:
s_add_u32 m0, s40, 0
s_add_u32 s48, s50, 16384
s_waitcnt vmcnt(22)
buffer_load_dwordx4 v20, s[4:7], s48 offen offset:0 nt lds
buffer_load_dwordx4 v21, s[4:7], s48 offen offset:1056 nt lds
s_waitcnt vmcnt(22)
buffer_load_dwordx4 v22, s[4:7], s48 offen offset:2112 nt lds
buffer_load_dwordx4 v23, s[4:7], s48 offen offset:3168 nt lds
s_add_u32 m0, s40, 4224
s_add_u32 s48, s50, 16896
s_waitcnt vmcnt(22)
buffer_load_dwordx4 v20, s[4:7], s48 offen offset:0 nt lds
buffer_load_dwordx4 v21, s[4:7], s48 offen offset:1056 nt lds
s_waitcnt vmcnt(22)
s_sub_i32 s42, s38, 2
s_max_i32 s49, s49, s42
v_mov_b32 v12, s49
ds_write_b32 v8, v12
buffer_load_dwordx4 v22, s[4:7], s48 offen offset:2112 nt lds
buffer_load_dwordx4 v23, s[4:7], s48 offen offset:3168 nt lds
s_add_u32 m0, s40, 8448
s_add_u32 s48, s50, 17408
s_waitcnt vmcnt(22)
buffer_load_dwordx4 v20, s[4:7], s48 offen offset:0 nt lds
buffer_load_dwordx4 v21, s[4:7], s48 offen offset:1056 nt lds
s_waitcnt vmcnt(22)
buffer_load_dwordx4 v22, s[4:7], s48 offen offset:2112 nt lds
buffer_load_dwordx4 v23, s[4:7], s48 offen offset:3168 nt lds
s_add_u32 m0, s40, 12672
s_add_u32 s48, s50, 17920
s_waitcnt vmcnt(22)
ds_read_b32 v13, v9
buffer_load_dwordx4 v20, s[4:7], s48 offen offset:0 nt lds
buffer_load_dwordx4 v21, s[4:7], s48 offen offset:1056 nt lds
s_waitcnt vmcnt(22)
buffer_load_dwordx4 v22, s[4:7], s48 offen offset:2112 nt lds
buffer_load_dwordx4 v23, s[4:7], s48 offen offset:3168 nt lds
s_add_u32 s38, s38, 1
s_add_u32 s40, s40, 16896
s_cmp_eq_u32 s40, 152064
s_cselect_b32 s40, 0, s40
s_sub_i32 s43, s38, 8
s_waitcnt lgkmcnt(0)
v_cmp_gt_i32 vcc, s43, v13
s_cbranch_vccz L_lg146
s_call_b64 s[84:85], L_lfull
L_lg146:
s_add_u32 m0, s40, 0
s_add_u32 s48, s50, 0
s_waitcnt vmcnt(22)
buffer_load_dwordx4 v20, s[8:11], s48 offen offset:0 nt lds
buffer_load_dwordx4 v21, s[8:11], s48 offen offset:1056 nt lds
s_waitcnt vmcnt(22)
buffer_load_dwordx4 v22, s[8:11], s48 offen offset:2112 nt lds
buffer_load_dwordx4 v23, s[8:11], s48 offen offset:3168 nt lds
s_add_u32 m0, s40, 4224
s_add_u32 s48, s50, 512
s_waitcnt vmcnt(22)
buffer_load_dwordx4 v20, s[8:11], s48 offen offset:0 nt lds
buffer_load_dwordx4 v21, s[8:11], s48 offen offset:1056 nt lds
s_waitcnt vmcnt(22)
s_sub_i32 s42, s38, 1
s_max_i32 s49, s49, s42
v_mov_b32 v12, s49
ds_write_b32 v8, v12
buffer_load_dwordx4 v22, s[8:11], s48 offen offset:2112 nt lds
buffer_load_dwordx4 v23, s[8:11], s48 offen offset:3168 nt lds
s_add_u32 m0, s40, 8448
s_add_u32 s48, s50, 1024
s_waitcnt vmcnt(22)
buffer_load_dwordx4 v20, s[8:11], s48 offen offset:0 nt lds
buffer_load_dwordx4 v21, s[8:11], s48 offen offset:1056 nt lds
s_waitcnt vmcnt(22)
buffer_load_dwordx4 v22, s[8:11], s48 offen offset:2112 nt lds
buffer_load_dwordx4 v23, s[8:11], s48 offen offset:3168 nt lds
s_add_u32 m0, s40, 12672
s_add_u32 s48, s50, 1536
s_waitcnt vmcnt(22)
ds_read_b32 v13, v9
buffer_load_dwordx4 v20, s[8:11], s48 offen offset:0 nt lds
buffer_load_dwordx4 v21, s[8:11], s48 offen offset:1056 nt lds
s_waitcnt vmcnt(22)
buffer_load_dwordx4 v22, s[8:11], s48 offen offset:2112 nt lds
buffer_load_dwordx4 v23, s[8:11], s48 offen offset:3168 nt lds
s_add_u32 s38, s38, 1
s_add_u32 s40, s40, 16896
s_cmp_eq_u32 s40, 152064
s_cselect_b32 s40, 0, s40
s_add_u32 s50, s50, 16384
s_sub_i32 s43, s38, 8
s_waitcnt lgkmcnt(0)
v_cmp_gt_i32 vcc, s43, v13
s_cbranch_vccz L_lg147
s_call_b64 s[84:85], L_lfull
L_lg147:
s_add_u32 m0, s40, 0
s_add_u32 s48, s50, 16384
s_waitcnt vmcnt(22)
buffer_load_dwordx4 v20, s[4:7], s48 offen offset:0 nt lds
buffer_load_dwordx4 v21, s[4:7], s48 offen offset:1056 nt lds
s_waitcnt vmcnt(22)
buffer_load_dwordx4 v22, s[4:7], s48 offen offset:2112 nt lds
buffer_load_dwordx4 v23, s[4:7], s48 offen offset:3168 nt lds
s_add_u32 m0, s40, 4224
s_add_u32 s48, s50, 16896
s_waitcnt vmcnt(22)
buffer_load_dwordx4 v20, s[4:7], s48 offen offset:0 nt lds
buffer_load_dwordx4 v21, s[4:7], s48 offen offset:1056 nt lds
s_waitcnt vmcnt(22)
s_sub_i32 s42, s38, 1
s_max_i32 s49, s49, s42
v_mov_b32 v12, s49
ds_write_b32 v8, v12
buffer_load_dwordx4 v22, s[4:7], s48 offen offset:2112 nt lds
buffer_load_dwordx4 v23, s[4:7], s48 offen offset:3168 nt lds
s_add_u32 m0, s40, 8448
s_add_u32 s48, s50, 17408
s_waitcnt vmcnt(22)
buffer_load_dwordx4 v20, s[4:7], s48 offen offset:0 nt lds
buffer_load_dwordx4 v21, s[4:7], s48 offen offset:1056 nt lds
s_waitcnt vmcnt(22)
buffer_load_dwordx4 v22, s[4:7], s48 offen offset:2112 nt lds
buffer_load_dwordx4 v23, s[4:7], s48 offen offset:3168 nt lds
s_add_u32 m0, s40, 12672
s_add_u32 s48, s50, 17920
s_waitcnt vmcnt(22)
ds_read_b32 v13, v9
buffer_load_dwordx4 v20, s[4:7], s48 offen offset:0 nt lds
buffer_load_dwordx4 v21, s[4:7], s48 offen offset:1056 nt lds
s_waitcnt vmcnt(22)
buffer_load_dwordx4 v22, s[4:7], s48 offen offset:2112 nt lds
buffer_load_dwordx4 v23, s[4:7], s48 offen offset:3168 nt lds
s_add_u32 s38, s38, 1
s_add_u32 s40, s40, 16896
s_cmp_eq_u32 s40, 152064
s_cselect_b32 s40, 0, s40
s_sub_i32 s43, s38, 8
s_waitcnt lgkmcnt(0)
v_cmp_gt_i32 vcc, s43, v13
s_cbranch_vccz L_lg148
s_call_b64 s[84:85], L_lfull
L_lg148:
s_add_u32 m0, s40, 0
s_add_u32 s48, s50, 0
s_waitcnt vmcnt(22)
buffer_load_dwordx4 v20, s[8:11], s48 offen offset:0 nt lds
buffer_load_dwordx4 v21, s[8:11], s48 offen offset:1056 nt lds
s_waitcnt vmcnt(22)
buffer_load_dwordx4 v22, s[8:11], s48 offen offset:2112 nt lds
buffer_load_dwordx4 v23, s[8:11], s48 offen offset:3168 nt lds
s_add_u32 m0, s40, 4224
s_add_u32 s48, s50, 512
s_waitcnt vmcnt(22)
buffer_load_dwordx4 v20, s[8:11], s48 offen offset:0 nt lds
buffer_load_dwordx4 v21, s[8:11], s48 offen offset:1056 nt lds
s_waitcnt vmcnt(22)
s_sub_i32 s42, s38, 1
s_max_i32 s49, s49, s42
v_mov_b32 v12, s49
ds_write_b32 v8, v12
buffer_load_dwordx4 v22, s[8:11], s48 offen offset:2112 nt lds
buffer_load_dwordx4 v23, s[8:11], s48 offen offset:3168 nt lds
s_add_u32 m0, s40, 8448
s_add_u32 s48, s50, 1024
s_waitcnt vmcnt(22)
buffer_load_dwordx4 v20, s[8:11], s48 offen offset:0 nt lds
buffer_load_dwordx4 v21, s[8:11], s48 offen offset:1056 nt lds
s_waitcnt vmcnt(22)
buffer_load_dwordx4 v22, s[8:11], s48 offen offset:2112 nt lds
buffer_load_dwordx4 v23, s[8:11], s48 offen offset:3168 nt lds
s_add_u32 m0, s40, 12672
s_add_u32 s48, s50, 1536
s_waitcnt vmcnt(22)
ds_read_b32 v13, v9
buffer_load_dwordx4 v20, s[8:11], s48 offen offset:0 nt lds
buffer_load_dwordx4 v21, s[8:11], s48 offen offset:1056 nt lds
s_waitcnt vmcnt(22)
buffer_load_dwordx4 v22, s[8:11], s48 offen offset:2112 nt lds
buffer_load_dwordx4 v23, s[8:11], s48 offen offset:3168 nt lds
s_add_u32 s38, s38, 1
s_add_u32 s40, s40, 16896
s_cmp_eq_u32 s40, 152064
s_cselect_b32 s40, 0, s40
s_add_u32 s50, s50, 16384
L_lkvX0:
s_sub_i32 s43, s38, 8
s_waitcnt lgkmcnt(0)
v_cmp_gt_i32 vcc, s43, v13
s_cbranch_vccz L_lg149
s_call_b64 s[84:85], L_lfull
L_lg149:
s_add_u32 m0, s40, 0
s_add_u32 s48, s50, 16384
s_waitcnt vmcnt(22)
buffer_load_dwordx4 v20, s[4:7], s48 offen offset:0 nt lds
buffer_load_dwordx4 v21, s[4:7], s48 offen offset:1056 nt lds
s_waitcnt vmcnt(22)
buffer_load_dwordx4 v22, s[4:7], s48 offen offset:2112 nt lds
buffer_load_dwordx4 v23, s[4:7], s48 offen offset:3168 nt lds
s_add_u32 m0, s40, 4224
s_add_u32 s48, s50, 16896
s_waitcnt vmcnt(22)
buffer_load_dwordx4 v20, s[4:7], s48 offen offset:0 nt lds
buffer_load_dwordx4 v21, s[4:7], s48 offen offset:1056 nt lds
s_waitcnt vmcnt(22)
s_sub_i32 s42, s38, 1
s_max_i32 s49, s49, s42
v_mov_b32 v12, s49
ds_write_b32 v8, v12
buffer_load_dwordx4 v22, s[4:7], s48 offen offset:2112 nt lds
buffer_load_dwordx4 v23, s[4:7], s48 offen offset:3168 nt lds
s_add_u32 m0, s40, 8448
s_add_u32 s48, s50, 17408
s_waitcnt vmcnt(22)
buffer_load_dwordx4 v20, s[4:7], s48 offen offset:0 nt lds
buffer_load_dwordx4 v21, s[4:7], s48 offen offset:1056 nt lds
s_waitcnt vmcnt(22)
buffer_load_dwordx4 v22, s[4:7], s48 offen offset:2112 nt lds
buffer_load_dwordx4 v23, s[4:7], s48 offen offset:3168 nt lds
s_add_u32 m0, s40, 12672
s_add_u32 s48, s50, 17920
s_waitcnt vmcnt(22)
ds_read_b32 v13, v9
buffer_load_dwordx4 v20, s[4:7], s48 offen offset:0 nt lds
buffer_load_dwordx4 v21, s[4:7], s48 offen offset:1056 nt lds
s_waitcnt vmcnt(22)
buffer_load_dwordx4 v22, s[4:7], s48 offen offset:2112 nt lds
buffer_load_dwordx4 v23, s[4:7], s48 offen offset:3168 nt lds
s_add_u32 s38, s38, 1
s_add_u32 s40, s40, 16896
s_cmp_eq_u32 s40, 152064
s_cselect_b32 s40, 0, s40
s_sub_i32 s43, s38, 8
s_waitcnt lgkmcnt(0)
v_cmp_gt_i32 vcc, s43, v13
s_cbranch_vccz L_lg150
s_call_b64 s[84:85], L_lfull
L_lg150:
s_add_u32 m0, s40, 0
s_add_u32 s48, s50, 0
s_waitcnt vmcnt(22)
buffer_load_dwordx4 v20, s[8:11], s48 offen offset:0 nt lds
buffer_load_dwordx4 v21, s[8:11], s48 offen offset:1056 nt lds
s_waitcnt vmcnt(22)
buffer_load_dwordx4 v22, s[8:11], s48 offen offset:2112 nt lds
buffer_load_dwordx4 v23, s[8:11], s48 offen offset:3168 nt lds
s_add_u32 m0, s40, 4224
s_add_u32 s48, s50, 512
s_waitcnt vmcnt(22)
buffer_load_dwordx4 v20, s[8:11], s48 offen offset:0 nt lds
buffer_load_dwordx4 v21, s[8:11], s48 offen offset:1056 nt lds
s_waitcnt vmcnt(22)
s_sub_i32 s42, s38, 1
s_max_i32 s49, s49, s42
v_mov_b32 v12, s49
ds_write_b32 v8, v12
buffer_load_dwordx4 v22, s[8:11], s48 offen offset:2112 nt lds
buffer_load_dwordx4 v23, s[8:11], s48 offen offset:3168 nt lds
s_add_u32 m0, s40, 8448
s_add_u32 s48, s50, 1024
s_waitcnt vmcnt(22)
buffer_load_dwordx4 v20, s[8:11], s48 offen offset:0 nt lds
buffer_load_dwordx4 v21, s[8:11], s48 offen offset:1056 nt lds
s_waitcnt vmcnt(22)
buffer_load_dwordx4 v22, s[8:11], s48 offen offset:2112 nt lds
buffer_load_dwordx4 v23, s[8:11], s48 offen offset:3168 nt lds
s_add_u32 m0, s40, 12672
s_add_u32 s48, s50, 1536
s_waitcnt vmcnt(22)
ds_read_b32 v13, v9
buffer_load_dwordx4 v20, s[8:11], s48 offen offset:0 nt lds
buffer_load_dwordx4 v21, s[8:11], s48 offen offset:1056 nt lds
s_waitcnt vmcnt(22)
buffer_load_dwordx4 v22, s[8:11], s48 offen offset:2112 nt lds
buffer_load_dwordx4 v23, s[8:11], s48 offen offset:3168 nt lds
s_add_u32 s38, s38, 1
s_add_u32 s40, s40, 16896
s_cmp_eq_u32 s40, 152064
s_cselect_b32 s40, 0, s40
s_add_u32 s50, s50, 16384
s_cmp_lt_u32 s50, 475136
s_cbranch_scc1 L_lkvX0
s_sub_i32 s43, s38, 8
s_waitcnt lgkmcnt(0)
v_cmp_gt_i32 vcc, s43, v13
s_cbranch_vccz L_lg151
s_call_b64 s[84:85], L_lfull
L_lg151:
s_add_u32 m0, s40, 0
s_add_u32 s48, s50, 0
s_waitcnt vmcnt(22)
buffer_load_dwordx4 v20, s[8:11], s48 offen offset:0 nt lds
buffer_load_dwordx4 v21, s[8:11], s48 offen offset:1056 nt lds
s_waitcnt vmcnt(22)
buffer_load_dwordx4 v22, s[8:11], s48 offen offset:2112 nt lds
buffer_load_dwordx4 v23, s[8:11], s48 offen offset:3168 nt lds
s_add_u32 m0, s40, 4224
s_add_u32 s48, s50, 512
s_waitcnt vmcnt(22)
buffer_load_dwordx4 v20, s[8:11], s48 offen offset:0 nt lds
buffer_load_dwordx4 v21, s[8:11], s48 offen offset:1056 nt lds
s_waitcnt vmcnt(22)
s_sub_i32 s42, s38, 1
s_max_i32 s49, s49, s42
v_mov_b32 v12, s49
ds_write_b32 v8, v12
buffer_load_dwordx4 v22, s[8:11], s48 offen offset:2112 nt lds
buffer_load_dwordx4 v23, s[8:11], s48 offen offset:3168 nt lds
s_add_u32 m0, s40, 8448
s_add_u32 s48, s50, 1024
s_waitcnt vmcnt(22)
buffer_load_dwordx4 v20, s[8:11], s48 offen offset:0 nt lds
buffer_load_dwordx4 v21, s[8:11], s48 offen offset:1056 nt lds
s_waitcnt vmcnt(22)
buffer_load_dwordx4 v22, s[8:11], s48 offen offset:2112 nt lds
buffer_load_dwordx4 v23, s[8:11], s48 offen offset:3168 nt lds
s_add_u32 m0, s40, 12672
s_add_u32 s48, s50, 1536
s_waitcnt vmcnt(22)
ds_read_b32 v13, v9
buffer_load_dwordx4 v20, s[8:11], s48 offen offset:0 nt lds
buffer_load_dwordx4 v21, s[8:11], s48 offen offset:1056 nt lds
s_waitcnt vmcnt(22)
buffer_load_dwordx4 v22, s[8:11], s48 offen offset:2112 nt lds
buffer_load_dwordx4 v23, s[8:11], s48 offen offset:3168 nt lds
s_add_u32 s38, s38, 1
s_add_u32 s40, s40, 16896
s_cmp_eq_u32 s40, 152064
s_cselect_b32 s40, 0, s40
s_waitcnt vmcnt(16)
s_sub_i32 s42, s38, 1
s_max_i32 s49, s49, s42
v_mov_b32 v12, s49
ds_write_b32 v8, v12
s_waitcnt vmcnt(0)
s_sub_i32 s42, s38, 0
s_max_i32 s49, s49, s42
v_mov_b32 v12, s49
ds_write_b32 v8, v12
s_waitcnt lgkmcnt(0)
s_branch L_reduce
L_lY:
s_lshl_b32 s50, s36, 19
s_sub_i32 s43, s38, 8
s_waitcnt lgkmcnt(0)
v_cmp_gt_i32 vcc, s43, v13
s_cbranch_vccz L_lg152
s_call_b64 s[84:85], L_lfull
L_lg152:
s_add_u32 m0, s40, 0
s_add_u32 s48, s50, 0
s_waitcnt vmcnt(26)
buffer_load_dwordx4 v24, s[12:15], s48 offen offset:0 lds
buffer_load_dwordx4 v25, s[12:15], s48 offen offset:1056 lds
s_waitcnt vmcnt(26)
buffer_load_dwordx4 v26, s[12:15], s48 offen offset:2112 lds
buffer_load_dwordx4 v27, s[12:15], s48 offen offset:3168 lds
s_add_u32 m0, s40, 4224
s_add_u32 s48, s50, 65536
s_waitcnt vmcnt(26)
buffer_load_dwordx4 v24, s[12:15], s48 offen offset:0 lds
buffer_load_dwordx4 v25, s[12:15], s48 offen offset:1056 lds
s_waitcnt vmcnt(26)
buffer_load_dwordx4 v26, s[12:15], s48 offen offset:2112 lds
buffer_load_dwordx4 v27, s[12:15], s48 offen offset:3168 lds
s_add_u32 m0, s40, 8448
s_add_u32 s48, s50, 131072
s_waitcnt vmcnt(26)
buffer_load_dwordx4 v24, s[12:15], s48 offen offset:0 lds
buffer_load_dwordx4 v25, s[12:15], s48 offen offset:1056 lds
s_waitcnt vmcnt(26)
buffer_load_dwordx4 v26, s[12:15], s48 offen offset:2112 lds
buffer_load_dwordx4 v27, s[12:15], s48 offen offset:3168 lds
s_add_u32 m0, s40, 12672
s_add_u32 s48, s50, 196608
s_waitcnt vmcnt(26)
ds_read_b32 v13, v9
buffer_load_dwordx4 v24, s[12:15], s48 offen offset:0 lds
buffer_load_dwordx4 v25, s[12:15], s48 offen offset:1056 lds
s_waitcnt vmcnt(26)
buffer_load_dwordx4 v26, s[12:15], s48 offen offset:2112 lds
buffer_load_dwordx4 v27, s[12:15], s48 offen offset:3168 lds
s_add_u32 s38, s38, 1
s_add_u32 s40, s40, 16896
s_cmp_eq_u32 s40, 152064
s_cselect_b32 s40, 0, s40
s_add_u32 s50, s50, 524288
s_cmp_eq_u32 s50, 3670016
s_cselect_b32 s50, 0, s50
s_sub_i32 s43, s38, 8
s_waitcnt lgkmcnt(0)
v_cmp_gt_i32 vcc, s43, v13
s_cbranch_vccz L_lg153
s_call_b64 s[84:85], L_lfull
L_lg153:
s_add_u32 m0, s40, 0
s_add_u32 s48, s50, 0
s_waitcnt vmcnt(26)
buffer_load_dwordx4 v24, s[12:15], s48 offen offset:0 lds
buffer_load_dwordx4 v25, s[12:15], s48 offen offset:1056 lds
s_waitcnt vmcnt(26)
buffer_load_dwordx4 v26, s[12:15], s48 offen offset:2112 lds
buffer_load_dwordx4 v27, s[12:15], s48 offen offset:3168 lds
s_add_u32 m0, s40, 4224
s_add_u32 s48, s50, 65536
s_waitcnt vmcnt(26)
buffer_load_dwordx4 v24, s[12:15], s48 offen offset:0 lds
buffer_load_dwordx4 v25, s[12:15], s48 offen offset:1056 lds
s_waitcnt vmcnt(26)
buffer_load_dwordx4 v26, s[12:15], s48 offen offset:2112 lds
buffer_load_dwordx4 v27, s[12:15], s48 offen offset:3168 lds
s_add_u32 m0, s40, 8448
s_add_u32 s48, s50, 131072
s_waitcnt vmcnt(26)
buffer_load_dwordx4 v24, s[12:15], s48 offen offset:0 lds
buffer_load_dwordx4 v25, s[12:15], s48 offen offset:1056 lds
s_waitcnt vmcnt(26)
buffer_load_dwordx4 v26, s[12:15], s48 offen offset:2112 lds
buffer_load_dwordx4 v27, s[12:15], s48 offen offset:3168 lds
s_add_u32 m0, s40, 12672
s_add_u32 s48, s50, 196608
s_waitcnt vmcnt(26)
ds_read_b32 v13, v9
buffer_load_dwordx4 v24, s[12:15], s48 offen offset:0 lds
buffer_load_dwordx4 v25, s[12:15], s48 offen offset:1056 lds
s_waitcnt vmcnt(26)
buffer_load_dwordx4 v26, s[12:15], s48 offen offset:2112 lds
buffer_load_dwordx4 v27, s[12:15], s48 offen offset:3168 lds
s_add_u32 s38, s38, 1
s_add_u32 s40, s40, 16896
s_cmp_eq_u32 s40, 152064
s_cselect_b32 s40, 0, s40
s_add_u32 s50, s50, 524288
s_cmp_eq_u32 s50, 3670016
s_cselect_b32 s50, 0, s50
s_sub_i32 s43, s38, 8
s_waitcnt lgkmcnt(0)
v_cmp_gt_i32 vcc, s43, v13
s_cbranch_vccz L_lg154
s_call_b64 s[84:85], L_lfull
L_lg154:
s_add_u32 m0, s40, 0
s_add_u32 s48, s50, 0
s_waitcnt vmcnt(26)
buffer_load_dwordx4 v24, s[12:15], s48 offen offset:0 lds
buffer_load_dwordx4 v25, s[12:15], s48 offen offset:1056 lds
s_waitcnt vmcnt(26)
buffer_load_dwordx4 v26, s[12:15], s48 offen offset:2112 lds
buffer_load_dwordx4 v27, s[12:15], s48 offen offset:3168 lds
s_add_u32 m0, s40, 4224
s_add_u32 s48, s50, 65536
s_waitcnt vmcnt(26)
buffer_load_dwordx4 v24, s[12:15], s48 offen offset:0 lds
buffer_load_dwordx4 v25, s[12:15], s48 offen offset:1056 lds
s_waitcnt vmcnt(26)
buffer_load_dwordx4 v26, s[12:15], s48 offen offset:2112 lds
buffer_load_dwordx4 v27, s[12:15], s48 offen offset:3168 lds
s_add_u32 m0, s40, 8448
s_add_u32 s48, s50, 131072
s_waitcnt vmcnt(26)
buffer_load_dwordx4 v24, s[12:15], s48 offen offset:0 lds
buffer_load_dwordx4 v25, s[12:15], s48 offen offset:1056 lds
s_waitcnt vmcnt(26)
s_max_i32 s49, s49, 1
v_mov_b32 v12, s49
ds_write_b32 v8, v12
buffer_load_dwordx4 v26, s[12:15], s48 offen offset:2112 lds
buffer_load_dwordx4 v27, s[12:15], s48 offen offset:3168 lds
s_add_u32 m0, s40, 12672
s_add_u32 s48, s50, 196608
s_waitcnt vmcnt(26)
ds_read_b32 v13, v9
buffer_load_dwordx4 v24, s[12:15], s48 offen offset:0 lds
buffer_load_dwordx4 v25, s[12:15], s48 offen offset:1056 lds
s_waitcnt vmcnt(26)
buffer_load_dwordx4 v26, s[12:15], s48 offen offset:2112 lds
buffer_load_dwordx4 v27, s[12:15], s48 offen offset:3168 lds
s_add_u32 s38, s38, 1
s_add_u32 s40, s40, 16896
s_cmp_eq_u32 s40, 152064
s_cselect_b32 s40, 0, s40
s_add_u32 s50, s50, 524288
s_cmp_eq_u32 s50, 3670016
s_cselect_b32 s50, 0, s50
s_sub_i32 s43, s38, 8
s_waitcnt lgkmcnt(0)
v_cmp_gt_i32 vcc, s43, v13
s_cbranch_vccz L_lg155
s_call_b64 s[84:85], L_lfull
L_lg155:
s_add_u32 m0, s40, 0
s_add_u32 s48, s50, 0
s_waitcnt vmcnt(26)
buffer_load_dwordx4 v24, s[12:15], s48 offen offset:0 lds
buffer_load_dwordx4 v25, s[12:15], s48 offen offset:1056 lds
s_waitcnt vmcnt(26)
buffer_load_dwordx4 v26, s[12:15], s48 offen offset:2112 lds
buffer_load_dwordx4 v27, s[12:15], s48 offen offset:3168 lds
s_add_u32 m0, s40, 4224
s_add_u32 s48, s50, 65536
s_waitcnt vmcnt(26)
buffer_load_dwordx4 v24, s[12:15], s48 offen offset:0 lds
buffer_load_dwordx4 v25, s[12:15], s48 offen offset:1056 lds
s_waitcnt vmcnt(26)
buffer_load_dwordx4 v26, s[12:15], s48 offen offset:2112 lds
buffer_load_dwordx4 v27, s[12:15], s48 offen offset:3168 lds
s_add_u32 m0, s40, 8448
s_add_u32 s48, s50, 131072
s_waitcnt vmcnt(26)
buffer_load_dwordx4 v24, s[12:15], s48 offen offset:0 lds
buffer_load_dwordx4 v25, s[12:15], s48 offen offset:1056 lds
s_waitcnt vmcnt(26)
s_max_i32 s49, s49, 2
v_mov_b32 v12, s49
ds_write_b32 v8, v12
buffer_load_dwordx4 v26, s[12:15], s48 offen offset:2112 lds
buffer_load_dwordx4 v27, s[12:15], s48 offen offset:3168 lds
s_add_u32 m0, s40, 12672
s_add_u32 s48, s50, 196608
s_waitcnt vmcnt(26)
ds_read_b32 v13, v9
buffer_load_dwordx4 v24, s[12:15], s48 offen offset:0 lds
buffer_load_dwordx4 v25, s[12:15], s48 offen offset:1056 lds
s_waitcnt vmcnt(26)
buffer_load_dwordx4 v26, s[12:15], s48 offen offset:2112 lds
buffer_load_dwordx4 v27, s[12:15], s48 offen offset:3168 lds
s_add_u32 s38, s38, 1
s_add_u32 s40, s40, 16896
s_cmp_eq_u32 s40, 152064
s_cselect_b32 s40, 0, s40
s_add_u32 s50, s50, 524288
s_cmp_eq_u32 s50, 3670016
s_cselect_b32 s50, 0, s50
s_sub_i32 s43, s38, 8
s_waitcnt lgkmcnt(0)
v_cmp_gt_i32 vcc, s43, v13
s_cbranch_vccz L_lg156
s_call_b64 s[84:85], L_lfull
L_lg156:
s_add_u32 m0, s40, 0
s_add_u32 s48, s50, 0
s_waitcnt vmcnt(26)
buffer_load_dwordx4 v24, s[12:15], s48 offen offset:0 lds
buffer_load_dwordx4 v25, s[12:15], s48 offen offset:1056 lds
s_waitcnt vmcnt(26)
buffer_load_dwordx4 v26, s[12:15], s48 offen offset:2112 lds
buffer_load_dwordx4 v27, s[12:15], s48 offen offset:3168 lds
s_add_u32 m0, s40, 4224
s_add_u32 s48, s50, 65536
s_waitcnt vmcnt(26)
buffer_load_dwordx4 v24, s[12:15], s48 offen offset:0 lds
buffer_load_dwordx4 v25, s[12:15], s48 offen offset:1056 lds
s_waitcnt vmcnt(26)
buffer_load_dwordx4 v26, s[12:15], s48 offen offset:2112 lds
buffer_load_dwordx4 v27, s[12:15], s48 offen offset:3168 lds
s_add_u32 m0, s40, 8448
s_add_u32 s48, s50, 131072
s_waitcnt vmcnt(26)
buffer_load_dwordx4 v24, s[12:15], s48 offen offset:0 lds
buffer_load_dwordx4 v25, s[12:15], s48 offen offset:1056 lds
s_waitcnt vmcnt(26)
s_max_i32 s49, s49, 3
v_mov_b32 v12, s49
ds_write_b32 v8, v12
buffer_load_dwordx4 v26, s[12:15], s48 offen offset:2112 lds
buffer_load_dwordx4 v27, s[12:15], s48 offen offset:3168 lds
s_add_u32 m0, s40, 12672
s_add_u32 s48, s50, 196608
s_waitcnt vmcnt(26)
ds_read_b32 v13, v9
buffer_load_dwordx4 v24, s[12:15], s48 offen offset:0 lds
buffer_load_dwordx4 v25, s[12:15], s48 offen offset:1056 lds
s_waitcnt vmcnt(26)
buffer_load_dwordx4 v26, s[12:15], s48 offen offset:2112 lds
buffer_load_dwordx4 v27, s[12:15], s48 offen offset:3168 lds
s_add_u32 s38, s38, 1
s_add_u32 s40, s40, 16896
s_cmp_eq_u32 s40, 152064
s_cselect_b32 s40, 0, s40
s_add_u32 s50, s50, 524288
s_cmp_eq_u32 s50, 3670016
s_cselect_b32 s50, 0, s50
s_mov_b32 s48, 65536
s_waitcnt vmcnt(26)
buffer_load_dwordx4 v[32:35], v20, s[8:11], s48 offen offset:0 nt
buffer_load_dwordx4 v[36:39], v21, s[8:11], s48 offen offset:1056 nt
s_waitcnt vmcnt(26)
buffer_load_dwordx4 v[40:43], v22, s[8:11], s48 offen offset:2112 nt
buffer_load_dwordx4 v[44:47], v23, s[8:11], s48 offen offset:3168 nt
s_mov_b32 s48, 66048
s_waitcnt vmcnt(26)
buffer_load_dwordx4 v[48:51], v20, s[8:11], s48 offen offset:0 nt
buffer_load_dwordx4 v[52:55], v21, s[8:11], s48 offen offset:1056 nt
s_waitcnt vmcnt(26)
buffer_load_dwordx4 v[56:59], v22, s[8:11], s48 offen offset:2112 nt
buffer_load_dwordx4 v[60:63], v23, s[8:11], s48 offen offset:3168 nt
s_mov_b32 s48, 66560
s_waitcnt vmcnt(26)
buffer_load_dwordx4 v[64:67], v20, s[8:11], s48 offen offset:0 nt
buffer_load_dwordx4 v[68:71], v21, s[8:11], s48 offen offset:1056 nt
s_waitcnt vmcnt(26)
s_max_i32 s49, s49, 4
v_mov_b32 v12, s49
ds_write_b32 v8, v12
buffer_load_dwordx4 v[72:75], v22, s[8:11], s48 offen offset:2112 nt
buffer_load_dwordx4 v[76:79], v23, s[8:11], s48 offen offset:3168 nt
s_mov_b32 s48, 67072
s_waitcnt vmcnt(26)
buffer_load_dwordx4 v[80:83], v20, s[8:11], s48 offen offset:0 nt
buffer_load_dwordx4 v[84:87], v21, s[8:11], s48 offen offset:1056 nt
s_waitcnt vmcnt(26)
buffer_load_dwordx4 v[88:91], v22, s[8:11], s48 offen offset:2112 nt
buffer_load_dwordx4 v[92:95], v23, s[8:11], s48 offen offset:3168 nt
ds_read_b32 v13, v9
s_add_u32 s38, s38, 4
s_mov_b32 s40, 0
s_sub_i32 s43, s38, 8
s_waitcnt lgkmcnt(0)
v_cmp_gt_i32 vcc, s43, v13
s_cbranch_vccz L_lg157
s_call_b64 s[84:85], L_lfull
L_lg157:
s_add_u32 m0, s40, 0
s_add_u32 s48, s50, 0
s_waitcnt vmcnt(26)
buffer_load_dwordx4 v24, s[12:15], s48 offen offset:0 lds
buffer_load_dwordx4 v25, s[12:15], s48 offen offset:1056 lds
s_waitcnt vmcnt(26)
buffer_load_dwordx4 v26, s[12:15], s48 offen offset:2112 lds
buffer_load_dwordx4 v27, s[12:15], s48 offen offset:3168 lds
s_add_u32 m0, s40, 4224
s_add_u32 s48, s50, 65536
s_waitcnt vmcnt(26)
buffer_load_dwordx4 v24, s[12:15], s48 offen offset:0 lds
buffer_load_dwordx4 v25, s[12:15], s48 offen offset:1056 lds
s_waitcnt vmcnt(26)
buffer_load_dwordx4 v26, s[12:15], s48 offen offset:2112 lds
buffer_load_dwordx4 v27, s[12:15], s48 offen offset:3168 lds
s_add_u32 m0, s40, 8448
s_add_u32 s48, s50, 131072
s_waitcnt vmcnt(26)
buffer_load_dwordx4 v24, s[12:15], s48 offen offset:0 lds
buffer_load_dwordx4 v25, s[12:15], s48 offen offset:1056 lds
s_waitcnt vmcnt(26)
s_max_i32 s49, s49, 9
v_mov_b32 v12, s49
ds_write_b32 v8, v12
buffer_load_dwordx4 v26, s[12:15], s48 offen offset:2112 lds
buffer_load_dwordx4 v27, s[12:15], s48 offen offset:3168 lds
s_add_u32 m0, s40, 12672
s_add_u32 s48, s50, 196608
s_waitcnt vmcnt(26)
ds_read_b32 v13, v9
buffer_load_dwordx4 v24, s[12:15], s48 offen offset:0 lds
buffer_load_dwordx4 v25, s[12:15], s48 offen offset:1056 lds
s_waitcnt vmcnt(26)
buffer_load_dwordx4 v26, s[12:15], s48 offen offset:2112 lds
buffer_load_dwordx4 v27, s[12:15], s48 offen offset:3168 lds
s_add_u32 s38, s38, 1
s_add_u32 s40, s40, 16896
s_cmp_eq_u32 s40, 152064
s_cselect_b32 s40, 0, s40
s_add_u32 s50, s50, 524288
s_cmp_eq_u32 s50, 3670016
s_cselect_b32 s50, 0, s50
s_mov_b32 s48, 98304
s_waitcnt vmcnt(26)
buffer_load_dwordx4 v[96:99], v20, s[8:11], s48 offen offset:0 nt
buffer_load_dwordx4 v[100:103], v21, s[8:11], s48 offen offset:1056 nt
s_waitcnt vmcnt(26)
buffer_load_dwordx4 v[104:107], v22, s[8:11], s48 offen offset:2112 nt
buffer_load_dwordx4 v[108:111], v23, s[8:11], s48 offen offset:3168 nt
s_mov_b32 s48, 98816
s_waitcnt vmcnt(26)
buffer_load_dwordx4 v[112:115], v20, s[8:11], s48 offen offset:0 nt
buffer_load_dwordx4 v[116:119], v21, s[8:11], s48 offen offset:1056 nt
s_waitcnt vmcnt(26)
buffer_load_dwordx4 v[120:123], v22, s[8:11], s48 offen offset:2112 nt
buffer_load_dwordx4 v[124:127], v23, s[8:11], s48 offen offset:3168 nt
s_mov_b32 s48, 99328
s_waitcnt vmcnt(26)
buffer_load_dwordx4 v[128:131], v20, s[8:11], s48 offen offset:0 nt
buffer_load_dwordx4 v[132:135], v21, s[8:11], s48 offen offset:1056 nt
s_waitcnt vmcnt(26)
buffer_load_dwordx4 v[136:139], v22, s[8:11], s48 offen offset:2112 nt
buffer_load_dwordx4 v[140:143], v23, s[8:11], s48 offen offset:3168 nt
s_mov_b32 s48, 99840
s_waitcnt vmcnt(26)
buffer_load_dwordx4 v[144:147], v20, s[8:11], s48 offen offset:0 nt
buffer_load_dwordx4 v[148:151], v21, s[8:11], s48 offen offset:1056 nt
s_waitcnt vmcnt(26)
buffer_load_dwordx4 v[152:155], v22, s[8:11], s48 offen offset:2112 nt
buffer_load_dwordx4 v[156:159], v23, s[8:11], s48 offen offset:3168 nt
ds_read_b32 v13, v9
s_sub_i32 s43, s38, 8
s_waitcnt lgkmcnt(0)
v_cmp_gt_i32 vcc, s43, v13
s_cbranch_vccz L_lg158
s_call_b64 s[84:85], L_lfull
L_lg158:
s_add_u32 m0, s40, 0
s_add_u32 s48, s50, 0
s_waitcnt vmcnt(26)
buffer_load_dwordx4 v24, s[12:15], s48 offen offset:0 lds
buffer_load_dwordx4 v25, s[12:15], s48 offen offset:1056 lds
s_waitcnt vmcnt(26)
buffer_load_dwordx4 v26, s[12:15], s48 offen offset:2112 lds
buffer_load_dwordx4 v27, s[12:15], s48 offen offset:3168 lds
s_add_u32 m0, s40, 4224
s_add_u32 s48, s50, 65536
s_waitcnt vmcnt(26)
buffer_load_dwordx4 v24, s[12:15], s48 offen offset:0 lds
buffer_load_dwordx4 v25, s[12:15], s48 offen offset:1056 lds
s_waitcnt vmcnt(26)
buffer_load_dwordx4 v26, s[12:15], s48 offen offset:2112 lds
buffer_load_dwordx4 v27, s[12:15], s48 offen offset:3168 lds
s_add_u32 m0, s40, 8448
s_add_u32 s48, s50, 131072
s_waitcnt vmcnt(26)
buffer_load_dwordx4 v24, s[12:15], s48 offen offset:0 lds
buffer_load_dwordx4 v25, s[12:15], s48 offen offset:1056 lds
s_waitcnt vmcnt(26)
s_max_i32 s49, s49, 10
v_mov_b32 v12, s49
ds_write_b32 v8, v12
buffer_load_dwordx4 v26, s[12:15], s48 offen offset:2112 lds
buffer_load_dwordx4 v27, s[12:15], s48 offen offset:3168 lds
s_add_u32 m0, s40, 12672
s_add_u32 s48, s50, 196608
s_waitcnt vmcnt(26)
ds_read_b32 v13, v9
buffer_load_dwordx4 v24, s[12:15], s48 offen offset:0 lds
buffer_load_dwordx4 v25, s[12:15], s48 offen offset:1056 lds
s_waitcnt vmcnt(26)
buffer_load_dwordx4 v26, s[12:15], s48 offen offset:2112 lds
buffer_load_dwordx4 v27, s[12:15], s48 offen offset:3168 lds
s_add_u32 s38, s38, 1
s_add_u32 s40, s40, 16896
s_cmp_eq_u32 s40, 152064
s_cselect_b32 s40, 0, s40
s_add_u32 s50, s50, 524288
s_cmp_eq_u32 s50, 3670016
s_cselect_b32 s50, 0, s50
s_add_u32 s50, s50, 256
s_mov_b32 s48, 131072
s_waitcnt vmcnt(26)
buffer_load_dwordx4 v[160:163], v20, s[8:11], s48 offen offset:0 nt
buffer_load_dwordx4 v[164:167], v21, s[8:11], s48 offen offset:1056 nt
s_waitcnt vmcnt(26)
buffer_load_dwordx4 v[168:171], v22, s[8:11], s48 offen offset:2112 nt
buffer_load_dwordx4 v[172:175], v23, s[8:11], s48 offen offset:3168 nt
s_mov_b32 s48, 131584
s_waitcnt vmcnt(26)
buffer_load_dwordx4 v[176:179], v20, s[8:11], s48 offen offset:0 nt
buffer_load_dwordx4 v[180:183], v21, s[8:11], s48 offen offset:1056 nt
s_waitcnt vmcnt(26)
buffer_load_dwordx4 v[184:187], v22, s[8:11], s48 offen offset:2112 nt
buffer_load_dwordx4 v[188:191], v23, s[8:11], s48 offen offset:3168 nt
s_mov_b32 s48, 132096
s_waitcnt vmcnt(26)
buffer_load_dwordx4 v[192:195], v20, s[8:11], s48 offen offset:0 nt
buffer_load_dwordx4 v[196:199], v21, s[8:11], s48 offen offset:1056 nt
s_waitcnt vmcnt(26)
buffer_load_dwordx4 v[200:203], v22, s[8:11], s48 offen offset:2112 nt
buffer_load_dwordx4 v[204:207], v23, s[8:11], s48 offen offset:3168 nt
s_mov_b32 s48, 132608
s_waitcnt vmcnt(26)
buffer_load_dwordx4 v[208:211], v20, s[8:11], s48 offen offset:0 nt
buffer_load_dwordx4 v[212:215], v21, s[8:11], s48 offen offset:1056 nt
s_waitcnt vmcnt(26)
buffer_load_dwordx4 v[216:219], v22, s[8:11], s48 offen offset:2112 nt
buffer_load_dwordx4 v[220:223], v23, s[8:11], s48 offen offset:3168 nt
ds_read_b32 v13, v9
s_sub_i32 s43, s38, 8
s_waitcnt lgkmcnt(0)
v_cmp_gt_i32 vcc, s43, v13
s_cbranch_vccz L_lg159
s_call_b64 s[84:85], L_lfull
L_lg159:
s_add_u32 m0, s40, 0
s_add_u32 s48, s50, 0
s_waitcnt vmcnt(26)
buffer_load_dwordx4 v24, s[12:15], s48 offen offset:0 lds
buffer_load_dwordx4 v25, s[12:15], s48 offen offset:1056 lds
s_waitcnt vmcnt(26)
buffer_load_dwordx4 v26, s[12:15], s48 offen offset:2112 lds
buffer_load_dwordx4 v27, s[12:15], s48 offen offset:3168 lds
s_add_u32 m0, s40, 4224
s_add_u32 s48, s50, 65536
s_waitcnt vmcnt(26)
buffer_load_dwordx4 v24, s[12:15], s48 offen offset:0 lds
buffer_load_dwordx4 v25, s[12:15], s48 offen offset:1056 lds
s_waitcnt vmcnt(26)
buffer_load_dwordx4 v26, s[12:15], s48 offen offset:2112 lds
buffer_load_dwordx4 v27, s[12:15], s48 offen offset:3168 lds
s_add_u32 m0, s40, 8448
s_add_u32 s48, s50, 131072
s_waitcnt vmcnt(26)
buffer_load_dwordx4 v24, s[12:15], s48 offen offset:0 lds
buffer_load_dwordx4 v25, s[12:15], s48 offen offset:1056 lds
s_waitcnt vmcnt(26)
s_max_i32 s49, s49, 11
v_mov_b32 v12, s49
ds_write_b32 v8, v12
buffer_load_dwordx4 v26, s[12:15], s48 offen offset:2112 lds
buffer_load_dwordx4 v27, s[12:15], s48 offen offset:3168 lds
s_add_u32 m0, s40, 12672
s_add_u32 s48, s50, 196608
s_waitcnt vmcnt(26)
ds_read_b32 v13, v9
buffer_load_dwordx4 v24, s[12:15], s48 offen offset:0 lds
buffer_load_dwordx4 v25, s[12:15], s48 offen offset:1056 lds
s_waitcnt vmcnt(26)
buffer_load_dwordx4 v26, s[12:15], s48 offen offset:2112 lds
buffer_load_dwordx4 v27, s[12:15], s48 offen offset:3168 lds
s_add_u32 s38, s38, 1
s_add_u32 s40, s40, 16896
s_cmp_eq_u32 s40, 152064
s_cselect_b32 s40, 0, s40
s_add_u32 s50, s50, 524288
s_cmp_eq_u32 s50, 3670272
s_cselect_b32 s50, 256, s50
s_mov_b32 s48, 163840
s_waitcnt vmcnt(26)
buffer_load_dwordx4 a[0:3], v20, s[8:11], s48 offen offset:0 nt
buffer_load_dwordx4 a[4:7], v21, s[8:11], s48 offen offset:1056 nt
s_waitcnt vmcnt(26)
buffer_load_dwordx4 a[8:11], v22, s[8:11], s48 offen offset:2112 nt
buffer_load_dwordx4 a[12:15], v23, s[8:11], s48 offen offset:3168 nt
s_mov_b32 s48, 164352
s_waitcnt vmcnt(26)
buffer_load_dwordx4 a[16:19], v20, s[8:11], s48 offen offset:0 nt
buffer_load_dwordx4 a[20:23], v21, s[8:11], s48 offen offset:1056 nt
s_waitcnt vmcnt(26)
buffer_load_dwordx4 a[24:27], v22, s[8:11], s48 offen offset:2112 nt
buffer_load_dwordx4 a[28:31], v23, s[8:11], s48 offen offset:3168 nt
s_mov_b32 s48, 164864
s_waitcnt vmcnt(26)
buffer_load_dwordx4 a[32:35], v20, s[8:11], s48 offen offset:0 nt
buffer_load_dwordx4 a[36:39], v21, s[8:11], s48 offen offset:1056 nt
s_waitcnt vmcnt(26)
buffer_load_dwordx4 a[40:43], v22, s[8:11], s48 offen offset:2112 nt
buffer_load_dwordx4 a[44:47], v23, s[8:11], s48 offen offset:3168 nt
s_mov_b32 s48, 165376
s_waitcnt vmcnt(26)
buffer_load_dwordx4 a[48:51], v20, s[8:11], s48 offen offset:0 nt
buffer_load_dwordx4 a[52:55], v21, s[8:11], s48 offen offset:1056 nt
s_waitcnt vmcnt(26)
buffer_load_dwordx4 a[56:59], v22, s[8:11], s48 offen offset:2112 nt
buffer_load_dwordx4 a[60:63], v23, s[8:11], s48 offen offset:3168 nt
ds_read_b32 v13, v9
s_sub_i32 s43, s38, 8
s_waitcnt lgkmcnt(0)
v_cmp_gt_i32 vcc, s43, v13
s_cbranch_vccz L_lg160
s_call_b64 s[84:85], L_lfull
L_lg160:
s_add_u32 m0, s40, 0
s_add_u32 s48, s50, 0
s_waitcnt vmcnt(26)
buffer_load_dwordx4 v24, s[12:15], s48 offen offset:0 lds
buffer_load_dwordx4 v25, s[12:15], s48 offen offset:1056 lds
s_waitcnt vmcnt(26)
buffer_load_dwordx4 v26, s[12:15], s48 offen offset:2112 lds
buffer_load_dwordx4 v27, s[12:15], s48 offen offset:3168 lds
s_add_u32 m0, s40, 4224
s_add_u32 s48, s50, 65536
s_waitcnt vmcnt(26)
buffer_load_dwordx4 v24, s[12:15], s48 offen offset:0 lds
buffer_load_dwordx4 v25, s[12:15], s48 offen offset:1056 lds
s_waitcnt vmcnt(26)
buffer_load_dwordx4 v26, s[12:15], s48 offen offset:2112 lds
buffer_load_dwordx4 v27, s[12:15], s48 offen offset:3168 lds
s_add_u32 m0, s40, 8448
s_add_u32 s48, s50, 131072
s_waitcnt vmcnt(26)
buffer_load_dwordx4 v24, s[12:15], s48 offen offset:0 lds
buffer_load_dwordx4 v25, s[12:15], s48 offen offset:1056 lds
s_waitcnt vmcnt(26)
s_max_i32 s49, s49, 12
v_mov_b32 v12, s49
ds_write_b32 v8, v12
buffer_load_dwordx4 v26, s[12:15], s48 offen offset:2112 lds
buffer_load_dwordx4 v27, s[12:15], s48 offen offset:3168 lds
s_add_u32 m0, s40, 12672
s_add_u32 s48, s50, 196608
s_waitcnt vmcnt(26)
ds_read_b32 v13, v9
buffer_load_dwordx4 v24, s[12:15], s48 offen offset:0 lds
buffer_load_dwordx4 v25, s[12:15], s48 offen offset:1056 lds
s_waitcnt vmcnt(26)
buffer_load_dwordx4 v26, s[12:15], s48 offen offset:2112 lds
buffer_load_dwordx4 v27, s[12:15], s48 offen offset:3168 lds
s_add_u32 s38, s38, 1
s_add_u32 s40, s40, 16896
s_cmp_eq_u32 s40, 152064
s_cselect_b32 s40, 0, s40
s_add_u32 s50, s50, 524288
s_cmp_eq_u32 s50, 3670272
s_cselect_b32 s50, 256, s50
s_mov_b32 s48, 196608
s_waitcnt vmcnt(26)
buffer_load_dwordx4 a[64:67], v20, s[8:11], s48 offen offset:0 nt
buffer_load_dwordx4 a[68:71], v21, s[8:11], s48 offen offset:1056 nt
s_waitcnt vmcnt(26)
buffer_load_dwordx4 a[72:75], v22, s[8:11], s48 offen offset:2112 nt
buffer_load_dwordx4 a[76:79], v23, s[8:11], s48 offen offset:3168 nt
s_mov_b32 s48, 197120
s_waitcnt vmcnt(26)
buffer_load_dwordx4 a[80:83], v20, s[8:11], s48 offen offset:0 nt
buffer_load_dwordx4 a[84:87], v21, s[8:11], s48 offen offset:1056 nt
s_waitcnt vmcnt(26)
buffer_load_dwordx4 a[88:91], v22, s[8:11], s48 offen offset:2112 nt
buffer_load_dwordx4 a[92:95], v23, s[8:11], s48 offen offset:3168 nt
s_mov_b32 s48, 197632
s_waitcnt vmcnt(26)
buffer_load_dwordx4 a[96:99], v20, s[8:11], s48 offen offset:0 nt
buffer_load_dwordx4 a[100:103], v21, s[8:11], s48 offen offset:1056 nt
s_waitcnt vmcnt(26)
buffer_load_dwordx4 a[104:107], v22, s[8:11], s48 offen offset:2112 nt
buffer_load_dwordx4 a[108:111], v23, s[8:11], s48 offen offset:3168 nt
s_mov_b32 s48, 198144
s_waitcnt vmcnt(26)
buffer_load_dwordx4 a[112:115], v20, s[8:11], s48 offen offset:0 nt
buffer_load_dwordx4 a[116:119], v21, s[8:11], s48 offen offset:1056 nt
s_waitcnt vmcnt(26)
buffer_load_dwordx4 a[120:123], v22, s[8:11], s48 offen offset:2112 nt
buffer_load_dwordx4 a[124:127], v23, s[8:11], s48 offen offset:3168 nt
ds_read_b32 v13, v9
s_sub_i32 s43, s38, 8
s_waitcnt lgkmcnt(0)
v_cmp_gt_i32 vcc, s43, v13
s_cbranch_vccz L_lg161
s_call_b64 s[84:85], L_lfull
L_lg161:
s_add_u32 m0, s40, 0
s_add_u32 s48, s50, 0
s_waitcnt vmcnt(26)
buffer_load_dwordx4 v24, s[12:15], s48 offen offset:0 lds
buffer_load_dwordx4 v25, s[12:15], s48 offen offset:1056 lds
s_waitcnt vmcnt(26)
buffer_load_dwordx4 v26, s[12:15], s48 offen offset:2112 lds
buffer_load_dwordx4 v27, s[12:15], s48 offen offset:3168 lds
s_add_u32 m0, s40, 4224
s_add_u32 s48, s50, 65536
s_waitcnt vmcnt(26)
buffer_load_dwordx4 v24, s[12:15], s48 offen offset:0 lds
buffer_load_dwordx4 v25, s[12:15], s48 offen offset:1056 lds
s_waitcnt vmcnt(26)
buffer_load_dwordx4 v26, s[12:15], s48 offen offset:2112 lds
buffer_load_dwordx4 v27, s[12:15], s48 offen offset:3168 lds
s_add_u32 m0, s40, 8448
s_add_u32 s48, s50, 131072
s_waitcnt vmcnt(26)
buffer_load_dwordx4 v24, s[12:15], s48 offen offset:0 lds
buffer_load_dwordx4 v25, s[12:15], s48 offen offset:1056 lds
s_waitcnt vmcnt(26)
s_max_i32 s49, s49, 13
v_mov_b32 v12, s49
ds_write_b32 v8, v12
buffer_load_dwordx4 v26, s[12:15], s48 offen offset:2112 lds
buffer_load_dwordx4 v27, s[12:15], s48 offen offset:3168 lds
s_add_u32 m0, s40, 12672
s_add_u32 s48, s50, 196608
s_waitcnt vmcnt(26)
ds_read_b32 v13, v9
buffer_load_dwordx4 v24, s[12:15], s48 offen offset:0 lds
buffer_load_dwordx4 v25, s[12:15], s48 offen offset:1056 lds
s_waitcnt vmcnt(26)
buffer_load_dwordx4 v26, s[12:15], s48 offen offset:2112 lds
buffer_load_dwordx4 v27, s[12:15], s48 offen offset:3168 lds
s_add_u32 s38, s38, 1
s_add_u32 s40, s40, 16896
s_cmp_eq_u32 s40, 152064
s_cselect_b32 s40, 0, s40
s_add_u32 s50, s50, 524288
s_cmp_eq_u32 s50, 3670272
s_cselect_b32 s50, 256, s50
s_sub_i32 s43, s38, 8
s_waitcnt lgkmcnt(0)
v_cmp_gt_i32 vcc, s43, v13
s_cbranch_vccz L_lg162
s_call_b64 s[84:85], L_lfull
L_lg162:
s_add_u32 m0, s40, 0
s_add_u32 s48, s50, 0
s_waitcnt vmcnt(26)
buffer_load_dwordx4 v24, s[12:15], s48 offen offset:0 lds
buffer_load_dwordx4 v25, s[12:15], s48 offen offset:1056 lds
s_waitcnt vmcnt(26)
buffer_load_dwordx4 v26, s[12:15], s48 offen offset:2112 lds
buffer_load_dwordx4 v27, s[12:15], s48 offen offset:3168 lds
s_add_u32 m0, s40, 4224
s_add_u32 s48, s50, 65536
s_waitcnt vmcnt(26)
buffer_load_dwordx4 v24, s[12:15], s48 offen offset:0 lds
buffer_load_dwordx4 v25, s[12:15], s48 offen offset:1056 lds
s_waitcnt vmcnt(26)
buffer_load_dwordx4 v26, s[12:15], s48 offen offset:2112 lds
buffer_load_dwordx4 v27, s[12:15], s48 offen offset:3168 lds
s_add_u32 m0, s40, 8448
s_add_u32 s48, s50, 131072
s_waitcnt vmcnt(26)
buffer_load_dwordx4 v24, s[12:15], s48 offen offset:0 lds
buffer_load_dwordx4 v25, s[12:15], s48 offen offset:1056 lds
s_waitcnt vmcnt(26)
buffer_load_dwordx4 v26, s[12:15], s48 offen offset:2112 lds
buffer_load_dwordx4 v27, s[12:15], s48 offen offset:3168 lds
s_add_u32 m0, s40, 12672
s_add_u32 s48, s50, 196608
s_waitcnt vmcnt(26)
ds_read_b32 v13, v9
buffer_load_dwordx4 v24, s[12:15], s48 offen offset:0 lds
buffer_load_dwordx4 v25, s[12:15], s48 offen offset:1056 lds
s_waitcnt vmcnt(26)
buffer_load_dwordx4 v26, s[12:15], s48 offen offset:2112 lds
buffer_load_dwordx4 v27, s[12:15], s48 offen offset:3168 lds
s_add_u32 s38, s38, 1
s_add_u32 s40, s40, 16896
s_cmp_eq_u32 s40, 152064
s_cselect_b32 s40, 0, s40
s_add_u32 s50, s50, 524288
s_cmp_eq_u32 s50, 3670272
s_cselect_b32 s50, 256, s50
s_sub_i32 s43, s38, 8
s_waitcnt lgkmcnt(0)
v_cmp_gt_i32 vcc, s43, v13
s_cbranch_vccz L_lg163
s_call_b64 s[84:85], L_lfull
L_lg163:
s_add_u32 m0, s40, 0
s_add_u32 s48, s50, 0
s_waitcnt vmcnt(26)
buffer_load_dwordx4 v24, s[12:15], s48 offen offset:0 lds
buffer_load_dwordx4 v25, s[12:15], s48 offen offset:1056 lds
s_waitcnt vmcnt(26)
buffer_load_dwordx4 v26, s[12:15], s48 offen offset:2112 lds
buffer_load_dwordx4 v27, s[12:15], s48 offen offset:3168 lds
s_add_u32 m0, s40, 4224
s_add_u32 s48, s50, 65536
s_waitcnt vmcnt(26)
buffer_load_dwordx4 v24, s[12:15], s48 offen offset:0 lds
buffer_load_dwordx4 v25, s[12:15], s48 offen offset:1056 lds
s_waitcnt vmcnt(26)
buffer_load_dwordx4 v26, s[12:15], s48 offen offset:2112 lds
buffer_load_dwordx4 v27, s[12:15], s48 offen offset:3168 lds
s_add_u32 m0, s40, 8448
s_add_u32 s48, s50, 131072
s_waitcnt vmcnt(26)
buffer_load_dwordx4 v24, s[12:15], s48 offen offset:0 lds
buffer_load_dwordx4 v25, s[12:15], s48 offen offset:1056 lds
s_waitcnt vmcnt(26)
s_max_i32 s49, s49, 14
v_mov_b32 v12, s49
ds_write_b32 v8, v12
buffer_load_dwordx4 v26, s[12:15], s48 offen offset:2112 lds
buffer_load_dwordx4 v27, s[12:15], s48 offen offset:3168 lds
s_add_u32 m0, s40, 12672
s_add_u32 s48, s50, 196608
s_waitcnt vmcnt(26)
ds_read_b32 v13, v9
buffer_load_dwordx4 v24, s[12:15], s48 offen offset:0 lds
buffer_load_dwordx4 v25, s[12:15], s48 offen offset:1056 lds
s_waitcnt vmcnt(26)
buffer_load_dwordx4 v26, s[12:15], s48 offen offset:2112 lds
buffer_load_dwordx4 v27, s[12:15], s48 offen offset:3168 lds
s_add_u32 s38, s38, 1
s_add_u32 s40, s40, 16896
s_cmp_eq_u32 s40, 152064
s_cselect_b32 s40, 0, s40
s_add_u32 s50, s50, 524288
s_cmp_eq_u32 s50, 3670272
s_cselect_b32 s50, 256, s50
s_sub_i32 s43, s38, 8
s_waitcnt lgkmcnt(0)
v_cmp_gt_i32 vcc, s43, v13
s_cbranch_vccz L_lg164
s_call_b64 s[84:85], L_lfull
L_lg164:
s_add_u32 m0, s40, 0
s_add_u32 s48, s50, 0
s_waitcnt vmcnt(26)
buffer_load_dwordx4 v24, s[12:15], s48 offen offset:0 lds
buffer_load_dwordx4 v25, s[12:15], s48 offen offset:1056 lds
s_waitcnt vmcnt(26)
buffer_load_dwordx4 v26, s[12:15], s48 offen offset:2112 lds
buffer_load_dwordx4 v27, s[12:15], s48 offen offset:3168 lds
s_add_u32 m0, s40, 4224
s_add_u32 s48, s50, 65536
s_waitcnt vmcnt(26)
buffer_load_dwordx4 v24, s[12:15], s48 offen offset:0 lds
buffer_load_dwordx4 v25, s[12:15], s48 offen offset:1056 lds
s_waitcnt vmcnt(26)
buffer_load_dwordx4 v26, s[12:15], s48 offen offset:2112 lds
buffer_load_dwordx4 v27, s[12:15], s48 offen offset:3168 lds
s_add_u32 m0, s40, 8448
s_add_u32 s48, s50, 131072
s_waitcnt vmcnt(26)
buffer_load_dwordx4 v24, s[12:15], s48 offen offset:0 lds
buffer_load_dwordx4 v25, s[12:15], s48 offen offset:1056 lds
s_waitcnt vmcnt(26)
s_max_i32 s49, s49, 15
v_mov_b32 v12, s49
ds_write_b32 v8, v12
buffer_load_dwordx4 v26, s[12:15], s48 offen offset:2112 lds
buffer_load_dwordx4 v27, s[12:15], s48 offen offset:3168 lds
s_add_u32 m0, s40, 12672
s_add_u32 s48, s50, 196608
s_waitcnt vmcnt(26)
ds_read_b32 v13, v9
buffer_load_dwordx4 v24, s[12:15], s48 offen offset:0 lds
buffer_load_dwordx4 v25, s[12:15], s48 offen offset:1056 lds
s_waitcnt vmcnt(26)
buffer_load_dwordx4 v26, s[12:15], s48 offen offset:2112 lds
buffer_load_dwordx4 v27, s[12:15], s48 offen offset:3168 lds
s_add_u32 s38, s38, 1
s_add_u32 s40, s40, 16896
s_cmp_eq_u32 s40, 152064
s_cselect_b32 s40, 0, s40
s_add_u32 s50, s50, 524288
s_cmp_eq_u32 s50, 3670272
s_cselect_b32 s50, 256, s50
s_sub_i32 s43, s38, 8
s_waitcnt lgkmcnt(0)
v_cmp_gt_i32 vcc, s43, v13
s_cbranch_vccz L_lg165
s_call_b64 s[84:85], L_lfull
L_lg165:
s_add_u32 m0, s40, 0
s_add_u32 s48, s50, 0
s_waitcnt vmcnt(26)
buffer_load_dwordx4 v24, s[12:15], s48 offen offset:0 lds
buffer_load_dwordx4 v25, s[12:15], s48 offen offset:1056 lds
s_waitcnt vmcnt(26)
buffer_load_dwordx4 v26, s[12:15], s48 offen offset:2112 lds
buffer_load_dwordx4 v27, s[12:15], s48 offen offset:3168 lds
s_add_u32 m0, s40, 4224
s_add_u32 s48, s50, 65536
s_waitcnt vmcnt(26)
buffer_load_dwordx4 v24, s[12:15], s48 offen offset:0 lds
buffer_load_dwordx4 v25, s[12:15], s48 offen offset:1056 lds
s_waitcnt vmcnt(26)
buffer_load_dwordx4 v26, s[12:15], s48 offen offset:2112 lds
buffer_load_dwordx4 v27, s[12:15], s48 offen offset:3168 lds
s_add_u32 m0, s40, 8448
s_add_u32 s48, s50, 131072
s_waitcnt vmcnt(26)
buffer_load_dwordx4 v24, s[12:15], s48 offen offset:0 lds
buffer_load_dwordx4 v25, s[12:15], s48 offen offset:1056 lds
s_waitcnt vmcnt(26)
s_max_i32 s49, s49, 16
v_mov_b32 v12, s49
ds_write_b32 v8, v12
buffer_load_dwordx4 v26, s[12:15], s48 offen offset:2112 lds
buffer_load_dwordx4 v27, s[12:15], s48 offen offset:3168 lds
s_add_u32 m0, s40, 12672
s_add_u32 s48, s50, 196608
s_waitcnt vmcnt(26)
ds_read_b32 v13, v9
buffer_load_dwordx4 v24, s[12:15], s48 offen offset:0 lds
buffer_load_dwordx4 v25, s[12:15], s48 offen offset:1056 lds
s_waitcnt vmcnt(26)
buffer_load_dwordx4 v26, s[12:15], s48 offen offset:2112 lds
buffer_load_dwordx4 v27, s[12:15], s48 offen offset:3168 lds
s_add_u32 s38, s38, 1
s_add_u32 s40, s40, 16896
s_cmp_eq_u32 s40, 152064
s_cselect_b32 s40, 0, s40
s_add_u32 s50, s50, 524288
s_cmp_eq_u32 s50, 3670272
s_cselect_b32 s50, 256, s50
s_mov_b32 s50, 0
s_sub_i32 s43, s38, 8
s_waitcnt lgkmcnt(0)
v_cmp_gt_i32 vcc, s43, v13
s_cbranch_vccz L_lg166
s_call_b64 s[84:85], L_lfull
L_lg166:
s_add_u32 m0, s40, 0
s_add_u32 s48, s50, 0
s_waitcnt vmcnt(30)
buffer_load_dwordx4 v20, s[96:99], s48 offen offset:0 nt lds
buffer_load_dwordx4 v21, s[96:99], s48 offen offset:1056 nt lds
s_waitcnt vmcnt(30)
buffer_load_dwordx4 v22, s[96:99], s48 offen offset:2112 nt lds
buffer_load_dwordx4 v23, s[96:99], s48 offen offset:3168 nt lds
s_add_u32 m0, s40, 4224
s_add_u32 s48, s50, 512
s_waitcnt vmcnt(30)
buffer_load_dwordx4 v20, s[96:99], s48 offen offset:0 nt lds
buffer_load_dwordx4 v21, s[96:99], s48 offen offset:1056 nt lds
s_waitcnt vmcnt(30)
buffer_load_dwordx4 v22, s[96:99], s48 offen offset:2112 nt lds
buffer_load_dwordx4 v23, s[96:99], s48 offen offset:3168 nt lds
s_add_u32 m0, s40, 8448
s_add_u32 s48, s50, 1024
s_waitcnt vmcnt(30)
buffer_load_dwordx4 v20, s[96:99], s48 offen offset:0 nt lds
buffer_load_dwordx4 v21, s[96:99], s48 offen offset:1056 nt lds
s_waitcnt vmcnt(30)
buffer_load_dwordx4 v22, s[96:99], s48 offen offset:2112 nt lds
buffer_load_dwordx4 v23, s[96:99], s48 offen offset:3168 nt lds
s_add_u32 m0, s40, 12672
s_add_u32 s48, s50, 1536
s_waitcnt vmcnt(30)
ds_read_b32 v13, v9
buffer_load_dwordx4 v20, s[96:99], s48 offen offset:0 nt lds
buffer_load_dwordx4 v21, s[96:99], s48 offen offset:1056 nt lds
s_waitcnt vmcnt(30)
s_max_i32 s49, s49, 17
v_mov_b32 v12, s49
ds_write_b32 v8, v12
buffer_load_dwordx4 v22, s[96:99], s48 offen offset:2112 nt lds
buffer_load_dwordx4 v23, s[96:99], s48 offen offset:3168 nt lds
s_add_u32 s38, s38, 1
s_add_u32 s40, s40, 16896
s_cmp_eq_u32 s40, 152064
s_cselect_b32 s40, 0, s40
s_sub_i32 s43, s38, 8
s_waitcnt lgkmcnt(0)
v_cmp_gt_i32 vcc, s43, v13
s_cbranch_vccz L_lg167
s_call_b64 s[84:85], L_lfull
L_lg167:
s_add_u32 m0, s40, 0
s_add_u32 s48, s50, 0
s_waitcnt vmcnt(30)
buffer_load_dwordx4 v20, s[4:7], s48 offen offset:0 nt lds
buffer_load_dwordx4 v21, s[4:7], s48 offen offset:1056 nt lds
s_waitcnt vmcnt(30)
buffer_load_dwordx4 v22, s[4:7], s48 offen offset:2112 nt lds
buffer_load_dwordx4 v23, s[4:7], s48 offen offset:3168 nt lds
s_add_u32 m0, s40, 4224
s_add_u32 s48, s50, 512
s_waitcnt vmcnt(30)
buffer_load_dwordx4 v20, s[4:7], s48 offen offset:0 nt lds
buffer_load_dwordx4 v21, s[4:7], s48 offen offset:1056 nt lds
s_waitcnt vmcnt(30)
buffer_load_dwordx4 v22, s[4:7], s48 offen offset:2112 nt lds
buffer_load_dwordx4 v23, s[4:7], s48 offen offset:3168 nt lds
s_add_u32 m0, s40, 8448
s_add_u32 s48, s50, 1024
s_waitcnt vmcnt(30)
buffer_load_dwordx4 v20, s[4:7], s48 offen offset:0 nt lds
buffer_load_dwordx4 v21, s[4:7], s48 offen offset:1056 nt lds
s_waitcnt vmcnt(30)
buffer_load_dwordx4 v22, s[4:7], s48 offen offset:2112 nt lds
buffer_load_dwordx4 v23, s[4:7], s48 offen offset:3168 nt lds
s_add_u32 m0, s40, 12672
s_add_u32 s48, s50, 1536
s_waitcnt vmcnt(30)
ds_read_b32 v13, v9
buffer_load_dwordx4 v20, s[4:7], s48 offen offset:0 nt lds
buffer_load_dwordx4 v21, s[4:7], s48 offen offset:1056 nt lds
s_waitcnt vmcnt(30)
s_max_i32 s49, s49, 18
v_mov_b32 v12, s49
ds_write_b32 v8, v12
buffer_load_dwordx4 v22, s[4:7], s48 offen offset:2112 nt lds
buffer_load_dwordx4 v23, s[4:7], s48 offen offset:3168 nt lds
s_add_u32 s38, s38, 1
s_add_u32 s40, s40, 16896
s_cmp_eq_u32 s40, 152064
s_cselect_b32 s40, 0, s40
s_sub_i32 s43, s38, 8
s_waitcnt lgkmcnt(0)
v_cmp_gt_i32 vcc, s43, v13
s_cbranch_vccz L_lg168
s_call_b64 s[84:85], L_lfull
L_lg168:
s_add_u32 m0, s40, 0
s_add_u32 s48, s50, 16384
s_waitcnt vmcnt(30)
buffer_load_dwordx4 v20, s[4:7], s48 offen offset:0 nt lds
buffer_load_dwordx4 v21, s[4:7], s48 offen offset:1056 nt lds
s_waitcnt vmcnt(30)
buffer_load_dwordx4 v22, s[4:7], s48 offen offset:2112 nt lds
buffer_load_dwordx4 v23, s[4:7], s48 offen offset:3168 nt lds
s_add_u32 m0, s40, 4224
s_add_u32 s48, s50, 16896
s_waitcnt vmcnt(30)
buffer_load_dwordx4 v20, s[4:7], s48 offen offset:0 nt lds
buffer_load_dwordx4 v21, s[4:7], s48 offen offset:1056 nt lds
s_waitcnt vmcnt(30)
buffer_load_dwordx4 v22, s[4:7], s48 offen offset:2112 nt lds
buffer_load_dwordx4 v23, s[4:7], s48 offen offset:3168 nt lds
s_add_u32 m0, s40, 8448
s_add_u32 s48, s50, 17408
s_waitcnt vmcnt(30)
buffer_load_dwordx4 v20, s[4:7], s48 offen offset:0 nt lds
buffer_load_dwordx4 v21, s[4:7], s48 offen offset:1056 nt lds
s_waitcnt vmcnt(30)
buffer_load_dwordx4 v22, s[4:7], s48 offen offset:2112 nt lds
buffer_load_dwordx4 v23, s[4:7], s48 offen offset:3168 nt lds
s_add_u32 m0, s40, 12672
s_add_u32 s48, s50, 17920
s_waitcnt vmcnt(30)
ds_read_b32 v13, v9
buffer_load_dwordx4 v20, s[4:7], s48 offen offset:0 nt lds
buffer_load_dwordx4 v21, s[4:7], s48 offen offset:1056 nt lds
s_waitcnt vmcnt(30)
s_max_i32 s49, s49, 19
v_mov_b32 v12, s49
ds_write_b32 v8, v12
buffer_load_dwordx4 v22, s[4:7], s48 offen offset:2112 nt lds
buffer_load_dwordx4 v23, s[4:7], s48 offen offset:3168 nt lds
s_add_u32 s38, s38, 1
s_add_u32 s40, s40, 16896
s_cmp_eq_u32 s40, 152064
s_cselect_b32 s40, 0, s40
s_sub_i32 s43, s38, 8
s_waitcnt lgkmcnt(0)
v_cmp_gt_i32 vcc, s43, v13
s_cbranch_vccz L_lg169
s_call_b64 s[84:85], L_lfull
L_lg169:
s_add_u32 m0, s40, 0
s_add_u32 s48, s50, 0
s_waitcnt vmcnt(30)
buffer_load_dwordx4 v20, s[8:11], s48 offen offset:0 nt lds
buffer_load_dwordx4 v21, s[8:11], s48 offen offset:1056 nt lds
s_waitcnt vmcnt(30)
buffer_load_dwordx4 v22, s[8:11], s48 offen offset:2112 nt lds
buffer_load_dwordx4 v23, s[8:11], s48 offen offset:3168 nt lds
s_add_u32 m0, s40, 4224
s_add_u32 s48, s50, 512
s_waitcnt vmcnt(30)
buffer_load_dwordx4 v20, s[8:11], s48 offen offset:0 nt lds
buffer_load_dwordx4 v21, s[8:11], s48 offen offset:1056 nt lds
s_waitcnt vmcnt(30)
buffer_load_dwordx4 v22, s[8:11], s48 offen offset:2112 nt lds
buffer_load_dwordx4 v23, s[8:11], s48 offen offset:3168 nt lds
s_add_u32 m0, s40, 8448
s_add_u32 s48, s50, 1024
s_waitcnt vmcnt(30)
buffer_load_dwordx4 v20, s[8:11], s48 offen offset:0 nt lds
buffer_load_dwordx4 v21, s[8:11], s48 offen offset:1056 nt lds
s_waitcnt vmcnt(30)
buffer_load_dwordx4 v22, s[8:11], s48 offen offset:2112 nt lds
buffer_load_dwordx4 v23, s[8:11], s48 offen offset:3168 nt lds
s_add_u32 m0, s40, 12672
s_add_u32 s48, s50, 1536
s_waitcnt vmcnt(30)
ds_read_b32 v13, v9
buffer_load_dwordx4 v20, s[8:11], s48 offen offset:0 nt lds
buffer_load_dwordx4 v21, s[8:11], s48 offen offset:1056 nt lds
s_waitcnt vmcnt(30)
s_max_i32 s49, s49, 20
v_mov_b32 v12, s49
ds_write_b32 v8, v12
buffer_load_dwordx4 v22, s[8:11], s48 offen offset:2112 nt lds
buffer_load_dwordx4 v23, s[8:11], s48 offen offset:3168 nt lds
s_add_u32 s38, s38, 1
s_add_u32 s40, s40, 16896
s_cmp_eq_u32 s40, 152064
s_cselect_b32 s40, 0, s40
s_add_u32 s50, s50, 16384
s_sub_i32 s43, s38, 8
s_waitcnt lgkmcnt(0)
v_cmp_gt_i32 vcc, s43, v13
s_cbranch_vccz L_lg170
s_call_b64 s[84:85], L_lfull
L_lg170:
s_add_u32 m0, s40, 0
s_add_u32 s48, s50, 16384
s_waitcnt vmcnt(30)
buffer_load_dwordx4 v20, s[4:7], s48 offen offset:0 nt lds
buffer_load_dwordx4 v21, s[4:7], s48 offen offset:1056 nt lds
s_waitcnt vmcnt(30)
buffer_load_dwordx4 v22, s[4:7], s48 offen offset:2112 nt lds
buffer_load_dwordx4 v23, s[4:7], s48 offen offset:3168 nt lds
s_add_u32 m0, s40, 4224
s_add_u32 s48, s50, 16896
s_waitcnt vmcnt(30)
buffer_load_dwordx4 v20, s[4:7], s48 offen offset:0 nt lds
buffer_load_dwordx4 v21, s[4:7], s48 offen offset:1056 nt lds
s_waitcnt vmcnt(30)
buffer_load_dwordx4 v22, s[4:7], s48 offen offset:2112 nt lds
buffer_load_dwordx4 v23, s[4:7], s48 offen offset:3168 nt lds
s_add_u32 m0, s40, 8448
s_add_u32 s48, s50, 17408
s_waitcnt vmcnt(30)
buffer_load_dwordx4 v20, s[4:7], s48 offen offset:0 nt lds
buffer_load_dwordx4 v21, s[4:7], s48 offen offset:1056 nt lds
s_waitcnt vmcnt(30)
buffer_load_dwordx4 v22, s[4:7], s48 offen offset:2112 nt lds
buffer_load_dwordx4 v23, s[4:7], s48 offen offset:3168 nt lds
s_add_u32 m0, s40, 12672
s_add_u32 s48, s50, 17920
s_waitcnt vmcnt(30)
ds_read_b32 v13, v9
buffer_load_dwordx4 v20, s[4:7], s48 offen offset:0 nt lds
buffer_load_dwordx4 v21, s[4:7], s48 offen offset:1056 nt lds
s_waitcnt vmcnt(30)
s_max_i32 s49, s49, 21
v_mov_b32 v12, s49
ds_write_b32 v8, v12
buffer_load_dwordx4 v22, s[4:7], s48 offen offset:2112 nt lds
buffer_load_dwordx4 v23, s[4:7], s48 offen offset:3168 nt lds
s_add_u32 s38, s38, 1
s_add_u32 s40, s40, 16896
s_cmp_eq_u32 s40, 152064
s_cselect_b32 s40, 0, s40
s_sub_i32 s43, s38, 8
s_waitcnt lgkmcnt(0)
v_cmp_gt_i32 vcc, s43, v13
s_cbranch_vccz L_lg171
s_call_b64 s[84:85], L_lfull
L_lg171:
s_add_u32 m0, s40, 0
s_add_u32 s48, s50, 0
s_waitcnt vmcnt(30)
buffer_load_dwordx4 v20, s[8:11], s48 offen offset:0 nt lds
buffer_load_dwordx4 v21, s[8:11], s48 offen offset:1056 nt lds
s_waitcnt vmcnt(30)
buffer_load_dwordx4 v22, s[8:11], s48 offen offset:2112 nt lds
buffer_load_dwordx4 v23, s[8:11], s48 offen offset:3168 nt lds
s_add_u32 m0, s40, 4224
s_add_u32 s48, s50, 512
s_waitcnt vmcnt(30)
buffer_load_dwordx4 v20, s[8:11], s48 offen offset:0 nt lds
buffer_load_dwordx4 v21, s[8:11], s48 offen offset:1056 nt lds
s_waitcnt vmcnt(30)
buffer_load_dwordx4 v22, s[8:11], s48 offen offset:2112 nt lds
buffer_load_dwordx4 v23, s[8:11], s48 offen offset:3168 nt lds
s_add_u32 m0, s40, 8448
s_add_u32 s48, s50, 1024
s_waitcnt vmcnt(30)
buffer_load_dwordx4 v20, s[8:11], s48 offen offset:0 nt lds
buffer_load_dwordx4 v21, s[8:11], s48 offen offset:1056 nt lds
s_waitcnt vmcnt(30)
buffer_load_dwordx4 v22, s[8:11], s48 offen offset:2112 nt lds
buffer_load_dwordx4 v23, s[8:11], s48 offen offset:3168 nt lds
s_add_u32 m0, s40, 12672
s_add_u32 s48, s50, 1536
s_waitcnt vmcnt(30)
ds_read_b32 v13, v9
buffer_load_dwordx4 v20, s[8:11], s48 offen offset:0 nt lds
buffer_load_dwordx4 v21, s[8:11], s48 offen offset:1056 nt lds
s_waitcnt vmcnt(30)
s_max_i32 s49, s49, 22
v_mov_b32 v12, s49
ds_write_b32 v8, v12
buffer_load_dwordx4 v22, s[8:11], s48 offen offset:2112 nt lds
buffer_load_dwordx4 v23, s[8:11], s48 offen offset:3168 nt lds
s_add_u32 s38, s38, 1
s_add_u32 s40, s40, 16896
s_cmp_eq_u32 s40, 152064
s_cselect_b32 s40, 0, s40
s_add_u32 s50, s50, 16384
s_sub_i32 s43, s38, 8
s_waitcnt lgkmcnt(0)
v_cmp_gt_i32 vcc, s43, v13
s_cbranch_vccz L_lg172
s_call_b64 s[84:85], L_lfull
L_lg172:
s_add_u32 m0, s40, 0
s_add_u32 s48, s50, 16384
s_waitcnt vmcnt(30)
buffer_load_dwordx4 v20, s[4:7], s48 offen offset:0 nt lds
buffer_load_dwordx4 v21, s[4:7], s48 offen offset:1056 nt lds
s_waitcnt vmcnt(30)
buffer_load_dwordx4 v22, s[4:7], s48 offen offset:2112 nt lds
buffer_load_dwordx4 v23, s[4:7], s48 offen offset:3168 nt lds
s_add_u32 m0, s40, 4224
s_add_u32 s48, s50, 16896
s_waitcnt vmcnt(30)
buffer_load_dwordx4 v20, s[4:7], s48 offen offset:0 nt lds
buffer_load_dwordx4 v21, s[4:7], s48 offen offset:1056 nt lds
s_waitcnt vmcnt(30)
buffer_load_dwordx4 v22, s[4:7], s48 offen offset:2112 nt lds
buffer_load_dwordx4 v23, s[4:7], s48 offen offset:3168 nt lds
s_add_u32 m0, s40, 8448
s_add_u32 s48, s50, 17408
s_waitcnt vmcnt(30)
buffer_load_dwordx4 v20, s[4:7], s48 offen offset:0 nt lds
buffer_load_dwordx4 v21, s[4:7], s48 offen offset:1056 nt lds
s_waitcnt vmcnt(30)
buffer_load_dwordx4 v22, s[4:7], s48 offen offset:2112 nt lds
buffer_load_dwordx4 v23, s[4:7], s48 offen offset:3168 nt lds
s_add_u32 m0, s40, 12672
s_add_u32 s48, s50, 17920
s_waitcnt vmcnt(30)
ds_read_b32 v13, v9
buffer_load_dwordx4 v20, s[4:7], s48 offen offset:0 nt lds
buffer_load_dwordx4 v21, s[4:7], s48 offen offset:1056 nt lds
s_waitcnt vmcnt(30)
s_max_i32 s49, s49, 23
v_mov_b32 v12, s49
ds_write_b32 v8, v12
buffer_load_dwordx4 v22, s[4:7], s48 offen offset:2112 nt lds
buffer_load_dwordx4 v23, s[4:7], s48 offen offset:3168 nt lds
s_add_u32 s38, s38, 1
s_add_u32 s40, s40, 16896
s_cmp_eq_u32 s40, 152064
s_cselect_b32 s40, 0, s40
s_sub_i32 s43, s38, 8
s_waitcnt lgkmcnt(0)
v_cmp_gt_i32 vcc, s43, v13
s_cbranch_vccz L_lg173
s_call_b64 s[84:85], L_lfull
L_lg173:
s_add_u32 m0, s40, 0
s_add_u32 s48, s50, 0
s_waitcnt vmcnt(30)
buffer_load_dwordx4 v20, s[8:11], s48 offen offset:0 nt lds
buffer_load_dwordx4 v21, s[8:11], s48 offen offset:1056 nt lds
s_waitcnt vmcnt(30)
buffer_load_dwordx4 v22, s[8:11], s48 offen offset:2112 nt lds
buffer_load_dwordx4 v23, s[8:11], s48 offen offset:3168 nt lds
s_add_u32 m0, s40, 4224
s_add_u32 s48, s50, 512
s_waitcnt vmcnt(30)
buffer_load_dwordx4 v20, s[8:11], s48 offen offset:0 nt lds
buffer_load_dwordx4 v21, s[8:11], s48 offen offset:1056 nt lds
s_waitcnt vmcnt(30)
buffer_load_dwordx4 v22, s[8:11], s48 offen offset:2112 nt lds
buffer_load_dwordx4 v23, s[8:11], s48 offen offset:3168 nt lds
s_add_u32 m0, s40, 8448
s_add_u32 s48, s50, 1024
s_waitcnt vmcnt(30)
buffer_load_dwordx4 v20, s[8:11], s48 offen offset:0 nt lds
buffer_load_dwordx4 v21, s[8:11], s48 offen offset:1056 nt lds
s_waitcnt vmcnt(30)
buffer_load_dwordx4 v22, s[8:11], s48 offen offset:2112 nt lds
buffer_load_dwordx4 v23, s[8:11], s48 offen offset:3168 nt lds
s_add_u32 m0, s40, 12672
s_add_u32 s48, s50, 1536
s_waitcnt vmcnt(30)
ds_read_b32 v13, v9
buffer_load_dwordx4 v20, s[8:11], s48 offen offset:0 nt lds
buffer_load_dwordx4 v21, s[8:11], s48 offen offset:1056 nt lds
s_waitcnt vmcnt(30)
s_max_i32 s49, s49, 24
v_mov_b32 v12, s49
ds_write_b32 v8, v12
buffer_load_dwordx4 v22, s[8:11], s48 offen offset:2112 nt lds
buffer_load_dwordx4 v23, s[8:11], s48 offen offset:3168 nt lds
s_add_u32 s38, s38, 1
s_add_u32 s40, s40, 16896
s_cmp_eq_u32 s40, 152064
s_cselect_b32 s40, 0, s40
s_add_u32 s50, s50, 16384
s_sub_i32 s43, s38, 8
s_waitcnt lgkmcnt(0)
v_cmp_gt_i32 vcc, s43, v13
s_cbranch_vccz L_lg174
s_call_b64 s[84:85], L_lfull
L_lg174:
s_add_u32 m0, s40, 0
s_add_u32 s48, s50, 16384
s_waitcnt vmcnt(30)
buffer_load_dwordx4 v20, s[4:7], s48 offen offset:0 nt lds
buffer_load_dwordx4 v21, s[4:7], s48 offen offset:1056 nt lds
s_waitcnt vmcnt(30)
buffer_load_dwordx4 v22, s[4:7], s48 offen offset:2112 nt lds
buffer_load_dwordx4 v23, s[4:7], s48 offen offset:3168 nt lds
s_add_u32 m0, s40, 4224
s_add_u32 s48, s50, 16896
s_waitcnt vmcnt(30)
buffer_load_dwordx4 v20, s[4:7], s48 offen offset:0 nt lds
buffer_load_dwordx4 v21, s[4:7], s48 offen offset:1056 nt lds
s_waitcnt vmcnt(30)
buffer_load_dwordx4 v22, s[4:7], s48 offen offset:2112 nt lds
buffer_load_dwordx4 v23, s[4:7], s48 offen offset:3168 nt lds
s_add_u32 m0, s40, 8448
s_add_u32 s48, s50, 17408
s_waitcnt vmcnt(30)
buffer_load_dwordx4 v20, s[4:7], s48 offen offset:0 nt lds
buffer_load_dwordx4 v21, s[4:7], s48 offen offset:1056 nt lds
s_waitcnt vmcnt(30)
buffer_load_dwordx4 v22, s[4:7], s48 offen offset:2112 nt lds
buffer_load_dwordx4 v23, s[4:7], s48 offen offset:3168 nt lds
s_add_u32 m0, s40, 12672
s_add_u32 s48, s50, 17920
s_waitcnt vmcnt(30)
ds_read_b32 v13, v9
buffer_load_dwordx4 v20, s[4:7], s48 offen offset:0 nt lds
buffer_load_dwordx4 v21, s[4:7], s48 offen offset:1056 nt lds
s_waitcnt vmcnt(30)
s_max_i32 s49, s49, 25
v_mov_b32 v12, s49
ds_write_b32 v8, v12
buffer_load_dwordx4 v22, s[4:7], s48 offen offset:2112 nt lds
buffer_load_dwordx4 v23, s[4:7], s48 offen offset:3168 nt lds
s_add_u32 s38, s38, 1
s_add_u32 s40, s40, 16896
s_cmp_eq_u32 s40, 152064
s_cselect_b32 s40, 0, s40
s_sub_i32 s43, s38, 8
s_waitcnt lgkmcnt(0)
v_cmp_gt_i32 vcc, s43, v13
s_cbranch_vccz L_lg175
s_call_b64 s[84:85], L_lfull
L_lg175:
s_add_u32 m0, s40, 0
s_add_u32 s48, s50, 0
s_waitcnt vmcnt(30)
buffer_load_dwordx4 v20, s[8:11], s48 offen offset:0 nt lds
buffer_load_dwordx4 v21, s[8:11], s48 offen offset:1056 nt lds
s_waitcnt vmcnt(30)
buffer_load_dwordx4 v22, s[8:11], s48 offen offset:2112 nt lds
buffer_load_dwordx4 v23, s[8:11], s48 offen offset:3168 nt lds
s_add_u32 m0, s40, 4224
s_add_u32 s48, s50, 512
s_waitcnt vmcnt(30)
buffer_load_dwordx4 v20, s[8:11], s48 offen offset:0 nt lds
buffer_load_dwordx4 v21, s[8:11], s48 offen offset:1056 nt lds
s_waitcnt vmcnt(30)
buffer_load_dwordx4 v22, s[8:11], s48 offen offset:2112 nt lds
buffer_load_dwordx4 v23, s[8:11], s48 offen offset:3168 nt lds
s_add_u32 m0, s40, 8448
s_add_u32 s48, s50, 1024
s_waitcnt vmcnt(30)
buffer_load_dwordx4 v20, s[8:11], s48 offen offset:0 nt lds
buffer_load_dwordx4 v21, s[8:11], s48 offen offset:1056 nt lds
s_waitcnt vmcnt(30)
buffer_load_dwordx4 v22, s[8:11], s48 offen offset:2112 nt lds
buffer_load_dwordx4 v23, s[8:11], s48 offen offset:3168 nt lds
s_add_u32 m0, s40, 12672
s_add_u32 s48, s50, 1536
s_waitcnt vmcnt(30)
ds_read_b32 v13, v9
buffer_load_dwordx4 v20, s[8:11], s48 offen offset:0 nt lds
buffer_load_dwordx4 v21, s[8:11], s48 offen offset:1056 nt lds
s_waitcnt vmcnt(30)
s_max_i32 s49, s49, 26
v_mov_b32 v12, s49
ds_write_b32 v8, v12
buffer_load_dwordx4 v22, s[8:11], s48 offen offset:2112 nt lds
buffer_load_dwordx4 v23, s[8:11], s48 offen offset:3168 nt lds
s_add_u32 s38, s38, 1
s_add_u32 s40, s40, 16896
s_cmp_eq_u32 s40, 152064
s_cselect_b32 s40, 0, s40
s_add_u32 s50, s50, 16384
s_sub_i32 s43, s38, 8
s_waitcnt lgkmcnt(0)
v_cmp_gt_i32 vcc, s43, v13
s_cbranch_vccz L_lg176
s_call_b64 s[84:85], L_lfull
L_lg176:
s_add_u32 m0, s40, 0
s_add_u32 s48, s50, 16384
s_waitcnt vmcnt(22)
buffer_load_dwordx4 v20, s[4:7], s48 offen offset:0 nt lds
buffer_load_dwordx4 v21, s[4:7], s48 offen offset:1056 nt lds
s_waitcnt vmcnt(22)
buffer_load_dwordx4 v22, s[4:7], s48 offen offset:2112 nt lds
buffer_load_dwordx4 v23, s[4:7], s48 offen offset:3168 nt lds
s_add_u32 m0, s40, 4224
s_add_u32 s48, s50, 16896
s_waitcnt vmcnt(22)
buffer_load_dwordx4 v20, s[4:7], s48 offen offset:0 nt lds
buffer_load_dwordx4 v21, s[4:7], s48 offen offset:1056 nt lds
s_waitcnt vmcnt(22)
s_sub_i32 s42, s38, 1
s_max_i32 s49, s49, s42
v_mov_b32 v12, s49
ds_write_b32 v8, v12
buffer_load_dwordx4 v22, s[4:7], s48 offen offset:2112 nt lds
buffer_load_dwordx4 v23, s[4:7], s48 offen offset:3168 nt lds
s_add_u32 m0, s40, 8448
s_add_u32 s48, s50, 17408
s_waitcnt vmcnt(22)
buffer_load_dwordx4 v20, s[4:7], s48 offen offset:0 nt lds
buffer_load_dwordx4 v21, s[4:7], s48 offen offset:1056 nt lds
s_waitcnt vmcnt(22)
buffer_load_dwordx4 v22, s[4:7], s48 offen offset:2112 nt lds
buffer_load_dwordx4 v23, s[4:7], s48 offen offset:3168 nt lds
s_add_u32 m0, s40, 12672
s_add_u32 s48, s50, 17920
s_waitcnt vmcnt(22)
ds_read_b32 v13, v9
buffer_load_dwordx4 v20, s[4:7], s48 offen offset:0 nt lds
buffer_load_dwordx4 v21, s[4:7], s48 offen offset:1056 nt lds
s_waitcnt vmcnt(22)
buffer_load_dwordx4 v22, s[4:7], s48 offen offset:2112 nt lds
buffer_load_dwordx4 v23, s[4:7], s48 offen offset:3168 nt lds
s_add_u32 s38, s38, 1
s_add_u32 s40, s40, 16896
s_cmp_eq_u32 s40, 152064
s_cselect_b32 s40, 0, s40
s_waitcnt vmcnt(32)
s_sub_i32 s43, s38, 8
s_waitcnt lgkmcnt(0)
v_cmp_gt_i32 vcc, s43, v13
s_cbranch_vccz L_lg177
s_call_b64 s[84:85], L_lfull
L_lg177:
v_add_u32 v16, s40, v15
ds_write_b128 v16, v[32:35] offset:0
ds_write_b128 v16, v[36:39] offset:1056
ds_write_b128 v16, v[40:43] offset:2112
ds_write_b128 v16, v[44:47] offset:3168
ds_write_b128 v16, v[48:51] offset:4224
ds_write_b128 v16, v[52:55] offset:5280
ds_write_b128 v16, v[56:59] offset:6336
ds_write_b128 v16, v[60:63] offset:7392
s_waitcnt lgkmcnt(4)
ds_write_b128 v16, v[64:67] offset:8448
ds_write_b128 v16, v[68:71] offset:9504
ds_write_b128 v16, v[72:75] offset:10560
ds_write_b128 v16, v[76:79] offset:11616
ds_write_b128 v16, v[80:83] offset:12672
ds_write_b128 v16, v[84:87] offset:13728
ds_write_b128 v16, v[88:91] offset:14784
ds_write_b128 v16, v[92:95] offset:15840
s_waitcnt lgkmcnt(4)
ds_read_b32 v13, v9
s_add_u32 s38, s38, 1
s_add_u32 s40, s40, 16896
s_cmp_eq_u32 s40, 152064
s_cselect_b32 s40, 0, s40
s_add_u32 s50, s50, 16384
s_sub_i32 s43, s38, 8
s_waitcnt lgkmcnt(0)
v_cmp_gt_i32 vcc, s43, v13
s_cbranch_vccz L_lg178
s_call_b64 s[84:85], L_lfull
L_lg178:
s_add_u32 m0, s40, 0
s_add_u32 s48, s50, 16384
s_waitcnt vmcnt(22)
buffer_load_dwordx4 v20, s[4:7], s48 offen offset:0 nt lds
buffer_load_dwordx4 v21, s[4:7], s48 offen offset:1056 nt lds
s_waitcnt vmcnt(22)
buffer_load_dwordx4 v22, s[4:7], s48 offen offset:2112 nt lds
buffer_load_dwordx4 v23, s[4:7], s48 offen offset:3168 nt lds
s_add_u32 m0, s40, 4224
s_add_u32 s48, s50, 16896
s_waitcnt vmcnt(22)
buffer_load_dwordx4 v20, s[4:7], s48 offen offset:0 nt lds
buffer_load_dwordx4 v21, s[4:7], s48 offen offset:1056 nt lds
s_waitcnt vmcnt(22)
s_sub_i32 s42, s38, 2
s_max_i32 s49, s49, s42
v_mov_b32 v12, s49
ds_write_b32 v8, v12
buffer_load_dwordx4 v22, s[4:7], s48 offen offset:2112 nt lds
buffer_load_dwordx4 v23, s[4:7], s48 offen offset:3168 nt lds
s_add_u32 m0, s40, 8448
s_add_u32 s48, s50, 17408
s_waitcnt vmcnt(22)
buffer_load_dwordx4 v20, s[4:7], s48 offen offset:0 nt lds
buffer_load_dwordx4 v21, s[4:7], s48 offen offset:1056 nt lds
s_waitcnt vmcnt(22)
buffer_load_dwordx4 v22, s[4:7], s48 offen offset:2112 nt lds
buffer_load_dwordx4 v23, s[4:7], s48 offen offset:3168 nt lds
s_add_u32 m0, s40, 12672
s_add_u32 s48, s50, 17920
s_waitcnt vmcnt(22)
ds_read_b32 v13, v9
buffer_load_dwordx4 v20, s[4:7], s48 offen offset:0 nt lds
buffer_load_dwordx4 v21, s[4:7], s48 offen offset:1056 nt lds
s_waitcnt vmcnt(22)
buffer_load_dwordx4 v22, s[4:7], s48 offen offset:2112 nt lds
buffer_load_dwordx4 v23, s[4:7], s48 offen offset:3168 nt lds
s_add_u32 s38, s38, 1
s_add_u32 s40, s40, 16896
s_cmp_eq_u32 s40, 152064
s_cselect_b32 s40, 0, s40
s_sub_i32 s43, s38, 8
s_waitcnt lgkmcnt(0)
v_cmp_gt_i32 vcc, s43, v13
s_cbranch_vccz L_lg179
s_call_b64 s[84:85], L_lfull
L_lg179:
s_add_u32 m0, s40, 0
s_add_u32 s48, s50, 0
s_waitcnt vmcnt(22)
buffer_load_dwordx4 v20, s[8:11], s48 offen offset:0 nt lds
buffer_load_dwordx4 v21, s[8:11], s48 offen offset:1056 nt lds
s_waitcnt vmcnt(22)
buffer_load_dwordx4 v22, s[8:11], s48 offen offset:2112 nt lds
buffer_load_dwordx4 v23, s[8:11], s48 offen offset:3168 nt lds
s_add_u32 m0, s40, 4224
s_add_u32 s48, s50, 512
s_waitcnt vmcnt(22)
buffer_load_dwordx4 v20, s[8:11], s48 offen offset:0 nt lds
buffer_load_dwordx4 v21, s[8:11], s48 offen offset:1056 nt lds
s_waitcnt vmcnt(22)
s_sub_i32 s42, s38, 1
s_max_i32 s49, s49, s42
v_mov_b32 v12, s49
ds_write_b32 v8, v12
buffer_load_dwordx4 v22, s[8:11], s48 offen offset:2112 nt lds
buffer_load_dwordx4 v23, s[8:11], s48 offen offset:3168 nt lds
s_add_u32 m0, s40, 8448
s_add_u32 s48, s50, 1024
s_waitcnt vmcnt(22)
buffer_load_dwordx4 v20, s[8:11], s48 offen offset:0 nt lds
buffer_load_dwordx4 v21, s[8:11], s48 offen offset:1056 nt lds
s_waitcnt vmcnt(22)
buffer_load_dwordx4 v22, s[8:11], s48 offen offset:2112 nt lds
buffer_load_dwordx4 v23, s[8:11], s48 offen offset:3168 nt lds
s_add_u32 m0, s40, 12672
s_add_u32 s48, s50, 1536
s_waitcnt vmcnt(22)
ds_read_b32 v13, v9
buffer_load_dwordx4 v20, s[8:11], s48 offen offset:0 nt lds
buffer_load_dwordx4 v21, s[8:11], s48 offen offset:1056 nt lds
s_waitcnt vmcnt(22)
buffer_load_dwordx4 v22, s[8:11], s48 offen offset:2112 nt lds
buffer_load_dwordx4 v23, s[8:11], s48 offen offset:3168 nt lds
s_add_u32 s38, s38, 1
s_add_u32 s40, s40, 16896
s_cmp_eq_u32 s40, 152064
s_cselect_b32 s40, 0, s40
s_add_u32 s50, s50, 16384
s_sub_i32 s43, s38, 8
s_waitcnt lgkmcnt(0)
v_cmp_gt_i32 vcc, s43, v13
s_cbranch_vccz L_lg180
s_call_b64 s[84:85], L_lfull
L_lg180:
s_add_u32 m0, s40, 0
s_add_u32 s48, s50, 16384
s_waitcnt vmcnt(22)
buffer_load_dwordx4 v20, s[4:7], s48 offen offset:0 nt lds
buffer_load_dwordx4 v21, s[4:7], s48 offen offset:1056 nt lds
s_waitcnt vmcnt(22)
buffer_load_dwordx4 v22, s[4:7], s48 offen offset:2112 nt lds
buffer_load_dwordx4 v23, s[4:7], s48 offen offset:3168 nt lds
s_add_u32 m0, s40, 4224
s_add_u32 s48, s50, 16896
s_waitcnt vmcnt(22)
buffer_load_dwordx4 v20, s[4:7], s48 offen offset:0 nt lds
buffer_load_dwordx4 v21, s[4:7], s48 offen offset:1056 nt lds
s_waitcnt vmcnt(22)
s_sub_i32 s42, s38, 1
s_max_i32 s49, s49, s42
v_mov_b32 v12, s49
ds_write_b32 v8, v12
buffer_load_dwordx4 v22, s[4:7], s48 offen offset:2112 nt lds
buffer_load_dwordx4 v23, s[4:7], s48 offen offset:3168 nt lds
s_add_u32 m0, s40, 8448
s_add_u32 s48, s50, 17408
s_waitcnt vmcnt(22)
buffer_load_dwordx4 v20, s[4:7], s48 offen offset:0 nt lds
buffer_load_dwordx4 v21, s[4:7], s48 offen offset:1056 nt lds
s_waitcnt vmcnt(22)
buffer_load_dwordx4 v22, s[4:7], s48 offen offset:2112 nt lds
buffer_load_dwordx4 v23, s[4:7], s48 offen offset:3168 nt lds
s_add_u32 m0, s40, 12672
s_add_u32 s48, s50, 17920
s_waitcnt vmcnt(22)
ds_read_b32 v13, v9
buffer_load_dwordx4 v20, s[4:7], s48 offen offset:0 nt lds
buffer_load_dwordx4 v21, s[4:7], s48 offen offset:1056 nt lds
s_waitcnt vmcnt(22)
buffer_load_dwordx4 v22, s[4:7], s48 offen offset:2112 nt lds
buffer_load_dwordx4 v23, s[4:7], s48 offen offset:3168 nt lds
s_add_u32 s38, s38, 1
s_add_u32 s40, s40, 16896
s_cmp_eq_u32 s40, 152064
s_cselect_b32 s40, 0, s40
s_sub_i32 s43, s38, 8
s_waitcnt lgkmcnt(0)
v_cmp_gt_i32 vcc, s43, v13
s_cbranch_vccz L_lg181
s_call_b64 s[84:85], L_lfull
L_lg181:
v_add_u32 v16, s40, v15
ds_write_b128 v16, v[96:99] offset:0
ds_write_b128 v16, v[100:103] offset:1056
ds_write_b128 v16, v[104:107] offset:2112
ds_write_b128 v16, v[108:111] offset:3168
ds_write_b128 v16, v[112:115] offset:4224
ds_write_b128 v16, v[116:119] offset:5280
ds_write_b128 v16, v[120:123] offset:6336
ds_write_b128 v16, v[124:127] offset:7392
s_waitcnt lgkmcnt(4)
ds_write_b128 v16, v[128:131] offset:8448
ds_write_b128 v16, v[132:135] offset:9504
ds_write_b128 v16, v[136:139] offset:10560
ds_write_b128 v16, v[140:143] offset:11616
ds_write_b128 v16, v[144:147] offset:12672
ds_write_b128 v16, v[148:151] offset:13728
ds_write_b128 v16, v[152:155] offset:14784
ds_write_b128 v16, v[156:159] offset:15840
s_waitcnt lgkmcnt(4)
ds_read_b32 v13, v9
s_add_u32 s38, s38, 1
s_add_u32 s40, s40, 16896
s_cmp_eq_u32 s40, 152064
s_cselect_b32 s40, 0, s40
s_add_u32 s50, s50, 16384
s_sub_i32 s43, s38, 8
s_waitcnt lgkmcnt(0)
v_cmp_gt_i32 vcc, s43, v13
s_cbranch_vccz L_lg182
s_call_b64 s[84:85], L_lfull
L_lg182:
s_add_u32 m0, s40, 0
s_add_u32 s48, s50, 16384
s_waitcnt vmcnt(22)
buffer_load_dwordx4 v20, s[4:7], s48 offen offset:0 nt lds
buffer_load_dwordx4 v21, s[4:7], s48 offen offset:1056 nt lds
s_waitcnt vmcnt(22)
buffer_load_dwordx4 v22, s[4:7], s48 offen offset:2112 nt lds
buffer_load_dwordx4 v23, s[4:7], s48 offen offset:3168 nt lds
s_add_u32 m0, s40, 4224
s_add_u32 s48, s50, 16896
s_waitcnt vmcnt(22)
buffer_load_dwordx4 v20, s[4:7], s48 offen offset:0 nt lds
buffer_load_dwordx4 v21, s[4:7], s48 offen offset:1056 nt lds
s_waitcnt vmcnt(22)
s_sub_i32 s42, s38, 2
s_max_i32 s49, s49, s42
v_mov_b32 v12, s49
ds_write_b32 v8, v12
buffer_load_dwordx4 v22, s[4:7], s48 offen offset:2112 nt lds
buffer_load_dwordx4 v23, s[4:7], s48 offen offset:3168 nt lds
s_add_u32 m0, s40, 8448
s_add_u32 s48, s50, 17408
s_waitcnt vmcnt(22)
buffer_load_dwordx4 v20, s[4:7], s48 offen offset:0 nt lds
buffer_load_dwordx4 v21, s[4:7], s48 offen offset:1056 nt lds
s_waitcnt vmcnt(22)
buffer_load_dwordx4 v22, s[4:7], s48 offen offset:2112 nt lds
buffer_load_dwordx4 v23, s[4:7], s48 offen offset:3168 nt lds
s_add_u32 m0, s40, 12672
s_add_u32 s48, s50, 17920
s_waitcnt vmcnt(22)
ds_read_b32 v13, v9
buffer_load_dwordx4 v20, s[4:7], s48 offen offset:0 nt lds
buffer_load_dwordx4 v21, s[4:7], s48 offen offset:1056 nt lds
s_waitcnt vmcnt(22)
buffer_load_dwordx4 v22, s[4:7], s48 offen offset:2112 nt lds
buffer_load_dwordx4 v23, s[4:7], s48 offen offset:3168 nt lds
s_add_u32 s38, s38, 1
s_add_u32 s40, s40, 16896
s_cmp_eq_u32 s40, 152064
s_cselect_b32 s40, 0, s40
s_sub_i32 s43, s38, 8
s_waitcnt lgkmcnt(0)
v_cmp_gt_i32 vcc, s43, v13
s_cbranch_vccz L_lg183
s_call_b64 s[84:85], L_lfull
L_lg183:
s_add_u32 m0, s40, 0
s_add_u32 s48, s50, 0
s_waitcnt vmcnt(22)
buffer_load_dwordx4 v20, s[8:11], s48 offen offset:0 nt lds
buffer_load_dwordx4 v21, s[8:11], s48 offen offset:1056 nt lds
s_waitcnt vmcnt(22)
buffer_load_dwordx4 v22, s[8:11], s48 offen offset:2112 nt lds
buffer_load_dwordx4 v23, s[8:11], s48 offen offset:3168 nt lds
s_add_u32 m0, s40, 4224
s_add_u32 s48, s50, 512
s_waitcnt vmcnt(22)
buffer_load_dwordx4 v20, s[8:11], s48 offen offset:0 nt lds
buffer_load_dwordx4 v21, s[8:11], s48 offen offset:1056 nt lds
s_waitcnt vmcnt(22)
s_sub_i32 s42, s38, 1
s_max_i32 s49, s49, s42
v_mov_b32 v12, s49
ds_write_b32 v8, v12
buffer_load_dwordx4 v22, s[8:11], s48 offen offset:2112 nt lds
buffer_load_dwordx4 v23, s[8:11], s48 offen offset:3168 nt lds
s_add_u32 m0, s40, 8448
s_add_u32 s48, s50, 1024
s_waitcnt vmcnt(22)
buffer_load_dwordx4 v20, s[8:11], s48 offen offset:0 nt lds
buffer_load_dwordx4 v21, s[8:11], s48 offen offset:1056 nt lds
s_waitcnt vmcnt(22)
buffer_load_dwordx4 v22, s[8:11], s48 offen offset:2112 nt lds
buffer_load_dwordx4 v23, s[8:11], s48 offen offset:3168 nt lds
s_add_u32 m0, s40, 12672
s_add_u32 s48, s50, 1536
s_waitcnt vmcnt(22)
ds_read_b32 v13, v9
buffer_load_dwordx4 v20, s[8:11], s48 offen offset:0 nt lds
buffer_load_dwordx4 v21, s[8:11], s48 offen offset:1056 nt lds
s_waitcnt vmcnt(22)
buffer_load_dwordx4 v22, s[8:11], s48 offen offset:2112 nt lds
buffer_load_dwordx4 v23, s[8:11], s48 offen offset:3168 nt lds
s_add_u32 s38, s38, 1
s_add_u32 s40, s40, 16896
s_cmp_eq_u32 s40, 152064
s_cselect_b32 s40, 0, s40
s_add_u32 s50, s50, 16384
s_sub_i32 s43, s38, 8
s_waitcnt lgkmcnt(0)
v_cmp_gt_i32 vcc, s43, v13
s_cbranch_vccz L_lg184
s_call_b64 s[84:85], L_lfull
L_lg184:
s_add_u32 m0, s40, 0
s_add_u32 s48, s50, 16384
s_waitcnt vmcnt(22)
buffer_load_dwordx4 v20, s[4:7], s48 offen offset:0 nt lds
buffer_load_dwordx4 v21, s[4:7], s48 offen offset:1056 nt lds
s_waitcnt vmcnt(22)
buffer_load_dwordx4 v22, s[4:7], s48 offen offset:2112 nt lds
buffer_load_dwordx4 v23, s[4:7], s48 offen offset:3168 nt lds
s_add_u32 m0, s40, 4224
s_add_u32 s48, s50, 16896
s_waitcnt vmcnt(22)
buffer_load_dwordx4 v20, s[4:7], s48 offen offset:0 nt lds
buffer_load_dwordx4 v21, s[4:7], s48 offen offset:1056 nt lds
s_waitcnt vmcnt(22)
s_sub_i32 s42, s38, 1
s_max_i32 s49, s49, s42
v_mov_b32 v12, s49
ds_write_b32 v8, v12
buffer_load_dwordx4 v22, s[4:7], s48 offen offset:2112 nt lds
buffer_load_dwordx4 v23, s[4:7], s48 offen offset:3168 nt lds
s_add_u32 m0, s40, 8448
s_add_u32 s48, s50, 17408
s_waitcnt vmcnt(22)
buffer_load_dwordx4 v20, s[4:7], s48 offen offset:0 nt lds
buffer_load_dwordx4 v21, s[4:7], s48 offen offset:1056 nt lds
s_waitcnt vmcnt(22)
buffer_load_dwordx4 v22, s[4:7], s48 offen offset:2112 nt lds
buffer_load_dwordx4 v23, s[4:7], s48 offen offset:3168 nt lds
s_add_u32 m0, s40, 12672
s_add_u32 s48, s50, 17920
s_waitcnt vmcnt(22)
ds_read_b32 v13, v9
buffer_load_dwordx4 v20, s[4:7], s48 offen offset:0 nt lds
buffer_load_dwordx4 v21, s[4:7], s48 offen offset:1056 nt lds
s_waitcnt vmcnt(22)
buffer_load_dwordx4 v22, s[4:7], s48 offen offset:2112 nt lds
buffer_load_dwordx4 v23, s[4:7], s48 offen offset:3168 nt lds
s_add_u32 s38, s38, 1
s_add_u32 s40, s40, 16896
s_cmp_eq_u32 s40, 152064
s_cselect_b32 s40, 0, s40
s_sub_i32 s43, s38, 8
s_waitcnt lgkmcnt(0)
v_cmp_gt_i32 vcc, s43, v13
s_cbranch_vccz L_lg185
s_call_b64 s[84:85], L_lfull
L_lg185:
v_add_u32 v16, s40, v15
ds_write_b128 v16, v[160:163] offset:0
ds_write_b128 v16, v[164:167] offset:1056
ds_write_b128 v16, v[168:171] offset:2112
ds_write_b128 v16, v[172:175] offset:3168
ds_write_b128 v16, v[176:179] offset:4224
ds_write_b128 v16, v[180:183] offset:5280
ds_write_b128 v16, v[184:187] offset:6336
ds_write_b128 v16, v[188:191] offset:7392
s_waitcnt lgkmcnt(4)
ds_write_b128 v16, v[192:195] offset:8448
ds_write_b128 v16, v[196:199] offset:9504
ds_write_b128 v16, v[200:203] offset:10560
ds_write_b128 v16, v[204:207] offset:11616
ds_write_b128 v16, v[208:211] offset:12672
ds_write_b128 v16, v[212:215] offset:13728
ds_write_b128 v16, v[216:219] offset:14784
ds_write_b128 v16, v[220:223] offset:15840
s_waitcnt lgkmcnt(4)
ds_read_b32 v13, v9
s_add_u32 s38, s38, 1
s_add_u32 s40, s40, 16896
s_cmp_eq_u32 s40, 152064
s_cselect_b32 s40, 0, s40
s_add_u32 s50, s50, 16384
s_sub_i32 s43, s38, 8
s_waitcnt lgkmcnt(0)
v_cmp_gt_i32 vcc, s43, v13
s_cbranch_vccz L_lg186
s_call_b64 s[84:85], L_lfull
L_lg186:
s_add_u32 m0, s40, 0
s_add_u32 s48, s50, 16384
s_waitcnt vmcnt(22)
buffer_load_dwordx4 v20, s[4:7], s48 offen offset:0 nt lds
buffer_load_dwordx4 v21, s[4:7], s48 offen offset:1056 nt lds
s_waitcnt vmcnt(22)
buffer_load_dwordx4 v22, s[4:7], s48 offen offset:2112 nt lds
buffer_load_dwordx4 v23, s[4:7], s48 offen offset:3168 nt lds
s_add_u32 m0, s40, 4224
s_add_u32 s48, s50, 16896
s_waitcnt vmcnt(22)
buffer_load_dwordx4 v20, s[4:7], s48 offen offset:0 nt lds
buffer_load_dwordx4 v21, s[4:7], s48 offen offset:1056 nt lds
s_waitcnt vmcnt(22)
s_sub_i32 s42, s38, 2
s_max_i32 s49, s49, s42
v_mov_b32 v12, s49
ds_write_b32 v8, v12
buffer_load_dwordx4 v22, s[4:7], s48 offen offset:2112 nt lds
buffer_load_dwordx4 v23, s[4:7], s48 offen offset:3168 nt lds
s_add_u32 m0, s40, 8448
s_add_u32 s48, s50, 17408
s_waitcnt vmcnt(22)
buffer_load_dwordx4 v20, s[4:7], s48 offen offset:0 nt lds
buffer_load_dwordx4 v21, s[4:7], s48 offen offset:1056 nt lds
s_waitcnt vmcnt(22)
buffer_load_dwordx4 v22, s[4:7], s48 offen offset:2112 nt lds
buffer_load_dwordx4 v23, s[4:7], s48 offen offset:3168 nt lds
s_add_u32 m0, s40, 12672
s_add_u32 s48, s50, 17920
s_waitcnt vmcnt(22)
ds_read_b32 v13, v9
buffer_load_dwordx4 v20, s[4:7], s48 offen offset:0 nt lds
buffer_load_dwordx4 v21, s[4:7], s48 offen offset:1056 nt lds
s_waitcnt vmcnt(22)
buffer_load_dwordx4 v22, s[4:7], s48 offen offset:2112 nt lds
buffer_load_dwordx4 v23, s[4:7], s48 offen offset:3168 nt lds
s_add_u32 s38, s38, 1
s_add_u32 s40, s40, 16896
s_cmp_eq_u32 s40, 152064
s_cselect_b32 s40, 0, s40
s_sub_i32 s43, s38, 8
s_waitcnt lgkmcnt(0)
v_cmp_gt_i32 vcc, s43, v13
s_cbranch_vccz L_lg187
s_call_b64 s[84:85], L_lfull
L_lg187:
s_add_u32 m0, s40, 0
s_add_u32 s48, s50, 0
s_waitcnt vmcnt(22)
buffer_load_dwordx4 v20, s[8:11], s48 offen offset:0 nt lds
buffer_load_dwordx4 v21, s[8:11], s48 offen offset:1056 nt lds
s_waitcnt vmcnt(22)
buffer_load_dwordx4 v22, s[8:11], s48 offen offset:2112 nt lds
buffer_load_dwordx4 v23, s[8:11], s48 offen offset:3168 nt lds
s_add_u32 m0, s40, 4224
s_add_u32 s48, s50, 512
s_waitcnt vmcnt(22)
buffer_load_dwordx4 v20, s[8:11], s48 offen offset:0 nt lds
buffer_load_dwordx4 v21, s[8:11], s48 offen offset:1056 nt lds
s_waitcnt vmcnt(22)
s_sub_i32 s42, s38, 1
s_max_i32 s49, s49, s42
v_mov_b32 v12, s49
ds_write_b32 v8, v12
buffer_load_dwordx4 v22, s[8:11], s48 offen offset:2112 nt lds
buffer_load_dwordx4 v23, s[8:11], s48 offen offset:3168 nt lds
s_add_u32 m0, s40, 8448
s_add_u32 s48, s50, 1024
s_waitcnt vmcnt(22)
buffer_load_dwordx4 v20, s[8:11], s48 offen offset:0 nt lds
buffer_load_dwordx4 v21, s[8:11], s48 offen offset:1056 nt lds
s_waitcnt vmcnt(22)
buffer_load_dwordx4 v22, s[8:11], s48 offen offset:2112 nt lds
buffer_load_dwordx4 v23, s[8:11], s48 offen offset:3168 nt lds
s_add_u32 m0, s40, 12672
s_add_u32 s48, s50, 1536
s_waitcnt vmcnt(22)
ds_read_b32 v13, v9
buffer_load_dwordx4 v20, s[8:11], s48 offen offset:0 nt lds
buffer_load_dwordx4 v21, s[8:11], s48 offen offset:1056 nt lds
s_waitcnt vmcnt(22)
buffer_load_dwordx4 v22, s[8:11], s48 offen offset:2112 nt lds
buffer_load_dwordx4 v23, s[8:11], s48 offen offset:3168 nt lds
s_add_u32 s38, s38, 1
s_add_u32 s40, s40, 16896
s_cmp_eq_u32 s40, 152064
s_cselect_b32 s40, 0, s40
s_add_u32 s50, s50, 16384
s_sub_i32 s43, s38, 8
s_waitcnt lgkmcnt(0)
v_cmp_gt_i32 vcc, s43, v13
s_cbranch_vccz L_lg188
s_call_b64 s[84:85], L_lfull
L_lg188:
s_add_u32 m0, s40, 0
s_add_u32 s48, s50, 16384
s_waitcnt vmcnt(22)
buffer_load_dwordx4 v20, s[4:7], s48 offen offset:0 nt lds
buffer_load_dwordx4 v21, s[4:7], s48 offen offset:1056 nt lds
s_waitcnt vmcnt(22)
buffer_load_dwordx4 v22, s[4:7], s48 offen offset:2112 nt lds
buffer_load_dwordx4 v23, s[4:7], s48 offen offset:3168 nt lds
s_add_u32 m0, s40, 4224
s_add_u32 s48, s50, 16896
s_waitcnt vmcnt(22)
buffer_load_dwordx4 v20, s[4:7], s48 offen offset:0 nt lds
buffer_load_dwordx4 v21, s[4:7], s48 offen offset:1056 nt lds
s_waitcnt vmcnt(22)
s_sub_i32 s42, s38, 1
s_max_i32 s49, s49, s42
v_mov_b32 v12, s49
ds_write_b32 v8, v12
buffer_load_dwordx4 v22, s[4:7], s48 offen offset:2112 nt lds
buffer_load_dwordx4 v23, s[4:7], s48 offen offset:3168 nt lds
s_add_u32 m0, s40, 8448
s_add_u32 s48, s50, 17408
s_waitcnt vmcnt(22)
buffer_load_dwordx4 v20, s[4:7], s48 offen offset:0 nt lds
buffer_load_dwordx4 v21, s[4:7], s48 offen offset:1056 nt lds
s_waitcnt vmcnt(22)
buffer_load_dwordx4 v22, s[4:7], s48 offen offset:2112 nt lds
buffer_load_dwordx4 v23, s[4:7], s48 offen offset:3168 nt lds
s_add_u32 m0, s40, 12672
s_add_u32 s48, s50, 17920
s_waitcnt vmcnt(22)
ds_read_b32 v13, v9
buffer_load_dwordx4 v20, s[4:7], s48 offen offset:0 nt lds
buffer_load_dwordx4 v21, s[4:7], s48 offen offset:1056 nt lds
s_waitcnt vmcnt(22)
buffer_load_dwordx4 v22, s[4:7], s48 offen offset:2112 nt lds
buffer_load_dwordx4 v23, s[4:7], s48 offen offset:3168 nt lds
s_add_u32 s38, s38, 1
s_add_u32 s40, s40, 16896
s_cmp_eq_u32 s40, 152064
s_cselect_b32 s40, 0, s40
s_sub_i32 s43, s38, 8
s_waitcnt lgkmcnt(0)
v_cmp_gt_i32 vcc, s43, v13
s_cbranch_vccz L_lg189
s_call_b64 s[84:85], L_lfull
L_lg189:
v_add_u32 v16, s40, v15
ds_write_b128 v16, a[0:3] offset:0
ds_write_b128 v16, a[4:7] offset:1056
ds_write_b128 v16, a[8:11] offset:2112
ds_write_b128 v16, a[12:15] offset:3168
ds_write_b128 v16, a[16:19] offset:4224
ds_write_b128 v16, a[20:23] offset:5280
ds_write_b128 v16, a[24:27] offset:6336
ds_write_b128 v16, a[28:31] offset:7392
s_waitcnt lgkmcnt(4)
ds_write_b128 v16, a[32:35] offset:8448
ds_write_b128 v16, a[36:39] offset:9504
ds_write_b128 v16, a[40:43] offset:10560
ds_write_b128 v16, a[44:47] offset:11616
ds_write_b128 v16, a[48:51] offset:12672
ds_write_b128 v16, a[52:55] offset:13728
ds_write_b128 v16, a[56:59] offset:14784
ds_write_b128 v16, a[60:63] offset:15840
s_waitcnt lgkmcnt(4)
ds_read_b32 v13, v9
s_add_u32 s38, s38, 1
s_add_u32 s40, s40, 16896
s_cmp_eq_u32 s40, 152064
s_cselect_b32 s40, 0, s40
s_add_u32 s50, s50, 16384
s_sub_i32 s43, s38, 8
s_waitcnt lgkmcnt(0)
v_cmp_gt_i32 vcc, s43, v13
s_cbranch_vccz L_lg190
s_call_b64 s[84:85], L_lfull
L_lg190:
s_add_u32 m0, s40, 0
s_add_u32 s48, s50, 16384
s_waitcnt vmcnt(22)
buffer_load_dwordx4 v20, s[4:7], s48 offen offset:0 nt lds
buffer_load_dwordx4 v21, s[4:7], s48 offen offset:1056 nt lds
s_waitcnt vmcnt(22)
buffer_load_dwordx4 v22, s[4:7], s48 offen offset:2112 nt lds
buffer_load_dwordx4 v23, s[4:7], s48 offen offset:3168 nt lds
s_add_u32 m0, s40, 4224
s_add_u32 s48, s50, 16896
s_waitcnt vmcnt(22)
buffer_load_dwordx4 v20, s[4:7], s48 offen offset:0 nt lds
buffer_load_dwordx4 v21, s[4:7], s48 offen offset:1056 nt lds
s_waitcnt vmcnt(22)
s_sub_i32 s42, s38, 2
s_max_i32 s49, s49, s42
v_mov_b32 v12, s49
ds_write_b32 v8, v12
buffer_load_dwordx4 v22, s[4:7], s48 offen offset:2112 nt lds
buffer_load_dwordx4 v23, s[4:7], s48 offen offset:3168 nt lds
s_add_u32 m0, s40, 8448
s_add_u32 s48, s50, 17408
s_waitcnt vmcnt(22)
buffer_load_dwordx4 v20, s[4:7], s48 offen offset:0 nt lds
buffer_load_dwordx4 v21, s[4:7], s48 offen offset:1056 nt lds
s_waitcnt vmcnt(22)
buffer_load_dwordx4 v22, s[4:7], s48 offen offset:2112 nt lds
buffer_load_dwordx4 v23, s[4:7], s48 offen offset:3168 nt lds
s_add_u32 m0, s40, 12672
s_add_u32 s48, s50, 17920
s_waitcnt vmcnt(22)
ds_read_b32 v13, v9
buffer_load_dwordx4 v20, s[4:7], s48 offen offset:0 nt lds
buffer_load_dwordx4 v21, s[4:7], s48 offen offset:1056 nt lds
s_waitcnt vmcnt(22)
buffer_load_dwordx4 v22, s[4:7], s48 offen offset:2112 nt lds
buffer_load_dwordx4 v23, s[4:7], s48 offen offset:3168 nt lds
s_add_u32 s38, s38, 1
s_add_u32 s40, s40, 16896
s_cmp_eq_u32 s40, 152064
s_cselect_b32 s40, 0, s40
s_sub_i32 s43, s38, 8
s_waitcnt lgkmcnt(0)
v_cmp_gt_i32 vcc, s43, v13
s_cbranch_vccz L_lg191
s_call_b64 s[84:85], L_lfull
L_lg191:
s_add_u32 m0, s40, 0
s_add_u32 s48, s50, 0
s_waitcnt vmcnt(22)
buffer_load_dwordx4 v20, s[8:11], s48 offen offset:0 nt lds
buffer_load_dwordx4 v21, s[8:11], s48 offen offset:1056 nt lds
s_waitcnt vmcnt(22)
buffer_load_dwordx4 v22, s[8:11], s48 offen offset:2112 nt lds
buffer_load_dwordx4 v23, s[8:11], s48 offen offset:3168 nt lds
s_add_u32 m0, s40, 4224
s_add_u32 s48, s50, 512
s_waitcnt vmcnt(22)
buffer_load_dwordx4 v20, s[8:11], s48 offen offset:0 nt lds
buffer_load_dwordx4 v21, s[8:11], s48 offen offset:1056 nt lds
s_waitcnt vmcnt(22)
s_sub_i32 s42, s38, 1
s_max_i32 s49, s49, s42
v_mov_b32 v12, s49
ds_write_b32 v8, v12
buffer_load_dwordx4 v22, s[8:11], s48 offen offset:2112 nt lds
buffer_load_dwordx4 v23, s[8:11], s48 offen offset:3168 nt lds
s_add_u32 m0, s40, 8448
s_add_u32 s48, s50, 1024
s_waitcnt vmcnt(22)
buffer_load_dwordx4 v20, s[8:11], s48 offen offset:0 nt lds
buffer_load_dwordx4 v21, s[8:11], s48 offen offset:1056 nt lds
s_waitcnt vmcnt(22)
buffer_load_dwordx4 v22, s[8:11], s48 offen offset:2112 nt lds
buffer_load_dwordx4 v23, s[8:11], s48 offen offset:3168 nt lds
s_add_u32 m0, s40, 12672
s_add_u32 s48, s50, 1536
s_waitcnt vmcnt(22)
ds_read_b32 v13, v9
buffer_load_dwordx4 v20, s[8:11], s48 offen offset:0 nt lds
buffer_load_dwordx4 v21, s[8:11], s48 offen offset:1056 nt lds
s_waitcnt vmcnt(22)
buffer_load_dwordx4 v22, s[8:11], s48 offen offset:2112 nt lds
buffer_load_dwordx4 v23, s[8:11], s48 offen offset:3168 nt lds
s_add_u32 s38, s38, 1
s_add_u32 s40, s40, 16896
s_cmp_eq_u32 s40, 152064
s_cselect_b32 s40, 0, s40
s_add_u32 s50, s50, 16384
s_sub_i32 s43, s38, 8
s_waitcnt lgkmcnt(0)
v_cmp_gt_i32 vcc, s43, v13
s_cbranch_vccz L_lg192
s_call_b64 s[84:85], L_lfull
L_lg192:
s_add_u32 m0, s40, 0
s_add_u32 s48, s50, 16384
s_waitcnt vmcnt(22)
buffer_load_dwordx4 v20, s[4:7], s48 offen offset:0 nt lds
buffer_load_dwordx4 v21, s[4:7], s48 offen offset:1056 nt lds
s_waitcnt vmcnt(22)
buffer_load_dwordx4 v22, s[4:7], s48 offen offset:2112 nt lds
buffer_load_dwordx4 v23, s[4:7], s48 offen offset:3168 nt lds
s_add_u32 m0, s40, 4224
s_add_u32 s48, s50, 16896
s_waitcnt vmcnt(22)
buffer_load_dwordx4 v20, s[4:7], s48 offen offset:0 nt lds
buffer_load_dwordx4 v21, s[4:7], s48 offen offset:1056 nt lds
s_waitcnt vmcnt(22)
s_sub_i32 s42, s38, 1
s_max_i32 s49, s49, s42
v_mov_b32 v12, s49
ds_write_b32 v8, v12
buffer_load_dwordx4 v22, s[4:7], s48 offen offset:2112 nt lds
buffer_load_dwordx4 v23, s[4:7], s48 offen offset:3168 nt lds
s_add_u32 m0, s40, 8448
s_add_u32 s48, s50, 17408
s_waitcnt vmcnt(22)
buffer_load_dwordx4 v20, s[4:7], s48 offen offset:0 nt lds
buffer_load_dwordx4 v21, s[4:7], s48 offen offset:1056 nt lds
s_waitcnt vmcnt(22)
buffer_load_dwordx4 v22, s[4:7], s48 offen offset:2112 nt lds
buffer_load_dwordx4 v23, s[4:7], s48 offen offset:3168 nt lds
s_add_u32 m0, s40, 12672
s_add_u32 s48, s50, 17920
s_waitcnt vmcnt(22)
ds_read_b32 v13, v9
buffer_load_dwordx4 v20, s[4:7], s48 offen offset:0 nt lds
buffer_load_dwordx4 v21, s[4:7], s48 offen offset:1056 nt lds
s_waitcnt vmcnt(22)
buffer_load_dwordx4 v22, s[4:7], s48 offen offset:2112 nt lds
buffer_load_dwordx4 v23, s[4:7], s48 offen offset:3168 nt lds
s_add_u32 s38, s38, 1
s_add_u32 s40, s40, 16896
s_cmp_eq_u32 s40, 152064
s_cselect_b32 s40, 0, s40
s_sub_i32 s43, s38, 8
s_waitcnt lgkmcnt(0)
v_cmp_gt_i32 vcc, s43, v13
s_cbranch_vccz L_lg193
s_call_b64 s[84:85], L_lfull
L_lg193:
v_add_u32 v16, s40, v15
ds_write_b128 v16, a[64:67] offset:0
ds_write_b128 v16, a[68:71] offset:1056
ds_write_b128 v16, a[72:75] offset:2112
ds_write_b128 v16, a[76:79] offset:3168
ds_write_b128 v16, a[80:83] offset:4224
ds_write_b128 v16, a[84:87] offset:5280
ds_write_b128 v16, a[88:91] offset:6336
ds_write_b128 v16, a[92:95] offset:7392
s_waitcnt lgkmcnt(4)
ds_write_b128 v16, a[96:99] offset:8448
ds_write_b128 v16, a[100:103] offset:9504
ds_write_b128 v16, a[104:107] offset:10560
ds_write_b128 v16, a[108:111] offset:11616
ds_write_b128 v16, a[112:115] offset:12672
ds_write_b128 v16, a[116:119] offset:13728
ds_write_b128 v16, a[120:123] offset:14784
ds_write_b128 v16, a[124:127] offset:15840
s_waitcnt lgkmcnt(4)
ds_read_b32 v13, v9
s_add_u32 s38, s38, 1
s_add_u32 s40, s40, 16896
s_cmp_eq_u32 s40, 152064
s_cselect_b32 s40, 0, s40
s_add_u32 s50, s50, 16384
s_sub_i32 s43, s38, 8
s_waitcnt lgkmcnt(0)
v_cmp_gt_i32 vcc, s43, v13
s_cbranch_vccz L_lg194
s_call_b64 s[84:85], L_lfull
L_lg194:
s_add_u32 m0, s40, 0
s_add_u32 s48, s50, 16384
s_waitcnt vmcnt(22)
buffer_load_dwordx4 v20, s[4:7], s48 offen offset:0 nt lds
buffer_load_dwordx4 v21, s[4:7], s48 offen offset:1056 nt lds
s_waitcnt vmcnt(22)
buffer_load_dwordx4 v22, s[4:7], s48 offen offset:2112 nt lds
buffer_load_dwordx4 v23, s[4:7], s48 offen offset:3168 nt lds
s_add_u32 m0, s40, 4224
s_add_u32 s48, s50, 16896
s_waitcnt vmcnt(22)
buffer_load_dwordx4 v20, s[4:7], s48 offen offset:0 nt lds
buffer_load_dwordx4 v21, s[4:7], s48 offen offset:1056 nt lds
s_waitcnt vmcnt(22)
s_sub_i32 s42, s38, 2
s_max_i32 s49, s49, s42
v_mov_b32 v12, s49
ds_write_b32 v8, v12
buffer_load_dwordx4 v22, s[4:7], s48 offen offset:2112 nt lds
buffer_load_dwordx4 v23, s[4:7], s48 offen offset:3168 nt lds
s_add_u32 m0, s40, 8448
s_add_u32 s48, s50, 17408
s_waitcnt vmcnt(22)
buffer_load_dwordx4 v20, s[4:7], s48 offen offset:0 nt lds
buffer_load_dwordx4 v21, s[4:7], s48 offen offset:1056 nt lds
s_waitcnt vmcnt(22)
buffer_load_dwordx4 v22, s[4:7], s48 offen offset:2112 nt lds
buffer_load_dwordx4 v23, s[4:7], s48 offen offset:3168 nt lds
s_add_u32 m0, s40, 12672
s_add_u32 s48, s50, 17920
s_waitcnt vmcnt(22)
ds_read_b32 v13, v9
buffer_load_dwordx4 v20, s[4:7], s48 offen offset:0 nt lds
buffer_load_dwordx4 v21, s[4:7], s48 offen offset:1056 nt lds
s_waitcnt vmcnt(22)
buffer_load_dwordx4 v22, s[4:7], s48 offen offset:2112 nt lds
buffer_load_dwordx4 v23, s[4:7], s48 offen offset:3168 nt lds
s_add_u32 s38, s38, 1
s_add_u32 s40, s40, 16896
s_cmp_eq_u32 s40, 152064
s_cselect_b32 s40, 0, s40
s_sub_i32 s43, s38, 8
s_waitcnt lgkmcnt(0)
v_cmp_gt_i32 vcc, s43, v13
s_cbranch_vccz L_lg195
s_call_b64 s[84:85], L_lfull
L_lg195:
s_add_u32 m0, s40, 0
s_add_u32 s48, s50, 0
s_waitcnt vmcnt(22)
buffer_load_dwordx4 v20, s[8:11], s48 offen offset:0 nt lds
buffer_load_dwordx4 v21, s[8:11], s48 offen offset:1056 nt lds
s_waitcnt vmcnt(22)
buffer_load_dwordx4 v22, s[8:11], s48 offen offset:2112 nt lds
buffer_load_dwordx4 v23, s[8:11], s48 offen offset:3168 nt lds
s_add_u32 m0, s40, 4224
s_add_u32 s48, s50, 512
s_waitcnt vmcnt(22)
buffer_load_dwordx4 v20, s[8:11], s48 offen offset:0 nt lds
buffer_load_dwordx4 v21, s[8:11], s48 offen offset:1056 nt lds
s_waitcnt vmcnt(22)
s_sub_i32 s42, s38, 1
s_max_i32 s49, s49, s42
v_mov_b32 v12, s49
ds_write_b32 v8, v12
buffer_load_dwordx4 v22, s[8:11], s48 offen offset:2112 nt lds
buffer_load_dwordx4 v23, s[8:11], s48 offen offset:3168 nt lds
s_add_u32 m0, s40, 8448
s_add_u32 s48, s50, 1024
s_waitcnt vmcnt(22)
buffer_load_dwordx4 v20, s[8:11], s48 offen offset:0 nt lds
buffer_load_dwordx4 v21, s[8:11], s48 offen offset:1056 nt lds
s_waitcnt vmcnt(22)
buffer_load_dwordx4 v22, s[8:11], s48 offen offset:2112 nt lds
buffer_load_dwordx4 v23, s[8:11], s48 offen offset:3168 nt lds
s_add_u32 m0, s40, 12672
s_add_u32 s48, s50, 1536
s_waitcnt vmcnt(22)
ds_read_b32 v13, v9
buffer_load_dwordx4 v20, s[8:11], s48 offen offset:0 nt lds
buffer_load_dwordx4 v21, s[8:11], s48 offen offset:1056 nt lds
s_waitcnt vmcnt(22)
buffer_load_dwordx4 v22, s[8:11], s48 offen offset:2112 nt lds
buffer_load_dwordx4 v23, s[8:11], s48 offen offset:3168 nt lds
s_add_u32 s38, s38, 1
s_add_u32 s40, s40, 16896
s_cmp_eq_u32 s40, 152064
s_cselect_b32 s40, 0, s40
s_add_u32 s50, s50, 16384
s_sub_i32 s43, s38, 8
s_waitcnt lgkmcnt(0)
v_cmp_gt_i32 vcc, s43, v13
s_cbranch_vccz L_lg196
s_call_b64 s[84:85], L_lfull
L_lg196:
s_add_u32 m0, s40, 0
s_add_u32 s48, s50, 16384
s_waitcnt vmcnt(22)
buffer_load_dwordx4 v20, s[4:7], s48 offen offset:0 nt lds
buffer_load_dwordx4 v21, s[4:7], s48 offen offset:1056 nt lds
s_waitcnt vmcnt(22)
buffer_load_dwordx4 v22, s[4:7], s48 offen offset:2112 nt lds
buffer_load_dwordx4 v23, s[4:7], s48 offen offset:3168 nt lds
s_add_u32 m0, s40, 4224
s_add_u32 s48, s50, 16896
s_waitcnt vmcnt(22)
buffer_load_dwordx4 v20, s[4:7], s48 offen offset:0 nt lds
buffer_load_dwordx4 v21, s[4:7], s48 offen offset:1056 nt lds
s_waitcnt vmcnt(22)
s_sub_i32 s42, s38, 1
s_max_i32 s49, s49, s42
v_mov_b32 v12, s49
ds_write_b32 v8, v12
buffer_load_dwordx4 v22, s[4:7], s48 offen offset:2112 nt lds
buffer_load_dwordx4 v23, s[4:7], s48 offen offset:3168 nt lds
s_add_u32 m0, s40, 8448
s_add_u32 s48, s50, 17408
s_waitcnt vmcnt(22)
buffer_load_dwordx4 v20, s[4:7], s48 offen offset:0 nt lds
buffer_load_dwordx4 v21, s[4:7], s48 offen offset:1056 nt lds
s_waitcnt vmcnt(22)
buffer_load_dwordx4 v22, s[4:7], s48 offen offset:2112 nt lds
buffer_load_dwordx4 v23, s[4:7], s48 offen offset:3168 nt lds
s_add_u32 m0, s40, 12672
s_add_u32 s48, s50, 17920
s_waitcnt vmcnt(22)
ds_read_b32 v13, v9
buffer_load_dwordx4 v20, s[4:7], s48 offen offset:0 nt lds
buffer_load_dwordx4 v21, s[4:7], s48 offen offset:1056 nt lds
s_waitcnt vmcnt(22)
buffer_load_dwordx4 v22, s[4:7], s48 offen offset:2112 nt lds
buffer_load_dwordx4 v23, s[4:7], s48 offen offset:3168 nt lds
s_add_u32 s38, s38, 1
s_add_u32 s40, s40, 16896
s_cmp_eq_u32 s40, 152064
s_cselect_b32 s40, 0, s40
s_sub_i32 s43, s38, 8
s_waitcnt lgkmcnt(0)
v_cmp_gt_i32 vcc, s43, v13
s_cbranch_vccz L_lg197
s_call_b64 s[84:85], L_lfull
L_lg197:
s_add_u32 m0, s40, 0
s_add_u32 s48, s50, 0
s_waitcnt vmcnt(22)
buffer_load_dwordx4 v20, s[8:11], s48 offen offset:0 nt lds
buffer_load_dwordx4 v21, s[8:11], s48 offen offset:1056 nt lds
s_waitcnt vmcnt(22)
buffer_load_dwordx4 v22, s[8:11], s48 offen offset:2112 nt lds
buffer_load_dwordx4 v23, s[8:11], s48 offen offset:3168 nt lds
s_add_u32 m0, s40, 4224
s_add_u32 s48, s50, 512
s_waitcnt vmcnt(22)
buffer_load_dwordx4 v20, s[8:11], s48 offen offset:0 nt lds
buffer_load_dwordx4 v21, s[8:11], s48 offen offset:1056 nt lds
s_waitcnt vmcnt(22)
s_sub_i32 s42, s38, 1
s_max_i32 s49, s49, s42
v_mov_b32 v12, s49
ds_write_b32 v8, v12
buffer_load_dwordx4 v22, s[8:11], s48 offen offset:2112 nt lds
buffer_load_dwordx4 v23, s[8:11], s48 offen offset:3168 nt lds
s_add_u32 m0, s40, 8448
s_add_u32 s48, s50, 1024
s_waitcnt vmcnt(22)
buffer_load_dwordx4 v20, s[8:11], s48 offen offset:0 nt lds
buffer_load_dwordx4 v21, s[8:11], s48 offen offset:1056 nt lds
s_waitcnt vmcnt(22)
buffer_load_dwordx4 v22, s[8:11], s48 offen offset:2112 nt lds
buffer_load_dwordx4 v23, s[8:11], s48 offen offset:3168 nt lds
s_add_u32 m0, s40, 12672
s_add_u32 s48, s50, 1536
s_waitcnt vmcnt(22)
ds_read_b32 v13, v9
buffer_load_dwordx4 v20, s[8:11], s48 offen offset:0 nt lds
buffer_load_dwordx4 v21, s[8:11], s48 offen offset:1056 nt lds
s_waitcnt vmcnt(22)
buffer_load_dwordx4 v22, s[8:11], s48 offen offset:2112 nt lds
buffer_load_dwordx4 v23, s[8:11], s48 offen offset:3168 nt lds
s_add_u32 s38, s38, 1
s_add_u32 s40, s40, 16896
s_cmp_eq_u32 s40, 152064
s_cselect_b32 s40, 0, s40
s_add_u32 s50, s50, 16384
L_lkvY0:
s_sub_i32 s43, s38, 8
s_waitcnt lgkmcnt(0)
v_cmp_gt_i32 vcc, s43, v13
s_cbranch_vccz L_lg198
s_call_b64 s[84:85], L_lfull
L_lg198:
s_add_u32 m0, s40, 0
s_add_u32 s48, s50, 16384
s_waitcnt vmcnt(22)
buffer_load_dwordx4 v20, s[4:7], s48 offen offset:0 nt lds
buffer_load_dwordx4 v21, s[4:7], s48 offen offset:1056 nt lds
s_waitcnt vmcnt(22)
buffer_load_dwordx4 v22, s[4:7], s48 offen offset:2112 nt lds
buffer_load_dwordx4 v23, s[4:7], s48 offen offset:3168 nt lds
s_add_u32 m0, s40, 4224
s_add_u32 s48, s50, 16896
s_waitcnt vmcnt(22)
buffer_load_dwordx4 v20, s[4:7], s48 offen offset:0 nt lds
buffer_load_dwordx4 v21, s[4:7], s48 offen offset:1056 nt lds
s_waitcnt vmcnt(22)
s_sub_i32 s42, s38, 1
s_max_i32 s49, s49, s42
v_mov_b32 v12, s49
ds_write_b32 v8, v12
buffer_load_dwordx4 v22, s[4:7], s48 offen offset:2112 nt lds
buffer_load_dwordx4 v23, s[4:7], s48 offen offset:3168 nt lds
s_add_u32 m0, s40, 8448
s_add_u32 s48, s50, 17408
s_waitcnt vmcnt(22)
buffer_load_dwordx4 v20, s[4:7], s48 offen offset:0 nt lds
buffer_load_dwordx4 v21, s[4:7], s48 offen offset:1056 nt lds
s_waitcnt vmcnt(22)
buffer_load_dwordx4 v22, s[4:7], s48 offen offset:2112 nt lds
buffer_load_dwordx4 v23, s[4:7], s48 offen offset:3168 nt lds
s_add_u32 m0, s40, 12672
s_add_u32 s48, s50, 17920
s_waitcnt vmcnt(22)
ds_read_b32 v13, v9
buffer_load_dwordx4 v20, s[4:7], s48 offen offset:0 nt lds
buffer_load_dwordx4 v21, s[4:7], s48 offen offset:1056 nt lds
s_waitcnt vmcnt(22)
buffer_load_dwordx4 v22, s[4:7], s48 offen offset:2112 nt lds
buffer_load_dwordx4 v23, s[4:7], s48 offen offset:3168 nt lds
s_add_u32 s38, s38, 1
s_add_u32 s40, s40, 16896
s_cmp_eq_u32 s40, 152064
s_cselect_b32 s40, 0, s40
s_sub_i32 s43, s38, 8
s_waitcnt lgkmcnt(0)
v_cmp_gt_i32 vcc, s43, v13
s_cbranch_vccz L_lg199
s_call_b64 s[84:85], L_lfull
L_lg199:
s_add_u32 m0, s40, 0
s_add_u32 s48, s50, 0
s_waitcnt vmcnt(22)
buffer_load_dwordx4 v20, s[8:11], s48 offen offset:0 nt lds
buffer_load_dwordx4 v21, s[8:11], s48 offen offset:1056 nt lds
s_waitcnt vmcnt(22)
buffer_load_dwordx4 v22, s[8:11], s48 offen offset:2112 nt lds
buffer_load_dwordx4 v23, s[8:11], s48 offen offset:3168 nt lds
s_add_u32 m0, s40, 4224
s_add_u32 s48, s50, 512
s_waitcnt vmcnt(22)
buffer_load_dwordx4 v20, s[8:11], s48 offen offset:0 nt lds
buffer_load_dwordx4 v21, s[8:11], s48 offen offset:1056 nt lds
s_waitcnt vmcnt(22)
s_sub_i32 s42, s38, 1
s_max_i32 s49, s49, s42
v_mov_b32 v12, s49
ds_write_b32 v8, v12
buffer_load_dwordx4 v22, s[8:11], s48 offen offset:2112 nt lds
buffer_load_dwordx4 v23, s[8:11], s48 offen offset:3168 nt lds
s_add_u32 m0, s40, 8448
s_add_u32 s48, s50, 1024
s_waitcnt vmcnt(22)
buffer_load_dwordx4 v20, s[8:11], s48 offen offset:0 nt lds
buffer_load_dwordx4 v21, s[8:11], s48 offen offset:1056 nt lds
s_waitcnt vmcnt(22)
buffer_load_dwordx4 v22, s[8:11], s48 offen offset:2112 nt lds
buffer_load_dwordx4 v23, s[8:11], s48 offen offset:3168 nt lds
s_add_u32 m0, s40, 12672
s_add_u32 s48, s50, 1536
s_waitcnt vmcnt(22)
ds_read_b32 v13, v9
buffer_load_dwordx4 v20, s[8:11], s48 offen offset:0 nt lds
buffer_load_dwordx4 v21, s[8:11], s48 offen offset:1056 nt lds
s_waitcnt vmcnt(22)
buffer_load_dwordx4 v22, s[8:11], s48 offen offset:2112 nt lds
buffer_load_dwordx4 v23, s[8:11], s48 offen offset:3168 nt lds
s_add_u32 s38, s38, 1
s_add_u32 s40, s40, 16896
s_cmp_eq_u32 s40, 152064
s_cselect_b32 s40, 0, s40
s_add_u32 s50, s50, 16384
s_cmp_lt_u32 s50, 475136
s_cbranch_scc1 L_lkvY0
L_lkvY1:
s_sub_i32 s43, s38, 8
s_waitcnt lgkmcnt(0)
v_cmp_gt_i32 vcc, s43, v13
s_cbranch_vccz L_lg200
s_call_b64 s[84:85], L_lfull
L_lg200:
s_add_u32 m0, s40, 0
s_add_u32 s48, s50, 16384
s_waitcnt vmcnt(30)
buffer_load_dwordx4 v20, s[4:7], s48 offen offset:0 nt lds
buffer_load_dwordx4 v21, s[4:7], s48 offen offset:1056 nt lds
s_waitcnt vmcnt(30)
buffer_load_dwordx4 v22, s[4:7], s48 offen offset:2112 nt lds
buffer_load_dwordx4 v23, s[4:7], s48 offen offset:3168 nt lds
s_add_u32 m0, s40, 4224
s_add_u32 s48, s50, 16896
s_waitcnt vmcnt(30)
buffer_load_dwordx4 v20, s[4:7], s48 offen offset:0 nt lds
buffer_load_dwordx4 v21, s[4:7], s48 offen offset:1056 nt lds
s_waitcnt vmcnt(30)
buffer_load_dwordx4 v22, s[4:7], s48 offen offset:2112 nt lds
buffer_load_dwordx4 v23, s[4:7], s48 offen offset:3168 nt lds
s_add_u32 m0, s40, 8448
s_add_u32 s48, s50, 17408
s_waitcnt vmcnt(30)
buffer_load_dwordx4 v20, s[4:7], s48 offen offset:0 nt lds
buffer_load_dwordx4 v21, s[4:7], s48 offen offset:1056 nt lds
s_waitcnt vmcnt(30)
buffer_load_dwordx4 v22, s[4:7], s48 offen offset:2112 nt lds
buffer_load_dwordx4 v23, s[4:7], s48 offen offset:3168 nt lds
s_add_u32 m0, s40, 12672
s_add_u32 s48, s50, 17920
s_waitcnt vmcnt(30)
ds_read_b32 v13, v9
buffer_load_dwordx4 v20, s[4:7], s48 offen offset:0 nt lds
buffer_load_dwordx4 v21, s[4:7], s48 offen offset:1056 nt lds
s_waitcnt vmcnt(30)
s_sub_i32 s42, s38, 1
s_max_i32 s49, s49, s42
v_mov_b32 v12, s49
ds_write_b32 v8, v12
buffer_load_dwordx4 v22, s[4:7], s48 offen offset:2112 nt lds
buffer_load_dwordx4 v23, s[4:7], s48 offen offset:3168 nt lds
s_add_u32 s38, s38, 1
s_add_u32 s40, s40, 16896
s_cmp_eq_u32 s40, 152064
s_cselect_b32 s40, 0, s40
s_sub_i32 s43, s38, 8
s_waitcnt lgkmcnt(0)
v_cmp_gt_i32 vcc, s43, v13
s_cbranch_vccz L_lg201
s_call_b64 s[84:85], L_lfull
L_lg201:
s_add_u32 m0, s40, 0
s_add_u32 s48, s50, 0
s_waitcnt vmcnt(30)
buffer_load_dwordx4 v20, s[8:11], s48 offen offset:0 nt lds
buffer_load_dwordx4 v21, s[8:11], s48 offen offset:1056 nt lds
s_waitcnt vmcnt(30)
buffer_load_dwordx4 v22, s[8:11], s48 offen offset:2112 nt lds
buffer_load_dwordx4 v23, s[8:11], s48 offen offset:3168 nt lds
s_add_u32 m0, s40, 4224
s_add_u32 s48, s50, 512
s_waitcnt vmcnt(30)
buffer_load_dwordx4 v20, s[8:11], s48 offen offset:0 nt lds
buffer_load_dwordx4 v21, s[8:11], s48 offen offset:1056 nt lds
s_waitcnt vmcnt(30)
buffer_load_dwordx4 v22, s[8:11], s48 offen offset:2112 nt lds
buffer_load_dwordx4 v23, s[8:11], s48 offen offset:3168 nt lds
s_add_u32 m0, s40, 8448
s_add_u32 s48, s50, 1024
s_waitcnt vmcnt(30)
buffer_load_dwordx4 v20, s[8:11], s48 offen offset:0 nt lds
buffer_load_dwordx4 v21, s[8:11], s48 offen offset:1056 nt lds
s_waitcnt vmcnt(30)
buffer_load_dwordx4 v22, s[8:11], s48 offen offset:2112 nt lds
buffer_load_dwordx4 v23, s[8:11], s48 offen offset:3168 nt lds
s_add_u32 m0, s40, 12672
s_add_u32 s48, s50, 1536
s_waitcnt vmcnt(30)
ds_read_b32 v13, v9
buffer_load_dwordx4 v20, s[8:11], s48 offen offset:0 nt lds
buffer_load_dwordx4 v21, s[8:11], s48 offen offset:1056 nt lds
s_waitcnt vmcnt(30)
s_sub_i32 s42, s38, 1
s_max_i32 s49, s49, s42
v_mov_b32 v12, s49
ds_write_b32 v8, v12
buffer_load_dwordx4 v22, s[8:11], s48 offen offset:2112 nt lds
buffer_load_dwordx4 v23, s[8:11], s48 offen offset:3168 nt lds
s_add_u32 s38, s38, 1
s_add_u32 s40, s40, 16896
s_cmp_eq_u32 s40, 152064
s_cselect_b32 s40, 0, s40
s_add_u32 s50, s50, 16384
s_cmp_lt_u32 s50, 540672
s_cbranch_scc1 L_lkvY1
s_sub_i32 s43, s38, 8
s_waitcnt lgkmcnt(0)
v_cmp_gt_i32 vcc, s43, v13
s_cbranch_vccz L_lg202
s_call_b64 s[84:85], L_lfull
L_lg202:
s_add_u32 m0, s40, 0
s_add_u32 s48, s50, 0
s_waitcnt vmcnt(30)
buffer_load_dwordx4 v20, s[8:11], s48 offen offset:0 nt lds
buffer_load_dwordx4 v21, s[8:11], s48 offen offset:1056 nt lds
s_waitcnt vmcnt(30)
buffer_load_dwordx4 v22, s[8:11], s48 offen offset:2112 nt lds
buffer_load_dwordx4 v23, s[8:11], s48 offen offset:3168 nt lds
s_add_u32 m0, s40, 4224
s_add_u32 s48, s50, 512
s_waitcnt vmcnt(30)
buffer_load_dwordx4 v20, s[8:11], s48 offen offset:0 nt lds
buffer_load_dwordx4 v21, s[8:11], s48 offen offset:1056 nt lds
s_waitcnt vmcnt(30)
buffer_load_dwordx4 v22, s[8:11], s48 offen offset:2112 nt lds
buffer_load_dwordx4 v23, s[8:11], s48 offen offset:3168 nt lds
s_add_u32 m0, s40, 8448
s_add_u32 s48, s50, 1024
s_waitcnt vmcnt(30)
buffer_load_dwordx4 v20, s[8:11], s48 offen offset:0 nt lds
buffer_load_dwordx4 v21, s[8:11], s48 offen offset:1056 nt lds
s_waitcnt vmcnt(30)
buffer_load_dwordx4 v22, s[8:11], s48 offen offset:2112 nt lds
buffer_load_dwordx4 v23, s[8:11], s48 offen offset:3168 nt lds
s_add_u32 m0, s40, 12672
s_add_u32 s48, s50, 1536
s_waitcnt vmcnt(30)
ds_read_b32 v13, v9
buffer_load_dwordx4 v20, s[8:11], s48 offen offset:0 nt lds
buffer_load_dwordx4 v21, s[8:11], s48 offen offset:1056 nt lds
s_waitcnt vmcnt(30)
s_sub_i32 s42, s38, 1
s_max_i32 s49, s49, s42
v_mov_b32 v12, s49
ds_write_b32 v8, v12
buffer_load_dwordx4 v22, s[8:11], s48 offen offset:2112 nt lds
buffer_load_dwordx4 v23, s[8:11], s48 offen offset:3168 nt lds
s_add_u32 s38, s38, 1
s_add_u32 s40, s40, 16896
s_cmp_eq_u32 s40, 152064
s_cselect_b32 s40, 0, s40
s_mov_b32 s45, 0
v_lshrrev_b32 v10, 5, v0
v_bfe_u32 v11, v0, 2, 3
v_mul_u32_u24 v28, 896, v11
v_lshl_add_u32 v28, v10, 6, v28
v_bfe_u32 v11, v0, 4, 1
v_lshlrev_b32 v11, 1, v11
v_and_b32 v12, 3, v0
v_xor_b32 v11, v11, v12
v_lshl_add_u32 v28, v11, 4, v28
v_add_u32 v29, 6144, v28
v_add_u32 v30, 12288, v28
v_add_u32 v31, 18432, v28
L_lo:
s_lshl_b32 s50, s45, 7
s_sub_i32 s43, s38, 8
s_waitcnt lgkmcnt(0)
v_cmp_gt_i32 vcc, s43, v13
s_cbranch_vccz L_lg203
s_call_b64 s[84:85], L_lfull
L_lg203:
s_add_u32 m0, s40, 0
s_add_u32 s48, s50, 0
s_waitcnt vmcnt(30)
buffer_load_dwordx4 v28, s[88:91], s48 offen offset:0 lds
buffer_load_dwordx4 v29, s[88:91], s48 offen offset:1024 lds
s_waitcnt vmcnt(30)
buffer_load_dwordx4 v30, s[88:91], s48 offen offset:2048 lds
buffer_load_dwordx4 v31, s[88:91], s48 offen offset:3072 lds
s_add_u32 m0, s40, 4096
s_add_u32 s48, s50, 28672
s_waitcnt vmcnt(30)
buffer_load_dwordx4 v28, s[88:91], s48 offen offset:0 lds
buffer_load_dwordx4 v29, s[88:91], s48 offen offset:1024 lds
s_waitcnt vmcnt(30)
buffer_load_dwordx4 v30, s[88:91], s48 offen offset:2048 lds
buffer_load_dwordx4 v31, s[88:91], s48 offen offset:3072 lds
s_add_u32 m0, s40, 8192
s_add_u32 s48, s50, 57344
s_waitcnt vmcnt(30)
buffer_load_dwordx4 v28, s[88:91], s48 offen offset:0 lds
buffer_load_dwordx4 v29, s[88:91], s48 offen offset:1024 lds
s_waitcnt vmcnt(30)
buffer_load_dwordx4 v30, s[88:91], s48 offen offset:2048 lds
buffer_load_dwordx4 v31, s[88:91], s48 offen offset:3072 lds
s_add_u32 m0, s40, 12288
s_add_u32 s48, s50, 86016
s_waitcnt vmcnt(30)
ds_read_b32 v13, v9
buffer_load_dwordx4 v28, s[88:91], s48 offen offset:0 lds
buffer_load_dwordx4 v29, s[88:91], s48 offen offset:1024 lds
s_waitcnt vmcnt(30)
s_sub_i32 s42, s38, 1
s_max_i32 s49, s49, s42
v_mov_b32 v12, s49
ds_write_b32 v8, v12
buffer_load_dwordx4 v30, s[88:91], s48 offen offset:2048 lds
buffer_load_dwordx4 v31, s[88:91], s48 offen offset:3072 lds
s_add_u32 s38, s38, 1
s_add_u32 s40, s40, 16896
s_cmp_eq_u32 s40, 152064
s_cselect_b32 s40, 0, s40
s_add_u32 s50, s50, 114688
s_sub_i32 s43, s38, 8
s_waitcnt lgkmcnt(0)
v_cmp_gt_i32 vcc, s43, v13
s_cbranch_vccz L_lg204
s_call_b64 s[84:85], L_lfull
L_lg204:
s_add_u32 m0, s40, 0
s_add_u32 s48, s50, 0
s_waitcnt vmcnt(30)
buffer_load_dwordx4 v28, s[88:91], s48 offen offset:0 lds
buffer_load_dwordx4 v29, s[88:91], s48 offen offset:1024 lds
s_waitcnt vmcnt(30)
buffer_load_dwordx4 v30, s[88:91], s48 offen offset:2048 lds
buffer_load_dwordx4 v31, s[88:91], s48 offen offset:3072 lds
s_add_u32 m0, s40, 4096
s_add_u32 s48, s50, 28672
s_waitcnt vmcnt(30)
buffer_load_dwordx4 v28, s[88:91], s48 offen offset:0 lds
buffer_load_dwordx4 v29, s[88:91], s48 offen offset:1024 lds
s_waitcnt vmcnt(30)
buffer_load_dwordx4 v30, s[88:91], s48 offen offset:2048 lds
buffer_load_dwordx4 v31, s[88:91], s48 offen offset:3072 lds
s_add_u32 m0, s40, 8192
s_add_u32 s48, s50, 57344
s_waitcnt vmcnt(30)
buffer_load_dwordx4 v28, s[88:91], s48 offen offset:0 lds
buffer_load_dwordx4 v29, s[88:91], s48 offen offset:1024 lds
s_waitcnt vmcnt(30)
buffer_load_dwordx4 v30, s[88:91], s48 offen offset:2048 lds
buffer_load_dwordx4 v31, s[88:91], s48 offen offset:3072 lds
s_add_u32 m0, s40, 12288
s_add_u32 s48, s50, 86016
s_waitcnt vmcnt(30)
ds_read_b32 v13, v9
buffer_load_dwordx4 v28, s[88:91], s48 offen offset:0 lds
buffer_load_dwordx4 v29, s[88:91], s48 offen offset:1024 lds
s_waitcnt vmcnt(30)
s_sub_i32 s42, s38, 1
s_max_i32 s49, s49, s42
v_mov_b32 v12, s49
ds_write_b32 v8, v12
buffer_load_dwordx4 v30, s[88:91], s48 offen offset:2048 lds
buffer_load_dwordx4 v31, s[88:91], s48 offen offset:3072 lds
s_add_u32 s38, s38, 1
s_add_u32 s40, s40, 16896
s_cmp_eq_u32 s40, 152064
s_cselect_b32 s40, 0, s40
s_add_u32 s45, s45, 1
s_cmp_lt_u32 s45, 7
s_cbranch_scc1 L_lo
s_waitcnt vmcnt(16)
s_sub_i32 s42, s38, 1
s_max_i32 s49, s49, s42
v_mov_b32 v12, s49
ds_write_b32 v8, v12
s_waitcnt vmcnt(0)
s_sub_i32 s42, s38, 0
s_max_i32 s49, s49, s42
v_mov_b32 v12, s49
ds_write_b32 v8, v12
s_waitcnt lgkmcnt(0)
s_endpgm
L_poll3:
ds_read_b32 v11, v9
s_waitcnt lgkmcnt(0)
v_readfirstlane_b32 s39, v11
s_nop 0
s_cmp_ge_u32 s39, s38
s_cbranch_scc1 L_ret4
s_sleep 1
s_add_u32 s53, s53, 1
s_cmp_lt_u32 s53, 1048576
s_cbranch_scc1 L_poll3
s_endpgm
L_poll5:
ds_read_b32 v11, v9
s_waitcnt lgkmcnt(0)
v_readfirstlane_b32 s39, v11
s_nop 0
s_cmp_ge_u32 s39, s38
s_cbranch_scc1 L_ret6
s_sleep 1
s_add_u32 s53, s53, 1
s_cmp_lt_u32 s53, 1048576
s_cbranch_scc1 L_poll5
s_endpgm
L_poll7:
ds_read_b32 v11, v9
s_waitcnt lgkmcnt(0)
v_readfirstlane_b32 s39, v11
s_nop 0
s_cmp_ge_u32 s39, s38
s_cbranch_scc1 L_ret8
s_sleep 1
s_add_u32 s53, s53, 1
s_cmp_lt_u32 s53, 1048576
s_cbranch_scc1 L_poll7
s_endpgm
L_poll9:
ds_read_b32 v11, v9
s_waitcnt lgkmcnt(0)
v_readfirstlane_b32 s39, v11
s_nop 0
s_cmp_ge_u32 s39, s38
s_cbranch_scc1 L_ret10
s_sleep 1
s_add_u32 s53, s53, 1
s_cmp_lt_u32 s53, 1048576
s_cbranch_scc1 L_poll9
s_endpgm
L_poll11:
ds_read_b32 v11, v9
s_waitcnt lgkmcnt(0)
v_readfirstlane_b32 s39, v11
s_nop 0
s_cmp_ge_u32 s39, s38
s_cbranch_scc1 L_ret12
s_sleep 1
s_add_u32 s53, s53, 1
s_cmp_lt_u32 s53, 1048576
s_cbranch_scc1 L_poll11
s_endpgm
L_poll13:
ds_read_b32 v11, v9
s_waitcnt lgkmcnt(0)
v_readfirstlane_b32 s39, v11
s_nop 0
s_cmp_ge_u32 s39, s38
s_cbranch_scc1 L_ret14
s_sleep 1
s_add_u32 s53, s53, 1
s_cmp_lt_u32 s53, 1048576
s_cbranch_scc1 L_poll13
s_endpgm
L_poll15:
ds_read_b32 v11, v9
s_waitcnt lgkmcnt(0)
v_readfirstlane_b32 s39, v11
s_nop 0
s_cmp_ge_u32 s39, s38
s_cbranch_scc1 L_ret16
s_sleep 1
s_add_u32 s53, s53, 1
s_cmp_lt_u32 s53, 1048576
s_cbranch_scc1 L_poll15
s_endpgm
L_poll17:
ds_read_b32 v11, v9
s_waitcnt lgkmcnt(0)
v_readfirstlane_b32 s39, v11
s_nop 0
s_cmp_ge_u32 s39, s38
s_cbranch_scc1 L_ret18
s_sleep 1
s_add_u32 s53, s53, 1
s_cmp_lt_u32 s53, 1048576
s_cbranch_scc1 L_poll17
s_endpgm
L_poll19:
ds_read_b32 v11, v9
s_waitcnt lgkmcnt(0)
v_readfirstlane_b32 s39, v11
s_nop 0
s_cmp_ge_u32 s39, s38
s_cbranch_scc1 L_ret20
s_sleep 1
s_add_u32 s53, s53, 1
s_cmp_lt_u32 s53, 1048576
s_cbranch_scc1 L_poll19
s_endpgm
L_poll21:
ds_read_b32 v11, v9
s_waitcnt lgkmcnt(0)
v_readfirstlane_b32 s39, v11
s_nop 0
s_cmp_ge_u32 s39, s38
s_cbranch_scc1 L_ret22
s_sleep 1
s_add_u32 s53, s53, 1
s_cmp_lt_u32 s53, 1048576
s_cbranch_scc1 L_poll21
s_endpgm
L_poll23:
ds_read_b32 v11, v9
s_waitcnt lgkmcnt(0)
v_readfirstlane_b32 s39, v11
s_nop 0
s_cmp_ge_u32 s39, s38
s_cbranch_scc1 L_ret24
s_sleep 1
s_add_u32 s53, s53, 1
s_cmp_lt_u32 s53, 1048576
s_cbranch_scc1 L_poll23
s_endpgm
L_poll25:
ds_read_b32 v11, v9
s_waitcnt lgkmcnt(0)
v_readfirstlane_b32 s39, v11
s_nop 0
s_cmp_ge_u32 s39, s38
s_cbranch_scc1 L_ret26
s_sleep 1
s_add_u32 s53, s53, 1
s_cmp_lt_u32 s53, 1048576
s_cbranch_scc1 L_poll25
s_endpgm
L_poll27:
ds_read_b32 v11, v9
s_waitcnt lgkmcnt(0)
v_readfirstlane_b32 s39, v11
s_nop 0
s_cmp_ge_u32 s39, s38
s_cbranch_scc1 L_ret28
s_sleep 1
s_add_u32 s53, s53, 1
s_cmp_lt_u32 s53, 1048576
s_cbranch_scc1 L_poll27
s_endpgm
L_poll29:
ds_read_b32 v11, v9
s_waitcnt lgkmcnt(0)
v_readfirstlane_b32 s39, v11
s_nop 0
s_cmp_ge_u32 s39, s38
s_cbranch_scc1 L_ret30
s_sleep 1
s_add_u32 s53, s53, 1
s_cmp_lt_u32 s53, 1048576
s_cbranch_scc1 L_poll29
s_endpgm
L_poll31:
ds_read_b32 v11, v9
s_waitcnt lgkmcnt(0)
v_readfirstlane_b32 s39, v11
s_nop 0
s_cmp_ge_u32 s39, s38
s_cbranch_scc1 L_ret32
s_sleep 1
s_add_u32 s53, s53, 1
s_cmp_lt_u32 s53, 1048576
s_cbranch_scc1 L_poll31
s_endpgm
L_poll33:
ds_read_b32 v11, v9
s_waitcnt lgkmcnt(0)
v_readfirstlane_b32 s39, v11
s_nop 0
s_cmp_ge_u32 s39, s38
s_cbranch_scc1 L_ret34
s_sleep 1
s_add_u32 s53, s53, 1
s_cmp_lt_u32 s53, 1048576
s_cbranch_scc1 L_poll33
s_endpgm
L_poll35:
ds_read_b32 v11, v9
s_waitcnt lgkmcnt(0)
v_readfirstlane_b32 s39, v11
s_nop 0
s_cmp_ge_u32 s39, s38
s_cbranch_scc1 L_ret36
s_sleep 1
s_add_u32 s53, s53, 1
s_cmp_lt_u32 s53, 1048576
s_cbranch_scc1 L_poll35
s_endpgm
L_slow_0_1:
s_nop 15
v_max3_f32 v22, v128, v129, v130
v_max3_f32 v22, v22, v131, v140
v_max3_f32 v22, v22, v141, v142
v_max_f32 v22, v22, v143
v_mov_b32 v23, v22
s_nop 1
v_permlane32_swap_b32 v23, v22
s_nop 1
v_max_f32 v22, v22, v23
v_mov_b32 v23, v22
s_nop 1
v_permlane16_swap_b32 v23, v22
s_nop 1
v_max_f32 v22, v22, v23
v_max_f32 v22, 0, v22
v_sub_f32 v128, v128, v22
v_sub_f32 v152, v152, v22
v_sub_f32 v129, v129, v22
v_sub_f32 v153, v153, v22
v_sub_f32 v130, v130, v22
v_sub_f32 v154, v154, v22
v_sub_f32 v131, v131, v22
v_sub_f32 v155, v155, v22
v_sub_f32 v140, v140, v22
v_sub_f32 v164, v164, v22
v_sub_f32 v141, v141, v22
v_sub_f32 v165, v165, v22
v_sub_f32 v142, v142, v22
v_sub_f32 v166, v166, v22
v_sub_f32 v143, v143, v22
v_sub_f32 v167, v167, v22
v_sub_f32 v224, v224, v22
v_sub_f32 v225, v225, v22
v_sub_f32 v226, v226, v22
v_sub_f32 v227, v227, v22
v_sub_f32 v23, 0, v22
v_exp_f32 v23, v23
s_nop 0
v_mul_f32 v19, v19, v23
v_accvgpr_read_b32 v12, a0
v_accvgpr_read_b32 v13, a1
v_accvgpr_read_b32 v14, a2
v_accvgpr_read_b32 v15, a3
v_mul_f32 v12, v12, v23
v_mul_f32 v13, v13, v23
v_mul_f32 v14, v14, v23
v_mul_f32 v15, v15, v23
v_accvgpr_write_b32 a0, v12
v_accvgpr_write_b32 a1, v13
v_accvgpr_write_b32 a2, v14
v_accvgpr_write_b32 a3, v15
v_accvgpr_read_b32 v12, a12
v_accvgpr_read_b32 v13, a13
v_accvgpr_read_b32 v14, a14
v_accvgpr_read_b32 v15, a15
v_mul_f32 v12, v12, v23
v_mul_f32 v13, v13, v23
v_mul_f32 v14, v14, v23
v_mul_f32 v15, v15, v23
v_accvgpr_write_b32 a12, v12
v_accvgpr_write_b32 a13, v13
v_accvgpr_write_b32 a14, v14
v_accvgpr_write_b32 a15, v15
v_accvgpr_read_b32 v12, a24
v_accvgpr_read_b32 v13, a25
v_accvgpr_read_b32 v14, a26
v_accvgpr_read_b32 v15, a27
v_mul_f32 v12, v12, v23
v_mul_f32 v13, v13, v23
v_mul_f32 v14, v14, v23
v_mul_f32 v15, v15, v23
v_accvgpr_write_b32 a24, v12
v_accvgpr_write_b32 a25, v13
v_accvgpr_write_b32 a26, v14
v_accvgpr_write_b32 a27, v15
v_accvgpr_read_b32 v12, a36
v_accvgpr_read_b32 v13, a37
v_accvgpr_read_b32 v14, a38
v_accvgpr_read_b32 v15, a39
v_mul_f32 v12, v12, v23
v_mul_f32 v13, v13, v23
v_mul_f32 v14, v14, v23
v_mul_f32 v15, v15, v23
v_accvgpr_write_b32 a36, v12
v_accvgpr_write_b32 a37, v13
v_accvgpr_write_b32 a38, v14
v_accvgpr_write_b32 a39, v15
v_accvgpr_read_b32 v12, a48
v_accvgpr_read_b32 v13, a49
v_accvgpr_read_b32 v14, a50
v_accvgpr_read_b32 v15, a51
v_mul_f32 v12, v12, v23
v_mul_f32 v13, v13, v23
v_mul_f32 v14, v14, v23
v_mul_f32 v15, v15, v23
v_accvgpr_write_b32 a48, v12
v_accvgpr_write_b32 a49, v13
v_accvgpr_write_b32 a50, v14
v_accvgpr_write_b32 a51, v15
v_accvgpr_read_b32 v12, a60
v_accvgpr_read_b32 v13, a61
v_accvgpr_read_b32 v14, a62
v_accvgpr_read_b32 v15, a63
v_mul_f32 v12, v12, v23
v_mul_f32 v13, v13, v23
v_mul_f32 v14, v14, v23
v_mul_f32 v15, v15, v23
v_accvgpr_write_b32 a60, v12
v_accvgpr_write_b32 a61, v13
v_accvgpr_write_b32 a62, v14
v_accvgpr_write_b32 a63, v15
v_accvgpr_read_b32 v12, a72
v_accvgpr_read_b32 v13, a73
v_accvgpr_read_b32 v14, a74
v_accvgpr_read_b32 v15, a75
v_mul_f32 v12, v12, v23
v_mul_f32 v13, v13, v23
v_mul_f32 v14, v14, v23
v_mul_f32 v15, v15, v23
v_accvgpr_write_b32 a72, v12
v_accvgpr_write_b32 a73, v13
v_accvgpr_write_b32 a74, v14
v_accvgpr_write_b32 a75, v15
v_accvgpr_read_b32 v12, a84
v_accvgpr_read_b32 v13, a85
v_accvgpr_read_b32 v14, a86
v_accvgpr_read_b32 v15, a87
v_mul_f32 v12, v12, v23
v_mul_f32 v13, v13, v23
v_mul_f32 v14, v14, v23
v_mul_f32 v15, v15, v23
v_accvgpr_write_b32 a84, v12
v_accvgpr_write_b32 a85, v13
v_accvgpr_write_b32 a86, v14
v_accvgpr_write_b32 a87, v15
v_accvgpr_read_b32 v12, a96
v_accvgpr_read_b32 v13, a97
v_accvgpr_read_b32 v14, a98
v_accvgpr_read_b32 v15, a99
v_mul_f32 v12, v12, v23
v_mul_f32 v13, v13, v23
v_mul_f32 v14, v14, v23
v_mul_f32 v15, v15, v23
v_accvgpr_write_b32 a96, v12
v_accvgpr_write_b32 a97, v13
v_accvgpr_write_b32 a98, v14
v_accvgpr_write_b32 a99, v15
v_accvgpr_read_b32 v12, a108
v_accvgpr_read_b32 v13, a109
v_accvgpr_read_b32 v14, a110
v_accvgpr_read_b32 v15, a111
v_mul_f32 v12, v12, v23
v_mul_f32 v13, v13, v23
v_mul_f32 v14, v14, v23
v_mul_f32 v15, v15, v23
v_accvgpr_write_b32 a108, v12
v_accvgpr_write_b32 a109, v13
v_accvgpr_write_b32 a110, v14
v_accvgpr_write_b32 a111, v15
v_accvgpr_read_b32 v12, a120
v_accvgpr_read_b32 v13, a121
v_accvgpr_read_b32 v14, a122
v_accvgpr_read_b32 v15, a123
v_mul_f32 v12, v12, v23
v_mul_f32 v13, v13, v23
v_mul_f32 v14, v14, v23
v_mul_f32 v15, v15, v23
v_accvgpr_write_b32 a120, v12
v_accvgpr_write_b32 a121, v13
v_accvgpr_write_b32 a122, v14
v_accvgpr_write_b32 a123, v15
v_accvgpr_read_b32 v12, a132
v_accvgpr_read_b32 v13, a133
v_accvgpr_read_b32 v14, a134
v_accvgpr_read_b32 v15, a135
v_mul_f32 v12, v12, v23
v_mul_f32 v13, v13, v23
v_mul_f32 v14, v14, v23
v_mul_f32 v15, v15, v23
v_accvgpr_write_b32 a132, v12
v_accvgpr_write_b32 a133, v13
v_accvgpr_write_b32 a134, v14
v_accvgpr_write_b32 a135, v15
v_accvgpr_read_b32 v12, a144
v_accvgpr_read_b32 v13, a145
v_accvgpr_read_b32 v14, a146
v_accvgpr_read_b32 v15, a147
v_mul_f32 v12, v12, v23
v_mul_f32 v13, v13, v23
v_mul_f32 v14, v14, v23
v_mul_f32 v15, v15, v23
v_accvgpr_write_b32 a144, v12
v_accvgpr_write_b32 a145, v13
v_accvgpr_write_b32 a146, v14
v_accvgpr_write_b32 a147, v15
v_accvgpr_read_b32 v12, a156
v_accvgpr_read_b32 v13, a157
v_accvgpr_read_b32 v14, a158
v_accvgpr_read_b32 v15, a159
v_mul_f32 v12, v12, v23
v_mul_f32 v13, v13, v23
v_mul_f32 v14, v14, v23
v_mul_f32 v15, v15, v23
v_accvgpr_write_b32 a156, v12
v_accvgpr_write_b32 a157, v13
v_accvgpr_write_b32 a158, v14
v_accvgpr_write_b32 a159, v15
v_accvgpr_read_b32 v12, a168
v_accvgpr_read_b32 v13, a169
v_accvgpr_read_b32 v14, a170
v_accvgpr_read_b32 v15, a171
v_mul_f32 v12, v12, v23
v_mul_f32 v13, v13, v23
v_mul_f32 v14, v14, v23
v_mul_f32 v15, v15, v23
v_accvgpr_write_b32 a168, v12
v_accvgpr_write_b32 a169, v13
v_accvgpr_write_b32 a170, v14
v_accvgpr_write_b32 a171, v15
v_accvgpr_read_b32 v12, a180
v_accvgpr_read_b32 v13, a181
v_accvgpr_read_b32 v14, a182
v_accvgpr_read_b32 v15, a183
v_mul_f32 v12, v12, v23
v_mul_f32 v13, v13, v23
v_mul_f32 v14, v14, v23
v_mul_f32 v15, v15, v23
v_accvgpr_write_b32 a180, v12
v_accvgpr_write_b32 a181, v13
v_accvgpr_write_b32 a182, v14
v_accvgpr_write_b32 a183, v15
v_exp_f32 v12, v128
v_exp_f32 v13, v129
v_exp_f32 v14, v130
v_add_f32 v16, v12, v13
v_cvt_pk_bf16_f32 v176, v12, v13
v_exp_f32 v15, v131
v_add_f32 v16, v16, v14
v_exp_f32 v12, v140
v_add_f32 v16, v16, v15
v_cvt_pk_bf16_f32 v177, v14, v15
v_exp_f32 v13, v141
v_add_f32 v16, v16, v12
v_exp_f32 v14, v142
v_add_f32 v16, v16, v13
v_cvt_pk_bf16_f32 v178, v12, v13
v_exp_f32 v15, v143
v_add_f32 v16, v16, v14
v_add_f32 v16, v16, v15
v_cvt_pk_bf16_f32 v179, v14, v15
v_max3_f32 v22, v132, v133, v134
v_max3_f32 v22, v22, v135, v144
v_max3_f32 v22, v22, v145, v146
v_max_f32 v22, v22, v147
v_mov_b32 v23, v22
s_nop 1
v_permlane32_swap_b32 v23, v22
s_nop 1
v_max_f32 v22, v22, v23
v_mov_b32 v23, v22
s_nop 1
v_permlane16_swap_b32 v23, v22
s_nop 1
v_max_f32 v22, v22, v23
v_max_f32 v22, 0, v22
v_sub_f32 v132, v132, v22
v_sub_f32 v156, v156, v22
v_sub_f32 v133, v133, v22
v_sub_f32 v157, v157, v22
v_sub_f32 v134, v134, v22
v_sub_f32 v158, v158, v22
v_sub_f32 v135, v135, v22
v_sub_f32 v159, v159, v22
v_sub_f32 v144, v144, v22
v_sub_f32 v168, v168, v22
v_sub_f32 v145, v145, v22
v_sub_f32 v169, v169, v22
v_sub_f32 v146, v146, v22
v_sub_f32 v170, v170, v22
v_sub_f32 v147, v147, v22
v_sub_f32 v171, v171, v22
v_sub_f32 v228, v228, v22
v_sub_f32 v229, v229, v22
v_sub_f32 v230, v230, v22
v_sub_f32 v231, v231, v22
v_sub_f32 v23, 0, v22
v_exp_f32 v23, v23
s_nop 0
v_mul_f32 v20, v20, v23
v_accvgpr_read_b32 v12, a4
v_accvgpr_read_b32 v13, a5
v_accvgpr_read_b32 v14, a6
v_accvgpr_read_b32 v15, a7
v_mul_f32 v12, v12, v23
v_mul_f32 v13, v13, v23
v_mul_f32 v14, v14, v23
v_mul_f32 v15, v15, v23
v_accvgpr_write_b32 a4, v12
v_accvgpr_write_b32 a5, v13
v_accvgpr_write_b32 a6, v14
v_accvgpr_write_b32 a7, v15
v_accvgpr_read_b32 v12, a16
v_accvgpr_read_b32 v13, a17
v_accvgpr_read_b32 v14, a18
v_accvgpr_read_b32 v15, a19
v_mul_f32 v12, v12, v23
v_mul_f32 v13, v13, v23
v_mul_f32 v14, v14, v23
v_mul_f32 v15, v15, v23
v_accvgpr_write_b32 a16, v12
v_accvgpr_write_b32 a17, v13
v_accvgpr_write_b32 a18, v14
v_accvgpr_write_b32 a19, v15
v_accvgpr_read_b32 v12, a28
v_accvgpr_read_b32 v13, a29
v_accvgpr_read_b32 v14, a30
v_accvgpr_read_b32 v15, a31
v_mul_f32 v12, v12, v23
v_mul_f32 v13, v13, v23
v_mul_f32 v14, v14, v23
v_mul_f32 v15, v15, v23
v_accvgpr_write_b32 a28, v12
v_accvgpr_write_b32 a29, v13
v_accvgpr_write_b32 a30, v14
v_accvgpr_write_b32 a31, v15
v_accvgpr_read_b32 v12, a40
v_accvgpr_read_b32 v13, a41
v_accvgpr_read_b32 v14, a42
v_accvgpr_read_b32 v15, a43
v_mul_f32 v12, v12, v23
v_mul_f32 v13, v13, v23
v_mul_f32 v14, v14, v23
v_mul_f32 v15, v15, v23
v_accvgpr_write_b32 a40, v12
v_accvgpr_write_b32 a41, v13
v_accvgpr_write_b32 a42, v14
v_accvgpr_write_b32 a43, v15
v_accvgpr_read_b32 v12, a52
v_accvgpr_read_b32 v13, a53
v_accvgpr_read_b32 v14, a54
v_accvgpr_read_b32 v15, a55
v_mul_f32 v12, v12, v23
v_mul_f32 v13, v13, v23
v_mul_f32 v14, v14, v23
v_mul_f32 v15, v15, v23
v_accvgpr_write_b32 a52, v12
v_accvgpr_write_b32 a53, v13
v_accvgpr_write_b32 a54, v14
v_accvgpr_write_b32 a55, v15
v_accvgpr_read_b32 v12, a64
v_accvgpr_read_b32 v13, a65
v_accvgpr_read_b32 v14, a66
v_accvgpr_read_b32 v15, a67
v_mul_f32 v12, v12, v23
v_mul_f32 v13, v13, v23
v_mul_f32 v14, v14, v23
v_mul_f32 v15, v15, v23
v_accvgpr_write_b32 a64, v12
v_accvgpr_write_b32 a65, v13
v_accvgpr_write_b32 a66, v14
v_accvgpr_write_b32 a67, v15
v_accvgpr_read_b32 v12, a76
v_accvgpr_read_b32 v13, a77
v_accvgpr_read_b32 v14, a78
v_accvgpr_read_b32 v15, a79
v_mul_f32 v12, v12, v23
v_mul_f32 v13, v13, v23
v_mul_f32 v14, v14, v23
v_mul_f32 v15, v15, v23
v_accvgpr_write_b32 a76, v12
v_accvgpr_write_b32 a77, v13
v_accvgpr_write_b32 a78, v14
v_accvgpr_write_b32 a79, v15
v_accvgpr_read_b32 v12, a88
v_accvgpr_read_b32 v13, a89
v_accvgpr_read_b32 v14, a90
v_accvgpr_read_b32 v15, a91
v_mul_f32 v12, v12, v23
v_mul_f32 v13, v13, v23
v_mul_f32 v14, v14, v23
v_mul_f32 v15, v15, v23
v_accvgpr_write_b32 a88, v12
v_accvgpr_write_b32 a89, v13
v_accvgpr_write_b32 a90, v14
v_accvgpr_write_b32 a91, v15
v_accvgpr_read_b32 v12, a100
v_accvgpr_read_b32 v13, a101
v_accvgpr_read_b32 v14, a102
v_accvgpr_read_b32 v15, a103
v_mul_f32 v12, v12, v23
v_mul_f32 v13, v13, v23
v_mul_f32 v14, v14, v23
v_mul_f32 v15, v15, v23
v_accvgpr_write_b32 a100, v12
v_accvgpr_write_b32 a101, v13
v_accvgpr_write_b32 a102, v14
v_accvgpr_write_b32 a103, v15
v_accvgpr_read_b32 v12, a112
v_accvgpr_read_b32 v13, a113
v_accvgpr_read_b32 v14, a114
v_accvgpr_read_b32 v15, a115
v_mul_f32 v12, v12, v23
v_mul_f32 v13, v13, v23
v_mul_f32 v14, v14, v23
v_mul_f32 v15, v15, v23
v_accvgpr_write_b32 a112, v12
v_accvgpr_write_b32 a113, v13
v_accvgpr_write_b32 a114, v14
v_accvgpr_write_b32 a115, v15
v_accvgpr_read_b32 v12, a124
v_accvgpr_read_b32 v13, a125
v_accvgpr_read_b32 v14, a126
v_accvgpr_read_b32 v15, a127
v_mul_f32 v12, v12, v23
v_mul_f32 v13, v13, v23
v_mul_f32 v14, v14, v23
v_mul_f32 v15, v15, v23
v_accvgpr_write_b32 a124, v12
v_accvgpr_write_b32 a125, v13
v_accvgpr_write_b32 a126, v14
v_accvgpr_write_b32 a127, v15
v_accvgpr_read_b32 v12, a136
v_accvgpr_read_b32 v13, a137
v_accvgpr_read_b32 v14, a138
v_accvgpr_read_b32 v15, a139
v_mul_f32 v12, v12, v23
v_mul_f32 v13, v13, v23
v_mul_f32 v14, v14, v23
v_mul_f32 v15, v15, v23
v_accvgpr_write_b32 a136, v12
v_accvgpr_write_b32 a137, v13
v_accvgpr_write_b32 a138, v14
v_accvgpr_write_b32 a139, v15
v_accvgpr_read_b32 v12, a148
v_accvgpr_read_b32 v13, a149
v_accvgpr_read_b32 v14, a150
v_accvgpr_read_b32 v15, a151
v_mul_f32 v12, v12, v23
v_mul_f32 v13, v13, v23
v_mul_f32 v14, v14, v23
v_mul_f32 v15, v15, v23
v_accvgpr_write_b32 a148, v12
v_accvgpr_write_b32 a149, v13
v_accvgpr_write_b32 a150, v14
v_accvgpr_write_b32 a151, v15
v_accvgpr_read_b32 v12, a160
v_accvgpr_read_b32 v13, a161
v_accvgpr_read_b32 v14, a162
v_accvgpr_read_b32 v15, a163
v_mul_f32 v12, v12, v23
v_mul_f32 v13, v13, v23
v_mul_f32 v14, v14, v23
v_mul_f32 v15, v15, v23
v_accvgpr_write_b32 a160, v12
v_accvgpr_write_b32 a161, v13
v_accvgpr_write_b32 a162, v14
v_accvgpr_write_b32 a163, v15
v_accvgpr_read_b32 v12, a172
v_accvgpr_read_b32 v13, a173
v_accvgpr_read_b32 v14, a174
v_accvgpr_read_b32 v15, a175
v_mul_f32 v12, v12, v23
v_mul_f32 v13, v13, v23
v_mul_f32 v14, v14, v23
v_mul_f32 v15, v15, v23
v_accvgpr_write_b32 a172, v12
v_accvgpr_write_b32 a173, v13
v_accvgpr_write_b32 a174, v14
v_accvgpr_write_b32 a175, v15
v_accvgpr_read_b32 v12, a184
v_accvgpr_read_b32 v13, a185
v_accvgpr_read_b32 v14, a186
v_accvgpr_read_b32 v15, a187
v_mul_f32 v12, v12, v23
v_mul_f32 v13, v13, v23
v_mul_f32 v14, v14, v23
v_mul_f32 v15, v15, v23
v_accvgpr_write_b32 a184, v12
v_accvgpr_write_b32 a185, v13
v_accvgpr_write_b32 a186, v14
v_accvgpr_write_b32 a187, v15
v_exp_f32 v12, v132
v_exp_f32 v13, v133
v_exp_f32 v14, v134
v_add_f32 v17, v12, v13
v_cvt_pk_bf16_f32 v180, v12, v13
v_exp_f32 v15, v135
v_add_f32 v17, v17, v14
v_exp_f32 v12, v144
v_add_f32 v17, v17, v15
v_cvt_pk_bf16_f32 v181, v14, v15
v_exp_f32 v13, v145
v_add_f32 v17, v17, v12
v_exp_f32 v14, v146
v_add_f32 v17, v17, v13
v_cvt_pk_bf16_f32 v182, v12, v13
v_exp_f32 v15, v147
v_add_f32 v17, v17, v14
v_add_f32 v17, v17, v15
v_cvt_pk_bf16_f32 v183, v14, v15
v_max3_f32 v22, v136, v137, v138
v_max3_f32 v22, v22, v139, v148
v_max3_f32 v22, v22, v149, v150
v_max_f32 v22, v22, v151
v_mov_b32 v23, v22
s_nop 1
v_permlane32_swap_b32 v23, v22
s_nop 1
v_max_f32 v22, v22, v23
v_mov_b32 v23, v22
s_nop 1
v_permlane16_swap_b32 v23, v22
s_nop 1
v_max_f32 v22, v22, v23
v_max_f32 v22, 0, v22
v_sub_f32 v136, v136, v22
v_sub_f32 v160, v160, v22
v_sub_f32 v137, v137, v22
v_sub_f32 v161, v161, v22
v_sub_f32 v138, v138, v22
v_sub_f32 v162, v162, v22
v_sub_f32 v139, v139, v22
v_sub_f32 v163, v163, v22
v_sub_f32 v148, v148, v22
v_sub_f32 v172, v172, v22
v_sub_f32 v149, v149, v22
v_sub_f32 v173, v173, v22
v_sub_f32 v150, v150, v22
v_sub_f32 v174, v174, v22
v_sub_f32 v151, v151, v22
v_sub_f32 v175, v175, v22
v_sub_f32 v232, v232, v22
v_sub_f32 v233, v233, v22
v_sub_f32 v234, v234, v22
v_sub_f32 v235, v235, v22
v_sub_f32 v23, 0, v22
v_exp_f32 v23, v23
s_nop 0
v_mul_f32 v21, v21, v23
v_accvgpr_read_b32 v12, a8
v_accvgpr_read_b32 v13, a9
v_accvgpr_read_b32 v14, a10
v_accvgpr_read_b32 v15, a11
v_mul_f32 v12, v12, v23
v_mul_f32 v13, v13, v23
v_mul_f32 v14, v14, v23
v_mul_f32 v15, v15, v23
v_accvgpr_write_b32 a8, v12
v_accvgpr_write_b32 a9, v13
v_accvgpr_write_b32 a10, v14
v_accvgpr_write_b32 a11, v15
v_accvgpr_read_b32 v12, a20
v_accvgpr_read_b32 v13, a21
v_accvgpr_read_b32 v14, a22
v_accvgpr_read_b32 v15, a23
v_mul_f32 v12, v12, v23
v_mul_f32 v13, v13, v23
v_mul_f32 v14, v14, v23
v_mul_f32 v15, v15, v23
v_accvgpr_write_b32 a20, v12
v_accvgpr_write_b32 a21, v13
v_accvgpr_write_b32 a22, v14
v_accvgpr_write_b32 a23, v15
v_accvgpr_read_b32 v12, a32
v_accvgpr_read_b32 v13, a33
v_accvgpr_read_b32 v14, a34
v_accvgpr_read_b32 v15, a35
v_mul_f32 v12, v12, v23
v_mul_f32 v13, v13, v23
v_mul_f32 v14, v14, v23
v_mul_f32 v15, v15, v23
v_accvgpr_write_b32 a32, v12
v_accvgpr_write_b32 a33, v13
v_accvgpr_write_b32 a34, v14
v_accvgpr_write_b32 a35, v15
v_accvgpr_read_b32 v12, a44
v_accvgpr_read_b32 v13, a45
v_accvgpr_read_b32 v14, a46
v_accvgpr_read_b32 v15, a47
v_mul_f32 v12, v12, v23
v_mul_f32 v13, v13, v23
v_mul_f32 v14, v14, v23
v_mul_f32 v15, v15, v23
v_accvgpr_write_b32 a44, v12
v_accvgpr_write_b32 a45, v13
v_accvgpr_write_b32 a46, v14
v_accvgpr_write_b32 a47, v15
v_accvgpr_read_b32 v12, a56
v_accvgpr_read_b32 v13, a57
v_accvgpr_read_b32 v14, a58
v_accvgpr_read_b32 v15, a59
v_mul_f32 v12, v12, v23
v_mul_f32 v13, v13, v23
v_mul_f32 v14, v14, v23
v_mul_f32 v15, v15, v23
v_accvgpr_write_b32 a56, v12
v_accvgpr_write_b32 a57, v13
v_accvgpr_write_b32 a58, v14
v_accvgpr_write_b32 a59, v15
v_accvgpr_read_b32 v12, a68
v_accvgpr_read_b32 v13, a69
v_accvgpr_read_b32 v14, a70
v_accvgpr_read_b32 v15, a71
v_mul_f32 v12, v12, v23
v_mul_f32 v13, v13, v23
v_mul_f32 v14, v14, v23
v_mul_f32 v15, v15, v23
v_accvgpr_write_b32 a68, v12
v_accvgpr_write_b32 a69, v13
v_accvgpr_write_b32 a70, v14
v_accvgpr_write_b32 a71, v15
v_accvgpr_read_b32 v12, a80
v_accvgpr_read_b32 v13, a81
v_accvgpr_read_b32 v14, a82
v_accvgpr_read_b32 v15, a83
v_mul_f32 v12, v12, v23
v_mul_f32 v13, v13, v23
v_mul_f32 v14, v14, v23
v_mul_f32 v15, v15, v23
v_accvgpr_write_b32 a80, v12
v_accvgpr_write_b32 a81, v13
v_accvgpr_write_b32 a82, v14
v_accvgpr_write_b32 a83, v15
v_accvgpr_read_b32 v12, a92
v_accvgpr_read_b32 v13, a93
v_accvgpr_read_b32 v14, a94
v_accvgpr_read_b32 v15, a95
v_mul_f32 v12, v12, v23
v_mul_f32 v13, v13, v23
v_mul_f32 v14, v14, v23
v_mul_f32 v15, v15, v23
v_accvgpr_write_b32 a92, v12
v_accvgpr_write_b32 a93, v13
v_accvgpr_write_b32 a94, v14
v_accvgpr_write_b32 a95, v15
v_accvgpr_read_b32 v12, a104
v_accvgpr_read_b32 v13, a105
v_accvgpr_read_b32 v14, a106
v_accvgpr_read_b32 v15, a107
v_mul_f32 v12, v12, v23
v_mul_f32 v13, v13, v23
v_mul_f32 v14, v14, v23
v_mul_f32 v15, v15, v23
v_accvgpr_write_b32 a104, v12
v_accvgpr_write_b32 a105, v13
v_accvgpr_write_b32 a106, v14
v_accvgpr_write_b32 a107, v15
v_accvgpr_read_b32 v12, a116
v_accvgpr_read_b32 v13, a117
v_accvgpr_read_b32 v14, a118
v_accvgpr_read_b32 v15, a119
v_mul_f32 v12, v12, v23
v_mul_f32 v13, v13, v23
v_mul_f32 v14, v14, v23
v_mul_f32 v15, v15, v23
v_accvgpr_write_b32 a116, v12
v_accvgpr_write_b32 a117, v13
v_accvgpr_write_b32 a118, v14
v_accvgpr_write_b32 a119, v15
v_accvgpr_read_b32 v12, a128
v_accvgpr_read_b32 v13, a129
v_accvgpr_read_b32 v14, a130
v_accvgpr_read_b32 v15, a131
v_mul_f32 v12, v12, v23
v_mul_f32 v13, v13, v23
v_mul_f32 v14, v14, v23
v_mul_f32 v15, v15, v23
v_accvgpr_write_b32 a128, v12
v_accvgpr_write_b32 a129, v13
v_accvgpr_write_b32 a130, v14
v_accvgpr_write_b32 a131, v15
v_accvgpr_read_b32 v12, a140
v_accvgpr_read_b32 v13, a141
v_accvgpr_read_b32 v14, a142
v_accvgpr_read_b32 v15, a143
v_mul_f32 v12, v12, v23
v_mul_f32 v13, v13, v23
v_mul_f32 v14, v14, v23
v_mul_f32 v15, v15, v23
v_accvgpr_write_b32 a140, v12
v_accvgpr_write_b32 a141, v13
v_accvgpr_write_b32 a142, v14
v_accvgpr_write_b32 a143, v15
v_accvgpr_read_b32 v12, a152
v_accvgpr_read_b32 v13, a153
v_accvgpr_read_b32 v14, a154
v_accvgpr_read_b32 v15, a155
v_mul_f32 v12, v12, v23
v_mul_f32 v13, v13, v23
v_mul_f32 v14, v14, v23
v_mul_f32 v15, v15, v23
v_accvgpr_write_b32 a152, v12
v_accvgpr_write_b32 a153, v13
v_accvgpr_write_b32 a154, v14
v_accvgpr_write_b32 a155, v15
v_accvgpr_read_b32 v12, a164
v_accvgpr_read_b32 v13, a165
v_accvgpr_read_b32 v14, a166
v_accvgpr_read_b32 v15, a167
v_mul_f32 v12, v12, v23
v_mul_f32 v13, v13, v23
v_mul_f32 v14, v14, v23
v_mul_f32 v15, v15, v23
v_accvgpr_write_b32 a164, v12
v_accvgpr_write_b32 a165, v13
v_accvgpr_write_b32 a166, v14
v_accvgpr_write_b32 a167, v15
v_accvgpr_read_b32 v12, a176
v_accvgpr_read_b32 v13, a177
v_accvgpr_read_b32 v14, a178
v_accvgpr_read_b32 v15, a179
v_mul_f32 v12, v12, v23
v_mul_f32 v13, v13, v23
v_mul_f32 v14, v14, v23
v_mul_f32 v15, v15, v23
v_accvgpr_write_b32 a176, v12
v_accvgpr_write_b32 a177, v13
v_accvgpr_write_b32 a178, v14
v_accvgpr_write_b32 a179, v15
v_accvgpr_read_b32 v12, a188
v_accvgpr_read_b32 v13, a189
v_accvgpr_read_b32 v14, a190
v_accvgpr_read_b32 v15, a191
v_mul_f32 v12, v12, v23
v_mul_f32 v13, v13, v23
v_mul_f32 v14, v14, v23
v_mul_f32 v15, v15, v23
v_accvgpr_write_b32 a188, v12
v_accvgpr_write_b32 a189, v13
v_accvgpr_write_b32 a190, v14
v_accvgpr_write_b32 a191, v15
v_exp_f32 v12, v136
v_exp_f32 v13, v137
v_exp_f32 v14, v138
v_add_f32 v18, v12, v13
v_cvt_pk_bf16_f32 v184, v12, v13
v_exp_f32 v15, v139
v_add_f32 v18, v18, v14
v_exp_f32 v12, v148
v_add_f32 v18, v18, v15
v_cvt_pk_bf16_f32 v185, v14, v15
v_exp_f32 v13, v149
v_add_f32 v18, v18, v12
v_exp_f32 v14, v150
v_add_f32 v18, v18, v13
v_cvt_pk_bf16_f32 v186, v12, v13
v_exp_f32 v15, v151
v_add_f32 v18, v18, v14
v_add_f32 v18, v18, v15
v_cvt_pk_bf16_f32 v187, v14, v15
s_nop 1
s_setpc_b64 s[84:85]
L_slow37:
s_call_b64 s[84:85], L_slow_0_1
s_branch L_back38
L_poll39:
ds_read_b32 v11, v9
s_waitcnt lgkmcnt(0)
v_readfirstlane_b32 s39, v11
s_nop 0
s_cmp_ge_u32 s39, s38
s_cbranch_scc1 L_ret40
s_sleep 1
s_add_u32 s53, s53, 1
s_cmp_lt_u32 s53, 1048576
s_cbranch_scc1 L_poll39
s_endpgm
L_poll41:
ds_read_b32 v11, v9
s_waitcnt lgkmcnt(0)
v_readfirstlane_b32 s39, v11
s_nop 0
s_cmp_ge_u32 s39, s38
s_cbranch_scc1 L_ret42
s_sleep 1
s_add_u32 s53, s53, 1
s_cmp_lt_u32 s53, 1048576
s_cbranch_scc1 L_poll41
s_endpgm
L_slow_1_1:
s_nop 15
v_max3_f32 v22, v152, v153, v154
v_max3_f32 v22, v22, v155, v164
v_max3_f32 v22, v22, v165, v166
v_max_f32 v22, v22, v167
v_mov_b32 v23, v22
s_nop 1
v_permlane32_swap_b32 v23, v22
s_nop 1
v_max_f32 v22, v22, v23
v_mov_b32 v23, v22
s_nop 1
v_permlane16_swap_b32 v23, v22
s_nop 1
v_max_f32 v22, v22, v23
v_max_f32 v22, 0, v22
v_sub_f32 v152, v152, v22
v_sub_f32 v128, v128, v22
v_sub_f32 v153, v153, v22
v_sub_f32 v129, v129, v22
v_sub_f32 v154, v154, v22
v_sub_f32 v130, v130, v22
v_sub_f32 v155, v155, v22
v_sub_f32 v131, v131, v22
v_sub_f32 v164, v164, v22
v_sub_f32 v140, v140, v22
v_sub_f32 v165, v165, v22
v_sub_f32 v141, v141, v22
v_sub_f32 v166, v166, v22
v_sub_f32 v142, v142, v22
v_sub_f32 v167, v167, v22
v_sub_f32 v143, v143, v22
v_sub_f32 v224, v224, v22
v_sub_f32 v225, v225, v22
v_sub_f32 v226, v226, v22
v_sub_f32 v227, v227, v22
v_sub_f32 v23, 0, v22
v_exp_f32 v23, v23
s_nop 0
v_mul_f32 v19, v19, v23
v_accvgpr_read_b32 v12, a0
v_accvgpr_read_b32 v13, a1
v_accvgpr_read_b32 v14, a2
v_accvgpr_read_b32 v15, a3
v_mul_f32 v12, v12, v23
v_mul_f32 v13, v13, v23
v_mul_f32 v14, v14, v23
v_mul_f32 v15, v15, v23
v_accvgpr_write_b32 a0, v12
v_accvgpr_write_b32 a1, v13
v_accvgpr_write_b32 a2, v14
v_accvgpr_write_b32 a3, v15
v_accvgpr_read_b32 v12, a12
v_accvgpr_read_b32 v13, a13
v_accvgpr_read_b32 v14, a14
v_accvgpr_read_b32 v15, a15
v_mul_f32 v12, v12, v23
v_mul_f32 v13, v13, v23
v_mul_f32 v14, v14, v23
v_mul_f32 v15, v15, v23
v_accvgpr_write_b32 a12, v12
v_accvgpr_write_b32 a13, v13
v_accvgpr_write_b32 a14, v14
v_accvgpr_write_b32 a15, v15
v_accvgpr_read_b32 v12, a24
v_accvgpr_read_b32 v13, a25
v_accvgpr_read_b32 v14, a26
v_accvgpr_read_b32 v15, a27
v_mul_f32 v12, v12, v23
v_mul_f32 v13, v13, v23
v_mul_f32 v14, v14, v23
v_mul_f32 v15, v15, v23
v_accvgpr_write_b32 a24, v12
v_accvgpr_write_b32 a25, v13
v_accvgpr_write_b32 a26, v14
v_accvgpr_write_b32 a27, v15
v_accvgpr_read_b32 v12, a36
v_accvgpr_read_b32 v13, a37
v_accvgpr_read_b32 v14, a38
v_accvgpr_read_b32 v15, a39
v_mul_f32 v12, v12, v23
v_mul_f32 v13, v13, v23
v_mul_f32 v14, v14, v23
v_mul_f32 v15, v15, v23
v_accvgpr_write_b32 a36, v12
v_accvgpr_write_b32 a37, v13
v_accvgpr_write_b32 a38, v14
v_accvgpr_write_b32 a39, v15
v_accvgpr_read_b32 v12, a48
v_accvgpr_read_b32 v13, a49
v_accvgpr_read_b32 v14, a50
v_accvgpr_read_b32 v15, a51
v_mul_f32 v12, v12, v23
v_mul_f32 v13, v13, v23
v_mul_f32 v14, v14, v23
v_mul_f32 v15, v15, v23
v_accvgpr_write_b32 a48, v12
v_accvgpr_write_b32 a49, v13
v_accvgpr_write_b32 a50, v14
v_accvgpr_write_b32 a51, v15
v_accvgpr_read_b32 v12, a60
v_accvgpr_read_b32 v13, a61
v_accvgpr_read_b32 v14, a62
v_accvgpr_read_b32 v15, a63
v_mul_f32 v12, v12, v23
v_mul_f32 v13, v13, v23
v_mul_f32 v14, v14, v23
v_mul_f32 v15, v15, v23
v_accvgpr_write_b32 a60, v12
v_accvgpr_write_b32 a61, v13
v_accvgpr_write_b32 a62, v14
v_accvgpr_write_b32 a63, v15
v_accvgpr_read_b32 v12, a72
v_accvgpr_read_b32 v13, a73
v_accvgpr_read_b32 v14, a74
v_accvgpr_read_b32 v15, a75
v_mul_f32 v12, v12, v23
v_mul_f32 v13, v13, v23
v_mul_f32 v14, v14, v23
v_mul_f32 v15, v15, v23
v_accvgpr_write_b32 a72, v12
v_accvgpr_write_b32 a73, v13
v_accvgpr_write_b32 a74, v14
v_accvgpr_write_b32 a75, v15
v_accvgpr_read_b32 v12, a84
v_accvgpr_read_b32 v13, a85
v_accvgpr_read_b32 v14, a86
v_accvgpr_read_b32 v15, a87
v_mul_f32 v12, v12, v23
v_mul_f32 v13, v13, v23
v_mul_f32 v14, v14, v23
v_mul_f32 v15, v15, v23
v_accvgpr_write_b32 a84, v12
v_accvgpr_write_b32 a85, v13
v_accvgpr_write_b32 a86, v14
v_accvgpr_write_b32 a87, v15
v_accvgpr_read_b32 v12, a96
v_accvgpr_read_b32 v13, a97
v_accvgpr_read_b32 v14, a98
v_accvgpr_read_b32 v15, a99
v_mul_f32 v12, v12, v23
v_mul_f32 v13, v13, v23
v_mul_f32 v14, v14, v23
v_mul_f32 v15, v15, v23
v_accvgpr_write_b32 a96, v12
v_accvgpr_write_b32 a97, v13
v_accvgpr_write_b32 a98, v14
v_accvgpr_write_b32 a99, v15
v_accvgpr_read_b32 v12, a108
v_accvgpr_read_b32 v13, a109
v_accvgpr_read_b32 v14, a110
v_accvgpr_read_b32 v15, a111
v_mul_f32 v12, v12, v23
v_mul_f32 v13, v13, v23
v_mul_f32 v14, v14, v23
v_mul_f32 v15, v15, v23
v_accvgpr_write_b32 a108, v12
v_accvgpr_write_b32 a109, v13
v_accvgpr_write_b32 a110, v14
v_accvgpr_write_b32 a111, v15
v_accvgpr_read_b32 v12, a120
v_accvgpr_read_b32 v13, a121
v_accvgpr_read_b32 v14, a122
v_accvgpr_read_b32 v15, a123
v_mul_f32 v12, v12, v23
v_mul_f32 v13, v13, v23
v_mul_f32 v14, v14, v23
v_mul_f32 v15, v15, v23
v_accvgpr_write_b32 a120, v12
v_accvgpr_write_b32 a121, v13
v_accvgpr_write_b32 a122, v14
v_accvgpr_write_b32 a123, v15
v_accvgpr_read_b32 v12, a132
v_accvgpr_read_b32 v13, a133
v_accvgpr_read_b32 v14, a134
v_accvgpr_read_b32 v15, a135
v_mul_f32 v12, v12, v23
v_mul_f32 v13, v13, v23
v_mul_f32 v14, v14, v23
v_mul_f32 v15, v15, v23
v_accvgpr_write_b32 a132, v12
v_accvgpr_write_b32 a133, v13
v_accvgpr_write_b32 a134, v14
v_accvgpr_write_b32 a135, v15
v_accvgpr_read_b32 v12, a144
v_accvgpr_read_b32 v13, a145
v_accvgpr_read_b32 v14, a146
v_accvgpr_read_b32 v15, a147
v_mul_f32 v12, v12, v23
v_mul_f32 v13, v13, v23
v_mul_f32 v14, v14, v23
v_mul_f32 v15, v15, v23
v_accvgpr_write_b32 a144, v12
v_accvgpr_write_b32 a145, v13
v_accvgpr_write_b32 a146, v14
v_accvgpr_write_b32 a147, v15
v_accvgpr_read_b32 v12, a156
v_accvgpr_read_b32 v13, a157
v_accvgpr_read_b32 v14, a158
v_accvgpr_read_b32 v15, a159
v_mul_f32 v12, v12, v23
v_mul_f32 v13, v13, v23
v_mul_f32 v14, v14, v23
v_mul_f32 v15, v15, v23
v_accvgpr_write_b32 a156, v12
v_accvgpr_write_b32 a157, v13
v_accvgpr_write_b32 a158, v14
v_accvgpr_write_b32 a159, v15
v_accvgpr_read_b32 v12, a168
v_accvgpr_read_b32 v13, a169
v_accvgpr_read_b32 v14, a170
v_accvgpr_read_b32 v15, a171
v_mul_f32 v12, v12, v23
v_mul_f32 v13, v13, v23
v_mul_f32 v14, v14, v23
v_mul_f32 v15, v15, v23
v_accvgpr_write_b32 a168, v12
v_accvgpr_write_b32 a169, v13
v_accvgpr_write_b32 a170, v14
v_accvgpr_write_b32 a171, v15
v_accvgpr_read_b32 v12, a180
v_accvgpr_read_b32 v13, a181
v_accvgpr_read_b32 v14, a182
v_accvgpr_read_b32 v15, a183
v_mul_f32 v12, v12, v23
v_mul_f32 v13, v13, v23
v_mul_f32 v14, v14, v23
v_mul_f32 v15, v15, v23
v_accvgpr_write_b32 a180, v12
v_accvgpr_write_b32 a181, v13
v_accvgpr_write_b32 a182, v14
v_accvgpr_write_b32 a183, v15
v_exp_f32 v12, v152
v_exp_f32 v13, v153
v_exp_f32 v14, v154
v_add_f32 v16, v12, v13
v_cvt_pk_bf16_f32 v188, v12, v13
v_exp_f32 v15, v155
v_add_f32 v16, v16, v14
v_exp_f32 v12, v164
v_add_f32 v16, v16, v15
v_cvt_pk_bf16_f32 v189, v14, v15
v_exp_f32 v13, v165
v_add_f32 v16, v16, v12
v_exp_f32 v14, v166
v_add_f32 v16, v16, v13
v_cvt_pk_bf16_f32 v190, v12, v13
v_exp_f32 v15, v167
v_add_f32 v16, v16, v14
v_add_f32 v16, v16, v15
v_cvt_pk_bf16_f32 v191, v14, v15
v_max3_f32 v22, v156, v157, v158
v_max3_f32 v22, v22, v159, v168
v_max3_f32 v22, v22, v169, v170
v_max_f32 v22, v22, v171
v_mov_b32 v23, v22
s_nop 1
v_permlane32_swap_b32 v23, v22
s_nop 1
v_max_f32 v22, v22, v23
v_mov_b32 v23, v22
s_nop 1
v_permlane16_swap_b32 v23, v22
s_nop 1
v_max_f32 v22, v22, v23
v_max_f32 v22, 0, v22
v_sub_f32 v156, v156, v22
v_sub_f32 v132, v132, v22
v_sub_f32 v157, v157, v22
v_sub_f32 v133, v133, v22
v_sub_f32 v158, v158, v22
v_sub_f32 v134, v134, v22
v_sub_f32 v159, v159, v22
v_sub_f32 v135, v135, v22
v_sub_f32 v168, v168, v22
v_sub_f32 v144, v144, v22
v_sub_f32 v169, v169, v22
v_sub_f32 v145, v145, v22
v_sub_f32 v170, v170, v22
v_sub_f32 v146, v146, v22
v_sub_f32 v171, v171, v22
v_sub_f32 v147, v147, v22
v_sub_f32 v228, v228, v22
v_sub_f32 v229, v229, v22
v_sub_f32 v230, v230, v22
v_sub_f32 v231, v231, v22
v_sub_f32 v23, 0, v22
v_exp_f32 v23, v23
s_nop 0
v_mul_f32 v20, v20, v23
v_accvgpr_read_b32 v12, a4
v_accvgpr_read_b32 v13, a5
v_accvgpr_read_b32 v14, a6
v_accvgpr_read_b32 v15, a7
v_mul_f32 v12, v12, v23
v_mul_f32 v13, v13, v23
v_mul_f32 v14, v14, v23
v_mul_f32 v15, v15, v23
v_accvgpr_write_b32 a4, v12
v_accvgpr_write_b32 a5, v13
v_accvgpr_write_b32 a6, v14
v_accvgpr_write_b32 a7, v15
v_accvgpr_read_b32 v12, a16
v_accvgpr_read_b32 v13, a17
v_accvgpr_read_b32 v14, a18
v_accvgpr_read_b32 v15, a19
v_mul_f32 v12, v12, v23
v_mul_f32 v13, v13, v23
v_mul_f32 v14, v14, v23
v_mul_f32 v15, v15, v23
v_accvgpr_write_b32 a16, v12
v_accvgpr_write_b32 a17, v13
v_accvgpr_write_b32 a18, v14
v_accvgpr_write_b32 a19, v15
v_accvgpr_read_b32 v12, a28
v_accvgpr_read_b32 v13, a29
v_accvgpr_read_b32 v14, a30
v_accvgpr_read_b32 v15, a31
v_mul_f32 v12, v12, v23
v_mul_f32 v13, v13, v23
v_mul_f32 v14, v14, v23
v_mul_f32 v15, v15, v23
v_accvgpr_write_b32 a28, v12
v_accvgpr_write_b32 a29, v13
v_accvgpr_write_b32 a30, v14
v_accvgpr_write_b32 a31, v15
v_accvgpr_read_b32 v12, a40
v_accvgpr_read_b32 v13, a41
v_accvgpr_read_b32 v14, a42
v_accvgpr_read_b32 v15, a43
v_mul_f32 v12, v12, v23
v_mul_f32 v13, v13, v23
v_mul_f32 v14, v14, v23
v_mul_f32 v15, v15, v23
v_accvgpr_write_b32 a40, v12
v_accvgpr_write_b32 a41, v13
v_accvgpr_write_b32 a42, v14
v_accvgpr_write_b32 a43, v15
v_accvgpr_read_b32 v12, a52
v_accvgpr_read_b32 v13, a53
v_accvgpr_read_b32 v14, a54
v_accvgpr_read_b32 v15, a55
v_mul_f32 v12, v12, v23
v_mul_f32 v13, v13, v23
v_mul_f32 v14, v14, v23
v_mul_f32 v15, v15, v23
v_accvgpr_write_b32 a52, v12
v_accvgpr_write_b32 a53, v13
v_accvgpr_write_b32 a54, v14
v_accvgpr_write_b32 a55, v15
v_accvgpr_read_b32 v12, a64
v_accvgpr_read_b32 v13, a65
v_accvgpr_read_b32 v14, a66
v_accvgpr_read_b32 v15, a67
v_mul_f32 v12, v12, v23
v_mul_f32 v13, v13, v23
v_mul_f32 v14, v14, v23
v_mul_f32 v15, v15, v23
v_accvgpr_write_b32 a64, v12
v_accvgpr_write_b32 a65, v13
v_accvgpr_write_b32 a66, v14
v_accvgpr_write_b32 a67, v15
v_accvgpr_read_b32 v12, a76
v_accvgpr_read_b32 v13, a77
v_accvgpr_read_b32 v14, a78
v_accvgpr_read_b32 v15, a79
v_mul_f32 v12, v12, v23
v_mul_f32 v13, v13, v23
v_mul_f32 v14, v14, v23
v_mul_f32 v15, v15, v23
v_accvgpr_write_b32 a76, v12
v_accvgpr_write_b32 a77, v13
v_accvgpr_write_b32 a78, v14
v_accvgpr_write_b32 a79, v15
v_accvgpr_read_b32 v12, a88
v_accvgpr_read_b32 v13, a89
v_accvgpr_read_b32 v14, a90
v_accvgpr_read_b32 v15, a91
v_mul_f32 v12, v12, v23
v_mul_f32 v13, v13, v23
v_mul_f32 v14, v14, v23
v_mul_f32 v15, v15, v23
v_accvgpr_write_b32 a88, v12
v_accvgpr_write_b32 a89, v13
v_accvgpr_write_b32 a90, v14
v_accvgpr_write_b32 a91, v15
v_accvgpr_read_b32 v12, a100
v_accvgpr_read_b32 v13, a101
v_accvgpr_read_b32 v14, a102
v_accvgpr_read_b32 v15, a103
v_mul_f32 v12, v12, v23
v_mul_f32 v13, v13, v23
v_mul_f32 v14, v14, v23
v_mul_f32 v15, v15, v23
v_accvgpr_write_b32 a100, v12
v_accvgpr_write_b32 a101, v13
v_accvgpr_write_b32 a102, v14
v_accvgpr_write_b32 a103, v15
v_accvgpr_read_b32 v12, a112
v_accvgpr_read_b32 v13, a113
v_accvgpr_read_b32 v14, a114
v_accvgpr_read_b32 v15, a115
v_mul_f32 v12, v12, v23
v_mul_f32 v13, v13, v23
v_mul_f32 v14, v14, v23
v_mul_f32 v15, v15, v23
v_accvgpr_write_b32 a112, v12
v_accvgpr_write_b32 a113, v13
v_accvgpr_write_b32 a114, v14
v_accvgpr_write_b32 a115, v15
v_accvgpr_read_b32 v12, a124
v_accvgpr_read_b32 v13, a125
v_accvgpr_read_b32 v14, a126
v_accvgpr_read_b32 v15, a127
v_mul_f32 v12, v12, v23
v_mul_f32 v13, v13, v23
v_mul_f32 v14, v14, v23
v_mul_f32 v15, v15, v23
v_accvgpr_write_b32 a124, v12
v_accvgpr_write_b32 a125, v13
v_accvgpr_write_b32 a126, v14
v_accvgpr_write_b32 a127, v15
v_accvgpr_read_b32 v12, a136
v_accvgpr_read_b32 v13, a137
v_accvgpr_read_b32 v14, a138
v_accvgpr_read_b32 v15, a139
v_mul_f32 v12, v12, v23
v_mul_f32 v13, v13, v23
v_mul_f32 v14, v14, v23
v_mul_f32 v15, v15, v23
v_accvgpr_write_b32 a136, v12
v_accvgpr_write_b32 a137, v13
v_accvgpr_write_b32 a138, v14
v_accvgpr_write_b32 a139, v15
v_accvgpr_read_b32 v12, a148
v_accvgpr_read_b32 v13, a149
v_accvgpr_read_b32 v14, a150
v_accvgpr_read_b32 v15, a151
v_mul_f32 v12, v12, v23
v_mul_f32 v13, v13, v23
v_mul_f32 v14, v14, v23
v_mul_f32 v15, v15, v23
v_accvgpr_write_b32 a148, v12
v_accvgpr_write_b32 a149, v13
v_accvgpr_write_b32 a150, v14
v_accvgpr_write_b32 a151, v15
v_accvgpr_read_b32 v12, a160
v_accvgpr_read_b32 v13, a161
v_accvgpr_read_b32 v14, a162
v_accvgpr_read_b32 v15, a163
v_mul_f32 v12, v12, v23
v_mul_f32 v13, v13, v23
v_mul_f32 v14, v14, v23
v_mul_f32 v15, v15, v23
v_accvgpr_write_b32 a160, v12
v_accvgpr_write_b32 a161, v13
v_accvgpr_write_b32 a162, v14
v_accvgpr_write_b32 a163, v15
v_accvgpr_read_b32 v12, a172
v_accvgpr_read_b32 v13, a173
v_accvgpr_read_b32 v14, a174
v_accvgpr_read_b32 v15, a175
v_mul_f32 v12, v12, v23
v_mul_f32 v13, v13, v23
v_mul_f32 v14, v14, v23
v_mul_f32 v15, v15, v23
v_accvgpr_write_b32 a172, v12
v_accvgpr_write_b32 a173, v13
v_accvgpr_write_b32 a174, v14
v_accvgpr_write_b32 a175, v15
v_accvgpr_read_b32 v12, a184
v_accvgpr_read_b32 v13, a185
v_accvgpr_read_b32 v14, a186
v_accvgpr_read_b32 v15, a187
v_mul_f32 v12, v12, v23
v_mul_f32 v13, v13, v23
v_mul_f32 v14, v14, v23
v_mul_f32 v15, v15, v23
v_accvgpr_write_b32 a184, v12
v_accvgpr_write_b32 a185, v13
v_accvgpr_write_b32 a186, v14
v_accvgpr_write_b32 a187, v15
v_exp_f32 v12, v156
v_exp_f32 v13, v157
v_exp_f32 v14, v158
v_add_f32 v17, v12, v13
v_cvt_pk_bf16_f32 v192, v12, v13
v_exp_f32 v15, v159
v_add_f32 v17, v17, v14
v_exp_f32 v12, v168
v_add_f32 v17, v17, v15
v_cvt_pk_bf16_f32 v193, v14, v15
v_exp_f32 v13, v169
v_add_f32 v17, v17, v12
v_exp_f32 v14, v170
v_add_f32 v17, v17, v13
v_cvt_pk_bf16_f32 v194, v12, v13
v_exp_f32 v15, v171
v_add_f32 v17, v17, v14
v_add_f32 v17, v17, v15
v_cvt_pk_bf16_f32 v195, v14, v15
v_max3_f32 v22, v160, v161, v162
v_max3_f32 v22, v22, v163, v172
v_max3_f32 v22, v22, v173, v174
v_max_f32 v22, v22, v175
v_mov_b32 v23, v22
s_nop 1
v_permlane32_swap_b32 v23, v22
s_nop 1
v_max_f32 v22, v22, v23
v_mov_b32 v23, v22
s_nop 1
v_permlane16_swap_b32 v23, v22
s_nop 1
v_max_f32 v22, v22, v23
v_max_f32 v22, 0, v22
v_sub_f32 v160, v160, v22
v_sub_f32 v136, v136, v22
v_sub_f32 v161, v161, v22
v_sub_f32 v137, v137, v22
v_sub_f32 v162, v162, v22
v_sub_f32 v138, v138, v22
v_sub_f32 v163, v163, v22
v_sub_f32 v139, v139, v22
v_sub_f32 v172, v172, v22
v_sub_f32 v148, v148, v22
v_sub_f32 v173, v173, v22
v_sub_f32 v149, v149, v22
v_sub_f32 v174, v174, v22
v_sub_f32 v150, v150, v22
v_sub_f32 v175, v175, v22
v_sub_f32 v151, v151, v22
v_sub_f32 v232, v232, v22
v_sub_f32 v233, v233, v22
v_sub_f32 v234, v234, v22
v_sub_f32 v235, v235, v22
v_sub_f32 v23, 0, v22
v_exp_f32 v23, v23
s_nop 0
v_mul_f32 v21, v21, v23
v_accvgpr_read_b32 v12, a8
v_accvgpr_read_b32 v13, a9
v_accvgpr_read_b32 v14, a10
v_accvgpr_read_b32 v15, a11
v_mul_f32 v12, v12, v23
v_mul_f32 v13, v13, v23
v_mul_f32 v14, v14, v23
v_mul_f32 v15, v15, v23
v_accvgpr_write_b32 a8, v12
v_accvgpr_write_b32 a9, v13
v_accvgpr_write_b32 a10, v14
v_accvgpr_write_b32 a11, v15
v_accvgpr_read_b32 v12, a20
v_accvgpr_read_b32 v13, a21
v_accvgpr_read_b32 v14, a22
v_accvgpr_read_b32 v15, a23
v_mul_f32 v12, v12, v23
v_mul_f32 v13, v13, v23
v_mul_f32 v14, v14, v23
v_mul_f32 v15, v15, v23
v_accvgpr_write_b32 a20, v12
v_accvgpr_write_b32 a21, v13
v_accvgpr_write_b32 a22, v14
v_accvgpr_write_b32 a23, v15
v_accvgpr_read_b32 v12, a32
v_accvgpr_read_b32 v13, a33
v_accvgpr_read_b32 v14, a34
v_accvgpr_read_b32 v15, a35
v_mul_f32 v12, v12, v23
v_mul_f32 v13, v13, v23
v_mul_f32 v14, v14, v23
v_mul_f32 v15, v15, v23
v_accvgpr_write_b32 a32, v12
v_accvgpr_write_b32 a33, v13
v_accvgpr_write_b32 a34, v14
v_accvgpr_write_b32 a35, v15
v_accvgpr_read_b32 v12, a44
v_accvgpr_read_b32 v13, a45
v_accvgpr_read_b32 v14, a46
v_accvgpr_read_b32 v15, a47
v_mul_f32 v12, v12, v23
v_mul_f32 v13, v13, v23
v_mul_f32 v14, v14, v23
v_mul_f32 v15, v15, v23
v_accvgpr_write_b32 a44, v12
v_accvgpr_write_b32 a45, v13
v_accvgpr_write_b32 a46, v14
v_accvgpr_write_b32 a47, v15
v_accvgpr_read_b32 v12, a56
v_accvgpr_read_b32 v13, a57
v_accvgpr_read_b32 v14, a58
v_accvgpr_read_b32 v15, a59
v_mul_f32 v12, v12, v23
v_mul_f32 v13, v13, v23
v_mul_f32 v14, v14, v23
v_mul_f32 v15, v15, v23
v_accvgpr_write_b32 a56, v12
v_accvgpr_write_b32 a57, v13
v_accvgpr_write_b32 a58, v14
v_accvgpr_write_b32 a59, v15
v_accvgpr_read_b32 v12, a68
v_accvgpr_read_b32 v13, a69
v_accvgpr_read_b32 v14, a70
v_accvgpr_read_b32 v15, a71
v_mul_f32 v12, v12, v23
v_mul_f32 v13, v13, v23
v_mul_f32 v14, v14, v23
v_mul_f32 v15, v15, v23
v_accvgpr_write_b32 a68, v12
v_accvgpr_write_b32 a69, v13
v_accvgpr_write_b32 a70, v14
v_accvgpr_write_b32 a71, v15
v_accvgpr_read_b32 v12, a80
v_accvgpr_read_b32 v13, a81
v_accvgpr_read_b32 v14, a82
v_accvgpr_read_b32 v15, a83
v_mul_f32 v12, v12, v23
v_mul_f32 v13, v13, v23
v_mul_f32 v14, v14, v23
v_mul_f32 v15, v15, v23
v_accvgpr_write_b32 a80, v12
v_accvgpr_write_b32 a81, v13
v_accvgpr_write_b32 a82, v14
v_accvgpr_write_b32 a83, v15
v_accvgpr_read_b32 v12, a92
v_accvgpr_read_b32 v13, a93
v_accvgpr_read_b32 v14, a94
v_accvgpr_read_b32 v15, a95
v_mul_f32 v12, v12, v23
v_mul_f32 v13, v13, v23
v_mul_f32 v14, v14, v23
v_mul_f32 v15, v15, v23
v_accvgpr_write_b32 a92, v12
v_accvgpr_write_b32 a93, v13
v_accvgpr_write_b32 a94, v14
v_accvgpr_write_b32 a95, v15
v_accvgpr_read_b32 v12, a104
v_accvgpr_read_b32 v13, a105
v_accvgpr_read_b32 v14, a106
v_accvgpr_read_b32 v15, a107
v_mul_f32 v12, v12, v23
v_mul_f32 v13, v13, v23
v_mul_f32 v14, v14, v23
v_mul_f32 v15, v15, v23
v_accvgpr_write_b32 a104, v12
v_accvgpr_write_b32 a105, v13
v_accvgpr_write_b32 a106, v14
v_accvgpr_write_b32 a107, v15
v_accvgpr_read_b32 v12, a116
v_accvgpr_read_b32 v13, a117
v_accvgpr_read_b32 v14, a118
v_accvgpr_read_b32 v15, a119
v_mul_f32 v12, v12, v23
v_mul_f32 v13, v13, v23
v_mul_f32 v14, v14, v23
v_mul_f32 v15, v15, v23
v_accvgpr_write_b32 a116, v12
v_accvgpr_write_b32 a117, v13
v_accvgpr_write_b32 a118, v14
v_accvgpr_write_b32 a119, v15
v_accvgpr_read_b32 v12, a128
v_accvgpr_read_b32 v13, a129
v_accvgpr_read_b32 v14, a130
v_accvgpr_read_b32 v15, a131
v_mul_f32 v12, v12, v23
v_mul_f32 v13, v13, v23
v_mul_f32 v14, v14, v23
v_mul_f32 v15, v15, v23
v_accvgpr_write_b32 a128, v12
v_accvgpr_write_b32 a129, v13
v_accvgpr_write_b32 a130, v14
v_accvgpr_write_b32 a131, v15
v_accvgpr_read_b32 v12, a140
v_accvgpr_read_b32 v13, a141
v_accvgpr_read_b32 v14, a142
v_accvgpr_read_b32 v15, a143
v_mul_f32 v12, v12, v23
v_mul_f32 v13, v13, v23
v_mul_f32 v14, v14, v23
v_mul_f32 v15, v15, v23
v_accvgpr_write_b32 a140, v12
v_accvgpr_write_b32 a141, v13
v_accvgpr_write_b32 a142, v14
v_accvgpr_write_b32 a143, v15
v_accvgpr_read_b32 v12, a152
v_accvgpr_read_b32 v13, a153
v_accvgpr_read_b32 v14, a154
v_accvgpr_read_b32 v15, a155
v_mul_f32 v12, v12, v23
v_mul_f32 v13, v13, v23
v_mul_f32 v14, v14, v23
v_mul_f32 v15, v15, v23
v_accvgpr_write_b32 a152, v12
v_accvgpr_write_b32 a153, v13
v_accvgpr_write_b32 a154, v14
v_accvgpr_write_b32 a155, v15
v_accvgpr_read_b32 v12, a164
v_accvgpr_read_b32 v13, a165
v_accvgpr_read_b32 v14, a166
v_accvgpr_read_b32 v15, a167
v_mul_f32 v12, v12, v23
v_mul_f32 v13, v13, v23
v_mul_f32 v14, v14, v23
v_mul_f32 v15, v15, v23
v_accvgpr_write_b32 a164, v12
v_accvgpr_write_b32 a165, v13
v_accvgpr_write_b32 a166, v14
v_accvgpr_write_b32 a167, v15
v_accvgpr_read_b32 v12, a176
v_accvgpr_read_b32 v13, a177
v_accvgpr_read_b32 v14, a178
v_accvgpr_read_b32 v15, a179
v_mul_f32 v12, v12, v23
v_mul_f32 v13, v13, v23
v_mul_f32 v14, v14, v23
v_mul_f32 v15, v15, v23
v_accvgpr_write_b32 a176, v12
v_accvgpr_write_b32 a177, v13
v_accvgpr_write_b32 a178, v14
v_accvgpr_write_b32 a179, v15
v_accvgpr_read_b32 v12, a188
v_accvgpr_read_b32 v13, a189
v_accvgpr_read_b32 v14, a190
v_accvgpr_read_b32 v15, a191
v_mul_f32 v12, v12, v23
v_mul_f32 v13, v13, v23
v_mul_f32 v14, v14, v23
v_mul_f32 v15, v15, v23
v_accvgpr_write_b32 a188, v12
v_accvgpr_write_b32 a189, v13
v_accvgpr_write_b32 a190, v14
v_accvgpr_write_b32 a191, v15
v_exp_f32 v12, v160
v_exp_f32 v13, v161
v_exp_f32 v14, v162
v_add_f32 v18, v12, v13
v_cvt_pk_bf16_f32 v196, v12, v13
v_exp_f32 v15, v163
v_add_f32 v18, v18, v14
v_exp_f32 v12, v172
v_add_f32 v18, v18, v15
v_cvt_pk_bf16_f32 v197, v14, v15
v_exp_f32 v13, v173
v_add_f32 v18, v18, v12
v_exp_f32 v14, v174
v_add_f32 v18, v18, v13
v_cvt_pk_bf16_f32 v198, v12, v13
v_exp_f32 v15, v175
v_add_f32 v18, v18, v14
v_add_f32 v18, v18, v15
v_cvt_pk_bf16_f32 v199, v14, v15
s_nop 1
s_setpc_b64 s[84:85]
L_slow43:
s_call_b64 s[84:85], L_slow_1_1
s_branch L_back44
L_poll45:
ds_read_b32 v11, v9
s_waitcnt lgkmcnt(0)
v_readfirstlane_b32 s39, v11
s_nop 0
s_cmp_ge_u32 s39, s38
s_cbranch_scc1 L_ret46
s_sleep 1
s_add_u32 s53, s53, 1
s_cmp_lt_u32 s53, 1048576
s_cbranch_scc1 L_poll45
s_endpgm
L_poll47:
ds_read_b32 v11, v9
s_waitcnt lgkmcnt(0)
v_readfirstlane_b32 s39, v11
s_nop 0
s_cmp_ge_u32 s39, s38
s_cbranch_scc1 L_ret48
s_sleep 1
s_add_u32 s53, s53, 1
s_cmp_lt_u32 s53, 1048576
s_cbranch_scc1 L_poll47
s_endpgm
L_slow51:
s_call_b64 s[84:85], L_slow_0_1
s_branch L_back52
L_poll53:
ds_read_b32 v11, v9
s_waitcnt lgkmcnt(0)
v_readfirstlane_b32 s39, v11
s_nop 0
s_cmp_ge_u32 s39, s38
s_cbranch_scc1 L_ret54
s_sleep 1
s_add_u32 s53, s53, 1
s_cmp_lt_u32 s53, 1048576
s_cbranch_scc1 L_poll53
s_endpgm
L_slow_1_0:
s_nop 15
v_max3_f32 v22, v152, v153, v154
v_max3_f32 v22, v22, v155, v164
v_max3_f32 v22, v22, v165, v166
v_max_f32 v22, v22, v167
v_mov_b32 v23, v22
s_nop 1
v_permlane32_swap_b32 v23, v22
s_nop 1
v_max_f32 v22, v22, v23
v_mov_b32 v23, v22
s_nop 1
v_permlane16_swap_b32 v23, v22
s_nop 1
v_max_f32 v22, v22, v23
v_max_f32 v22, 0, v22
v_sub_f32 v152, v152, v22
v_sub_f32 v153, v153, v22
v_sub_f32 v154, v154, v22
v_sub_f32 v155, v155, v22
v_sub_f32 v164, v164, v22
v_sub_f32 v165, v165, v22
v_sub_f32 v166, v166, v22
v_sub_f32 v167, v167, v22
v_sub_f32 v224, v224, v22
v_sub_f32 v225, v225, v22
v_sub_f32 v226, v226, v22
v_sub_f32 v227, v227, v22
v_sub_f32 v23, 0, v22
v_exp_f32 v23, v23
s_nop 0
v_mul_f32 v19, v19, v23
v_accvgpr_read_b32 v12, a0
v_accvgpr_read_b32 v13, a1
v_accvgpr_read_b32 v14, a2
v_accvgpr_read_b32 v15, a3
v_mul_f32 v12, v12, v23
v_mul_f32 v13, v13, v23
v_mul_f32 v14, v14, v23
v_mul_f32 v15, v15, v23
v_accvgpr_write_b32 a0, v12
v_accvgpr_write_b32 a1, v13
v_accvgpr_write_b32 a2, v14
v_accvgpr_write_b32 a3, v15
v_accvgpr_read_b32 v12, a12
v_accvgpr_read_b32 v13, a13
v_accvgpr_read_b32 v14, a14
v_accvgpr_read_b32 v15, a15
v_mul_f32 v12, v12, v23
v_mul_f32 v13, v13, v23
v_mul_f32 v14, v14, v23
v_mul_f32 v15, v15, v23
v_accvgpr_write_b32 a12, v12
v_accvgpr_write_b32 a13, v13
v_accvgpr_write_b32 a14, v14
v_accvgpr_write_b32 a15, v15
v_accvgpr_read_b32 v12, a24
v_accvgpr_read_b32 v13, a25
v_accvgpr_read_b32 v14, a26
v_accvgpr_read_b32 v15, a27
v_mul_f32 v12, v12, v23
v_mul_f32 v13, v13, v23
v_mul_f32 v14, v14, v23
v_mul_f32 v15, v15, v23
v_accvgpr_write_b32 a24, v12
v_accvgpr_write_b32 a25, v13
v_accvgpr_write_b32 a26, v14
v_accvgpr_write_b32 a27, v15
v_accvgpr_read_b32 v12, a36
v_accvgpr_read_b32 v13, a37
v_accvgpr_read_b32 v14, a38
v_accvgpr_read_b32 v15, a39
v_mul_f32 v12, v12, v23
v_mul_f32 v13, v13, v23
v_mul_f32 v14, v14, v23
v_mul_f32 v15, v15, v23
v_accvgpr_write_b32 a36, v12
v_accvgpr_write_b32 a37, v13
v_accvgpr_write_b32 a38, v14
v_accvgpr_write_b32 a39, v15
v_accvgpr_read_b32 v12, a48
v_accvgpr_read_b32 v13, a49
v_accvgpr_read_b32 v14, a50
v_accvgpr_read_b32 v15, a51
v_mul_f32 v12, v12, v23
v_mul_f32 v13, v13, v23
v_mul_f32 v14, v14, v23
v_mul_f32 v15, v15, v23
v_accvgpr_write_b32 a48, v12
v_accvgpr_write_b32 a49, v13
v_accvgpr_write_b32 a50, v14
v_accvgpr_write_b32 a51, v15
v_accvgpr_read_b32 v12, a60
v_accvgpr_read_b32 v13, a61
v_accvgpr_read_b32 v14, a62
v_accvgpr_read_b32 v15, a63
v_mul_f32 v12, v12, v23
v_mul_f32 v13, v13, v23
v_mul_f32 v14, v14, v23
v_mul_f32 v15, v15, v23
v_accvgpr_write_b32 a60, v12
v_accvgpr_write_b32 a61, v13
v_accvgpr_write_b32 a62, v14
v_accvgpr_write_b32 a63, v15
v_accvgpr_read_b32 v12, a72
v_accvgpr_read_b32 v13, a73
v_accvgpr_read_b32 v14, a74
v_accvgpr_read_b32 v15, a75
v_mul_f32 v12, v12, v23
v_mul_f32 v13, v13, v23
v_mul_f32 v14, v14, v23
v_mul_f32 v15, v15, v23
v_accvgpr_write_b32 a72, v12
v_accvgpr_write_b32 a73, v13
v_accvgpr_write_b32 a74, v14
v_accvgpr_write_b32 a75, v15
v_accvgpr_read_b32 v12, a84
v_accvgpr_read_b32 v13, a85
v_accvgpr_read_b32 v14, a86
v_accvgpr_read_b32 v15, a87
v_mul_f32 v12, v12, v23
v_mul_f32 v13, v13, v23
v_mul_f32 v14, v14, v23
v_mul_f32 v15, v15, v23
v_accvgpr_write_b32 a84, v12
v_accvgpr_write_b32 a85, v13
v_accvgpr_write_b32 a86, v14
v_accvgpr_write_b32 a87, v15
v_accvgpr_read_b32 v12, a96
v_accvgpr_read_b32 v13, a97
v_accvgpr_read_b32 v14, a98
v_accvgpr_read_b32 v15, a99
v_mul_f32 v12, v12, v23
v_mul_f32 v13, v13, v23
v_mul_f32 v14, v14, v23
v_mul_f32 v15, v15, v23
v_accvgpr_write_b32 a96, v12
v_accvgpr_write_b32 a97, v13
v_accvgpr_write_b32 a98, v14
v_accvgpr_write_b32 a99, v15
v_accvgpr_read_b32 v12, a108
v_accvgpr_read_b32 v13, a109
v_accvgpr_read_b32 v14, a110
v_accvgpr_read_b32 v15, a111
v_mul_f32 v12, v12, v23
v_mul_f32 v13, v13, v23
v_mul_f32 v14, v14, v23
v_mul_f32 v15, v15, v23
v_accvgpr_write_b32 a108, v12
v_accvgpr_write_b32 a109, v13
v_accvgpr_write_b32 a110, v14
v_accvgpr_write_b32 a111, v15
v_accvgpr_read_b32 v12, a120
v_accvgpr_read_b32 v13, a121
v_accvgpr_read_b32 v14, a122
v_accvgpr_read_b32 v15, a123
v_mul_f32 v12, v12, v23
v_mul_f32 v13, v13, v23
v_mul_f32 v14, v14, v23
v_mul_f32 v15, v15, v23
v_accvgpr_write_b32 a120, v12
v_accvgpr_write_b32 a121, v13
v_accvgpr_write_b32 a122, v14
v_accvgpr_write_b32 a123, v15
v_accvgpr_read_b32 v12, a132
v_accvgpr_read_b32 v13, a133
v_accvgpr_read_b32 v14, a134
v_accvgpr_read_b32 v15, a135
v_mul_f32 v12, v12, v23
v_mul_f32 v13, v13, v23
v_mul_f32 v14, v14, v23
v_mul_f32 v15, v15, v23
v_accvgpr_write_b32 a132, v12
v_accvgpr_write_b32 a133, v13
v_accvgpr_write_b32 a134, v14
v_accvgpr_write_b32 a135, v15
v_accvgpr_read_b32 v12, a144
v_accvgpr_read_b32 v13, a145
v_accvgpr_read_b32 v14, a146
v_accvgpr_read_b32 v15, a147
v_mul_f32 v12, v12, v23
v_mul_f32 v13, v13, v23
v_mul_f32 v14, v14, v23
v_mul_f32 v15, v15, v23
v_accvgpr_write_b32 a144, v12
v_accvgpr_write_b32 a145, v13
v_accvgpr_write_b32 a146, v14
v_accvgpr_write_b32 a147, v15
v_accvgpr_read_b32 v12, a156
v_accvgpr_read_b32 v13, a157
v_accvgpr_read_b32 v14, a158
v_accvgpr_read_b32 v15, a159
v_mul_f32 v12, v12, v23
v_mul_f32 v13, v13, v23
v_mul_f32 v14, v14, v23
v_mul_f32 v15, v15, v23
v_accvgpr_write_b32 a156, v12
v_accvgpr_write_b32 a157, v13
v_accvgpr_write_b32 a158, v14
v_accvgpr_write_b32 a159, v15
v_accvgpr_read_b32 v12, a168
v_accvgpr_read_b32 v13, a169
v_accvgpr_read_b32 v14, a170
v_accvgpr_read_b32 v15, a171
v_mul_f32 v12, v12, v23
v_mul_f32 v13, v13, v23
v_mul_f32 v14, v14, v23
v_mul_f32 v15, v15, v23
v_accvgpr_write_b32 a168, v12
v_accvgpr_write_b32 a169, v13
v_accvgpr_write_b32 a170, v14
v_accvgpr_write_b32 a171, v15
v_accvgpr_read_b32 v12, a180
v_accvgpr_read_b32 v13, a181
v_accvgpr_read_b32 v14, a182
v_accvgpr_read_b32 v15, a183
v_mul_f32 v12, v12, v23
v_mul_f32 v13, v13, v23
v_mul_f32 v14, v14, v23
v_mul_f32 v15, v15, v23
v_accvgpr_write_b32 a180, v12
v_accvgpr_write_b32 a181, v13
v_accvgpr_write_b32 a182, v14
v_accvgpr_write_b32 a183, v15
v_exp_f32 v12, v152
v_exp_f32 v13, v153
v_exp_f32 v14, v154
v_add_f32 v16, v12, v13
v_cvt_pk_bf16_f32 v188, v12, v13
v_exp_f32 v15, v155
v_add_f32 v16, v16, v14
v_exp_f32 v12, v164
v_add_f32 v16, v16, v15
v_cvt_pk_bf16_f32 v189, v14, v15
v_exp_f32 v13, v165
v_add_f32 v16, v16, v12
v_exp_f32 v14, v166
v_add_f32 v16, v16, v13
v_cvt_pk_bf16_f32 v190, v12, v13
v_exp_f32 v15, v167
v_add_f32 v16, v16, v14
v_add_f32 v16, v16, v15
v_cvt_pk_bf16_f32 v191, v14, v15
v_max3_f32 v22, v156, v157, v158
v_max3_f32 v22, v22, v159, v168
v_max3_f32 v22, v22, v169, v170
v_max_f32 v22, v22, v171
v_mov_b32 v23, v22
s_nop 1
v_permlane32_swap_b32 v23, v22
s_nop 1
v_max_f32 v22, v22, v23
v_mov_b32 v23, v22
s_nop 1
v_permlane16_swap_b32 v23, v22
s_nop 1
v_max_f32 v22, v22, v23
v_max_f32 v22, 0, v22
v_sub_f32 v156, v156, v22
v_sub_f32 v157, v157, v22
v_sub_f32 v158, v158, v22
v_sub_f32 v159, v159, v22
v_sub_f32 v168, v168, v22
v_sub_f32 v169, v169, v22
v_sub_f32 v170, v170, v22
v_sub_f32 v171, v171, v22
v_sub_f32 v228, v228, v22
v_sub_f32 v229, v229, v22
v_sub_f32 v230, v230, v22
v_sub_f32 v231, v231, v22
v_sub_f32 v23, 0, v22
v_exp_f32 v23, v23
s_nop 0
v_mul_f32 v20, v20, v23
v_accvgpr_read_b32 v12, a4
v_accvgpr_read_b32 v13, a5
v_accvgpr_read_b32 v14, a6
v_accvgpr_read_b32 v15, a7
v_mul_f32 v12, v12, v23
v_mul_f32 v13, v13, v23
v_mul_f32 v14, v14, v23
v_mul_f32 v15, v15, v23
v_accvgpr_write_b32 a4, v12
v_accvgpr_write_b32 a5, v13
v_accvgpr_write_b32 a6, v14
v_accvgpr_write_b32 a7, v15
v_accvgpr_read_b32 v12, a16
v_accvgpr_read_b32 v13, a17
v_accvgpr_read_b32 v14, a18
v_accvgpr_read_b32 v15, a19
v_mul_f32 v12, v12, v23
v_mul_f32 v13, v13, v23
v_mul_f32 v14, v14, v23
v_mul_f32 v15, v15, v23
v_accvgpr_write_b32 a16, v12
v_accvgpr_write_b32 a17, v13
v_accvgpr_write_b32 a18, v14
v_accvgpr_write_b32 a19, v15
v_accvgpr_read_b32 v12, a28
v_accvgpr_read_b32 v13, a29
v_accvgpr_read_b32 v14, a30
v_accvgpr_read_b32 v15, a31
v_mul_f32 v12, v12, v23
v_mul_f32 v13, v13, v23
v_mul_f32 v14, v14, v23
v_mul_f32 v15, v15, v23
v_accvgpr_write_b32 a28, v12
v_accvgpr_write_b32 a29, v13
v_accvgpr_write_b32 a30, v14
v_accvgpr_write_b32 a31, v15
v_accvgpr_read_b32 v12, a40
v_accvgpr_read_b32 v13, a41
v_accvgpr_read_b32 v14, a42
v_accvgpr_read_b32 v15, a43
v_mul_f32 v12, v12, v23
v_mul_f32 v13, v13, v23
v_mul_f32 v14, v14, v23
v_mul_f32 v15, v15, v23
v_accvgpr_write_b32 a40, v12
v_accvgpr_write_b32 a41, v13
v_accvgpr_write_b32 a42, v14
v_accvgpr_write_b32 a43, v15
v_accvgpr_read_b32 v12, a52
v_accvgpr_read_b32 v13, a53
v_accvgpr_read_b32 v14, a54
v_accvgpr_read_b32 v15, a55
v_mul_f32 v12, v12, v23
v_mul_f32 v13, v13, v23
v_mul_f32 v14, v14, v23
v_mul_f32 v15, v15, v23
v_accvgpr_write_b32 a52, v12
v_accvgpr_write_b32 a53, v13
v_accvgpr_write_b32 a54, v14
v_accvgpr_write_b32 a55, v15
v_accvgpr_read_b32 v12, a64
v_accvgpr_read_b32 v13, a65
v_accvgpr_read_b32 v14, a66
v_accvgpr_read_b32 v15, a67
v_mul_f32 v12, v12, v23
v_mul_f32 v13, v13, v23
v_mul_f32 v14, v14, v23
v_mul_f32 v15, v15, v23
v_accvgpr_write_b32 a64, v12
v_accvgpr_write_b32 a65, v13
v_accvgpr_write_b32 a66, v14
v_accvgpr_write_b32 a67, v15
v_accvgpr_read_b32 v12, a76
v_accvgpr_read_b32 v13, a77
v_accvgpr_read_b32 v14, a78
v_accvgpr_read_b32 v15, a79
v_mul_f32 v12, v12, v23
v_mul_f32 v13, v13, v23
v_mul_f32 v14, v14, v23
v_mul_f32 v15, v15, v23
v_accvgpr_write_b32 a76, v12
v_accvgpr_write_b32 a77, v13
v_accvgpr_write_b32 a78, v14
v_accvgpr_write_b32 a79, v15
v_accvgpr_read_b32 v12, a88
v_accvgpr_read_b32 v13, a89
v_accvgpr_read_b32 v14, a90
v_accvgpr_read_b32 v15, a91
v_mul_f32 v12, v12, v23
v_mul_f32 v13, v13, v23
v_mul_f32 v14, v14, v23
v_mul_f32 v15, v15, v23
v_accvgpr_write_b32 a88, v12
v_accvgpr_write_b32 a89, v13
v_accvgpr_write_b32 a90, v14
v_accvgpr_write_b32 a91, v15
v_accvgpr_read_b32 v12, a100
v_accvgpr_read_b32 v13, a101
v_accvgpr_read_b32 v14, a102
v_accvgpr_read_b32 v15, a103
v_mul_f32 v12, v12, v23
v_mul_f32 v13, v13, v23
v_mul_f32 v14, v14, v23
v_mul_f32 v15, v15, v23
v_accvgpr_write_b32 a100, v12
v_accvgpr_write_b32 a101, v13
v_accvgpr_write_b32 a102, v14
v_accvgpr_write_b32 a103, v15
v_accvgpr_read_b32 v12, a112
v_accvgpr_read_b32 v13, a113
v_accvgpr_read_b32 v14, a114
v_accvgpr_read_b32 v15, a115
v_mul_f32 v12, v12, v23
v_mul_f32 v13, v13, v23
v_mul_f32 v14, v14, v23
v_mul_f32 v15, v15, v23
v_accvgpr_write_b32 a112, v12
v_accvgpr_write_b32 a113, v13
v_accvgpr_write_b32 a114, v14
v_accvgpr_write_b32 a115, v15
v_accvgpr_read_b32 v12, a124
v_accvgpr_read_b32 v13, a125
v_accvgpr_read_b32 v14, a126
v_accvgpr_read_b32 v15, a127
v_mul_f32 v12, v12, v23
v_mul_f32 v13, v13, v23
v_mul_f32 v14, v14, v23
v_mul_f32 v15, v15, v23
v_accvgpr_write_b32 a124, v12
v_accvgpr_write_b32 a125, v13
v_accvgpr_write_b32 a126, v14
v_accvgpr_write_b32 a127, v15
v_accvgpr_read_b32 v12, a136
v_accvgpr_read_b32 v13, a137
v_accvgpr_read_b32 v14, a138
v_accvgpr_read_b32 v15, a139
v_mul_f32 v12, v12, v23
v_mul_f32 v13, v13, v23
v_mul_f32 v14, v14, v23
v_mul_f32 v15, v15, v23
v_accvgpr_write_b32 a136, v12
v_accvgpr_write_b32 a137, v13
v_accvgpr_write_b32 a138, v14
v_accvgpr_write_b32 a139, v15
v_accvgpr_read_b32 v12, a148
v_accvgpr_read_b32 v13, a149
v_accvgpr_read_b32 v14, a150
v_accvgpr_read_b32 v15, a151
v_mul_f32 v12, v12, v23
v_mul_f32 v13, v13, v23
v_mul_f32 v14, v14, v23
v_mul_f32 v15, v15, v23
v_accvgpr_write_b32 a148, v12
v_accvgpr_write_b32 a149, v13
v_accvgpr_write_b32 a150, v14
v_accvgpr_write_b32 a151, v15
v_accvgpr_read_b32 v12, a160
v_accvgpr_read_b32 v13, a161
v_accvgpr_read_b32 v14, a162
v_accvgpr_read_b32 v15, a163
v_mul_f32 v12, v12, v23
v_mul_f32 v13, v13, v23
v_mul_f32 v14, v14, v23
v_mul_f32 v15, v15, v23
v_accvgpr_write_b32 a160, v12
v_accvgpr_write_b32 a161, v13
v_accvgpr_write_b32 a162, v14
v_accvgpr_write_b32 a163, v15
v_accvgpr_read_b32 v12, a172
v_accvgpr_read_b32 v13, a173
v_accvgpr_read_b32 v14, a174
v_accvgpr_read_b32 v15, a175
v_mul_f32 v12, v12, v23
v_mul_f32 v13, v13, v23
v_mul_f32 v14, v14, v23
v_mul_f32 v15, v15, v23
v_accvgpr_write_b32 a172, v12
v_accvgpr_write_b32 a173, v13
v_accvgpr_write_b32 a174, v14
v_accvgpr_write_b32 a175, v15
v_accvgpr_read_b32 v12, a184
v_accvgpr_read_b32 v13, a185
v_accvgpr_read_b32 v14, a186
v_accvgpr_read_b32 v15, a187
v_mul_f32 v12, v12, v23
v_mul_f32 v13, v13, v23
v_mul_f32 v14, v14, v23
v_mul_f32 v15, v15, v23
v_accvgpr_write_b32 a184, v12
v_accvgpr_write_b32 a185, v13
v_accvgpr_write_b32 a186, v14
v_accvgpr_write_b32 a187, v15
v_exp_f32 v12, v156
v_exp_f32 v13, v157
v_exp_f32 v14, v158
v_add_f32 v17, v12, v13
v_cvt_pk_bf16_f32 v192, v12, v13
v_exp_f32 v15, v159
v_add_f32 v17, v17, v14
v_exp_f32 v12, v168
v_add_f32 v17, v17, v15
v_cvt_pk_bf16_f32 v193, v14, v15
v_exp_f32 v13, v169
v_add_f32 v17, v17, v12
v_exp_f32 v14, v170
v_add_f32 v17, v17, v13
v_cvt_pk_bf16_f32 v194, v12, v13
v_exp_f32 v15, v171
v_add_f32 v17, v17, v14
v_add_f32 v17, v17, v15
v_cvt_pk_bf16_f32 v195, v14, v15
v_max3_f32 v22, v160, v161, v162
v_max3_f32 v22, v22, v163, v172
v_max3_f32 v22, v22, v173, v174
v_max_f32 v22, v22, v175
v_mov_b32 v23, v22
s_nop 1
v_permlane32_swap_b32 v23, v22
s_nop 1
v_max_f32 v22, v22, v23
v_mov_b32 v23, v22
s_nop 1
v_permlane16_swap_b32 v23, v22
s_nop 1
v_max_f32 v22, v22, v23
v_max_f32 v22, 0, v22
v_sub_f32 v160, v160, v22
v_sub_f32 v161, v161, v22
v_sub_f32 v162, v162, v22
v_sub_f32 v163, v163, v22
v_sub_f32 v172, v172, v22
v_sub_f32 v173, v173, v22
v_sub_f32 v174, v174, v22
v_sub_f32 v175, v175, v22
v_sub_f32 v232, v232, v22
v_sub_f32 v233, v233, v22
v_sub_f32 v234, v234, v22
v_sub_f32 v235, v235, v22
v_sub_f32 v23, 0, v22
v_exp_f32 v23, v23
s_nop 0
v_mul_f32 v21, v21, v23
v_accvgpr_read_b32 v12, a8
v_accvgpr_read_b32 v13, a9
v_accvgpr_read_b32 v14, a10
v_accvgpr_read_b32 v15, a11
v_mul_f32 v12, v12, v23
v_mul_f32 v13, v13, v23
v_mul_f32 v14, v14, v23
v_mul_f32 v15, v15, v23
v_accvgpr_write_b32 a8, v12
v_accvgpr_write_b32 a9, v13
v_accvgpr_write_b32 a10, v14
v_accvgpr_write_b32 a11, v15
v_accvgpr_read_b32 v12, a20
v_accvgpr_read_b32 v13, a21
v_accvgpr_read_b32 v14, a22
v_accvgpr_read_b32 v15, a23
v_mul_f32 v12, v12, v23
v_mul_f32 v13, v13, v23
v_mul_f32 v14, v14, v23
v_mul_f32 v15, v15, v23
v_accvgpr_write_b32 a20, v12
v_accvgpr_write_b32 a21, v13
v_accvgpr_write_b32 a22, v14
v_accvgpr_write_b32 a23, v15
v_accvgpr_read_b32 v12, a32
v_accvgpr_read_b32 v13, a33
v_accvgpr_read_b32 v14, a34
v_accvgpr_read_b32 v15, a35
v_mul_f32 v12, v12, v23
v_mul_f32 v13, v13, v23
v_mul_f32 v14, v14, v23
v_mul_f32 v15, v15, v23
v_accvgpr_write_b32 a32, v12
v_accvgpr_write_b32 a33, v13
v_accvgpr_write_b32 a34, v14
v_accvgpr_write_b32 a35, v15
v_accvgpr_read_b32 v12, a44
v_accvgpr_read_b32 v13, a45
v_accvgpr_read_b32 v14, a46
v_accvgpr_read_b32 v15, a47
v_mul_f32 v12, v12, v23
v_mul_f32 v13, v13, v23
v_mul_f32 v14, v14, v23
v_mul_f32 v15, v15, v23
v_accvgpr_write_b32 a44, v12
v_accvgpr_write_b32 a45, v13
v_accvgpr_write_b32 a46, v14
v_accvgpr_write_b32 a47, v15
v_accvgpr_read_b32 v12, a56
v_accvgpr_read_b32 v13, a57
v_accvgpr_read_b32 v14, a58
v_accvgpr_read_b32 v15, a59
v_mul_f32 v12, v12, v23
v_mul_f32 v13, v13, v23
v_mul_f32 v14, v14, v23
v_mul_f32 v15, v15, v23
v_accvgpr_write_b32 a56, v12
v_accvgpr_write_b32 a57, v13
v_accvgpr_write_b32 a58, v14
v_accvgpr_write_b32 a59, v15
v_accvgpr_read_b32 v12, a68
v_accvgpr_read_b32 v13, a69
v_accvgpr_read_b32 v14, a70
v_accvgpr_read_b32 v15, a71
v_mul_f32 v12, v12, v23
v_mul_f32 v13, v13, v23
v_mul_f32 v14, v14, v23
v_mul_f32 v15, v15, v23
v_accvgpr_write_b32 a68, v12
v_accvgpr_write_b32 a69, v13
v_accvgpr_write_b32 a70, v14
v_accvgpr_write_b32 a71, v15
v_accvgpr_read_b32 v12, a80
v_accvgpr_read_b32 v13, a81
v_accvgpr_read_b32 v14, a82
v_accvgpr_read_b32 v15, a83
v_mul_f32 v12, v12, v23
v_mul_f32 v13, v13, v23
v_mul_f32 v14, v14, v23
v_mul_f32 v15, v15, v23
v_accvgpr_write_b32 a80, v12
v_accvgpr_write_b32 a81, v13
v_accvgpr_write_b32 a82, v14
v_accvgpr_write_b32 a83, v15
v_accvgpr_read_b32 v12, a92
v_accvgpr_read_b32 v13, a93
v_accvgpr_read_b32 v14, a94
v_accvgpr_read_b32 v15, a95
v_mul_f32 v12, v12, v23
v_mul_f32 v13, v13, v23
v_mul_f32 v14, v14, v23
v_mul_f32 v15, v15, v23
v_accvgpr_write_b32 a92, v12
v_accvgpr_write_b32 a93, v13
v_accvgpr_write_b32 a94, v14
v_accvgpr_write_b32 a95, v15
v_accvgpr_read_b32 v12, a104
v_accvgpr_read_b32 v13, a105
v_accvgpr_read_b32 v14, a106
v_accvgpr_read_b32 v15, a107
v_mul_f32 v12, v12, v23
v_mul_f32 v13, v13, v23
v_mul_f32 v14, v14, v23
v_mul_f32 v15, v15, v23
v_accvgpr_write_b32 a104, v12
v_accvgpr_write_b32 a105, v13
v_accvgpr_write_b32 a106, v14
v_accvgpr_write_b32 a107, v15
v_accvgpr_read_b32 v12, a116
v_accvgpr_read_b32 v13, a117
v_accvgpr_read_b32 v14, a118
v_accvgpr_read_b32 v15, a119
v_mul_f32 v12, v12, v23
v_mul_f32 v13, v13, v23
v_mul_f32 v14, v14, v23
v_mul_f32 v15, v15, v23
v_accvgpr_write_b32 a116, v12
v_accvgpr_write_b32 a117, v13
v_accvgpr_write_b32 a118, v14
v_accvgpr_write_b32 a119, v15
v_accvgpr_read_b32 v12, a128
v_accvgpr_read_b32 v13, a129
v_accvgpr_read_b32 v14, a130
v_accvgpr_read_b32 v15, a131
v_mul_f32 v12, v12, v23
v_mul_f32 v13, v13, v23
v_mul_f32 v14, v14, v23
v_mul_f32 v15, v15, v23
v_accvgpr_write_b32 a128, v12
v_accvgpr_write_b32 a129, v13
v_accvgpr_write_b32 a130, v14
v_accvgpr_write_b32 a131, v15
v_accvgpr_read_b32 v12, a140
v_accvgpr_read_b32 v13, a141
v_accvgpr_read_b32 v14, a142
v_accvgpr_read_b32 v15, a143
v_mul_f32 v12, v12, v23
v_mul_f32 v13, v13, v23
v_mul_f32 v14, v14, v23
v_mul_f32 v15, v15, v23
v_accvgpr_write_b32 a140, v12
v_accvgpr_write_b32 a141, v13
v_accvgpr_write_b32 a142, v14
v_accvgpr_write_b32 a143, v15
v_accvgpr_read_b32 v12, a152
v_accvgpr_read_b32 v13, a153
v_accvgpr_read_b32 v14, a154
v_accvgpr_read_b32 v15, a155
v_mul_f32 v12, v12, v23
v_mul_f32 v13, v13, v23
v_mul_f32 v14, v14, v23
v_mul_f32 v15, v15, v23
v_accvgpr_write_b32 a152, v12
v_accvgpr_write_b32 a153, v13
v_accvgpr_write_b32 a154, v14
v_accvgpr_write_b32 a155, v15
v_accvgpr_read_b32 v12, a164
v_accvgpr_read_b32 v13, a165
v_accvgpr_read_b32 v14, a166
v_accvgpr_read_b32 v15, a167
v_mul_f32 v12, v12, v23
v_mul_f32 v13, v13, v23
v_mul_f32 v14, v14, v23
v_mul_f32 v15, v15, v23
v_accvgpr_write_b32 a164, v12
v_accvgpr_write_b32 a165, v13
v_accvgpr_write_b32 a166, v14
v_accvgpr_write_b32 a167, v15
v_accvgpr_read_b32 v12, a176
v_accvgpr_read_b32 v13, a177
v_accvgpr_read_b32 v14, a178
v_accvgpr_read_b32 v15, a179
v_mul_f32 v12, v12, v23
v_mul_f32 v13, v13, v23
v_mul_f32 v14, v14, v23
v_mul_f32 v15, v15, v23
v_accvgpr_write_b32 a176, v12
v_accvgpr_write_b32 a177, v13
v_accvgpr_write_b32 a178, v14
v_accvgpr_write_b32 a179, v15
v_accvgpr_read_b32 v12, a188
v_accvgpr_read_b32 v13, a189
v_accvgpr_read_b32 v14, a190
v_accvgpr_read_b32 v15, a191
v_mul_f32 v12, v12, v23
v_mul_f32 v13, v13, v23
v_mul_f32 v14, v14, v23
v_mul_f32 v15, v15, v23
v_accvgpr_write_b32 a188, v12
v_accvgpr_write_b32 a189, v13
v_accvgpr_write_b32 a190, v14
v_accvgpr_write_b32 a191, v15
v_exp_f32 v12, v160
v_exp_f32 v13, v161
v_exp_f32 v14, v162
v_add_f32 v18, v12, v13
v_cvt_pk_bf16_f32 v196, v12, v13
v_exp_f32 v15, v163
v_add_f32 v18, v18, v14
v_exp_f32 v12, v172
v_add_f32 v18, v18, v15
v_cvt_pk_bf16_f32 v197, v14, v15
v_exp_f32 v13, v173
v_add_f32 v18, v18, v12
v_exp_f32 v14, v174
v_add_f32 v18, v18, v13
v_cvt_pk_bf16_f32 v198, v12, v13
v_exp_f32 v15, v175
v_add_f32 v18, v18, v14
v_add_f32 v18, v18, v15
v_cvt_pk_bf16_f32 v199, v14, v15
s_nop 1
s_setpc_b64 s[84:85]
L_slow55:
s_call_b64 s[84:85], L_slow_1_0
s_branch L_back56
L_poll57:
ds_read_b32 v11, v9
s_waitcnt lgkmcnt(0)
v_readfirstlane_b32 s39, v11
s_nop 0
s_cmp_ge_u32 s39, s38
s_cbranch_scc1 L_ret58
s_sleep 1
s_add_u32 s53, s53, 1
s_cmp_lt_u32 s53, 1048576
s_cbranch_scc1 L_poll57
s_endpgm
L_op59:
buffer_load_dwordx2 v[214:215], v217, s[20:23], s51 offen sc1
s_waitcnt vmcnt(0)
v_readfirstlane_b32 s42, v214
v_readfirstlane_b32 s43, v215
s_nop 0
s_cmp_eq_u64 s[42:43], s[56:57]
s_cbranch_scc1 L_ok60
s_sleep 2
s_add_u32 s53, s53, 1
s_cmp_lt_u32 s53, 1048576
s_cbranch_scc1 L_op59
s_endpgm
L_slow63:
s_call_b64 s[84:85], L_slow_0_1
s_branch L_back64
L_poll65:
ds_read_b32 v11, v9
s_waitcnt lgkmcnt(0)
v_readfirstlane_b32 s39, v11
s_nop 0
s_cmp_ge_u32 s39, s38
s_cbranch_scc1 L_ret66
s_sleep 1
s_add_u32 s53, s53, 1
s_cmp_lt_u32 s53, 1048576
s_cbranch_scc1 L_poll65
s_endpgm
L_slow67:
s_call_b64 s[84:85], L_slow_1_0
s_branch L_back68
L_poll69:
ds_read_b32 v11, v9
s_waitcnt lgkmcnt(0)
v_readfirstlane_b32 s39, v11
s_nop 0
s_cmp_ge_u32 s39, s38
s_cbranch_scc1 L_ret70
s_sleep 1
s_add_u32 s53, s53, 1
s_cmp_lt_u32 s53, 1048576
s_cbranch_scc1 L_poll69
s_endpgm
L_merge71:
s_nop 15
s_waitcnt vmcnt(0)
v_sub_f32 v22, v224, v200
v_max_f32 v22, 0, v22
v_sub_f32 v224, v224, v22
v_sub_f32 v225, v225, v22
v_sub_f32 v226, v226, v22
v_sub_f32 v227, v227, v22
v_sub_f32 v23, 0, v22
v_exp_f32 v23, v23
s_nop 0
v_mul_f32 v19, v19, v23
v_accvgpr_read_b32 v12, a0
v_accvgpr_read_b32 v13, a1
v_accvgpr_read_b32 v14, a2
v_accvgpr_read_b32 v15, a3
v_mul_f32 v12, v12, v23
v_mul_f32 v13, v13, v23
v_mul_f32 v14, v14, v23
v_mul_f32 v15, v15, v23
v_accvgpr_write_b32 a0, v12
v_accvgpr_write_b32 a1, v13
v_accvgpr_write_b32 a2, v14
v_accvgpr_write_b32 a3, v15
v_accvgpr_read_b32 v12, a12
v_accvgpr_read_b32 v13, a13
v_accvgpr_read_b32 v14, a14
v_accvgpr_read_b32 v15, a15
v_mul_f32 v12, v12, v23
v_mul_f32 v13, v13, v23
v_mul_f32 v14, v14, v23
v_mul_f32 v15, v15, v23
v_accvgpr_write_b32 a12, v12
v_accvgpr_write_b32 a13, v13
v_accvgpr_write_b32 a14, v14
v_accvgpr_write_b32 a15, v15
v_accvgpr_read_b32 v12, a24
v_accvgpr_read_b32 v13, a25
v_accvgpr_read_b32 v14, a26
v_accvgpr_read_b32 v15, a27
v_mul_f32 v12, v12, v23
v_mul_f32 v13, v13, v23
v_mul_f32 v14, v14, v23
v_mul_f32 v15, v15, v23
v_accvgpr_write_b32 a24, v12
v_accvgpr_write_b32 a25, v13
v_accvgpr_write_b32 a26, v14
v_accvgpr_write_b32 a27, v15
v_accvgpr_read_b32 v12, a36
v_accvgpr_read_b32 v13, a37
v_accvgpr_read_b32 v14, a38
v_accvgpr_read_b32 v15, a39
v_mul_f32 v12, v12, v23
v_mul_f32 v13, v13, v23
v_mul_f32 v14, v14, v23
v_mul_f32 v15, v15, v23
v_accvgpr_write_b32 a36, v12
v_accvgpr_write_b32 a37, v13
v_accvgpr_write_b32 a38, v14
v_accvgpr_write_b32 a39, v15
v_accvgpr_read_b32 v12, a48
v_accvgpr_read_b32 v13, a49
v_accvgpr_read_b32 v14, a50
v_accvgpr_read_b32 v15, a51
v_mul_f32 v12, v12, v23
v_mul_f32 v13, v13, v23
v_mul_f32 v14, v14, v23
v_mul_f32 v15, v15, v23
v_accvgpr_write_b32 a48, v12
v_accvgpr_write_b32 a49, v13
v_accvgpr_write_b32 a50, v14
v_accvgpr_write_b32 a51, v15
v_accvgpr_read_b32 v12, a60
v_accvgpr_read_b32 v13, a61
v_accvgpr_read_b32 v14, a62
v_accvgpr_read_b32 v15, a63
v_mul_f32 v12, v12, v23
v_mul_f32 v13, v13, v23
v_mul_f32 v14, v14, v23
v_mul_f32 v15, v15, v23
v_accvgpr_write_b32 a60, v12
v_accvgpr_write_b32 a61, v13
v_accvgpr_write_b32 a62, v14
v_accvgpr_write_b32 a63, v15
v_accvgpr_read_b32 v12, a72
v_accvgpr_read_b32 v13, a73
v_accvgpr_read_b32 v14, a74
v_accvgpr_read_b32 v15, a75
v_mul_f32 v12, v12, v23
v_mul_f32 v13, v13, v23
v_mul_f32 v14, v14, v23
v_mul_f32 v15, v15, v23
v_accvgpr_write_b32 a72, v12
v_accvgpr_write_b32 a73, v13
v_accvgpr_write_b32 a74, v14
v_accvgpr_write_b32 a75, v15
v_accvgpr_read_b32 v12, a84
v_accvgpr_read_b32 v13, a85
v_accvgpr_read_b32 v14, a86
v_accvgpr_read_b32 v15, a87
v_mul_f32 v12, v12, v23
v_mul_f32 v13, v13, v23
v_mul_f32 v14, v14, v23
v_mul_f32 v15, v15, v23
v_accvgpr_write_b32 a84, v12
v_accvgpr_write_b32 a85, v13
v_accvgpr_write_b32 a86, v14
v_accvgpr_write_b32 a87, v15
v_accvgpr_read_b32 v12, a96
v_accvgpr_read_b32 v13, a97
v_accvgpr_read_b32 v14, a98
v_accvgpr_read_b32 v15, a99
v_mul_f32 v12, v12, v23
v_mul_f32 v13, v13, v23
v_mul_f32 v14, v14, v23
v_mul_f32 v15, v15, v23
v_accvgpr_write_b32 a96, v12
v_accvgpr_write_b32 a97, v13
v_accvgpr_write_b32 a98, v14
v_accvgpr_write_b32 a99, v15
v_accvgpr_read_b32 v12, a108
v_accvgpr_read_b32 v13, a109
v_accvgpr_read_b32 v14, a110
v_accvgpr_read_b32 v15, a111
v_mul_f32 v12, v12, v23
v_mul_f32 v13, v13, v23
v_mul_f32 v14, v14, v23
v_mul_f32 v15, v15, v23
v_accvgpr_write_b32 a108, v12
v_accvgpr_write_b32 a109, v13
v_accvgpr_write_b32 a110, v14
v_accvgpr_write_b32 a111, v15
v_accvgpr_read_b32 v12, a120
v_accvgpr_read_b32 v13, a121
v_accvgpr_read_b32 v14, a122
v_accvgpr_read_b32 v15, a123
v_mul_f32 v12, v12, v23
v_mul_f32 v13, v13, v23
v_mul_f32 v14, v14, v23
v_mul_f32 v15, v15, v23
v_accvgpr_write_b32 a120, v12
v_accvgpr_write_b32 a121, v13
v_accvgpr_write_b32 a122, v14
v_accvgpr_write_b32 a123, v15
v_accvgpr_read_b32 v12, a132
v_accvgpr_read_b32 v13, a133
v_accvgpr_read_b32 v14, a134
v_accvgpr_read_b32 v15, a135
v_mul_f32 v12, v12, v23
v_mul_f32 v13, v13, v23
v_mul_f32 v14, v14, v23
v_mul_f32 v15, v15, v23
v_accvgpr_write_b32 a132, v12
v_accvgpr_write_b32 a133, v13
v_accvgpr_write_b32 a134, v14
v_accvgpr_write_b32 a135, v15
v_accvgpr_read_b32 v12, a144
v_accvgpr_read_b32 v13, a145
v_accvgpr_read_b32 v14, a146
v_accvgpr_read_b32 v15, a147
v_mul_f32 v12, v12, v23
v_mul_f32 v13, v13, v23
v_mul_f32 v14, v14, v23
v_mul_f32 v15, v15, v23
v_accvgpr_write_b32 a144, v12
v_accvgpr_write_b32 a145, v13
v_accvgpr_write_b32 a146, v14
v_accvgpr_write_b32 a147, v15
v_accvgpr_read_b32 v12, a156
v_accvgpr_read_b32 v13, a157
v_accvgpr_read_b32 v14, a158
v_accvgpr_read_b32 v15, a159
v_mul_f32 v12, v12, v23
v_mul_f32 v13, v13, v23
v_mul_f32 v14, v14, v23
v_mul_f32 v15, v15, v23
v_accvgpr_write_b32 a156, v12
v_accvgpr_write_b32 a157, v13
v_accvgpr_write_b32 a158, v14
v_accvgpr_write_b32 a159, v15
v_accvgpr_read_b32 v12, a168
v_accvgpr_read_b32 v13, a169
v_accvgpr_read_b32 v14, a170
v_accvgpr_read_b32 v15, a171
v_mul_f32 v12, v12, v23
v_mul_f32 v13, v13, v23
v_mul_f32 v14, v14, v23
v_mul_f32 v15, v15, v23
v_accvgpr_write_b32 a168, v12
v_accvgpr_write_b32 a169, v13
v_accvgpr_write_b32 a170, v14
v_accvgpr_write_b32 a171, v15
v_accvgpr_read_b32 v12, a180
v_accvgpr_read_b32 v13, a181
v_accvgpr_read_b32 v14, a182
v_accvgpr_read_b32 v15, a183
v_mul_f32 v12, v12, v23
v_mul_f32 v13, v13, v23
v_mul_f32 v14, v14, v23
v_mul_f32 v15, v15, v23
v_accvgpr_write_b32 a180, v12
v_accvgpr_write_b32 a181, v13
v_accvgpr_write_b32 a182, v14
v_accvgpr_write_b32 a183, v15
v_sub_f32 v22, v224, v200
v_exp_f32 v22, v22
s_nop 0
v_mul_f32 v201, v201, v22
v_lshlrev_b32 v12, 16, v32
v_and_b32 v13, 0xffff0000, v32
v_mul_f32 v12, v12, v22
v_mul_f32 v13, v13, v22
v_cvt_pk_bf16_f32 v32, v12, v13
v_lshlrev_b32 v12, 16, v33
v_and_b32 v13, 0xffff0000, v33
v_mul_f32 v12, v12, v22
v_mul_f32 v13, v13, v22
v_cvt_pk_bf16_f32 v33, v12, v13
v_lshlrev_b32 v12, 16, v34
v_and_b32 v13, 0xffff0000, v34
v_mul_f32 v12, v12, v22
v_mul_f32 v13, v13, v22
v_cvt_pk_bf16_f32 v34, v12, v13
v_lshlrev_b32 v12, 16, v35
v_and_b32 v13, 0xffff0000, v35
v_mul_f32 v12, v12, v22
v_mul_f32 v13, v13, v22
v_cvt_pk_bf16_f32 v35, v12, v13
v_lshlrev_b32 v12, 16, v44
v_and_b32 v13, 0xffff0000, v44
v_mul_f32 v12, v12, v22
v_mul_f32 v13, v13, v22
v_cvt_pk_bf16_f32 v44, v12, v13
v_lshlrev_b32 v12, 16, v45
v_and_b32 v13, 0xffff0000, v45
v_mul_f32 v12, v12, v22
v_mul_f32 v13, v13, v22
v_cvt_pk_bf16_f32 v45, v12, v13
v_lshlrev_b32 v12, 16, v46
v_and_b32 v13, 0xffff0000, v46
v_mul_f32 v12, v12, v22
v_mul_f32 v13, v13, v22
v_cvt_pk_bf16_f32 v46, v12, v13
v_lshlrev_b32 v12, 16, v47
v_and_b32 v13, 0xffff0000, v47
v_mul_f32 v12, v12, v22
v_mul_f32 v13, v13, v22
v_cvt_pk_bf16_f32 v47, v12, v13
v_lshlrev_b32 v12, 16, v56
v_and_b32 v13, 0xffff0000, v56
v_mul_f32 v12, v12, v22
v_mul_f32 v13, v13, v22
v_cvt_pk_bf16_f32 v56, v12, v13
v_lshlrev_b32 v12, 16, v57
v_and_b32 v13, 0xffff0000, v57
v_mul_f32 v12, v12, v22
v_mul_f32 v13, v13, v22
v_cvt_pk_bf16_f32 v57, v12, v13
v_lshlrev_b32 v12, 16, v58
v_and_b32 v13, 0xffff0000, v58
v_mul_f32 v12, v12, v22
v_mul_f32 v13, v13, v22
v_cvt_pk_bf16_f32 v58, v12, v13
v_lshlrev_b32 v12, 16, v59
v_and_b32 v13, 0xffff0000, v59
v_mul_f32 v12, v12, v22
v_mul_f32 v13, v13, v22
v_cvt_pk_bf16_f32 v59, v12, v13
v_lshlrev_b32 v12, 16, v68
v_and_b32 v13, 0xffff0000, v68
v_mul_f32 v12, v12, v22
v_mul_f32 v13, v13, v22
v_cvt_pk_bf16_f32 v68, v12, v13
v_lshlrev_b32 v12, 16, v69
v_and_b32 v13, 0xffff0000, v69
v_mul_f32 v12, v12, v22
v_mul_f32 v13, v13, v22
v_cvt_pk_bf16_f32 v69, v12, v13
v_lshlrev_b32 v12, 16, v70
v_and_b32 v13, 0xffff0000, v70
v_mul_f32 v12, v12, v22
v_mul_f32 v13, v13, v22
v_cvt_pk_bf16_f32 v70, v12, v13
v_lshlrev_b32 v12, 16, v71
v_and_b32 v13, 0xffff0000, v71
v_mul_f32 v12, v12, v22
v_mul_f32 v13, v13, v22
v_cvt_pk_bf16_f32 v71, v12, v13
v_lshlrev_b32 v12, 16, v80
v_and_b32 v13, 0xffff0000, v80
v_mul_f32 v12, v12, v22
v_mul_f32 v13, v13, v22
v_cvt_pk_bf16_f32 v80, v12, v13
v_lshlrev_b32 v12, 16, v81
v_and_b32 v13, 0xffff0000, v81
v_mul_f32 v12, v12, v22
v_mul_f32 v13, v13, v22
v_cvt_pk_bf16_f32 v81, v12, v13
v_lshlrev_b32 v12, 16, v82
v_and_b32 v13, 0xffff0000, v82
v_mul_f32 v12, v12, v22
v_mul_f32 v13, v13, v22
v_cvt_pk_bf16_f32 v82, v12, v13
v_lshlrev_b32 v12, 16, v83
v_and_b32 v13, 0xffff0000, v83
v_mul_f32 v12, v12, v22
v_mul_f32 v13, v13, v22
v_cvt_pk_bf16_f32 v83, v12, v13
v_lshlrev_b32 v12, 16, v92
v_and_b32 v13, 0xffff0000, v92
v_mul_f32 v12, v12, v22
v_mul_f32 v13, v13, v22
v_cvt_pk_bf16_f32 v92, v12, v13
v_lshlrev_b32 v12, 16, v93
v_and_b32 v13, 0xffff0000, v93
v_mul_f32 v12, v12, v22
v_mul_f32 v13, v13, v22
v_cvt_pk_bf16_f32 v93, v12, v13
v_lshlrev_b32 v12, 16, v94
v_and_b32 v13, 0xffff0000, v94
v_mul_f32 v12, v12, v22
v_mul_f32 v13, v13, v22
v_cvt_pk_bf16_f32 v94, v12, v13
v_lshlrev_b32 v12, 16, v95
v_and_b32 v13, 0xffff0000, v95
v_mul_f32 v12, v12, v22
v_mul_f32 v13, v13, v22
v_cvt_pk_bf16_f32 v95, v12, v13
v_lshlrev_b32 v12, 16, v104
v_and_b32 v13, 0xffff0000, v104
v_mul_f32 v12, v12, v22
v_mul_f32 v13, v13, v22
v_cvt_pk_bf16_f32 v104, v12, v13
v_lshlrev_b32 v12, 16, v105
v_and_b32 v13, 0xffff0000, v105
v_mul_f32 v12, v12, v22
v_mul_f32 v13, v13, v22
v_cvt_pk_bf16_f32 v105, v12, v13
v_lshlrev_b32 v12, 16, v106
v_and_b32 v13, 0xffff0000, v106
v_mul_f32 v12, v12, v22
v_mul_f32 v13, v13, v22
v_cvt_pk_bf16_f32 v106, v12, v13
v_lshlrev_b32 v12, 16, v107
v_and_b32 v13, 0xffff0000, v107
v_mul_f32 v12, v12, v22
v_mul_f32 v13, v13, v22
v_cvt_pk_bf16_f32 v107, v12, v13
v_lshlrev_b32 v12, 16, v116
v_and_b32 v13, 0xffff0000, v116
v_mul_f32 v12, v12, v22
v_mul_f32 v13, v13, v22
v_cvt_pk_bf16_f32 v116, v12, v13
v_lshlrev_b32 v12, 16, v117
v_and_b32 v13, 0xffff0000, v117
v_mul_f32 v12, v12, v22
v_mul_f32 v13, v13, v22
v_cvt_pk_bf16_f32 v117, v12, v13
v_lshlrev_b32 v12, 16, v118
v_and_b32 v13, 0xffff0000, v118
v_mul_f32 v12, v12, v22
v_mul_f32 v13, v13, v22
v_cvt_pk_bf16_f32 v118, v12, v13
v_lshlrev_b32 v12, 16, v119
v_and_b32 v13, 0xffff0000, v119
v_mul_f32 v12, v12, v22
v_mul_f32 v13, v13, v22
v_cvt_pk_bf16_f32 v119, v12, v13
v_sub_f32 v22, v228, v202
v_max_f32 v22, 0, v22
v_sub_f32 v228, v228, v22
v_sub_f32 v229, v229, v22
v_sub_f32 v230, v230, v22
v_sub_f32 v231, v231, v22
v_sub_f32 v23, 0, v22
v_exp_f32 v23, v23
s_nop 0
v_mul_f32 v20, v20, v23
v_accvgpr_read_b32 v12, a4
v_accvgpr_read_b32 v13, a5
v_accvgpr_read_b32 v14, a6
v_accvgpr_read_b32 v15, a7
v_mul_f32 v12, v12, v23
v_mul_f32 v13, v13, v23
v_mul_f32 v14, v14, v23
v_mul_f32 v15, v15, v23
v_accvgpr_write_b32 a4, v12
v_accvgpr_write_b32 a5, v13
v_accvgpr_write_b32 a6, v14
v_accvgpr_write_b32 a7, v15
v_accvgpr_read_b32 v12, a16
v_accvgpr_read_b32 v13, a17
v_accvgpr_read_b32 v14, a18
v_accvgpr_read_b32 v15, a19
v_mul_f32 v12, v12, v23
v_mul_f32 v13, v13, v23
v_mul_f32 v14, v14, v23
v_mul_f32 v15, v15, v23
v_accvgpr_write_b32 a16, v12
v_accvgpr_write_b32 a17, v13
v_accvgpr_write_b32 a18, v14
v_accvgpr_write_b32 a19, v15
v_accvgpr_read_b32 v12, a28
v_accvgpr_read_b32 v13, a29
v_accvgpr_read_b32 v14, a30
v_accvgpr_read_b32 v15, a31
v_mul_f32 v12, v12, v23
v_mul_f32 v13, v13, v23
v_mul_f32 v14, v14, v23
v_mul_f32 v15, v15, v23
v_accvgpr_write_b32 a28, v12
v_accvgpr_write_b32 a29, v13
v_accvgpr_write_b32 a30, v14
v_accvgpr_write_b32 a31, v15
v_accvgpr_read_b32 v12, a40
v_accvgpr_read_b32 v13, a41
v_accvgpr_read_b32 v14, a42
v_accvgpr_read_b32 v15, a43
v_mul_f32 v12, v12, v23
v_mul_f32 v13, v13, v23
v_mul_f32 v14, v14, v23
v_mul_f32 v15, v15, v23
v_accvgpr_write_b32 a40, v12
v_accvgpr_write_b32 a41, v13
v_accvgpr_write_b32 a42, v14
v_accvgpr_write_b32 a43, v15
v_accvgpr_read_b32 v12, a52
v_accvgpr_read_b32 v13, a53
v_accvgpr_read_b32 v14, a54
v_accvgpr_read_b32 v15, a55
v_mul_f32 v12, v12, v23
v_mul_f32 v13, v13, v23
v_mul_f32 v14, v14, v23
v_mul_f32 v15, v15, v23
v_accvgpr_write_b32 a52, v12
v_accvgpr_write_b32 a53, v13
v_accvgpr_write_b32 a54, v14
v_accvgpr_write_b32 a55, v15
v_accvgpr_read_b32 v12, a64
v_accvgpr_read_b32 v13, a65
v_accvgpr_read_b32 v14, a66
v_accvgpr_read_b32 v15, a67
v_mul_f32 v12, v12, v23
v_mul_f32 v13, v13, v23
v_mul_f32 v14, v14, v23
v_mul_f32 v15, v15, v23
v_accvgpr_write_b32 a64, v12
v_accvgpr_write_b32 a65, v13
v_accvgpr_write_b32 a66, v14
v_accvgpr_write_b32 a67, v15
v_accvgpr_read_b32 v12, a76
v_accvgpr_read_b32 v13, a77
v_accvgpr_read_b32 v14, a78
v_accvgpr_read_b32 v15, a79
v_mul_f32 v12, v12, v23
v_mul_f32 v13, v13, v23
v_mul_f32 v14, v14, v23
v_mul_f32 v15, v15, v23
v_accvgpr_write_b32 a76, v12
v_accvgpr_write_b32 a77, v13
v_accvgpr_write_b32 a78, v14
v_accvgpr_write_b32 a79, v15
v_accvgpr_read_b32 v12, a88
v_accvgpr_read_b32 v13, a89
v_accvgpr_read_b32 v14, a90
v_accvgpr_read_b32 v15, a91
v_mul_f32 v12, v12, v23
v_mul_f32 v13, v13, v23
v_mul_f32 v14, v14, v23
v_mul_f32 v15, v15, v23
v_accvgpr_write_b32 a88, v12
v_accvgpr_write_b32 a89, v13
v_accvgpr_write_b32 a90, v14
v_accvgpr_write_b32 a91, v15
v_accvgpr_read_b32 v12, a100
v_accvgpr_read_b32 v13, a101
v_accvgpr_read_b32 v14, a102
v_accvgpr_read_b32 v15, a103
v_mul_f32 v12, v12, v23
v_mul_f32 v13, v13, v23
v_mul_f32 v14, v14, v23
v_mul_f32 v15, v15, v23
v_accvgpr_write_b32 a100, v12
v_accvgpr_write_b32 a101, v13
v_accvgpr_write_b32 a102, v14
v_accvgpr_write_b32 a103, v15
v_accvgpr_read_b32 v12, a112
v_accvgpr_read_b32 v13, a113
v_accvgpr_read_b32 v14, a114
v_accvgpr_read_b32 v15, a115
v_mul_f32 v12, v12, v23
v_mul_f32 v13, v13, v23
v_mul_f32 v14, v14, v23
v_mul_f32 v15, v15, v23
v_accvgpr_write_b32 a112, v12
v_accvgpr_write_b32 a113, v13
v_accvgpr_write_b32 a114, v14
v_accvgpr_write_b32 a115, v15
v_accvgpr_read_b32 v12, a124
v_accvgpr_read_b32 v13, a125
v_accvgpr_read_b32 v14, a126
v_accvgpr_read_b32 v15, a127
v_mul_f32 v12, v12, v23
v_mul_f32 v13, v13, v23
v_mul_f32 v14, v14, v23
v_mul_f32 v15, v15, v23
v_accvgpr_write_b32 a124, v12
v_accvgpr_write_b32 a125, v13
v_accvgpr_write_b32 a126, v14
v_accvgpr_write_b32 a127, v15
v_accvgpr_read_b32 v12, a136
v_accvgpr_read_b32 v13, a137
v_accvgpr_read_b32 v14, a138
v_accvgpr_read_b32 v15, a139
v_mul_f32 v12, v12, v23
v_mul_f32 v13, v13, v23
v_mul_f32 v14, v14, v23
v_mul_f32 v15, v15, v23
v_accvgpr_write_b32 a136, v12
v_accvgpr_write_b32 a137, v13
v_accvgpr_write_b32 a138, v14
v_accvgpr_write_b32 a139, v15
v_accvgpr_read_b32 v12, a148
v_accvgpr_read_b32 v13, a149
v_accvgpr_read_b32 v14, a150
v_accvgpr_read_b32 v15, a151
v_mul_f32 v12, v12, v23
v_mul_f32 v13, v13, v23
v_mul_f32 v14, v14, v23
v_mul_f32 v15, v15, v23
v_accvgpr_write_b32 a148, v12
v_accvgpr_write_b32 a149, v13
v_accvgpr_write_b32 a150, v14
v_accvgpr_write_b32 a151, v15
v_accvgpr_read_b32 v12, a160
v_accvgpr_read_b32 v13, a161
v_accvgpr_read_b32 v14, a162
v_accvgpr_read_b32 v15, a163
v_mul_f32 v12, v12, v23
v_mul_f32 v13, v13, v23
v_mul_f32 v14, v14, v23
v_mul_f32 v15, v15, v23
v_accvgpr_write_b32 a160, v12
v_accvgpr_write_b32 a161, v13
v_accvgpr_write_b32 a162, v14
v_accvgpr_write_b32 a163, v15
v_accvgpr_read_b32 v12, a172
v_accvgpr_read_b32 v13, a173
v_accvgpr_read_b32 v14, a174
v_accvgpr_read_b32 v15, a175
v_mul_f32 v12, v12, v23
v_mul_f32 v13, v13, v23
v_mul_f32 v14, v14, v23
v_mul_f32 v15, v15, v23
v_accvgpr_write_b32 a172, v12
v_accvgpr_write_b32 a173, v13
v_accvgpr_write_b32 a174, v14
v_accvgpr_write_b32 a175, v15
v_accvgpr_read_b32 v12, a184
v_accvgpr_read_b32 v13, a185
v_accvgpr_read_b32 v14, a186
v_accvgpr_read_b32 v15, a187
v_mul_f32 v12, v12, v23
v_mul_f32 v13, v13, v23
v_mul_f32 v14, v14, v23
v_mul_f32 v15, v15, v23
v_accvgpr_write_b32 a184, v12
v_accvgpr_write_b32 a185, v13
v_accvgpr_write_b32 a186, v14
v_accvgpr_write_b32 a187, v15
v_sub_f32 v22, v228, v202
v_exp_f32 v22, v22
s_nop 0
v_mul_f32 v203, v203, v22
v_lshlrev_b32 v12, 16, v36
v_and_b32 v13, 0xffff0000, v36
v_mul_f32 v12, v12, v22
v_mul_f32 v13, v13, v22
v_cvt_pk_bf16_f32 v36, v12, v13
v_lshlrev_b32 v12, 16, v37
v_and_b32 v13, 0xffff0000, v37
v_mul_f32 v12, v12, v22
v_mul_f32 v13, v13, v22
v_cvt_pk_bf16_f32 v37, v12, v13
v_lshlrev_b32 v12, 16, v38
v_and_b32 v13, 0xffff0000, v38
v_mul_f32 v12, v12, v22
v_mul_f32 v13, v13, v22
v_cvt_pk_bf16_f32 v38, v12, v13
v_lshlrev_b32 v12, 16, v39
v_and_b32 v13, 0xffff0000, v39
v_mul_f32 v12, v12, v22
v_mul_f32 v13, v13, v22
v_cvt_pk_bf16_f32 v39, v12, v13
v_lshlrev_b32 v12, 16, v48
v_and_b32 v13, 0xffff0000, v48
v_mul_f32 v12, v12, v22
v_mul_f32 v13, v13, v22
v_cvt_pk_bf16_f32 v48, v12, v13
v_lshlrev_b32 v12, 16, v49
v_and_b32 v13, 0xffff0000, v49
v_mul_f32 v12, v12, v22
v_mul_f32 v13, v13, v22
v_cvt_pk_bf16_f32 v49, v12, v13
v_lshlrev_b32 v12, 16, v50
v_and_b32 v13, 0xffff0000, v50
v_mul_f32 v12, v12, v22
v_mul_f32 v13, v13, v22
v_cvt_pk_bf16_f32 v50, v12, v13
v_lshlrev_b32 v12, 16, v51
v_and_b32 v13, 0xffff0000, v51
v_mul_f32 v12, v12, v22
v_mul_f32 v13, v13, v22
v_cvt_pk_bf16_f32 v51, v12, v13
v_lshlrev_b32 v12, 16, v60
v_and_b32 v13, 0xffff0000, v60
v_mul_f32 v12, v12, v22
v_mul_f32 v13, v13, v22
v_cvt_pk_bf16_f32 v60, v12, v13
v_lshlrev_b32 v12, 16, v61
v_and_b32 v13, 0xffff0000, v61
v_mul_f32 v12, v12, v22
v_mul_f32 v13, v13, v22
v_cvt_pk_bf16_f32 v61, v12, v13
v_lshlrev_b32 v12, 16, v62
v_and_b32 v13, 0xffff0000, v62
v_mul_f32 v12, v12, v22
v_mul_f32 v13, v13, v22
v_cvt_pk_bf16_f32 v62, v12, v13
v_lshlrev_b32 v12, 16, v63
v_and_b32 v13, 0xffff0000, v63
v_mul_f32 v12, v12, v22
v_mul_f32 v13, v13, v22
v_cvt_pk_bf16_f32 v63, v12, v13
v_lshlrev_b32 v12, 16, v72
v_and_b32 v13, 0xffff0000, v72
v_mul_f32 v12, v12, v22
v_mul_f32 v13, v13, v22
v_cvt_pk_bf16_f32 v72, v12, v13
v_lshlrev_b32 v12, 16, v73
v_and_b32 v13, 0xffff0000, v73
v_mul_f32 v12, v12, v22
v_mul_f32 v13, v13, v22
v_cvt_pk_bf16_f32 v73, v12, v13
v_lshlrev_b32 v12, 16, v74
v_and_b32 v13, 0xffff0000, v74
v_mul_f32 v12, v12, v22
v_mul_f32 v13, v13, v22
v_cvt_pk_bf16_f32 v74, v12, v13
v_lshlrev_b32 v12, 16, v75
v_and_b32 v13, 0xffff0000, v75
v_mul_f32 v12, v12, v22
v_mul_f32 v13, v13, v22
v_cvt_pk_bf16_f32 v75, v12, v13
v_lshlrev_b32 v12, 16, v84
v_and_b32 v13, 0xffff0000, v84
v_mul_f32 v12, v12, v22
v_mul_f32 v13, v13, v22
v_cvt_pk_bf16_f32 v84, v12, v13
v_lshlrev_b32 v12, 16, v85
v_and_b32 v13, 0xffff0000, v85
v_mul_f32 v12, v12, v22
v_mul_f32 v13, v13, v22
v_cvt_pk_bf16_f32 v85, v12, v13
v_lshlrev_b32 v12, 16, v86
v_and_b32 v13, 0xffff0000, v86
v_mul_f32 v12, v12, v22
v_mul_f32 v13, v13, v22
v_cvt_pk_bf16_f32 v86, v12, v13
v_lshlrev_b32 v12, 16, v87
v_and_b32 v13, 0xffff0000, v87
v_mul_f32 v12, v12, v22
v_mul_f32 v13, v13, v22
v_cvt_pk_bf16_f32 v87, v12, v13
v_lshlrev_b32 v12, 16, v96
v_and_b32 v13, 0xffff0000, v96
v_mul_f32 v12, v12, v22
v_mul_f32 v13, v13, v22
v_cvt_pk_bf16_f32 v96, v12, v13
v_lshlrev_b32 v12, 16, v97
v_and_b32 v13, 0xffff0000, v97
v_mul_f32 v12, v12, v22
v_mul_f32 v13, v13, v22
v_cvt_pk_bf16_f32 v97, v12, v13
v_lshlrev_b32 v12, 16, v98
v_and_b32 v13, 0xffff0000, v98
v_mul_f32 v12, v12, v22
v_mul_f32 v13, v13, v22
v_cvt_pk_bf16_f32 v98, v12, v13
v_lshlrev_b32 v12, 16, v99
v_and_b32 v13, 0xffff0000, v99
v_mul_f32 v12, v12, v22
v_mul_f32 v13, v13, v22
v_cvt_pk_bf16_f32 v99, v12, v13
v_lshlrev_b32 v12, 16, v108
v_and_b32 v13, 0xffff0000, v108
v_mul_f32 v12, v12, v22
v_mul_f32 v13, v13, v22
v_cvt_pk_bf16_f32 v108, v12, v13
v_lshlrev_b32 v12, 16, v109
v_and_b32 v13, 0xffff0000, v109
v_mul_f32 v12, v12, v22
v_mul_f32 v13, v13, v22
v_cvt_pk_bf16_f32 v109, v12, v13
v_lshlrev_b32 v12, 16, v110
v_and_b32 v13, 0xffff0000, v110
v_mul_f32 v12, v12, v22
v_mul_f32 v13, v13, v22
v_cvt_pk_bf16_f32 v110, v12, v13
v_lshlrev_b32 v12, 16, v111
v_and_b32 v13, 0xffff0000, v111
v_mul_f32 v12, v12, v22
v_mul_f32 v13, v13, v22
v_cvt_pk_bf16_f32 v111, v12, v13
v_lshlrev_b32 v12, 16, v120
v_and_b32 v13, 0xffff0000, v120
v_mul_f32 v12, v12, v22
v_mul_f32 v13, v13, v22
v_cvt_pk_bf16_f32 v120, v12, v13
v_lshlrev_b32 v12, 16, v121
v_and_b32 v13, 0xffff0000, v121
v_mul_f32 v12, v12, v22
v_mul_f32 v13, v13, v22
v_cvt_pk_bf16_f32 v121, v12, v13
v_lshlrev_b32 v12, 16, v122
v_and_b32 v13, 0xffff0000, v122
v_mul_f32 v12, v12, v22
v_mul_f32 v13, v13, v22
v_cvt_pk_bf16_f32 v122, v12, v13
v_lshlrev_b32 v12, 16, v123
v_and_b32 v13, 0xffff0000, v123
v_mul_f32 v12, v12, v22
v_mul_f32 v13, v13, v22
v_cvt_pk_bf16_f32 v123, v12, v13
v_sub_f32 v22, v232, v204
v_max_f32 v22, 0, v22
v_sub_f32 v232, v232, v22
v_sub_f32 v233, v233, v22
v_sub_f32 v234, v234, v22
v_sub_f32 v235, v235, v22
v_sub_f32 v23, 0, v22
v_exp_f32 v23, v23
s_nop 0
v_mul_f32 v21, v21, v23
v_accvgpr_read_b32 v12, a8
v_accvgpr_read_b32 v13, a9
v_accvgpr_read_b32 v14, a10
v_accvgpr_read_b32 v15, a11
v_mul_f32 v12, v12, v23
v_mul_f32 v13, v13, v23
v_mul_f32 v14, v14, v23
v_mul_f32 v15, v15, v23
v_accvgpr_write_b32 a8, v12
v_accvgpr_write_b32 a9, v13
v_accvgpr_write_b32 a10, v14
v_accvgpr_write_b32 a11, v15
v_accvgpr_read_b32 v12, a20
v_accvgpr_read_b32 v13, a21
v_accvgpr_read_b32 v14, a22
v_accvgpr_read_b32 v15, a23
v_mul_f32 v12, v12, v23
v_mul_f32 v13, v13, v23
v_mul_f32 v14, v14, v23
v_mul_f32 v15, v15, v23
v_accvgpr_write_b32 a20, v12
v_accvgpr_write_b32 a21, v13
v_accvgpr_write_b32 a22, v14
v_accvgpr_write_b32 a23, v15
v_accvgpr_read_b32 v12, a32
v_accvgpr_read_b32 v13, a33
v_accvgpr_read_b32 v14, a34
v_accvgpr_read_b32 v15, a35
v_mul_f32 v12, v12, v23
v_mul_f32 v13, v13, v23
v_mul_f32 v14, v14, v23
v_mul_f32 v15, v15, v23
v_accvgpr_write_b32 a32, v12
v_accvgpr_write_b32 a33, v13
v_accvgpr_write_b32 a34, v14
v_accvgpr_write_b32 a35, v15
v_accvgpr_read_b32 v12, a44
v_accvgpr_read_b32 v13, a45
v_accvgpr_read_b32 v14, a46
v_accvgpr_read_b32 v15, a47
v_mul_f32 v12, v12, v23
v_mul_f32 v13, v13, v23
v_mul_f32 v14, v14, v23
v_mul_f32 v15, v15, v23
v_accvgpr_write_b32 a44, v12
v_accvgpr_write_b32 a45, v13
v_accvgpr_write_b32 a46, v14
v_accvgpr_write_b32 a47, v15
v_accvgpr_read_b32 v12, a56
v_accvgpr_read_b32 v13, a57
v_accvgpr_read_b32 v14, a58
v_accvgpr_read_b32 v15, a59
v_mul_f32 v12, v12, v23
v_mul_f32 v13, v13, v23
v_mul_f32 v14, v14, v23
v_mul_f32 v15, v15, v23
v_accvgpr_write_b32 a56, v12
v_accvgpr_write_b32 a57, v13
v_accvgpr_write_b32 a58, v14
v_accvgpr_write_b32 a59, v15
v_accvgpr_read_b32 v12, a68
v_accvgpr_read_b32 v13, a69
v_accvgpr_read_b32 v14, a70
v_accvgpr_read_b32 v15, a71
v_mul_f32 v12, v12, v23
v_mul_f32 v13, v13, v23
v_mul_f32 v14, v14, v23
v_mul_f32 v15, v15, v23
v_accvgpr_write_b32 a68, v12
v_accvgpr_write_b32 a69, v13
v_accvgpr_write_b32 a70, v14
v_accvgpr_write_b32 a71, v15
v_accvgpr_read_b32 v12, a80
v_accvgpr_read_b32 v13, a81
v_accvgpr_read_b32 v14, a82
v_accvgpr_read_b32 v15, a83
v_mul_f32 v12, v12, v23
v_mul_f32 v13, v13, v23
v_mul_f32 v14, v14, v23
v_mul_f32 v15, v15, v23
v_accvgpr_write_b32 a80, v12
v_accvgpr_write_b32 a81, v13
v_accvgpr_write_b32 a82, v14
v_accvgpr_write_b32 a83, v15
v_accvgpr_read_b32 v12, a92
v_accvgpr_read_b32 v13, a93
v_accvgpr_read_b32 v14, a94
v_accvgpr_read_b32 v15, a95
v_mul_f32 v12, v12, v23
v_mul_f32 v13, v13, v23
v_mul_f32 v14, v14, v23
v_mul_f32 v15, v15, v23
v_accvgpr_write_b32 a92, v12
v_accvgpr_write_b32 a93, v13
v_accvgpr_write_b32 a94, v14
v_accvgpr_write_b32 a95, v15
v_accvgpr_read_b32 v12, a104
v_accvgpr_read_b32 v13, a105
v_accvgpr_read_b32 v14, a106
v_accvgpr_read_b32 v15, a107
v_mul_f32 v12, v12, v23
v_mul_f32 v13, v13, v23
v_mul_f32 v14, v14, v23
v_mul_f32 v15, v15, v23
v_accvgpr_write_b32 a104, v12
v_accvgpr_write_b32 a105, v13
v_accvgpr_write_b32 a106, v14
v_accvgpr_write_b32 a107, v15
v_accvgpr_read_b32 v12, a116
v_accvgpr_read_b32 v13, a117
v_accvgpr_read_b32 v14, a118
v_accvgpr_read_b32 v15, a119
v_mul_f32 v12, v12, v23
v_mul_f32 v13, v13, v23
v_mul_f32 v14, v14, v23
v_mul_f32 v15, v15, v23
v_accvgpr_write_b32 a116, v12
v_accvgpr_write_b32 a117, v13
v_accvgpr_write_b32 a118, v14
v_accvgpr_write_b32 a119, v15
v_accvgpr_read_b32 v12, a128
v_accvgpr_read_b32 v13, a129
v_accvgpr_read_b32 v14, a130
v_accvgpr_read_b32 v15, a131
v_mul_f32 v12, v12, v23
v_mul_f32 v13, v13, v23
v_mul_f32 v14, v14, v23
v_mul_f32 v15, v15, v23
v_accvgpr_write_b32 a128, v12
v_accvgpr_write_b32 a129, v13
v_accvgpr_write_b32 a130, v14
v_accvgpr_write_b32 a131, v15
v_accvgpr_read_b32 v12, a140
v_accvgpr_read_b32 v13, a141
v_accvgpr_read_b32 v14, a142
v_accvgpr_read_b32 v15, a143
v_mul_f32 v12, v12, v23
v_mul_f32 v13, v13, v23
v_mul_f32 v14, v14, v23
v_mul_f32 v15, v15, v23
v_accvgpr_write_b32 a140, v12
v_accvgpr_write_b32 a141, v13
v_accvgpr_write_b32 a142, v14
v_accvgpr_write_b32 a143, v15
v_accvgpr_read_b32 v12, a152
v_accvgpr_read_b32 v13, a153
v_accvgpr_read_b32 v14, a154
v_accvgpr_read_b32 v15, a155
v_mul_f32 v12, v12, v23
v_mul_f32 v13, v13, v23
v_mul_f32 v14, v14, v23
v_mul_f32 v15, v15, v23
v_accvgpr_write_b32 a152, v12
v_accvgpr_write_b32 a153, v13
v_accvgpr_write_b32 a154, v14
v_accvgpr_write_b32 a155, v15
v_accvgpr_read_b32 v12, a164
v_accvgpr_read_b32 v13, a165
v_accvgpr_read_b32 v14, a166
v_accvgpr_read_b32 v15, a167
v_mul_f32 v12, v12, v23
v_mul_f32 v13, v13, v23
v_mul_f32 v14, v14, v23
v_mul_f32 v15, v15, v23
v_accvgpr_write_b32 a164, v12
v_accvgpr_write_b32 a165, v13
v_accvgpr_write_b32 a166, v14
v_accvgpr_write_b32 a167, v15
v_accvgpr_read_b32 v12, a176
v_accvgpr_read_b32 v13, a177
v_accvgpr_read_b32 v14, a178
v_accvgpr_read_b32 v15, a179
v_mul_f32 v12, v12, v23
v_mul_f32 v13, v13, v23
v_mul_f32 v14, v14, v23
v_mul_f32 v15, v15, v23
v_accvgpr_write_b32 a176, v12
v_accvgpr_write_b32 a177, v13
v_accvgpr_write_b32 a178, v14
v_accvgpr_write_b32 a179, v15
v_accvgpr_read_b32 v12, a188
v_accvgpr_read_b32 v13, a189
v_accvgpr_read_b32 v14, a190
v_accvgpr_read_b32 v15, a191
v_mul_f32 v12, v12, v23
v_mul_f32 v13, v13, v23
v_mul_f32 v14, v14, v23
v_mul_f32 v15, v15, v23
v_accvgpr_write_b32 a188, v12
v_accvgpr_write_b32 a189, v13
v_accvgpr_write_b32 a190, v14
v_accvgpr_write_b32 a191, v15
v_sub_f32 v22, v232, v204
v_exp_f32 v22, v22
s_nop 0
v_mul_f32 v205, v205, v22
v_lshlrev_b32 v12, 16, v40
v_and_b32 v13, 0xffff0000, v40
v_mul_f32 v12, v12, v22
v_mul_f32 v13, v13, v22
v_cvt_pk_bf16_f32 v40, v12, v13
v_lshlrev_b32 v12, 16, v41
v_and_b32 v13, 0xffff0000, v41
v_mul_f32 v12, v12, v22
v_mul_f32 v13, v13, v22
v_cvt_pk_bf16_f32 v41, v12, v13
v_lshlrev_b32 v12, 16, v42
v_and_b32 v13, 0xffff0000, v42
v_mul_f32 v12, v12, v22
v_mul_f32 v13, v13, v22
v_cvt_pk_bf16_f32 v42, v12, v13
v_lshlrev_b32 v12, 16, v43
v_and_b32 v13, 0xffff0000, v43
v_mul_f32 v12, v12, v22
v_mul_f32 v13, v13, v22
v_cvt_pk_bf16_f32 v43, v12, v13
v_lshlrev_b32 v12, 16, v52
v_and_b32 v13, 0xffff0000, v52
v_mul_f32 v12, v12, v22
v_mul_f32 v13, v13, v22
v_cvt_pk_bf16_f32 v52, v12, v13
v_lshlrev_b32 v12, 16, v53
v_and_b32 v13, 0xffff0000, v53
v_mul_f32 v12, v12, v22
v_mul_f32 v13, v13, v22
v_cvt_pk_bf16_f32 v53, v12, v13
v_lshlrev_b32 v12, 16, v54
v_and_b32 v13, 0xffff0000, v54
v_mul_f32 v12, v12, v22
v_mul_f32 v13, v13, v22
v_cvt_pk_bf16_f32 v54, v12, v13
v_lshlrev_b32 v12, 16, v55
v_and_b32 v13, 0xffff0000, v55
v_mul_f32 v12, v12, v22
v_mul_f32 v13, v13, v22
v_cvt_pk_bf16_f32 v55, v12, v13
v_lshlrev_b32 v12, 16, v64
v_and_b32 v13, 0xffff0000, v64
v_mul_f32 v12, v12, v22
v_mul_f32 v13, v13, v22
v_cvt_pk_bf16_f32 v64, v12, v13
v_lshlrev_b32 v12, 16, v65
v_and_b32 v13, 0xffff0000, v65
v_mul_f32 v12, v12, v22
v_mul_f32 v13, v13, v22
v_cvt_pk_bf16_f32 v65, v12, v13
v_lshlrev_b32 v12, 16, v66
v_and_b32 v13, 0xffff0000, v66
v_mul_f32 v12, v12, v22
v_mul_f32 v13, v13, v22
v_cvt_pk_bf16_f32 v66, v12, v13
v_lshlrev_b32 v12, 16, v67
v_and_b32 v13, 0xffff0000, v67
v_mul_f32 v12, v12, v22
v_mul_f32 v13, v13, v22
v_cvt_pk_bf16_f32 v67, v12, v13
v_lshlrev_b32 v12, 16, v76
v_and_b32 v13, 0xffff0000, v76
v_mul_f32 v12, v12, v22
v_mul_f32 v13, v13, v22
v_cvt_pk_bf16_f32 v76, v12, v13
v_lshlrev_b32 v12, 16, v77
v_and_b32 v13, 0xffff0000, v77
v_mul_f32 v12, v12, v22
v_mul_f32 v13, v13, v22
v_cvt_pk_bf16_f32 v77, v12, v13
v_lshlrev_b32 v12, 16, v78
v_and_b32 v13, 0xffff0000, v78
v_mul_f32 v12, v12, v22
v_mul_f32 v13, v13, v22
v_cvt_pk_bf16_f32 v78, v12, v13
v_lshlrev_b32 v12, 16, v79
v_and_b32 v13, 0xffff0000, v79
v_mul_f32 v12, v12, v22
v_mul_f32 v13, v13, v22
v_cvt_pk_bf16_f32 v79, v12, v13
v_lshlrev_b32 v12, 16, v88
v_and_b32 v13, 0xffff0000, v88
v_mul_f32 v12, v12, v22
v_mul_f32 v13, v13, v22
v_cvt_pk_bf16_f32 v88, v12, v13
v_lshlrev_b32 v12, 16, v89
v_and_b32 v13, 0xffff0000, v89
v_mul_f32 v12, v12, v22
v_mul_f32 v13, v13, v22
v_cvt_pk_bf16_f32 v89, v12, v13
v_lshlrev_b32 v12, 16, v90
v_and_b32 v13, 0xffff0000, v90
v_mul_f32 v12, v12, v22
v_mul_f32 v13, v13, v22
v_cvt_pk_bf16_f32 v90, v12, v13
v_lshlrev_b32 v12, 16, v91
v_and_b32 v13, 0xffff0000, v91
v_mul_f32 v12, v12, v22
v_mul_f32 v13, v13, v22
v_cvt_pk_bf16_f32 v91, v12, v13
v_lshlrev_b32 v12, 16, v100
v_and_b32 v13, 0xffff0000, v100
v_mul_f32 v12, v12, v22
v_mul_f32 v13, v13, v22
v_cvt_pk_bf16_f32 v100, v12, v13
v_lshlrev_b32 v12, 16, v101
v_and_b32 v13, 0xffff0000, v101
v_mul_f32 v12, v12, v22
v_mul_f32 v13, v13, v22
v_cvt_pk_bf16_f32 v101, v12, v13
v_lshlrev_b32 v12, 16, v102
v_and_b32 v13, 0xffff0000, v102
v_mul_f32 v12, v12, v22
v_mul_f32 v13, v13, v22
v_cvt_pk_bf16_f32 v102, v12, v13
v_lshlrev_b32 v12, 16, v103
v_and_b32 v13, 0xffff0000, v103
v_mul_f32 v12, v12, v22
v_mul_f32 v13, v13, v22
v_cvt_pk_bf16_f32 v103, v12, v13
v_lshlrev_b32 v12, 16, v112
v_and_b32 v13, 0xffff0000, v112
v_mul_f32 v12, v12, v22
v_mul_f32 v13, v13, v22
v_cvt_pk_bf16_f32 v112, v12, v13
v_lshlrev_b32 v12, 16, v113
v_and_b32 v13, 0xffff0000, v113
v_mul_f32 v12, v12, v22
v_mul_f32 v13, v13, v22
v_cvt_pk_bf16_f32 v113, v12, v13
v_lshlrev_b32 v12, 16, v114
v_and_b32 v13, 0xffff0000, v114
v_mul_f32 v12, v12, v22
v_mul_f32 v13, v13, v22
v_cvt_pk_bf16_f32 v114, v12, v13
v_lshlrev_b32 v12, 16, v115
v_and_b32 v13, 0xffff0000, v115
v_mul_f32 v12, v12, v22
v_mul_f32 v13, v13, v22
v_cvt_pk_bf16_f32 v115, v12, v13
v_lshlrev_b32 v12, 16, v124
v_and_b32 v13, 0xffff0000, v124
v_mul_f32 v12, v12, v22
v_mul_f32 v13, v13, v22
v_cvt_pk_bf16_f32 v124, v12, v13
v_lshlrev_b32 v12, 16, v125
v_and_b32 v13, 0xffff0000, v125
v_mul_f32 v12, v12, v22
v_mul_f32 v13, v13, v22
v_cvt_pk_bf16_f32 v125, v12, v13
v_lshlrev_b32 v12, 16, v126
v_and_b32 v13, 0xffff0000, v126
v_mul_f32 v12, v12, v22
v_mul_f32 v13, v13, v22
v_cvt_pk_bf16_f32 v126, v12, v13
v_lshlrev_b32 v12, 16, v127
v_and_b32 v13, 0xffff0000, v127
v_mul_f32 v12, v12, v22
v_mul_f32 v13, v13, v22
v_cvt_pk_bf16_f32 v127, v12, v13
s_nop 1
s_branch L_mback72
L_poll73:
ds_read_b32 v11, v9
s_waitcnt lgkmcnt(0)
v_readfirstlane_b32 s39, v11
s_nop 0
s_cmp_ge_u32 s39, s38
s_cbranch_scc1 L_ret74
s_sleep 1
s_add_u32 s53, s53, 1
s_cmp_lt_u32 s53, 1048576
s_cbranch_scc1 L_poll73
s_endpgm
L_poll75:
ds_read_b32 v11, v9
s_waitcnt lgkmcnt(0)
v_readfirstlane_b32 s39, v11
s_nop 0
s_cmp_ge_u32 s39, s38
s_cbranch_scc1 L_ret76
s_sleep 1
s_add_u32 s53, s53, 1
s_cmp_lt_u32 s53, 1048576
s_cbranch_scc1 L_poll75
s_endpgm
L_poll77:
ds_read_b32 v11, v9
s_waitcnt lgkmcnt(0)
v_readfirstlane_b32 s39, v11
s_nop 0
s_cmp_ge_u32 s39, s38
s_cbranch_scc1 L_ret78
s_sleep 1
s_add_u32 s53, s53, 1
s_cmp_lt_u32 s53, 1048576
s_cbranch_scc1 L_poll77
s_endpgm
L_poll79:
ds_read_b32 v11, v9
s_waitcnt lgkmcnt(0)
v_readfirstlane_b32 s39, v11
s_nop 0
s_cmp_ge_u32 s39, s38
s_cbranch_scc1 L_ret80
s_sleep 1
s_add_u32 s53, s53, 1
s_cmp_lt_u32 s53, 1048576
s_cbranch_scc1 L_poll79
s_endpgm
L_poll81:
ds_read_b32 v11, v9
s_waitcnt lgkmcnt(0)
v_readfirstlane_b32 s39, v11
s_nop 0
s_cmp_ge_u32 s39, s38
s_cbranch_scc1 L_ret82
s_sleep 1
s_add_u32 s53, s53, 1
s_cmp_lt_u32 s53, 1048576
s_cbranch_scc1 L_poll81
s_endpgm
L_poll83:
ds_read_b32 v11, v9
s_waitcnt lgkmcnt(0)
v_readfirstlane_b32 s39, v11
s_nop 0
s_cmp_ge_u32 s39, s38
s_cbranch_scc1 L_ret84
s_sleep 1
s_add_u32 s53, s53, 1
s_cmp_lt_u32 s53, 1048576
s_cbranch_scc1 L_poll83
s_endpgm
L_poll85:
ds_read_b32 v11, v9
s_waitcnt lgkmcnt(0)
v_readfirstlane_b32 s39, v11
s_nop 0
s_cmp_ge_u32 s39, s38
s_cbranch_scc1 L_ret86
s_sleep 1
s_add_u32 s53, s53, 1
s_cmp_lt_u32 s53, 1048576
s_cbranch_scc1 L_poll85
s_endpgm
L_poll87:
ds_read_b32 v11, v9
s_waitcnt lgkmcnt(0)
v_readfirstlane_b32 s39, v11
s_nop 0
s_cmp_ge_u32 s39, s38
s_cbranch_scc1 L_ret88
s_sleep 1
s_add_u32 s53, s53, 1
s_cmp_lt_u32 s53, 1048576
s_cbranch_scc1 L_poll87
s_endpgm
L_poll89:
ds_read_b32 v11, v9
s_waitcnt lgkmcnt(0)
v_readfirstlane_b32 s39, v11
s_nop 0
s_cmp_ge_u32 s39, s38
s_cbranch_scc1 L_ret90
s_sleep 1
s_add_u32 s53, s53, 1
s_cmp_lt_u32 s53, 1048576
s_cbranch_scc1 L_poll89
s_endpgm
L_poll91:
ds_read_b32 v11, v9
s_waitcnt lgkmcnt(0)
v_readfirstlane_b32 s39, v11
s_nop 0
s_cmp_ge_u32 s39, s38
s_cbranch_scc1 L_ret92
s_sleep 1
s_add_u32 s53, s53, 1
s_cmp_lt_u32 s53, 1048576
s_cbranch_scc1 L_poll91
s_endpgm
L_poll93:
ds_read_b32 v11, v9
s_waitcnt lgkmcnt(0)
v_readfirstlane_b32 s39, v11
s_nop 0
s_cmp_ge_u32 s39, s38
s_cbranch_scc1 L_ret94
s_sleep 1
s_add_u32 s53, s53, 1
s_cmp_lt_u32 s53, 1048576
s_cbranch_scc1 L_poll93
s_endpgm
L_poll95:
ds_read_b32 v11, v9
s_waitcnt lgkmcnt(0)
v_readfirstlane_b32 s39, v11
s_nop 0
s_cmp_ge_u32 s39, s38
s_cbranch_scc1 L_ret96
s_sleep 1
s_add_u32 s53, s53, 1
s_cmp_lt_u32 s53, 1048576
s_cbranch_scc1 L_poll95
s_endpgm
L_poll97:
ds_read_b32 v11, v9
s_waitcnt lgkmcnt(0)
v_readfirstlane_b32 s39, v11
s_nop 0
s_cmp_ge_u32 s39, s38
s_cbranch_scc1 L_ret98
s_sleep 1
s_add_u32 s53, s53, 1
s_cmp_lt_u32 s53, 1048576
s_cbranch_scc1 L_poll97
s_endpgm
L_poll99:
ds_read_b32 v11, v9
s_waitcnt lgkmcnt(0)
v_readfirstlane_b32 s39, v11
s_nop 0
s_cmp_ge_u32 s39, s38
s_cbranch_scc1 L_ret100
s_sleep 1
s_add_u32 s53, s53, 1
s_cmp_lt_u32 s53, 1048576
s_cbranch_scc1 L_poll99
s_endpgm
L_lfull:
s_waitcnt vmcnt(0)
s_max_i32 s49, s49, s38
v_mov_b32 v12, s49
ds_write_b32 v8, v12
L_lfull1:
ds_read_b32 v13, v9
s_waitcnt lgkmcnt(0)
v_cmp_gt_i32 vcc, s43, v13
s_cbranch_vccnz L_lfull2
s_setpc_b64 s[84:85]
L_lfull2:
s_sleep 1
s_add_u32 s53, s53, 1
s_cmp_lt_u32 s53, 1048576
s_cbranch_scc1 L_lfull1
s_endpgm
L_end:
s_endpgm
.section .rodata,"a"
.p2align 6
.amdhsa_kernel standalone__mha_block_cached__near_ridge_kernel
  .amdhsa_next_free_vgpr 512
  .amdhsa_next_free_sgpr 100
  .amdhsa_accum_offset 256
  .amdhsa_group_segment_fixed_size 0
  .amdhsa_kernarg_size 64
  .amdhsa_user_sgpr_count 2
  .amdhsa_user_sgpr_kernarg_segment_ptr 1
  .amdhsa_system_sgpr_workgroup_id_x 1
  .amdhsa_float_denorm_mode_32 3
.end_amdhsa_kernel
```
